```python
import torch

def _softmax(x, axis=-1):
    return torch.softmax(x, dim=axis)
def _gelu(x):
    return torch.nn.functional.gelu(x, approximate="tanh")
def _silu(x):
    return torch.nn.functional.silu(x)
def _sigmoid(x):
    return torch.sigmoid(x)
def _layernorm(x, axis=-1, eps=1e-5):
    m = x.mean(dim=axis, keepdim=True)
    v = x.var(dim=axis, keepdim=True, unbiased=False)
    return (x - m) / torch.sqrt(v + eps)
def _scatter_add(tgt, idx, src, axis=0):
    return tgt.clone().index_add_(axis, idx, src)
def _segment_sum(src, seg, n):
    out = torch.zeros((n,) + src.shape[1:], dtype=src.dtype)
    return out.index_add_(0, seg, src)
def _pad(x, pw):
    flat = tuple(v for pair in reversed(pw) for v in pair)
    return torch.nn.functional.pad(x, flat)

kernel_name = 'concat_heads__sliding_local_dilated__spectral_fnet__prompt'

def setup_inputs():

    _w = (lambda a: (lambda t: t.to(torch.bfloat16) if t.is_floating_point() else t)(torch.as_tensor(a)))
    def _A_setup():
        B, S, D = 1, 2048, 448
        return {
            "x": _w((lambda *s: torch.randn(*s, dtype=torch.bfloat16) * 0.2)(B, S, D)),
            "wqkv": _w((lambda *s: torch.randn(*s, dtype=torch.bfloat16) * 0.8)(D, 3 * D)),
            "wo": _w((lambda *s: torch.randn(*s, dtype=torch.bfloat16) * 0.2)(D, D)),
        }
    _A_in = _A_setup()

    def _B_setup():
        B, S, D = 1, 2048, 448
        ns = torch.arange(S)[:, None] * torch.arange(S)[None, :]
        nd = torch.arange(D)[:, None] * torch.arange(D)[None, :]
        Ws_re = torch.cos(-2.0 * torch.pi * ns / S).to(float)
        Ws_im = torch.sin(-2.0 * torch.pi * ns / S).to(float)
        Wd_re = torch.cos(-2.0 * torch.pi * nd / D).to(float)
        Wd_im = torch.sin(-2.0 * torch.pi * nd / D).to(float)
        return {
            "x": _w((lambda *s: torch.randn(*s, dtype=torch.bfloat16) * 0.05)(B, S, D)),
            "dft_seq_re": _w(Ws_re),
            "dft_seq_im": _w(Ws_im),
            "dft_hid_re": _w(Wd_re),
            "dft_hid_im": _w(Wd_im),
        }
    _B_in = _B_setup()

    return {
        "A_x": _A_in["x"],
        "A_wqkv": _A_in["wqkv"],
        "A_wo": _A_in["wo"],
        "B_x": _B_in["x"],
        "B_dft_seq_re": _B_in["dft_seq_re"],
        "B_dft_seq_im": _B_in["dft_seq_im"],
        "B_dft_hid_re": _B_in["dft_hid_re"],
        "B_dft_hid_im": _B_in["dft_hid_im"],
    }

def reference(A_x, A_wqkv, A_wo, B_x, B_dft_seq_re, B_dft_seq_im, B_dft_hid_re, B_dft_hid_im):
    def _A_ref(x, wqkv, wo):
        B, S, D = x.shape
        H = 16; Dh = D // H
        W, dil = 8, 2
        qkv = (lambda x, *d: x.permute(*d))((x @ wqkv).reshape(B, S, 3, H, Dh), 2, 0, 3, 1, 4)
        q, k, v = qkv[0], qkv[1], qkv[2]
        scale = Dh ** -0.5
        pos = torch.arange(S)
        off = torch.arange(W) * dil
        idx = pos[:, None] - off[None, :]
        mask = idx >= 0
        idx_c = torch.where(mask, idx, 0).reshape(-1)
        kg = k[:, :, idx_c, :].reshape(B, H, S, W, Dh)
        vg = v[:, :, idx_c, :].reshape(B, H, S, W, Dh)
        logits = torch.einsum("bhsd,bhswd->bhsw", q, kg) * scale
        logits = torch.where(mask[None, None, :, :], logits, -1e9)
        attn = _softmax(logits, axis=-1)
        o = torch.einsum("bhsw,bhswd->bhsd", attn, vg)
        return (lambda x, *d: x.permute(*d))(o, 0, 2, 1, 3).reshape(B, S, D) @ wo

    def _B_ref(x, dft_seq_re, dft_seq_im, dft_hid_re, dft_hid_im):
        a = torch.einsum("bsd,ed->bse", x, dft_hid_re)
        b = torch.einsum("bsd,ed->bse", x, dft_hid_im)
        y = torch.einsum("ts,bse->bte", dft_seq_re, a) - torch.einsum("ts,bse->bte", dft_seq_im, b)
        return y

    a = _A_ref(A_x, A_wqkv, A_wo)
    b = _B_ref(B_x, B_dft_seq_re, B_dft_seq_im, B_dft_hid_re, B_dft_hid_im)
    return torch.concatenate([a, b], axis=-1)
```

```asm
; @launch kernel=fa_p1_kernel grid=(256,1,1) block=(256,1,1) lds=147456
; @launch kernel=fa_p2_kernel grid=(256,1,1) block=(256,1,1) lds=66560
.amdgcn_target "amdgcn-amd-amdhsa--gfx950"
.text
.globl fa_p1_kernel
.p2align 8
.type fa_p1_kernel,@function
fa_p1_kernel:
    s_cmp_ge_u32 s2, 256
    s_cbranch_scc1 L1_end
    s_load_dwordx4 s[4:7], s[0:1], 0
    s_load_dwordx2 s[8:9], s[0:1], 24
    s_load_dwordx2 s[10:11], s[0:1], 80
    v_lshrrev_b32 v2, 6, v0
    v_and_b32 v1, 63, v0
    v_readfirstlane_b32 s3, v2
    s_and_b32 s24, s2, 7
    s_lshr_b32 s25, s2, 3
    s_cmp_ge_u32 s25, 24
    s_cbranch_scc1 L1_B
    s_lshr_b32 s35, s24, 1
    s_mul_i32 s35, s35, 3
    s_lshr_b32 s36, s25, 3
    s_add_u32 s35, s35, s36
    s_and_b32 s27, s35, 1
    s_lshr_b32 s29, s35, 1
    s_and_b32 s37, s24, 1
    s_lshl_b32 s37, s37, 3
    s_and_b32 s38, s25, 7
    s_add_u32 s26, s37, s38
    s_mul_i32 s36, s36, 3
    s_add_u32 s36, s36, s38
    s_cmp_ge_u32 s36, 7
    s_cselect_b32 s37, 7, 0
    s_sub_u32 s30, s36, s37
    s_mul_i32 s28, s29, 11
    s_cmp_eq_u32 s29, 5
    s_cselect_b32 s37, 1, 0
    s_sub_u32 s28, s28, s37
    s_mul_i32 s36, s3, 3
    s_add_u32 s36, s36, s28
    s_lshl_b32 s37, s36, 5
    s_add_u32 s37, s37, s27
    s_sub_u32 s37, s37, 32
    s_mul_i32 s37, s37, 896
    v_lshrrev_b32 v32, 3, v1
    v_mul_u32_u24 v32, 1792, v32
    v_and_b32 v33, 7, v1
    v_lshrrev_b32 v34, 4, v1
    v_xor_b32 v33, v33, v34
    v_lshl_add_u32 v32, v33, 4, v32
    v_xor_b32 v33, 64, v32
    s_add_u32 s38, s37, 0
    s_cmp_eq_u32 s3, 0
    s_cselect_b32 s38, 0x40000000, s38
    v_add_u32 v2, s38, v32
    s_add_u32 s38, s37, 14336
    s_cmp_eq_u32 s36, 0
    s_cselect_b32 s38, 0x40000000, s38
    v_add_u32 v3, s38, v33
    s_add_u32 s38, s37, 28672
    v_add_u32 v4, s38, v32
    s_add_u32 s38, s37, 43008
    v_add_u32 v5, s38, v33
    s_add_u32 s38, s37, 57344
    s_lshr_b32 s39, s29, 2
    s_add_u32 s39, s39, s3
    s_cmp_eq_u32 s39, 4
    s_cselect_b32 s38, 0x40000000, s38
    v_add_u32 v6, s38, v32
    s_add_u32 s38, s37, 71680
    s_cmp_eq_u32 s39, 4
    s_cselect_b32 s38, 0x40000000, s38
    v_add_u32 v7, s38, v33
    v_lshrrev_b32 v32, 5, v1
    v_bfe_u32 v33, v1, 4, 1
    v_bfe_u32 v35, v1, 2, 2
    v_lshl_add_u32 v36, v32, 2, v35
    v_lshl_add_u32 v36, v33, 3, v36
    v_mul_u32_u24 v36, 2688, v36
    v_lshlrev_b32 v37, 1, v33
    v_xor_b32 v37, v37, v1
    v_and_b32 v37, 3, v37
    v_lshlrev_b32 v37, 4, v37
    v_min_u32 v37, 40, v37
    s_mul_i32 s38, s3, 16*2688
    s_mul_i32 s40, s26, 56
    s_add_u32 s38, s38, s40
    v_add3_u32 v8, v36, v37, s38
    s_mul_i32 s31, s3, 6144
    s_add_u32 s31, s31, 12288
    s_mul_i32 s32, s3, 3072
    s_waitcnt lgkmcnt(0)
    s_mov_b32 s12, s4
    s_and_b32 s13, s5, 0xffff
    s_mov_b32 s14, 0x1c0000
    s_mov_b32 s15, 0x20000
    s_mov_b32 s16, s6
    s_and_b32 s17, s7, 0xffff
    s_mov_b32 s18, 0x126000
    s_mov_b32 s19, 0x20000
    s_mov_b32 s20, s10
    s_and_b32 s21, s11, 0xffff
    s_mov_b32 s22, 0x1000000
    s_mov_b32 s23, 0x20000
    s_lshl_b32 s33, s30, 7
    s_mul_i32 s34, s30, 64*2688
    s_add_u32 s30, s30, 1
    s_cmp_eq_u32 s30, 7
    s_cselect_b32 s30, 0, s30
    s_add_u32 m0, s32, 0
    s_nop 0
    buffer_load_dwordx4 v8, s[16:19], s34 offen offset:0 lds
    s_add_u32 m0, s31, 0
    s_nop 0
    buffer_load_dwordx4 v2, s[12:15], s33 offen lds
    s_add_u32 m0, s31, 1024
    s_nop 0
    buffer_load_dwordx4 v3, s[12:15], s33 offen lds
    s_add_u32 m0, s32, 128
    s_nop 0
    buffer_load_dwordx4 v8, s[16:19], s34 offen offset:896 lds
    s_add_u32 m0, s31, 2048
    s_nop 0
    buffer_load_dwordx4 v4, s[12:15], s33 offen lds
    s_add_u32 m0, s31, 3072
    s_nop 0
    buffer_load_dwordx4 v5, s[12:15], s33 offen lds
    s_add_u32 m0, s32, 256
    s_nop 0
    buffer_load_dwordx4 v8, s[16:19], s34 offen offset:1792 lds
    s_add_u32 m0, s31, 4096
    s_nop 0
    buffer_load_dwordx4 v6, s[12:15], s33 offen lds
    s_add_u32 m0, s31, 5120
    s_nop 0
    buffer_load_dwordx4 v7, s[12:15], s33 offen lds
    s_lshl_b32 s33, s30, 7
    s_mul_i32 s34, s30, 64*2688
    s_add_u32 s30, s30, 1
    s_cmp_eq_u32 s30, 7
    s_cselect_b32 s30, 0, s30
    s_add_u32 m0, s32, 36864
    s_nop 0
    buffer_load_dwordx4 v8, s[16:19], s34 offen offset:0 lds
    s_add_u32 m0, s31, 36864
    s_nop 0
    buffer_load_dwordx4 v2, s[12:15], s33 offen lds
    s_add_u32 m0, s31, 37888
    s_nop 0
    buffer_load_dwordx4 v3, s[12:15], s33 offen lds
    s_add_u32 m0, s32, 36992
    s_nop 0
    buffer_load_dwordx4 v8, s[16:19], s34 offen offset:896 lds
    s_add_u32 m0, s31, 38912
    s_nop 0
    buffer_load_dwordx4 v4, s[12:15], s33 offen lds
    s_add_u32 m0, s31, 39936
    s_nop 0
    buffer_load_dwordx4 v5, s[12:15], s33 offen lds
    s_add_u32 m0, s32, 37120
    s_nop 0
    buffer_load_dwordx4 v8, s[16:19], s34 offen offset:1792 lds
    s_add_u32 m0, s31, 40960
    s_nop 0
    buffer_load_dwordx4 v6, s[12:15], s33 offen lds
    s_add_u32 m0, s31, 41984
    s_nop 0
    buffer_load_dwordx4 v7, s[12:15], s33 offen lds
    s_lshl_b32 s33, s30, 7
    s_mul_i32 s34, s30, 64*2688
    s_add_u32 s30, s30, 1
    s_cmp_eq_u32 s30, 7
    s_cselect_b32 s30, 0, s30
    s_add_u32 m0, s32, 73728
    s_nop 0
    buffer_load_dwordx4 v8, s[16:19], s34 offen offset:0 lds
    s_add_u32 m0, s31, 73728
    s_nop 0
    buffer_load_dwordx4 v2, s[12:15], s33 offen lds
    s_add_u32 m0, s31, 74752
    s_nop 0
    buffer_load_dwordx4 v3, s[12:15], s33 offen lds
    s_add_u32 m0, s32, 73856
    s_nop 0
    buffer_load_dwordx4 v8, s[16:19], s34 offen offset:896 lds
    s_add_u32 m0, s31, 75776
    s_nop 0
    buffer_load_dwordx4 v4, s[12:15], s33 offen lds
    s_add_u32 m0, s31, 76800
    s_nop 0
    buffer_load_dwordx4 v5, s[12:15], s33 offen lds
    s_add_u32 m0, s32, 73984
    s_nop 0
    buffer_load_dwordx4 v8, s[16:19], s34 offen offset:1792 lds
    s_add_u32 m0, s31, 77824
    s_nop 0
    buffer_load_dwordx4 v6, s[12:15], s33 offen lds
    s_add_u32 m0, s31, 78848
    s_nop 0
    buffer_load_dwordx4 v7, s[12:15], s33 offen lds
    v_mul_u32_u24 v36, 3072, v32
    v_lshl_add_u32 v36, v33, 8, v36
    v_lshl_add_u32 v36, v35, 6, v36
    v_lshl_add_u32 v36, v33, 5, v36
    v_and_b32 v37, 3, v1
    v_lshl_add_u32 v9, v37, 3, v36
    v_lshrrev_b32 v38, 1, v37
    v_xor_b32 v37, v37, v38
    v_xor_b32 v36, 32, v36
    v_lshl_add_u32 v10, v37, 3, v36
    v_and_b32 v36, 15, v1
    v_lshrrev_b32 v37, 1, v36
    v_xor_b32 v37, v37, v34
    v_lshlrev_b32 v37, 4, v37
    v_lshl_add_u32 v37, v36, 7, v37
    v_add_u32 v11, s31, v37
    v_xor_b32 v12, 64, v11
    v_lshlrev_b32 v37, 2, v34
    v_sub_u32 v37, v36, v37
    v_mov_b32 v39, 0xff800000
    v_subrev_u32 v38, 0, v37
    v_cmp_gt_u32 vcc, 8, v38
    s_nop 1
    v_cndmask_b32 v24, v39, 0, vcc
    v_cmp_ge_i32 vcc, -9, v38
    s_nop 1
    v_cndmask_b32 v20, v39, 0, vcc
    v_cmp_le_i32 vcc, 0, v38
    s_nop 1
    v_cndmask_b32 v40, 0, -1, vcc
    v_subrev_u32 v38, 1, v37
    v_cmp_gt_u32 vcc, 8, v38
    s_nop 1
    v_cndmask_b32 v25, v39, 0, vcc
    v_cmp_ge_i32 vcc, -9, v38
    s_nop 1
    v_cndmask_b32 v21, v39, 0, vcc
    v_cmp_le_i32 vcc, 0, v38
    s_nop 1
    v_cndmask_b32 v41, 0, -1, vcc
    v_subrev_u32 v38, 2, v37
    v_cmp_gt_u32 vcc, 8, v38
    s_nop 1
    v_cndmask_b32 v26, v39, 0, vcc
    v_cmp_ge_i32 vcc, -9, v38
    s_nop 1
    v_cndmask_b32 v22, v39, 0, vcc
    v_cmp_le_i32 vcc, 0, v38
    s_nop 1
    v_cndmask_b32 v42, 0, -1, vcc
    v_subrev_u32 v38, 3, v37
    v_cmp_gt_u32 vcc, 8, v38
    s_nop 1
    v_cndmask_b32 v27, v39, 0, vcc
    v_cmp_ge_i32 vcc, -9, v38
    s_nop 1
    v_cndmask_b32 v23, v39, 0, vcc
    v_cmp_le_i32 vcc, 0, v38
    s_nop 1
    v_cndmask_b32 v43, 0, -1, vcc
    v_mov_b32 v38, 0xffff
    v_bfi_b32 v28, v38, v40, v41
    v_bfi_b32 v29, v38, v42, v43
    v_cmp_ne_u32 vcc, 3, v34
    s_nop 1
    v_cndmask_b32 v30, 0, -1, vcc
    s_cmp_eq_u32 s36, 0
    s_cselect_b32 s38, 0xff800000, 0
    v_or_b32 v56, s38, v20
    v_or_b32 v57, s38, v21
    v_or_b32 v58, s38, v22
    v_or_b32 v59, s38, v23
    s_lshl_b32 s38, s27, 6
    s_add_u32 s38, s38, s36
    s_lshl_b32 s38, s38, 4
    s_add_u32 s38, s38, s26
    s_lshl_b32 s38, s38, 10
    v_lshl_add_u32 v31, v1, 4, s38
    s_waitcnt vmcnt(18) lgkmcnt(0)
    s_barrier
    v_add_u32 v13, 0, v9
    v_add_u32 v15, 0, v11
    v_add_u32 v14, 0, v10
    v_add_u32 v16, 0, v12
    ds_read_b128 v[136:139], v15 offset:0
    ds_read_b64_tr_b16 v[160:161], v13 offset:0
    ds_read_b64_tr_b16 v[162:163], v13 offset:512
    ds_read_b128 v[140:143], v15 offset:2048
    ds_read_b64_tr_b16 v[164:165], v14 offset:0
    ds_read_b64_tr_b16 v[166:167], v14 offset:512
    ds_read_b128 v[144:147], v15 offset:4096
    ds_read_b64_tr_b16 v[168:169], v13 offset:1024
    ds_read_b64_tr_b16 v[170:171], v13 offset:1536
    ds_read_b64_tr_b16 v[172:173], v14 offset:1024
    ds_read_b64_tr_b16 v[174:175], v14 offset:1536
    ds_read_b64_tr_b16 v[176:177], v13 offset:2048
    ds_read_b64_tr_b16 v[178:179], v13 offset:2560
    ds_read_b64_tr_b16 v[180:181], v14 offset:2048
    ds_read_b64_tr_b16 v[182:183], v14 offset:2560
    s_lshl_b32 s33, s30, 7
    s_mul_i32 s34, s30, 64*2688
    s_add_u32 s30, s30, 1
    s_cmp_eq_u32 s30, 7
    s_cselect_b32 s30, 0, s30
    s_add_u32 m0, s32, 110592
    s_nop 0
    buffer_load_dwordx4 v8, s[16:19], s34 offen offset:0 lds
    s_add_u32 m0, s31, 110592
    s_nop 0
    buffer_load_dwordx4 v2, s[12:15], s33 offen lds
    s_add_u32 m0, s31, 111616
    s_nop 0
    buffer_load_dwordx4 v3, s[12:15], s33 offen lds
    s_add_u32 m0, s32, 110720
    s_nop 0
    buffer_load_dwordx4 v8, s[16:19], s34 offen offset:896 lds
    s_waitcnt lgkmcnt(0)
    ds_read_b128 v[148:151], v16 offset:0
    ds_read_b64_tr_b16 v[184:185], v13 offset:6144
    v_mfma_f32_16x16x32_bf16 v[64:67], v[160:163], v[136:139], 0
    ds_read_b64_tr_b16 v[186:187], v13 offset:6656
    ds_read_b128 v[152:155], v16 offset:2048
    v_mfma_f32_16x16x32_bf16 v[88:91], v[160:163], v[140:143], 0
    ds_read_b64_tr_b16 v[188:189], v14 offset:6144
    ds_read_b64_tr_b16 v[190:191], v14 offset:6656
    v_mfma_f32_16x16x32_bf16 v[112:115], v[160:163], v[144:147], 0
    ds_read_b128 v[156:159], v16 offset:4096
    ds_read_b64_tr_b16 v[192:193], v13 offset:7168
    v_mfma_f32_16x16x32_bf16 v[68:71], v[164:167], v[136:139], 0
    ds_read_b64_tr_b16 v[194:195], v13 offset:7680
    ds_read_b64_tr_b16 v[196:197], v14 offset:7168
    v_mfma_f32_16x16x32_bf16 v[92:95], v[164:167], v[140:143], 0
    ds_read_b64_tr_b16 v[198:199], v14 offset:7680
    ds_read_b64_tr_b16 v[200:201], v13 offset:8192
    v_mfma_f32_16x16x32_bf16 v[116:119], v[164:167], v[144:147], 0
    ds_read_b64_tr_b16 v[202:203], v13 offset:8704
    ds_read_b64_tr_b16 v[204:205], v14 offset:8192
    v_mfma_f32_16x16x32_bf16 v[72:75], v[168:171], v[136:139], 0
    ds_read_b64_tr_b16 v[206:207], v14 offset:8704
    v_mfma_f32_16x16x32_bf16 v[96:99], v[168:171], v[140:143], 0
    s_add_u32 m0, s31, 112640
    s_nop 0
    buffer_load_dwordx4 v4, s[12:15], s33 offen lds
    v_mfma_f32_16x16x32_bf16 v[120:123], v[168:171], v[144:147], 0
    v_mfma_f32_16x16x32_bf16 v[76:79], v[172:175], v[136:139], 0
    s_add_u32 m0, s31, 113664
    s_nop 0
    buffer_load_dwordx4 v5, s[12:15], s33 offen lds
    v_mfma_f32_16x16x32_bf16 v[100:103], v[172:175], v[140:143], 0
    v_mfma_f32_16x16x32_bf16 v[124:127], v[172:175], v[144:147], 0
    s_add_u32 m0, s32, 110848
    s_nop 0
    buffer_load_dwordx4 v8, s[16:19], s34 offen offset:1792 lds
    v_mfma_f32_16x16x32_bf16 v[80:83], v[136:139], v[176:179], 0
    v_mfma_f32_16x16x32_bf16 v[104:107], v[140:143], v[176:179], 0
    s_add_u32 m0, s31, 114688
    s_nop 0
    buffer_load_dwordx4 v6, s[12:15], s33 offen lds
    v_mfma_f32_16x16x32_bf16 v[128:131], v[144:147], v[176:179], 0
    v_mfma_f32_16x16x32_bf16 v[84:87], v[136:139], v[180:183], 0
    s_add_u32 m0, s31, 115712
    s_nop 0
    buffer_load_dwordx4 v7, s[12:15], s33 offen lds
    v_mfma_f32_16x16x32_bf16 v[108:111], v[140:143], v[180:183], 0
    v_mfma_f32_16x16x32_bf16 v[132:135], v[144:147], v[180:183], 0
    s_waitcnt vmcnt(18) lgkmcnt(0)
    s_barrier
    v_add_u32 v13, 36864, v9
    v_add_u32 v15, 36864, v11
    v_add_u32 v14, 36864, v10
    v_add_u32 v16, 36864, v12
    ds_read_b128 v[136:139], v15 offset:0
    ds_read_b64_tr_b16 v[160:161], v13 offset:0
    v_mfma_f32_16x16x32_bf16 v[64:67], v[184:187], v[148:151], v[64:67]
    ds_read_b64_tr_b16 v[162:163], v13 offset:512
    ds_read_b128 v[140:143], v15 offset:2048
    v_mfma_f32_16x16x32_bf16 v[88:91], v[184:187], v[152:155], v[88:91]
    ds_read_b64_tr_b16 v[164:165], v14 offset:0
    ds_read_b64_tr_b16 v[166:167], v14 offset:512
    v_mfma_f32_16x16x32_bf16 v[112:115], v[184:187], v[156:159], v[112:115]
    ds_read_b128 v[144:147], v15 offset:4096
    ds_read_b64_tr_b16 v[168:169], v13 offset:1024
    v_mfma_f32_16x16x32_bf16 v[68:71], v[188:191], v[148:151], v[68:71]
    ds_read_b64_tr_b16 v[170:171], v13 offset:1536
    ds_read_b64_tr_b16 v[172:173], v14 offset:1024
    v_mfma_f32_16x16x32_bf16 v[92:95], v[188:191], v[152:155], v[92:95]
    ds_read_b64_tr_b16 v[174:175], v14 offset:1536
    ds_read_b64_tr_b16 v[176:177], v13 offset:2048
    v_mfma_f32_16x16x32_bf16 v[116:119], v[188:191], v[156:159], v[116:119]
    ds_read_b64_tr_b16 v[178:179], v13 offset:2560
    ds_read_b64_tr_b16 v[180:181], v14 offset:2048
    v_mfma_f32_16x16x32_bf16 v[72:75], v[192:195], v[148:151], v[72:75]
    ds_read_b64_tr_b16 v[182:183], v14 offset:2560
    v_mfma_f32_16x16x32_bf16 v[96:99], v[192:195], v[152:155], v[96:99]
    s_lshl_b32 s33, s30, 7
    s_mul_i32 s34, s30, 64*2688
    s_add_u32 s30, s30, 1
    s_cmp_eq_u32 s30, 7
    s_cselect_b32 s30, 0, s30
    v_mfma_f32_16x16x32_bf16 v[120:123], v[192:195], v[156:159], v[120:123]
    v_mfma_f32_16x16x32_bf16 v[76:79], v[196:199], v[148:151], v[76:79]
    s_add_u32 m0, s32, 0
    s_nop 0
    buffer_load_dwordx4 v8, s[16:19], s34 offen offset:0 lds
    v_mfma_f32_16x16x32_bf16 v[100:103], v[196:199], v[152:155], v[100:103]
    v_mfma_f32_16x16x32_bf16 v[124:127], v[196:199], v[156:159], v[124:127]
    s_add_u32 m0, s31, 0
    s_nop 0
    buffer_load_dwordx4 v2, s[12:15], s33 offen lds
    v_mfma_f32_16x16x32_bf16 v[80:83], v[148:151], v[200:203], v[80:83]
    v_mfma_f32_16x16x32_bf16 v[104:107], v[152:155], v[200:203], v[104:107]
    s_add_u32 m0, s31, 1024
    s_nop 0
    buffer_load_dwordx4 v3, s[12:15], s33 offen lds
    v_mfma_f32_16x16x32_bf16 v[128:131], v[156:159], v[200:203], v[128:131]
    v_mfma_f32_16x16x32_bf16 v[84:87], v[148:151], v[204:207], v[84:87]
    s_add_u32 m0, s32, 128
    s_nop 0
    buffer_load_dwordx4 v8, s[16:19], s34 offen offset:896 lds
    v_mfma_f32_16x16x32_bf16 v[108:111], v[152:155], v[204:207], v[108:111]
    v_mfma_f32_16x16x32_bf16 v[132:135], v[156:159], v[204:207], v[132:135]
    s_waitcnt lgkmcnt(0)
    ds_read_b128 v[148:151], v16 offset:0
    ds_read_b64_tr_b16 v[184:185], v13 offset:6144
    v_mfma_f32_16x16x32_bf16 v[64:67], v[160:163], v[136:139], v[64:67]
    ds_read_b64_tr_b16 v[186:187], v13 offset:6656
    ds_read_b128 v[152:155], v16 offset:2048
    v_mfma_f32_16x16x32_bf16 v[88:91], v[160:163], v[140:143], v[88:91]
    ds_read_b64_tr_b16 v[188:189], v14 offset:6144
    ds_read_b64_tr_b16 v[190:191], v14 offset:6656
    v_mfma_f32_16x16x32_bf16 v[112:115], v[160:163], v[144:147], v[112:115]
    ds_read_b128 v[156:159], v16 offset:4096
    ds_read_b64_tr_b16 v[192:193], v13 offset:7168
    v_mfma_f32_16x16x32_bf16 v[68:71], v[164:167], v[136:139], v[68:71]
    ds_read_b64_tr_b16 v[194:195], v13 offset:7680
    ds_read_b64_tr_b16 v[196:197], v14 offset:7168
    v_mfma_f32_16x16x32_bf16 v[92:95], v[164:167], v[140:143], v[92:95]
    ds_read_b64_tr_b16 v[198:199], v14 offset:7680
    ds_read_b64_tr_b16 v[200:201], v13 offset:8192
    v_mfma_f32_16x16x32_bf16 v[116:119], v[164:167], v[144:147], v[116:119]
    ds_read_b64_tr_b16 v[202:203], v13 offset:8704
    ds_read_b64_tr_b16 v[204:205], v14 offset:8192
    v_mfma_f32_16x16x32_bf16 v[72:75], v[168:171], v[136:139], v[72:75]
    ds_read_b64_tr_b16 v[206:207], v14 offset:8704
    v_mfma_f32_16x16x32_bf16 v[96:99], v[168:171], v[140:143], v[96:99]
    s_add_u32 m0, s31, 2048
    s_nop 0
    buffer_load_dwordx4 v4, s[12:15], s33 offen lds
    v_mfma_f32_16x16x32_bf16 v[120:123], v[168:171], v[144:147], v[120:123]
    v_mfma_f32_16x16x32_bf16 v[76:79], v[172:175], v[136:139], v[76:79]
    s_add_u32 m0, s31, 3072
    s_nop 0
    buffer_load_dwordx4 v5, s[12:15], s33 offen lds
    v_mfma_f32_16x16x32_bf16 v[100:103], v[172:175], v[140:143], v[100:103]
    v_mfma_f32_16x16x32_bf16 v[124:127], v[172:175], v[144:147], v[124:127]
    s_add_u32 m0, s32, 256
    s_nop 0
    buffer_load_dwordx4 v8, s[16:19], s34 offen offset:1792 lds
    v_mfma_f32_16x16x32_bf16 v[80:83], v[136:139], v[176:179], v[80:83]
    v_mfma_f32_16x16x32_bf16 v[104:107], v[140:143], v[176:179], v[104:107]
    s_add_u32 m0, s31, 4096
    s_nop 0
    buffer_load_dwordx4 v6, s[12:15], s33 offen lds
    v_mfma_f32_16x16x32_bf16 v[128:131], v[144:147], v[176:179], v[128:131]
    v_mfma_f32_16x16x32_bf16 v[84:87], v[136:139], v[180:183], v[84:87]
    s_add_u32 m0, s31, 5120
    s_nop 0
    buffer_load_dwordx4 v7, s[12:15], s33 offen lds
    v_mfma_f32_16x16x32_bf16 v[108:111], v[140:143], v[180:183], v[108:111]
    v_mfma_f32_16x16x32_bf16 v[132:135], v[144:147], v[180:183], v[132:135]
    s_waitcnt vmcnt(18) lgkmcnt(0)
    s_barrier
    v_add_u32 v13, 73728, v9
    v_add_u32 v15, 73728, v11
    v_add_u32 v14, 73728, v10
    v_add_u32 v16, 73728, v12
    ds_read_b128 v[136:139], v15 offset:0
    ds_read_b64_tr_b16 v[160:161], v13 offset:0
    v_mfma_f32_16x16x32_bf16 v[64:67], v[184:187], v[148:151], v[64:67]
    ds_read_b64_tr_b16 v[162:163], v13 offset:512
    ds_read_b128 v[140:143], v15 offset:2048
    v_mfma_f32_16x16x32_bf16 v[88:91], v[184:187], v[152:155], v[88:91]
    ds_read_b64_tr_b16 v[164:165], v14 offset:0
    ds_read_b64_tr_b16 v[166:167], v14 offset:512
    v_mfma_f32_16x16x32_bf16 v[112:115], v[184:187], v[156:159], v[112:115]
    ds_read_b128 v[144:147], v15 offset:4096
    ds_read_b64_tr_b16 v[168:169], v13 offset:1024
    v_mfma_f32_16x16x32_bf16 v[68:71], v[188:191], v[148:151], v[68:71]
    ds_read_b64_tr_b16 v[170:171], v13 offset:1536
    ds_read_b64_tr_b16 v[172:173], v14 offset:1024
    v_mfma_f32_16x16x32_bf16 v[92:95], v[188:191], v[152:155], v[92:95]
    ds_read_b64_tr_b16 v[174:175], v14 offset:1536
    ds_read_b64_tr_b16 v[176:177], v13 offset:2048
    v_mfma_f32_16x16x32_bf16 v[116:119], v[188:191], v[156:159], v[116:119]
    ds_read_b64_tr_b16 v[178:179], v13 offset:2560
    ds_read_b64_tr_b16 v[180:181], v14 offset:2048
    v_mfma_f32_16x16x32_bf16 v[72:75], v[192:195], v[148:151], v[72:75]
    ds_read_b64_tr_b16 v[182:183], v14 offset:2560
    v_mfma_f32_16x16x32_bf16 v[96:99], v[192:195], v[152:155], v[96:99]
    s_lshl_b32 s33, s30, 7
    s_mul_i32 s34, s30, 64*2688
    s_add_u32 s30, s30, 1
    s_cmp_eq_u32 s30, 7
    s_cselect_b32 s30, 0, s30
    v_mfma_f32_16x16x32_bf16 v[120:123], v[192:195], v[156:159], v[120:123]
    v_mfma_f32_16x16x32_bf16 v[76:79], v[196:199], v[148:151], v[76:79]
    s_add_u32 m0, s32, 36864
    s_nop 0
    buffer_load_dwordx4 v8, s[16:19], s34 offen offset:0 lds
    v_mfma_f32_16x16x32_bf16 v[100:103], v[196:199], v[152:155], v[100:103]
    v_mfma_f32_16x16x32_bf16 v[124:127], v[196:199], v[156:159], v[124:127]
    s_add_u32 m0, s31, 36864
    s_nop 0
    buffer_load_dwordx4 v2, s[12:15], s33 offen lds
    v_mfma_f32_16x16x32_bf16 v[80:83], v[148:151], v[200:203], v[80:83]
    v_mfma_f32_16x16x32_bf16 v[104:107], v[152:155], v[200:203], v[104:107]
    s_add_u32 m0, s31, 37888
    s_nop 0
    buffer_load_dwordx4 v3, s[12:15], s33 offen lds
    v_mfma_f32_16x16x32_bf16 v[128:131], v[156:159], v[200:203], v[128:131]
    v_mfma_f32_16x16x32_bf16 v[84:87], v[148:151], v[204:207], v[84:87]
    s_add_u32 m0, s32, 36992
    s_nop 0
    buffer_load_dwordx4 v8, s[16:19], s34 offen offset:896 lds
    v_mfma_f32_16x16x32_bf16 v[108:111], v[152:155], v[204:207], v[108:111]
    v_mfma_f32_16x16x32_bf16 v[132:135], v[156:159], v[204:207], v[132:135]
    s_waitcnt lgkmcnt(0)
    ds_read_b128 v[148:151], v16 offset:0
    ds_read_b64_tr_b16 v[184:185], v13 offset:6144
    v_mfma_f32_16x16x32_bf16 v[64:67], v[160:163], v[136:139], v[64:67]
    ds_read_b64_tr_b16 v[186:187], v13 offset:6656
    ds_read_b128 v[152:155], v16 offset:2048
    v_mfma_f32_16x16x32_bf16 v[88:91], v[160:163], v[140:143], v[88:91]
    ds_read_b64_tr_b16 v[188:189], v14 offset:6144
    ds_read_b64_tr_b16 v[190:191], v14 offset:6656
    v_mfma_f32_16x16x32_bf16 v[112:115], v[160:163], v[144:147], v[112:115]
    ds_read_b128 v[156:159], v16 offset:4096
    ds_read_b64_tr_b16 v[192:193], v13 offset:7168
    v_mfma_f32_16x16x32_bf16 v[68:71], v[164:167], v[136:139], v[68:71]
    ds_read_b64_tr_b16 v[194:195], v13 offset:7680
    ds_read_b64_tr_b16 v[196:197], v14 offset:7168
    v_mfma_f32_16x16x32_bf16 v[92:95], v[164:167], v[140:143], v[92:95]
    ds_read_b64_tr_b16 v[198:199], v14 offset:7680
    ds_read_b64_tr_b16 v[200:201], v13 offset:8192
    v_mfma_f32_16x16x32_bf16 v[116:119], v[164:167], v[144:147], v[116:119]
    ds_read_b64_tr_b16 v[202:203], v13 offset:8704
    ds_read_b64_tr_b16 v[204:205], v14 offset:8192
    v_mfma_f32_16x16x32_bf16 v[72:75], v[168:171], v[136:139], v[72:75]
    ds_read_b64_tr_b16 v[206:207], v14 offset:8704
    v_mfma_f32_16x16x32_bf16 v[96:99], v[168:171], v[140:143], v[96:99]
    s_add_u32 m0, s31, 38912
    s_nop 0
    buffer_load_dwordx4 v4, s[12:15], s33 offen lds
    v_mfma_f32_16x16x32_bf16 v[120:123], v[168:171], v[144:147], v[120:123]
    v_mfma_f32_16x16x32_bf16 v[76:79], v[172:175], v[136:139], v[76:79]
    s_add_u32 m0, s31, 39936
    s_nop 0
    buffer_load_dwordx4 v5, s[12:15], s33 offen lds
    v_mfma_f32_16x16x32_bf16 v[100:103], v[172:175], v[140:143], v[100:103]
    v_mfma_f32_16x16x32_bf16 v[124:127], v[172:175], v[144:147], v[124:127]
    s_add_u32 m0, s32, 37120
    s_nop 0
    buffer_load_dwordx4 v8, s[16:19], s34 offen offset:1792 lds
    v_mfma_f32_16x16x32_bf16 v[80:83], v[136:139], v[176:179], v[80:83]
    v_mfma_f32_16x16x32_bf16 v[104:107], v[140:143], v[176:179], v[104:107]
    s_add_u32 m0, s31, 40960
    s_nop 0
    buffer_load_dwordx4 v6, s[12:15], s33 offen lds
    v_mfma_f32_16x16x32_bf16 v[128:131], v[144:147], v[176:179], v[128:131]
    v_mfma_f32_16x16x32_bf16 v[84:87], v[136:139], v[180:183], v[84:87]
    s_add_u32 m0, s31, 41984
    s_nop 0
    buffer_load_dwordx4 v7, s[12:15], s33 offen lds
    v_mfma_f32_16x16x32_bf16 v[108:111], v[140:143], v[180:183], v[108:111]
    v_mfma_f32_16x16x32_bf16 v[132:135], v[144:147], v[180:183], v[132:135]
    s_waitcnt vmcnt(18) lgkmcnt(0)
    s_barrier
    v_add_u32 v13, 110592, v9
    v_add_u32 v15, 110592, v11
    v_add_u32 v14, 110592, v10
    v_add_u32 v16, 110592, v12
    ds_read_b128 v[136:139], v15 offset:0
    ds_read_b64_tr_b16 v[160:161], v13 offset:0
    v_mfma_f32_16x16x32_bf16 v[64:67], v[184:187], v[148:151], v[64:67]
    ds_read_b64_tr_b16 v[162:163], v13 offset:512
    ds_read_b128 v[140:143], v15 offset:2048
    v_mfma_f32_16x16x32_bf16 v[88:91], v[184:187], v[152:155], v[88:91]
    ds_read_b64_tr_b16 v[164:165], v14 offset:0
    ds_read_b64_tr_b16 v[166:167], v14 offset:512
    v_mfma_f32_16x16x32_bf16 v[112:115], v[184:187], v[156:159], v[112:115]
    ds_read_b128 v[144:147], v15 offset:4096
    ds_read_b64_tr_b16 v[168:169], v13 offset:1024
    v_mfma_f32_16x16x32_bf16 v[68:71], v[188:191], v[148:151], v[68:71]
    ds_read_b64_tr_b16 v[170:171], v13 offset:1536
    ds_read_b64_tr_b16 v[172:173], v14 offset:1024
    v_mfma_f32_16x16x32_bf16 v[92:95], v[188:191], v[152:155], v[92:95]
    ds_read_b64_tr_b16 v[174:175], v14 offset:1536
    ds_read_b64_tr_b16 v[176:177], v13 offset:2048
    v_mfma_f32_16x16x32_bf16 v[116:119], v[188:191], v[156:159], v[116:119]
    ds_read_b64_tr_b16 v[178:179], v13 offset:2560
    ds_read_b64_tr_b16 v[180:181], v14 offset:2048
    v_mfma_f32_16x16x32_bf16 v[72:75], v[192:195], v[148:151], v[72:75]
    ds_read_b64_tr_b16 v[182:183], v14 offset:2560
    v_mfma_f32_16x16x32_bf16 v[96:99], v[192:195], v[152:155], v[96:99]
    s_lshl_b32 s33, s30, 7
    s_mul_i32 s34, s30, 64*2688
    s_add_u32 s30, s30, 1
    s_cmp_eq_u32 s30, 7
    s_cselect_b32 s30, 0, s30
    v_mfma_f32_16x16x32_bf16 v[120:123], v[192:195], v[156:159], v[120:123]
    v_mfma_f32_16x16x32_bf16 v[76:79], v[196:199], v[148:151], v[76:79]
    s_add_u32 m0, s32, 73728
    s_nop 0
    buffer_load_dwordx4 v8, s[16:19], s34 offen offset:0 lds
    v_mfma_f32_16x16x32_bf16 v[100:103], v[196:199], v[152:155], v[100:103]
    v_mfma_f32_16x16x32_bf16 v[124:127], v[196:199], v[156:159], v[124:127]
    s_add_u32 m0, s31, 73728
    s_nop 0
    buffer_load_dwordx4 v2, s[12:15], s33 offen lds
    v_mfma_f32_16x16x32_bf16 v[80:83], v[148:151], v[200:203], v[80:83]
    v_mfma_f32_16x16x32_bf16 v[104:107], v[152:155], v[200:203], v[104:107]
    s_add_u32 m0, s31, 74752
    s_nop 0
    buffer_load_dwordx4 v3, s[12:15], s33 offen lds
    v_mfma_f32_16x16x32_bf16 v[128:131], v[156:159], v[200:203], v[128:131]
    v_mfma_f32_16x16x32_bf16 v[84:87], v[148:151], v[204:207], v[84:87]
    s_add_u32 m0, s32, 73856
    s_nop 0
    buffer_load_dwordx4 v8, s[16:19], s34 offen offset:896 lds
    v_mfma_f32_16x16x32_bf16 v[108:111], v[152:155], v[204:207], v[108:111]
    v_mfma_f32_16x16x32_bf16 v[132:135], v[156:159], v[204:207], v[132:135]
    s_waitcnt lgkmcnt(0)
    ds_read_b128 v[148:151], v16 offset:0
    ds_read_b64_tr_b16 v[184:185], v13 offset:6144
    v_mfma_f32_16x16x32_bf16 v[64:67], v[160:163], v[136:139], v[64:67]
    ds_read_b64_tr_b16 v[186:187], v13 offset:6656
    ds_read_b128 v[152:155], v16 offset:2048
    v_mfma_f32_16x16x32_bf16 v[88:91], v[160:163], v[140:143], v[88:91]
    ds_read_b64_tr_b16 v[188:189], v14 offset:6144
    ds_read_b64_tr_b16 v[190:191], v14 offset:6656
    v_mfma_f32_16x16x32_bf16 v[112:115], v[160:163], v[144:147], v[112:115]
    ds_read_b128 v[156:159], v16 offset:4096
    ds_read_b64_tr_b16 v[192:193], v13 offset:7168
    v_mfma_f32_16x16x32_bf16 v[68:71], v[164:167], v[136:139], v[68:71]
    ds_read_b64_tr_b16 v[194:195], v13 offset:7680
    ds_read_b64_tr_b16 v[196:197], v14 offset:7168
    v_mfma_f32_16x16x32_bf16 v[92:95], v[164:167], v[140:143], v[92:95]
    ds_read_b64_tr_b16 v[198:199], v14 offset:7680
    ds_read_b64_tr_b16 v[200:201], v13 offset:8192
    v_mfma_f32_16x16x32_bf16 v[116:119], v[164:167], v[144:147], v[116:119]
    ds_read_b64_tr_b16 v[202:203], v13 offset:8704
    ds_read_b64_tr_b16 v[204:205], v14 offset:8192
    v_mfma_f32_16x16x32_bf16 v[72:75], v[168:171], v[136:139], v[72:75]
    ds_read_b64_tr_b16 v[206:207], v14 offset:8704
    v_mfma_f32_16x16x32_bf16 v[96:99], v[168:171], v[140:143], v[96:99]
    s_add_u32 m0, s31, 75776
    s_nop 0
    buffer_load_dwordx4 v4, s[12:15], s33 offen lds
    v_mfma_f32_16x16x32_bf16 v[120:123], v[168:171], v[144:147], v[120:123]
    v_mfma_f32_16x16x32_bf16 v[76:79], v[172:175], v[136:139], v[76:79]
    s_add_u32 m0, s31, 76800
    s_nop 0
    buffer_load_dwordx4 v5, s[12:15], s33 offen lds
    v_mfma_f32_16x16x32_bf16 v[100:103], v[172:175], v[140:143], v[100:103]
    v_mfma_f32_16x16x32_bf16 v[124:127], v[172:175], v[144:147], v[124:127]
    s_add_u32 m0, s32, 73984
    s_nop 0
    buffer_load_dwordx4 v8, s[16:19], s34 offen offset:1792 lds
    v_mfma_f32_16x16x32_bf16 v[80:83], v[136:139], v[176:179], v[80:83]
    v_mfma_f32_16x16x32_bf16 v[104:107], v[140:143], v[176:179], v[104:107]
    s_add_u32 m0, s31, 77824
    s_nop 0
    buffer_load_dwordx4 v6, s[12:15], s33 offen lds
    v_mfma_f32_16x16x32_bf16 v[128:131], v[144:147], v[176:179], v[128:131]
    v_mfma_f32_16x16x32_bf16 v[84:87], v[136:139], v[180:183], v[84:87]
    s_add_u32 m0, s31, 78848
    s_nop 0
    buffer_load_dwordx4 v7, s[12:15], s33 offen lds
    v_mfma_f32_16x16x32_bf16 v[108:111], v[140:143], v[180:183], v[108:111]
    v_mfma_f32_16x16x32_bf16 v[132:135], v[144:147], v[180:183], v[132:135]
    s_waitcnt vmcnt(18) lgkmcnt(0)
    s_barrier
    v_add_u32 v13, 0, v9
    v_add_u32 v15, 0, v11
    v_add_u32 v14, 0, v10
    v_add_u32 v16, 0, v12
    ds_read_b128 v[136:139], v15 offset:0
    ds_read_b64_tr_b16 v[160:161], v13 offset:0
    v_mfma_f32_16x16x32_bf16 v[64:67], v[184:187], v[148:151], v[64:67]
    ds_read_b64_tr_b16 v[162:163], v13 offset:512
    ds_read_b128 v[140:143], v15 offset:2048
    v_mfma_f32_16x16x32_bf16 v[88:91], v[184:187], v[152:155], v[88:91]
    ds_read_b64_tr_b16 v[164:165], v14 offset:0
    ds_read_b64_tr_b16 v[166:167], v14 offset:512
    v_mfma_f32_16x16x32_bf16 v[112:115], v[184:187], v[156:159], v[112:115]
    ds_read_b128 v[144:147], v15 offset:4096
    ds_read_b64_tr_b16 v[168:169], v13 offset:1024
    v_mfma_f32_16x16x32_bf16 v[68:71], v[188:191], v[148:151], v[68:71]
    ds_read_b64_tr_b16 v[170:171], v13 offset:1536
    ds_read_b64_tr_b16 v[172:173], v14 offset:1024
    v_mfma_f32_16x16x32_bf16 v[92:95], v[188:191], v[152:155], v[92:95]
    ds_read_b64_tr_b16 v[174:175], v14 offset:1536
    ds_read_b64_tr_b16 v[176:177], v13 offset:2048
    v_mfma_f32_16x16x32_bf16 v[116:119], v[188:191], v[156:159], v[116:119]
    ds_read_b64_tr_b16 v[178:179], v13 offset:2560
    ds_read_b64_tr_b16 v[180:181], v14 offset:2048
    v_mfma_f32_16x16x32_bf16 v[72:75], v[192:195], v[148:151], v[72:75]
    ds_read_b64_tr_b16 v[182:183], v14 offset:2560
    v_mfma_f32_16x16x32_bf16 v[96:99], v[192:195], v[152:155], v[96:99]
    v_mfma_f32_16x16x32_bf16 v[120:123], v[192:195], v[156:159], v[120:123]
    v_mfma_f32_16x16x32_bf16 v[76:79], v[196:199], v[148:151], v[76:79]
    v_mfma_f32_16x16x32_bf16 v[100:103], v[196:199], v[152:155], v[100:103]
    v_mfma_f32_16x16x32_bf16 v[124:127], v[196:199], v[156:159], v[124:127]
    v_mfma_f32_16x16x32_bf16 v[80:83], v[148:151], v[200:203], v[80:83]
    v_mfma_f32_16x16x32_bf16 v[104:107], v[152:155], v[200:203], v[104:107]
    v_mfma_f32_16x16x32_bf16 v[128:131], v[156:159], v[200:203], v[128:131]
    v_mfma_f32_16x16x32_bf16 v[84:87], v[148:151], v[204:207], v[84:87]
    v_mfma_f32_16x16x32_bf16 v[108:111], v[152:155], v[204:207], v[108:111]
    v_mfma_f32_16x16x32_bf16 v[132:135], v[156:159], v[204:207], v[132:135]
    s_waitcnt lgkmcnt(0)
    ds_read_b128 v[148:151], v16 offset:0
    ds_read_b64_tr_b16 v[184:185], v13 offset:6144
    v_mfma_f32_16x16x32_bf16 v[64:67], v[160:163], v[136:139], v[64:67]
    ds_read_b64_tr_b16 v[186:187], v13 offset:6656
    ds_read_b128 v[152:155], v16 offset:2048
    v_mfma_f32_16x16x32_bf16 v[88:91], v[160:163], v[140:143], v[88:91]
    ds_read_b64_tr_b16 v[188:189], v14 offset:6144
    ds_read_b64_tr_b16 v[190:191], v14 offset:6656
    v_mfma_f32_16x16x32_bf16 v[112:115], v[160:163], v[144:147], v[112:115]
    ds_read_b128 v[156:159], v16 offset:4096
    ds_read_b64_tr_b16 v[192:193], v13 offset:7168
    v_mfma_f32_16x16x32_bf16 v[68:71], v[164:167], v[136:139], v[68:71]
    ds_read_b64_tr_b16 v[194:195], v13 offset:7680
    ds_read_b64_tr_b16 v[196:197], v14 offset:7168
    v_mfma_f32_16x16x32_bf16 v[92:95], v[164:167], v[140:143], v[92:95]
    ds_read_b64_tr_b16 v[198:199], v14 offset:7680
    ds_read_b64_tr_b16 v[200:201], v13 offset:8192
    v_mfma_f32_16x16x32_bf16 v[116:119], v[164:167], v[144:147], v[116:119]
    ds_read_b64_tr_b16 v[202:203], v13 offset:8704
    ds_read_b64_tr_b16 v[204:205], v14 offset:8192
    v_mfma_f32_16x16x32_bf16 v[72:75], v[168:171], v[136:139], v[72:75]
    ds_read_b64_tr_b16 v[206:207], v14 offset:8704
    v_mfma_f32_16x16x32_bf16 v[96:99], v[168:171], v[140:143], v[96:99]
    v_mfma_f32_16x16x32_bf16 v[120:123], v[168:171], v[144:147], v[120:123]
    v_mfma_f32_16x16x32_bf16 v[76:79], v[172:175], v[136:139], v[76:79]
    v_mfma_f32_16x16x32_bf16 v[100:103], v[172:175], v[140:143], v[100:103]
    v_mfma_f32_16x16x32_bf16 v[124:127], v[172:175], v[144:147], v[124:127]
    v_mfma_f32_16x16x32_bf16 v[80:83], v[136:139], v[176:179], v[80:83]
    v_mfma_f32_16x16x32_bf16 v[104:107], v[140:143], v[176:179], v[104:107]
    v_mfma_f32_16x16x32_bf16 v[128:131], v[144:147], v[176:179], v[128:131]
    v_mfma_f32_16x16x32_bf16 v[84:87], v[136:139], v[180:183], v[84:87]
    v_mfma_f32_16x16x32_bf16 v[108:111], v[140:143], v[180:183], v[108:111]
    v_mfma_f32_16x16x32_bf16 v[132:135], v[144:147], v[180:183], v[132:135]
    s_waitcnt vmcnt(9) lgkmcnt(0)
    s_barrier
    v_add_u32 v13, 36864, v9
    v_add_u32 v15, 36864, v11
    v_add_u32 v14, 36864, v10
    v_add_u32 v16, 36864, v12
    ds_read_b128 v[136:139], v15 offset:0
    ds_read_b64_tr_b16 v[160:161], v13 offset:0
    v_mfma_f32_16x16x32_bf16 v[64:67], v[184:187], v[148:151], v[64:67]
    ds_read_b64_tr_b16 v[162:163], v13 offset:512
    ds_read_b128 v[140:143], v15 offset:2048
    v_mfma_f32_16x16x32_bf16 v[88:91], v[184:187], v[152:155], v[88:91]
    ds_read_b64_tr_b16 v[164:165], v14 offset:0
    ds_read_b64_tr_b16 v[166:167], v14 offset:512
    v_mfma_f32_16x16x32_bf16 v[112:115], v[184:187], v[156:159], v[112:115]
    ds_read_b128 v[144:147], v15 offset:4096
    ds_read_b64_tr_b16 v[168:169], v13 offset:1024
    v_mfma_f32_16x16x32_bf16 v[68:71], v[188:191], v[148:151], v[68:71]
    ds_read_b64_tr_b16 v[170:171], v13 offset:1536
    ds_read_b64_tr_b16 v[172:173], v14 offset:1024
    v_mfma_f32_16x16x32_bf16 v[92:95], v[188:191], v[152:155], v[92:95]
    ds_read_b64_tr_b16 v[174:175], v14 offset:1536
    ds_read_b64_tr_b16 v[176:177], v13 offset:2048
    v_mfma_f32_16x16x32_bf16 v[116:119], v[188:191], v[156:159], v[116:119]
    ds_read_b64_tr_b16 v[178:179], v13 offset:2560
    ds_read_b64_tr_b16 v[180:181], v14 offset:2048
    v_mfma_f32_16x16x32_bf16 v[72:75], v[192:195], v[148:151], v[72:75]
    ds_read_b64_tr_b16 v[182:183], v14 offset:2560
    v_mfma_f32_16x16x32_bf16 v[96:99], v[192:195], v[152:155], v[96:99]
    v_mfma_f32_16x16x32_bf16 v[120:123], v[192:195], v[156:159], v[120:123]
    v_mfma_f32_16x16x32_bf16 v[76:79], v[196:199], v[148:151], v[76:79]
    v_mfma_f32_16x16x32_bf16 v[100:103], v[196:199], v[152:155], v[100:103]
    v_mfma_f32_16x16x32_bf16 v[124:127], v[196:199], v[156:159], v[124:127]
    v_mfma_f32_16x16x32_bf16 v[80:83], v[148:151], v[200:203], v[80:83]
    v_mfma_f32_16x16x32_bf16 v[104:107], v[152:155], v[200:203], v[104:107]
    v_mfma_f32_16x16x32_bf16 v[128:131], v[156:159], v[200:203], v[128:131]
    v_mfma_f32_16x16x32_bf16 v[84:87], v[148:151], v[204:207], v[84:87]
    v_mfma_f32_16x16x32_bf16 v[108:111], v[152:155], v[204:207], v[108:111]
    v_mfma_f32_16x16x32_bf16 v[132:135], v[156:159], v[204:207], v[132:135]
    s_waitcnt lgkmcnt(0)
    ds_read_b128 v[148:151], v16 offset:0
    ds_read_b64_tr_b16 v[184:185], v13 offset:6144
    v_mfma_f32_16x16x32_bf16 v[64:67], v[160:163], v[136:139], v[64:67]
    ds_read_b64_tr_b16 v[186:187], v13 offset:6656
    ds_read_b128 v[152:155], v16 offset:2048
    v_mfma_f32_16x16x32_bf16 v[88:91], v[160:163], v[140:143], v[88:91]
    ds_read_b64_tr_b16 v[188:189], v14 offset:6144
    ds_read_b64_tr_b16 v[190:191], v14 offset:6656
    v_mfma_f32_16x16x32_bf16 v[112:115], v[160:163], v[144:147], v[112:115]
    ds_read_b128 v[156:159], v16 offset:4096
    ds_read_b64_tr_b16 v[192:193], v13 offset:7168
    v_mfma_f32_16x16x32_bf16 v[68:71], v[164:167], v[136:139], v[68:71]
    ds_read_b64_tr_b16 v[194:195], v13 offset:7680
    ds_read_b64_tr_b16 v[196:197], v14 offset:7168
    v_mfma_f32_16x16x32_bf16 v[92:95], v[164:167], v[140:143], v[92:95]
    ds_read_b64_tr_b16 v[198:199], v14 offset:7680
    ds_read_b64_tr_b16 v[200:201], v13 offset:8192
    v_mfma_f32_16x16x32_bf16 v[116:119], v[164:167], v[144:147], v[116:119]
    ds_read_b64_tr_b16 v[202:203], v13 offset:8704
    ds_read_b64_tr_b16 v[204:205], v14 offset:8192
    v_mfma_f32_16x16x32_bf16 v[72:75], v[168:171], v[136:139], v[72:75]
    ds_read_b64_tr_b16 v[206:207], v14 offset:8704
    v_mfma_f32_16x16x32_bf16 v[96:99], v[168:171], v[140:143], v[96:99]
    v_mfma_f32_16x16x32_bf16 v[120:123], v[168:171], v[144:147], v[120:123]
    v_mfma_f32_16x16x32_bf16 v[76:79], v[172:175], v[136:139], v[76:79]
    v_mfma_f32_16x16x32_bf16 v[100:103], v[172:175], v[140:143], v[100:103]
    v_mfma_f32_16x16x32_bf16 v[124:127], v[172:175], v[144:147], v[124:127]
    v_mfma_f32_16x16x32_bf16 v[80:83], v[136:139], v[176:179], v[80:83]
    v_mfma_f32_16x16x32_bf16 v[104:107], v[140:143], v[176:179], v[104:107]
    v_mfma_f32_16x16x32_bf16 v[128:131], v[144:147], v[176:179], v[128:131]
    v_mfma_f32_16x16x32_bf16 v[84:87], v[136:139], v[180:183], v[84:87]
    v_mfma_f32_16x16x32_bf16 v[108:111], v[140:143], v[180:183], v[108:111]
    v_mfma_f32_16x16x32_bf16 v[132:135], v[144:147], v[180:183], v[132:135]
    s_waitcnt vmcnt(0) lgkmcnt(0)
    s_barrier
    v_add_u32 v13, 73728, v9
    v_add_u32 v15, 73728, v11
    v_add_u32 v14, 73728, v10
    v_add_u32 v16, 73728, v12
    ds_read_b128 v[136:139], v15 offset:0
    ds_read_b64_tr_b16 v[160:161], v13 offset:0
    v_mfma_f32_16x16x32_bf16 v[64:67], v[184:187], v[148:151], v[64:67]
    ds_read_b64_tr_b16 v[162:163], v13 offset:512
    ds_read_b128 v[140:143], v15 offset:2048
    v_mfma_f32_16x16x32_bf16 v[88:91], v[184:187], v[152:155], v[88:91]
    ds_read_b64_tr_b16 v[164:165], v14 offset:0
    ds_read_b64_tr_b16 v[166:167], v14 offset:512
    v_mfma_f32_16x16x32_bf16 v[112:115], v[184:187], v[156:159], v[112:115]
    ds_read_b128 v[144:147], v15 offset:4096
    ds_read_b64_tr_b16 v[168:169], v13 offset:1024
    v_mfma_f32_16x16x32_bf16 v[68:71], v[188:191], v[148:151], v[68:71]
    ds_read_b64_tr_b16 v[170:171], v13 offset:1536
    ds_read_b64_tr_b16 v[172:173], v14 offset:1024
    v_mfma_f32_16x16x32_bf16 v[92:95], v[188:191], v[152:155], v[92:95]
    ds_read_b64_tr_b16 v[174:175], v14 offset:1536
    ds_read_b64_tr_b16 v[176:177], v13 offset:2048
    v_mfma_f32_16x16x32_bf16 v[116:119], v[188:191], v[156:159], v[116:119]
    ds_read_b64_tr_b16 v[178:179], v13 offset:2560
    ds_read_b64_tr_b16 v[180:181], v14 offset:2048
    v_mfma_f32_16x16x32_bf16 v[72:75], v[192:195], v[148:151], v[72:75]
    ds_read_b64_tr_b16 v[182:183], v14 offset:2560
    v_mfma_f32_16x16x32_bf16 v[96:99], v[192:195], v[152:155], v[96:99]
    v_mfma_f32_16x16x32_bf16 v[120:123], v[192:195], v[156:159], v[120:123]
    v_mfma_f32_16x16x32_bf16 v[76:79], v[196:199], v[148:151], v[76:79]
    v_mfma_f32_16x16x32_bf16 v[100:103], v[196:199], v[152:155], v[100:103]
    v_mfma_f32_16x16x32_bf16 v[124:127], v[196:199], v[156:159], v[124:127]
    v_mfma_f32_16x16x32_bf16 v[80:83], v[148:151], v[200:203], v[80:83]
    v_mfma_f32_16x16x32_bf16 v[104:107], v[152:155], v[200:203], v[104:107]
    v_mfma_f32_16x16x32_bf16 v[128:131], v[156:159], v[200:203], v[128:131]
    v_mfma_f32_16x16x32_bf16 v[84:87], v[148:151], v[204:207], v[84:87]
    v_mfma_f32_16x16x32_bf16 v[108:111], v[152:155], v[204:207], v[108:111]
    v_mfma_f32_16x16x32_bf16 v[132:135], v[156:159], v[204:207], v[132:135]
    s_waitcnt lgkmcnt(0)
    ds_read_b128 v[148:151], v16 offset:0
    ds_read_b64_tr_b16 v[184:185], v13 offset:6144
    v_mfma_f32_16x16x32_bf16 v[64:67], v[160:163], v[136:139], v[64:67]
    ds_read_b64_tr_b16 v[186:187], v13 offset:6656
    ds_read_b128 v[152:155], v16 offset:2048
    v_mfma_f32_16x16x32_bf16 v[88:91], v[160:163], v[140:143], v[88:91]
    ds_read_b64_tr_b16 v[188:189], v14 offset:6144
    ds_read_b64_tr_b16 v[190:191], v14 offset:6656
    v_mfma_f32_16x16x32_bf16 v[112:115], v[160:163], v[144:147], v[112:115]
    ds_read_b128 v[156:159], v16 offset:4096
    ds_read_b64_tr_b16 v[192:193], v13 offset:7168
    v_mfma_f32_16x16x32_bf16 v[68:71], v[164:167], v[136:139], v[68:71]
    ds_read_b64_tr_b16 v[194:195], v13 offset:7680
    ds_read_b64_tr_b16 v[196:197], v14 offset:7168
    v_mfma_f32_16x16x32_bf16 v[92:95], v[164:167], v[140:143], v[92:95]
    ds_read_b64_tr_b16 v[198:199], v14 offset:7680
    ds_read_b64_tr_b16 v[200:201], v13 offset:8192
    v_mfma_f32_16x16x32_bf16 v[116:119], v[164:167], v[144:147], v[116:119]
    ds_read_b64_tr_b16 v[202:203], v13 offset:8704
    ds_read_b64_tr_b16 v[204:205], v14 offset:8192
    v_mfma_f32_16x16x32_bf16 v[72:75], v[168:171], v[136:139], v[72:75]
    ds_read_b64_tr_b16 v[206:207], v14 offset:8704
    v_mfma_f32_16x16x32_bf16 v[96:99], v[168:171], v[140:143], v[96:99]
    v_mfma_f32_16x16x32_bf16 v[120:123], v[168:171], v[144:147], v[120:123]
    v_mfma_f32_16x16x32_bf16 v[76:79], v[172:175], v[136:139], v[76:79]
    v_mfma_f32_16x16x32_bf16 v[100:103], v[172:175], v[140:143], v[100:103]
    v_mfma_f32_16x16x32_bf16 v[124:127], v[172:175], v[144:147], v[124:127]
    v_mfma_f32_16x16x32_bf16 v[80:83], v[136:139], v[176:179], v[80:83]
    v_mfma_f32_16x16x32_bf16 v[104:107], v[140:143], v[176:179], v[104:107]
    v_mfma_f32_16x16x32_bf16 v[128:131], v[144:147], v[176:179], v[128:131]
    v_mfma_f32_16x16x32_bf16 v[84:87], v[136:139], v[180:183], v[84:87]
    v_mfma_f32_16x16x32_bf16 v[108:111], v[140:143], v[180:183], v[108:111]
    v_mfma_f32_16x16x32_bf16 v[132:135], v[144:147], v[180:183], v[132:135]
    s_waitcnt lgkmcnt(0)
    s_lshl_b32 s38, s3, 11
    v_lshl_add_u32 v32, v1, 4, s38
    v_mfma_f32_16x16x32_bf16 v[120:123], v[192:195], v[156:159], v[120:123]
    v_mfma_f32_16x16x32_bf16 v[124:127], v[196:199], v[156:159], v[124:127]
    v_mfma_f32_16x16x32_bf16 v[128:131], v[156:159], v[200:203], v[128:131]
    v_mfma_f32_16x16x32_bf16 v[132:135], v[156:159], v[204:207], v[132:135]
    v_mfma_f32_16x16x32_bf16 v[112:115], v[184:187], v[156:159], v[112:115]
    v_mfma_f32_16x16x32_bf16 v[116:119], v[188:191], v[156:159], v[116:119]
    v_mfma_f32_16x16x32_bf16 v[88:91], v[184:187], v[152:155], v[88:91]
    v_mfma_f32_16x16x32_bf16 v[92:95], v[188:191], v[152:155], v[92:95]
    v_mfma_f32_16x16x32_bf16 v[96:99], v[192:195], v[152:155], v[96:99]
    v_mfma_f32_16x16x32_bf16 v[100:103], v[196:199], v[152:155], v[100:103]
    v_mfma_f32_16x16x32_bf16 v[104:107], v[152:155], v[200:203], v[104:107]
    v_mfma_f32_16x16x32_bf16 v[108:111], v[152:155], v[204:207], v[108:111]
    v_mfma_f32_16x16x32_bf16 v[64:67], v[184:187], v[148:151], v[64:67]
    v_cvt_pk_bf16_f32 v220, v120, v121
    v_cvt_pk_bf16_f32 v221, v122, v123
    v_mfma_f32_16x16x32_bf16 v[68:71], v[188:191], v[148:151], v[68:71]
    v_cvt_pk_bf16_f32 v222, v124, v125
    v_cvt_pk_bf16_f32 v223, v126, v127
    v_mfma_f32_16x16x32_bf16 v[72:75], v[192:195], v[148:151], v[72:75]
    v_cvt_pk_bf16_f32 v230, v128, v129
    v_cvt_pk_bf16_f32 v231, v130, v131
    v_mfma_f32_16x16x32_bf16 v[76:79], v[196:199], v[148:151], v[76:79]
    v_cvt_pk_bf16_f32 v238, v132, v133
    v_cvt_pk_bf16_f32 v239, v134, v135
    v_mfma_f32_16x16x32_bf16 v[80:83], v[148:151], v[200:203], v[80:83]
    v_mfma_f32_16x16x32_bf16 v[84:87], v[148:151], v[204:207], v[84:87]
    ds_write_b128 v32, v[220:223] offset:2048
    ds_write_b64 v32, v[230:231] offset:3072
    ds_write_b64 v32, v[238:239] offset:3080
    v_cvt_pk_bf16_f32 v248, v112, v113
    v_cvt_pk_bf16_f32 v249, v114, v115
    v_cvt_pk_bf16_f32 v250, v116, v117
    v_cvt_pk_bf16_f32 v251, v118, v119
    v_and_b32 v250, v30, v250
    v_and_b32 v251, v30, v251
    v_cvt_pk_bf16_f32 v216, v96, v97
    v_cvt_pk_bf16_f32 v217, v98, v99
    v_cvt_pk_bf16_f32 v218, v100, v101
    v_cvt_pk_bf16_f32 v219, v102, v103
    v_cvt_pk_bf16_f32 v228, v104, v105
    v_cvt_pk_bf16_f32 v229, v106, v107
    v_cvt_pk_bf16_f32 v236, v108, v109
    v_cvt_pk_bf16_f32 v237, v110, v111
    v_cvt_pk_bf16_f32 v244, v88, v89
    v_cvt_pk_bf16_f32 v245, v90, v91
    v_cvt_pk_bf16_f32 v246, v92, v93
    v_cvt_pk_bf16_f32 v247, v94, v95
    v_and_b32 v246, v30, v246
    v_and_b32 v247, v30, v247
    s_waitcnt lgkmcnt(0)
    s_barrier
    ds_read_b128 v[208:211], v32
    ds_read_b64 v[224:225], v32 offset:1024
    ds_read_b64 v[232:233], v32 offset:1032
    v_cvt_pk_bf16_f32 v212, v72, v73
    v_cvt_pk_bf16_f32 v213, v74, v75
    v_cvt_pk_bf16_f32 v214, v76, v77
    v_cvt_pk_bf16_f32 v215, v78, v79
    v_cvt_pk_bf16_f32 v226, v80, v81
    v_cvt_pk_bf16_f32 v227, v82, v83
    v_cvt_pk_bf16_f32 v234, v84, v85
    v_cvt_pk_bf16_f32 v235, v86, v87
    v_cvt_pk_bf16_f32 v240, v64, v65
    v_cvt_pk_bf16_f32 v241, v66, v67
    v_cvt_pk_bf16_f32 v242, v68, v69
    v_cvt_pk_bf16_f32 v243, v70, v71
    v_and_b32 v242, v30, v242
    v_and_b32 v243, v30, v243
    s_mov_b32 s38, 0x3e8b97f6
    v_mfma_f32_16x16x32_bf16 v[80:83], v[216:219], v[248:251], v[20:23]
    v_mfma_f32_16x16x32_bf16 v[84:87], v[220:223], v[248:251], v[24:27]
    v_mfma_f32_16x16x32_bf16 v[72:75], v[212:215], v[244:247], v[56:59]
    v_mfma_f32_16x16x32_bf16 v[76:79], v[216:219], v[244:247], v[24:27]
    v_mfma_f32_16x16x32_bf16 v[68:71], v[212:215], v[240:243], v[24:27]
    s_waitcnt lgkmcnt(0)
    v_mfma_f32_16x16x32_bf16 v[64:67], v[208:211], v[240:243], v[20:23]
    s_nop 2
    v_max_f32 v80, v80, v84
    v_max_f32 v81, v81, v85
    v_max_f32 v82, v82, v86
    v_max_f32 v83, v83, v87
    v_max_f32 v72, v72, v76
    v_max_f32 v73, v73, v77
    v_max_f32 v74, v74, v78
    v_max_f32 v75, v75, v79
    v_max_f32 v64, v64, v68
    v_max_f32 v65, v65, v69
    v_max_f32 v66, v66, v70
    v_max_f32 v67, v67, v71
    v_max3_f32 v98, v80, v81, v82
    v_max3_f32 v97, v72, v73, v74
    v_max3_f32 v96, v64, v65, v66
    v_max_f32 v98, v98, v83
    v_max_f32 v97, v97, v75
    v_max_f32 v96, v96, v67
    v_mov_b32 v102, v98
    v_mov_b32 v101, v97
    v_mov_b32 v100, v96
    v_permlane32_swap_b32 v98, v102
    v_permlane32_swap_b32 v97, v101
    v_permlane32_swap_b32 v96, v100
    v_max_f32 v98, v98, v102
    v_max_f32 v97, v97, v101
    v_max_f32 v96, v96, v100
    v_mov_b32 v102, v98
    v_mov_b32 v101, v97
    v_mov_b32 v100, v96
    v_permlane16_swap_b32 v98, v102
    v_permlane16_swap_b32 v97, v101
    v_permlane16_swap_b32 v96, v100
    v_max_f32 v98, v98, v102
    v_max_f32 v97, v97, v101
    v_max_f32 v96, v96, v100
    v_mul_f32 v98, s38, v98
    v_mul_f32 v97, s38, v97
    v_mul_f32 v96, s38, v96
    v_fma_f32 v80, v80, s38, -v98
    v_fma_f32 v81, v81, s38, -v98
    v_fma_f32 v82, v82, s38, -v98
    v_fma_f32 v83, v83, s38, -v98
    v_fma_f32 v72, v72, s38, -v97
    v_fma_f32 v73, v73, s38, -v97
    v_fma_f32 v74, v74, s38, -v97
    v_fma_f32 v75, v75, s38, -v97
    v_fma_f32 v64, v64, s38, -v96
    v_fma_f32 v65, v65, s38, -v96
    v_fma_f32 v66, v66, s38, -v96
    v_fma_f32 v67, v67, s38, -v96
    v_exp_f32 v80, v80
    v_exp_f32 v81, v81
    v_exp_f32 v82, v82
    v_exp_f32 v83, v83
    v_exp_f32 v72, v72
    v_exp_f32 v73, v73
    v_exp_f32 v74, v74
    v_exp_f32 v75, v75
    v_exp_f32 v64, v64
    v_exp_f32 v65, v65
    v_exp_f32 v66, v66
    v_exp_f32 v67, v67
    v_add_f32 v106, v80, v81
    v_add_f32 v105, v72, v73
    v_add_f32 v104, v64, v65
    v_add_f32 v102, v82, v83
    v_add_f32 v101, v74, v75
    v_add_f32 v100, v66, v67
    v_add_f32 v106, v106, v102
    v_add_f32 v105, v105, v101
    v_add_f32 v104, v104, v100
    v_mov_b32 v102, v106
    v_mov_b32 v101, v105
    v_mov_b32 v100, v104
    v_permlane32_swap_b32 v106, v102
    v_permlane32_swap_b32 v105, v101
    v_permlane32_swap_b32 v104, v100
    v_add_f32 v106, v106, v102
    v_add_f32 v105, v105, v101
    v_add_f32 v104, v104, v100
    v_mov_b32 v102, v106
    v_mov_b32 v101, v105
    v_mov_b32 v100, v104
    v_permlane16_swap_b32 v106, v102
    v_permlane16_swap_b32 v105, v101
    v_permlane16_swap_b32 v104, v100
    v_add_f32 v106, v106, v102
    v_add_f32 v105, v105, v101
    v_add_f32 v104, v104, v100
    v_rcp_f32 v106, v106
    v_rcp_f32 v105, v105
    v_rcp_f32 v104, v104
    v_mul_f32 v80, v80, v106
    v_mul_f32 v81, v81, v106
    v_mul_f32 v82, v82, v106
    v_mul_f32 v83, v83, v106
    v_mul_f32 v72, v72, v105
    v_mul_f32 v73, v73, v105
    v_mul_f32 v74, v74, v105
    v_mul_f32 v75, v75, v105
    v_mul_f32 v64, v64, v104
    v_mul_f32 v65, v65, v104
    v_mul_f32 v66, v66, v104
    v_mul_f32 v67, v67, v104
    v_cvt_pk_bf16_f32 v84, v80, v81
    v_cvt_pk_bf16_f32 v85, v82, v83
    v_cvt_pk_bf16_f32 v76, v72, v73
    v_cvt_pk_bf16_f32 v77, v74, v75
    v_cvt_pk_bf16_f32 v68, v64, v65
    v_cvt_pk_bf16_f32 v69, v66, v67
    v_bfi_b32 v116, v28, 0, v84
    v_and_b32 v118, v28, v84
    v_bfi_b32 v117, v29, 0, v85
    v_and_b32 v119, v29, v85
    v_bfi_b32 v112, v28, 0, v76
    v_and_b32 v114, v28, v76
    v_bfi_b32 v113, v29, 0, v77
    v_and_b32 v115, v29, v77
    v_bfi_b32 v108, v28, 0, v68
    v_and_b32 v110, v28, v68
    v_bfi_b32 v109, v29, 0, v69
    v_and_b32 v111, v29, v69
    v_mfma_f32_16x16x32_bf16 v[152:155], v[228:231], v[116:119], 0
    v_mfma_f32_16x16x32_bf16 v[156:159], v[236:239], v[116:119], 0
    v_mfma_f32_16x16x32_bf16 v[144:147], v[226:229], v[112:115], 0
    v_mfma_f32_16x16x32_bf16 v[148:151], v[234:237], v[112:115], 0
    v_mfma_f32_16x16x32_bf16 v[136:139], v[224:227], v[108:111], 0
    v_mfma_f32_16x16x32_bf16 v[140:143], v[232:235], v[108:111], 0
    s_cmp_eq_u32 s3, 0
    s_cselect_b32 s40, 0x40000000, 0
    s_cmp_eq_u32 s39, 4
    s_cselect_b32 s41, 0x40000000, 0
    s_add_u32 s41, s41, 16384
    v_subrev_u32 v33, 16384, v31
    v_or_b32 v33, s40, v33
    v_and_b32 v33, 0x7fffffff, v33
    v_cvt_pk_bf16_f32 v168, v152, v153
    v_cvt_pk_bf16_f32 v169, v154, v155
    v_cvt_pk_bf16_f32 v170, v156, v157
    v_cvt_pk_bf16_f32 v171, v158, v159
    v_and_b32 v170, v30, v170
    v_and_b32 v171, v30, v171
    buffer_store_dwordx4 v[168:171], v31, s[20:23], s41 offen
    v_cvt_pk_bf16_f32 v164, v144, v145
    v_cvt_pk_bf16_f32 v165, v146, v147
    v_cvt_pk_bf16_f32 v166, v148, v149
    v_cvt_pk_bf16_f32 v167, v150, v151
    v_and_b32 v166, v30, v166
    v_and_b32 v167, v30, v167
    buffer_store_dwordx4 v[164:167], v31, s[20:23], 0 offen
    v_cvt_pk_bf16_f32 v160, v136, v137
    v_cvt_pk_bf16_f32 v161, v138, v139
    v_cvt_pk_bf16_f32 v162, v140, v141
    v_cvt_pk_bf16_f32 v163, v142, v143
    v_and_b32 v162, v30, v162
    v_and_b32 v163, v30, v163
    buffer_store_dwordx4 v[160:163], v33, s[20:23], 0 offen
    s_endpgm
L1_B:
    s_lshl_b32 s26, s24, 3
    s_add_u32 s26, s26, s25
    s_sub_u32 s26, s26, 24
    v_lshrrev_b32 v2, 5, v1
    v_and_b32 v3, 31, v1
    s_lshl_b32 s27, s3, 9
    s_add_u32 s27, s27, s26
    s_mul_i32 s27, s27, 896
    v_mul_u32_u24 v4, 64*896, v2
    v_add_u32 v4, s27, v4
    v_cmp_gt_u32 vcc, 28, v3
    v_mov_b32 v8, 0x40000000
    s_nop 0
    v_cndmask_b32 v4, v8, v4, vcc
    v_lshlrev_b32 v5, 4, v3
    v_sub_u32 v6, v4, v5
    v_add_u32 v6, 880, v6
    v_add_u32 v5, v4, v5
    v_add_u32 v7, 16, v6
    v_cmp_ne_u32 vcc, 0, v3
    s_nop 1
    v_cndmask_b32 v7, v8, v7, vcc
    v_lshrrev_b32 v9, 4, v1
    v_and_b32 v10, 15, v1
    s_mul_i32 s28, s26, 896
    s_add_u32 s28, s28, 448
    v_mul_u32_u24 v11, 256*896, v9
    v_add_u32 v11, s28, v11
    s_waitcnt lgkmcnt(0)
    s_mov_b32 s12, s8
    s_and_b32 s13, s9, 0xffff
    s_mov_b32 s14, 0x1c0000
    s_mov_b32 s15, 0x20000
    s_mov_b32 s20, s10
    s_and_b32 s21, s11, 0xffff
    s_mov_b32 s22, 0x1000000
    s_mov_b32 s23, 0x20000
    s_mov_b32 s29, 0
    buffer_load_dwordx4 v[64:67], v5, s[12:15], s29 offen
    buffer_load_dwordx4 v[80:83], v6, s[12:15], s29 offen
    buffer_load_ushort v96, v7, s[12:15], s29 offen
    s_mov_b32 s29, 114688
    buffer_load_dwordx4 v[68:71], v5, s[12:15], s29 offen
    buffer_load_dwordx4 v[84:87], v6, s[12:15], s29 offen
    buffer_load_ushort v97, v7, s[12:15], s29 offen
    s_mov_b32 s29, 229376
    buffer_load_dwordx4 v[72:75], v5, s[12:15], s29 offen
    buffer_load_dwordx4 v[88:91], v6, s[12:15], s29 offen
    buffer_load_ushort v98, v7, s[12:15], s29 offen
    s_mov_b32 s29, 344064
    buffer_load_dwordx4 v[76:79], v5, s[12:15], s29 offen
    buffer_load_dwordx4 v[92:95], v6, s[12:15], s29 offen
    buffer_load_ushort v99, v7, s[12:15], s29 offen
    s_mov_b32 s29, 0
    buffer_load_ushort v100, v11, s[12:15], s29 offen
    s_mov_b32 s29, 57344
    buffer_load_ushort v101, v11, s[12:15], s29 offen
    s_mov_b32 s29, 114688
    buffer_load_ushort v102, v11, s[12:15], s29 offen
    s_mov_b32 s29, 172032
    buffer_load_ushort v103, v11, s[12:15], s29 offen
    s_mov_b32 s29, 917504
    buffer_load_ushort v104, v11, s[12:15], s29 offen
    s_mov_b32 s29, 974848
    buffer_load_ushort v105, v11, s[12:15], s29 offen
    s_mov_b32 s29, 1032192
    buffer_load_ushort v106, v11, s[12:15], s29 offen
    s_mov_b32 s29, 1089536
    buffer_load_ushort v107, v11, s[12:15], s29 offen
    v_lshlrev_b32 v12, 8, v9
    v_add_u32 v12, s26, v12
    v_cvt_f32_u32 v12, v12
    v_cvt_f32_u32 v13, v10
    v_mul_f32 v13, 0x3a000000, v13
    v_add_f32 v32, 0x00000000, v12
    v_add_f32 v33, 0x42800000, v12
    v_add_f32 v34, 0x43000000, v12
    v_add_f32 v35, 0x43400000, v12
    v_add_f32 v36, 0x44800000, v12
    v_add_f32 v37, 0x44880000, v12
    v_add_f32 v38, 0x44900000, v12
    v_add_f32 v39, 0x44980000, v12
    v_mul_f32 v32, v32, v13
    v_mul_f32 v33, v33, v13
    v_mul_f32 v34, v34, v13
    v_mul_f32 v35, v35, v13
    v_mul_f32 v36, v36, v13
    v_mul_f32 v37, v37, v13
    v_mul_f32 v38, v38, v13
    v_mul_f32 v39, v39, v13
    v_cos_f32 v40, v32
    v_cos_f32 v41, v33
    v_cos_f32 v42, v34
    v_cos_f32 v43, v35
    v_cos_f32 v44, v36
    v_cos_f32 v45, v37
    v_cos_f32 v46, v38
    v_cos_f32 v47, v39
    v_sin_f32 v48, v32
    v_sin_f32 v49, v33
    v_sin_f32 v50, v34
    v_sin_f32 v51, v35
    v_sin_f32 v52, v36
    v_sin_f32 v53, v37
    v_sin_f32 v54, v38
    v_sin_f32 v55, v39
    v_cvt_pk_bf16_f32 v112, v40, v41
    v_cvt_pk_bf16_f32 v120, v48, v49
    v_cvt_pk_bf16_f32 v128, -v48, -v49
    v_cvt_pk_bf16_f32 v113, v42, v43
    v_cvt_pk_bf16_f32 v121, v50, v51
    v_cvt_pk_bf16_f32 v129, -v50, -v51
    v_cvt_pk_bf16_f32 v114, v44, v45
    v_cvt_pk_bf16_f32 v122, v52, v53
    v_cvt_pk_bf16_f32 v130, -v52, -v53
    v_cvt_pk_bf16_f32 v115, v46, v47
    v_cvt_pk_bf16_f32 v123, v54, v55
    v_cvt_pk_bf16_f32 v131, -v54, -v55
    v_add_f32 v13, 0x3c000000, v13
    v_add_f32 v32, 0x00000000, v12
    v_add_f32 v33, 0x42800000, v12
    v_add_f32 v34, 0x43000000, v12
    v_add_f32 v35, 0x43400000, v12
    v_add_f32 v36, 0x44800000, v12
    v_add_f32 v37, 0x44880000, v12
    v_add_f32 v38, 0x44900000, v12
    v_add_f32 v39, 0x44980000, v12
    v_mul_f32 v32, v32, v13
    v_mul_f32 v33, v33, v13
    v_mul_f32 v34, v34, v13
    v_mul_f32 v35, v35, v13
    v_mul_f32 v36, v36, v13
    v_mul_f32 v37, v37, v13
    v_mul_f32 v38, v38, v13
    v_mul_f32 v39, v39, v13
    v_cos_f32 v40, v32
    v_cos_f32 v41, v33
    v_cos_f32 v42, v34
    v_cos_f32 v43, v35
    v_cos_f32 v44, v36
    v_cos_f32 v45, v37
    v_cos_f32 v46, v38
    v_cos_f32 v47, v39
    v_sin_f32 v48, v32
    v_sin_f32 v49, v33
    v_sin_f32 v50, v34
    v_sin_f32 v51, v35
    v_sin_f32 v52, v36
    v_sin_f32 v53, v37
    v_sin_f32 v54, v38
    v_sin_f32 v55, v39
    v_cvt_pk_bf16_f32 v116, v40, v41
    v_cvt_pk_bf16_f32 v124, v48, v49
    v_cvt_pk_bf16_f32 v132, -v48, -v49
    v_cvt_pk_bf16_f32 v117, v42, v43
    v_cvt_pk_bf16_f32 v125, v50, v51
    v_cvt_pk_bf16_f32 v133, -v50, -v51
    v_cvt_pk_bf16_f32 v118, v44, v45
    v_cvt_pk_bf16_f32 v126, v52, v53
    v_cvt_pk_bf16_f32 v134, -v52, -v53
    v_cvt_pk_bf16_f32 v119, v46, v47
    v_cvt_pk_bf16_f32 v127, v54, v55
    v_cvt_pk_bf16_f32 v135, -v54, -v55
    s_lshr_b32 s29, s3, 1
    s_mul_i32 s29, s29, 7168
    s_and_b32 s30, s3, 1
    s_lshl_b32 s30, s30, 3
    v_add_u32 v14, s30, v2
    v_and_b32 v15, 7, v3
    v_xor_b32 v14, v14, v15
    v_lshlrev_b32 v14, 4, v14
    v_lshl_add_u32 v14, v3, 8, v14
    v_add_u32 v14, s29, v14
    v_xor_b32 v15, v10, v9
    v_lshlrev_b32 v15, 4, v15
    v_lshl_add_u32 v15, v9, 8, v15
    v_xor_b32 v16, 64, v15
    v_cmp_gt_u32 s[30:31], 28, v3
    v_mov_b32 v17, 0xffff0000
    s_waitcnt vmcnt(17)
    v_lshlrev_b32 v32, 16, v64
    v_and_b32 v33, v17, v64
    v_lshlrev_b32 v34, 16, v65
    v_and_b32 v35, v17, v65
    v_lshlrev_b32 v36, 16, v66
    v_and_b32 v37, v17, v66
    v_lshlrev_b32 v38, 16, v67
    v_and_b32 v39, v17, v67
    v_lshlrev_b32 v40, 16, v96
    v_and_b32 v41, v17, v83
    v_lshlrev_b32 v42, 16, v83
    v_and_b32 v43, v17, v82
    v_lshlrev_b32 v44, 16, v82
    v_and_b32 v45, v17, v81
    v_lshlrev_b32 v46, 16, v81
    v_and_b32 v47, v17, v80
    v_pk_add_f32 v[48:49], v[32:33], v[40:41]
    v_pk_add_f32 v[56:57], v[32:33], v[40:41] neg_lo:[0,1] neg_hi:[0,1]
    v_pk_add_f32 v[50:51], v[34:35], v[42:43]
    v_pk_add_f32 v[58:59], v[34:35], v[42:43] neg_lo:[0,1] neg_hi:[0,1]
    v_pk_add_f32 v[52:53], v[36:37], v[44:45]
    v_pk_add_f32 v[60:61], v[36:37], v[44:45] neg_lo:[0,1] neg_hi:[0,1]
    v_pk_add_f32 v[54:55], v[38:39], v[46:47]
    v_pk_add_f32 v[62:63], v[38:39], v[46:47] neg_lo:[0,1] neg_hi:[0,1]
    v_cvt_pk_bf16_f32 v64, v48, v49
    v_cvt_pk_bf16_f32 v80, v56, v57
    v_cvt_pk_bf16_f32 v65, v50, v51
    v_cvt_pk_bf16_f32 v81, v58, v59
    v_cvt_pk_bf16_f32 v66, v52, v53
    v_cvt_pk_bf16_f32 v82, v60, v61
    v_cvt_pk_bf16_f32 v67, v54, v55
    v_cvt_pk_bf16_f32 v83, v62, v63
    s_mov_b64 exec, s[30:31]
    ds_write_b128 v14, v[64:67]
    ds_write_b128 v14, v[80:83] offset:14336
    s_mov_b64 exec, -1
    s_waitcnt vmcnt(14)
    v_lshlrev_b32 v32, 16, v68
    v_and_b32 v33, v17, v68
    v_lshlrev_b32 v34, 16, v69
    v_and_b32 v35, v17, v69
    v_lshlrev_b32 v36, 16, v70
    v_and_b32 v37, v17, v70
    v_lshlrev_b32 v38, 16, v71
    v_and_b32 v39, v17, v71
    v_lshlrev_b32 v40, 16, v97
    v_and_b32 v41, v17, v87
    v_lshlrev_b32 v42, 16, v87
    v_and_b32 v43, v17, v86
    v_lshlrev_b32 v44, 16, v86
    v_and_b32 v45, v17, v85
    v_lshlrev_b32 v46, 16, v85
    v_and_b32 v47, v17, v84
    v_pk_add_f32 v[48:49], v[32:33], v[40:41]
    v_pk_add_f32 v[56:57], v[32:33], v[40:41] neg_lo:[0,1] neg_hi:[0,1]
    v_pk_add_f32 v[50:51], v[34:35], v[42:43]
    v_pk_add_f32 v[58:59], v[34:35], v[42:43] neg_lo:[0,1] neg_hi:[0,1]
    v_pk_add_f32 v[52:53], v[36:37], v[44:45]
    v_pk_add_f32 v[60:61], v[36:37], v[44:45] neg_lo:[0,1] neg_hi:[0,1]
    v_pk_add_f32 v[54:55], v[38:39], v[46:47]
    v_pk_add_f32 v[62:63], v[38:39], v[46:47] neg_lo:[0,1] neg_hi:[0,1]
    v_cvt_pk_bf16_f32 v68, v48, v49
    v_cvt_pk_bf16_f32 v84, v56, v57
    v_cvt_pk_bf16_f32 v69, v50, v51
    v_cvt_pk_bf16_f32 v85, v58, v59
    v_cvt_pk_bf16_f32 v70, v52, v53
    v_cvt_pk_bf16_f32 v86, v60, v61
    v_cvt_pk_bf16_f32 v71, v54, v55
    v_cvt_pk_bf16_f32 v87, v62, v63
    v_xor_b32 v18, 32, v14
    s_mov_b64 exec, s[30:31]
    ds_write_b128 v18, v[68:71]
    ds_write_b128 v18, v[84:87] offset:14336
    s_mov_b64 exec, -1
    s_waitcnt vmcnt(11)
    v_lshlrev_b32 v32, 16, v72
    v_and_b32 v33, v17, v72
    v_lshlrev_b32 v34, 16, v73
    v_and_b32 v35, v17, v73
    v_lshlrev_b32 v36, 16, v74
    v_and_b32 v37, v17, v74
    v_lshlrev_b32 v38, 16, v75
    v_and_b32 v39, v17, v75
    v_lshlrev_b32 v40, 16, v98
    v_and_b32 v41, v17, v91
    v_lshlrev_b32 v42, 16, v91
    v_and_b32 v43, v17, v90
    v_lshlrev_b32 v44, 16, v90
    v_and_b32 v45, v17, v89
    v_lshlrev_b32 v46, 16, v89
    v_and_b32 v47, v17, v88
    v_pk_add_f32 v[48:49], v[32:33], v[40:41]
    v_pk_add_f32 v[56:57], v[32:33], v[40:41] neg_lo:[0,1] neg_hi:[0,1]
    v_pk_add_f32 v[50:51], v[34:35], v[42:43]
    v_pk_add_f32 v[58:59], v[34:35], v[42:43] neg_lo:[0,1] neg_hi:[0,1]
    v_pk_add_f32 v[52:53], v[36:37], v[44:45]
    v_pk_add_f32 v[60:61], v[36:37], v[44:45] neg_lo:[0,1] neg_hi:[0,1]
    v_pk_add_f32 v[54:55], v[38:39], v[46:47]
    v_pk_add_f32 v[62:63], v[38:39], v[46:47] neg_lo:[0,1] neg_hi:[0,1]
    v_cvt_pk_bf16_f32 v72, v48, v49
    v_cvt_pk_bf16_f32 v88, v56, v57
    v_cvt_pk_bf16_f32 v73, v50, v51
    v_cvt_pk_bf16_f32 v89, v58, v59
    v_cvt_pk_bf16_f32 v74, v52, v53
    v_cvt_pk_bf16_f32 v90, v60, v61
    v_cvt_pk_bf16_f32 v75, v54, v55
    v_cvt_pk_bf16_f32 v91, v62, v63
    v_xor_b32 v18, 64, v14
    s_mov_b64 exec, s[30:31]
    ds_write_b128 v18, v[72:75]
    ds_write_b128 v18, v[88:91] offset:14336
    s_mov_b64 exec, -1
    s_waitcnt vmcnt(8)
    v_lshlrev_b32 v32, 16, v76
    v_and_b32 v33, v17, v76
    v_lshlrev_b32 v34, 16, v77
    v_and_b32 v35, v17, v77
    v_lshlrev_b32 v36, 16, v78
    v_and_b32 v37, v17, v78
    v_lshlrev_b32 v38, 16, v79
    v_and_b32 v39, v17, v79
    v_lshlrev_b32 v40, 16, v99
    v_and_b32 v41, v17, v95
    v_lshlrev_b32 v42, 16, v95
    v_and_b32 v43, v17, v94
    v_lshlrev_b32 v44, 16, v94
    v_and_b32 v45, v17, v93
    v_lshlrev_b32 v46, 16, v93
    v_and_b32 v47, v17, v92
    v_pk_add_f32 v[48:49], v[32:33], v[40:41]
    v_pk_add_f32 v[56:57], v[32:33], v[40:41] neg_lo:[0,1] neg_hi:[0,1]
    v_pk_add_f32 v[50:51], v[34:35], v[42:43]
    v_pk_add_f32 v[58:59], v[34:35], v[42:43] neg_lo:[0,1] neg_hi:[0,1]
    v_pk_add_f32 v[52:53], v[36:37], v[44:45]
    v_pk_add_f32 v[60:61], v[36:37], v[44:45] neg_lo:[0,1] neg_hi:[0,1]
    v_pk_add_f32 v[54:55], v[38:39], v[46:47]
    v_pk_add_f32 v[62:63], v[38:39], v[46:47] neg_lo:[0,1] neg_hi:[0,1]
    v_cvt_pk_bf16_f32 v76, v48, v49
    v_cvt_pk_bf16_f32 v92, v56, v57
    v_cvt_pk_bf16_f32 v77, v50, v51
    v_cvt_pk_bf16_f32 v93, v58, v59
    v_cvt_pk_bf16_f32 v78, v52, v53
    v_cvt_pk_bf16_f32 v94, v60, v61
    v_cvt_pk_bf16_f32 v79, v54, v55
    v_cvt_pk_bf16_f32 v95, v62, v63
    v_xor_b32 v18, 96, v14
    s_mov_b64 exec, s[30:31]
    ds_write_b128 v18, v[76:79]
    ds_write_b128 v18, v[92:95] offset:14336
    s_mov_b64 exec, -1
    s_waitcnt vmcnt(0) lgkmcnt(0)
    s_barrier
    ds_read_b128 a[0:3], v15 offset:0
    ds_read_b128 a[4:7], v16 offset:1024
    ds_read_b128 a[8:11], v15 offset:2048
    ds_read_b128 a[12:15], v16 offset:3072
    ds_read_b128 a[16:19], v15 offset:4096
    ds_read_b128 a[20:23], v16 offset:5120
    ds_read_b128 a[24:27], v15 offset:6144
    ds_read_b128 a[28:31], v15 offset:7168
    ds_read_b128 a[32:35], v16 offset:8192
    ds_read_b128 a[36:39], v15 offset:9216
    ds_read_b128 a[40:43], v16 offset:10240
    ds_read_b128 a[44:47], v15 offset:11264
    ds_read_b128 a[48:51], v16 offset:12288
    ds_read_b128 a[52:55], v15 offset:13312
    ds_read_b128 a[56:59], v15 offset:14336
    ds_read_b128 a[60:63], v16 offset:15360
    ds_read_b128 a[64:67], v15 offset:16384
    ds_read_b128 a[68:71], v16 offset:17408
    ds_read_b128 a[72:75], v15 offset:18432
    ds_read_b128 a[76:79], v16 offset:19456
    ds_read_b128 a[80:83], v15 offset:20480
    ds_read_b128 a[84:87], v15 offset:21504
    ds_read_b128 a[88:91], v16 offset:22528
    ds_read_b128 a[92:95], v15 offset:23552
    ds_read_b128 a[96:99], v16 offset:24576
    ds_read_b128 a[100:103], v15 offset:25600
    ds_read_b128 a[104:107], v16 offset:26624
    ds_read_b128 a[108:111], v15 offset:27648
    v_and_b32 v32, 1, v10
    v_xor_b32 v32, 1, v32
    v_lshlrev_b32 v32, 31, v32
    v_lshlrev_b32 v100, 16, v100
    v_xor_b32 v100, v32, v100
    v_lshlrev_b32 v101, 16, v101
    v_xor_b32 v101, v32, v101
    v_lshlrev_b32 v102, 16, v102
    v_xor_b32 v102, v32, v102
    v_lshlrev_b32 v103, 16, v103
    v_xor_b32 v103, v32, v103
    v_lshlrev_b32 v104, 16, v104
    v_xor_b32 v104, v32, v104
    v_lshlrev_b32 v105, 16, v105
    v_xor_b32 v105, v32, v105
    v_lshlrev_b32 v106, 16, v106
    v_xor_b32 v106, v32, v106
    v_lshlrev_b32 v107, 16, v107
    v_xor_b32 v107, v32, v107
    s_lshl_b32 s29, s26, 7
    s_add_u32 s29, s29, 2097152
    v_lshlrev_b32 v19, 16, v10
    v_lshl_add_u32 v19, v9, 4, v19
    v_add_u32 v19, s29, v19
    v_lshlrev_b32 v20, 3, v9
    v_cvt_f32_u32 v20, v20
    s_lshl_b32 s32, s3, 2
    s_add_u32 s33, s32, 4
    s_min_u32 s33, s33, 15
    s_waitcnt lgkmcnt(0)
L1_Btile:
    s_lshl_b32 s34, s32, 4
    s_add_u32 s34, s34, 1
    s_cmp_eq_u32 s32, 14
    s_cselect_b32 s34, -1, s34
    v_add_u32 v21, s34, v10
    v_cvt_f32_i32 v21, v21
    v_mul_f32 v21, 0x3b124925, v21
    v_mul_f32 v32, v20, v21
    v_mul_f32 v24, 0x42000000, v21
    v_fmamk_f32 v33, v21, 0x3f800000, v32
    v_fmamk_f32 v34, v21, 0x40000000, v32
    v_fmamk_f32 v35, v21, 0x40400000, v32
    v_fmamk_f32 v36, v21, 0x40800000, v32
    v_fmamk_f32 v37, v21, 0x40a00000, v32
    v_fmamk_f32 v38, v21, 0x40c00000, v32
    v_fmamk_f32 v39, v21, 0x40e00000, v32
    v_cos_f32 v22, v24
    v_add_f32 v40, v24, v32
    v_add_f32 v41, v24, v33
    v_add_f32 v42, v24, v34
    v_add_f32 v43, v24, v35
    v_add_f32 v44, v24, v36
    v_add_f32 v45, v24, v37
    v_add_f32 v46, v24, v38
    v_add_f32 v47, v24, v39
    v_add_f32 v22, v22, v22
    v_cos_f32 v136, v32
    v_cos_f32 v137, v33
    v_cos_f32 v138, v34
    v_cos_f32 v139, v35
    v_cos_f32 v140, v36
    v_cos_f32 v141, v37
    v_cos_f32 v142, v38
    v_cos_f32 v143, v39
    v_mov_b32 v23, v22
    v_sin_f32 v144, v32
    v_sin_f32 v145, v33
    v_sin_f32 v146, v34
    v_sin_f32 v147, v35
    v_sin_f32 v148, v36
    v_sin_f32 v149, v37
    v_sin_f32 v150, v38
    v_sin_f32 v151, v39
    v_cvt_pk_bf16_f32 v168, v136, v137
    v_cvt_pk_bf16_f32 v169, v138, v139
    v_cvt_pk_bf16_f32 v170, v140, v141
    v_cvt_pk_bf16_f32 v171, v142, v143
    v_cvt_pk_bf16_f32 v172, v144, v145
    v_cvt_pk_bf16_f32 v173, v146, v147
    v_cvt_pk_bf16_f32 v174, v148, v149
    v_cvt_pk_bf16_f32 v175, v150, v151
    v_mfma_f32_16x16x32_bf16 v[184:187], a[0:3], v[168:171], v[100:103]
    v_cos_f32 v152, v40
    v_cos_f32 v153, v41
    v_cos_f32 v154, v42
    v_cos_f32 v155, v43
    v_mfma_f32_16x16x32_bf16 v[188:191], a[28:31], v[168:171], v[104:107]
    v_cos_f32 v156, v44
    v_cos_f32 v157, v45
    v_cos_f32 v158, v46
    v_cos_f32 v159, v47
    v_mfma_f32_16x16x32_bf16 v[192:195], a[56:59], v[172:175], 0
    v_sin_f32 v160, v40
    v_sin_f32 v161, v41
    v_sin_f32 v162, v42
    v_sin_f32 v163, v43
    v_mfma_f32_16x16x32_bf16 v[196:199], a[84:87], v[172:175], 0
    v_sin_f32 v164, v44
    v_sin_f32 v165, v45
    v_sin_f32 v166, v46
    v_sin_f32 v167, v47
    v_cvt_pk_bf16_f32 v176, v152, v153
    v_cvt_pk_bf16_f32 v177, v154, v155
    v_cvt_pk_bf16_f32 v178, v156, v157
    v_cvt_pk_bf16_f32 v179, v158, v159
    v_cvt_pk_bf16_f32 v180, v160, v161
    v_cvt_pk_bf16_f32 v181, v162, v163
    v_cvt_pk_bf16_f32 v182, v164, v165
    v_cvt_pk_bf16_f32 v183, v166, v167
    v_mfma_f32_16x16x32_bf16 v[184:187], a[4:7], v[176:179], v[184:187]
    v_pk_fma_f32 v[136:137], v[22:23], v[152:153], v[136:137] neg_lo:[0,0,1] neg_hi:[0,0,1]
    v_pk_fma_f32 v[138:139], v[22:23], v[154:155], v[138:139] neg_lo:[0,0,1] neg_hi:[0,0,1]
    v_pk_fma_f32 v[140:141], v[22:23], v[156:157], v[140:141] neg_lo:[0,0,1] neg_hi:[0,0,1]
    v_pk_fma_f32 v[142:143], v[22:23], v[158:159], v[142:143] neg_lo:[0,0,1] neg_hi:[0,0,1]
    v_mfma_f32_16x16x32_bf16 v[188:191], a[32:35], v[176:179], v[188:191]
    v_pk_fma_f32 v[144:145], v[22:23], v[160:161], v[144:145] neg_lo:[0,0,1] neg_hi:[0,0,1]
    v_pk_fma_f32 v[146:147], v[22:23], v[162:163], v[146:147] neg_lo:[0,0,1] neg_hi:[0,0,1]
    v_pk_fma_f32 v[148:149], v[22:23], v[164:165], v[148:149] neg_lo:[0,0,1] neg_hi:[0,0,1]
    v_pk_fma_f32 v[150:151], v[22:23], v[166:167], v[150:151] neg_lo:[0,0,1] neg_hi:[0,0,1]
    v_mfma_f32_16x16x32_bf16 v[192:195], a[60:63], v[180:183], v[192:195]
    v_cvt_pk_bf16_f32 v168, v136, v137
    v_cvt_pk_bf16_f32 v169, v138, v139
    v_cvt_pk_bf16_f32 v170, v140, v141
    v_cvt_pk_bf16_f32 v171, v142, v143
    v_mfma_f32_16x16x32_bf16 v[196:199], a[88:91], v[180:183], v[196:199]
    v_cvt_pk_bf16_f32 v172, v144, v145
    v_cvt_pk_bf16_f32 v173, v146, v147
    v_cvt_pk_bf16_f32 v174, v148, v149
    v_cvt_pk_bf16_f32 v175, v150, v151
    v_mfma_f32_16x16x32_bf16 v[184:187], a[8:11], v[168:171], v[184:187]
    v_pk_fma_f32 v[152:153], v[22:23], v[136:137], v[152:153] neg_lo:[0,0,1] neg_hi:[0,0,1]
    v_pk_fma_f32 v[154:155], v[22:23], v[138:139], v[154:155] neg_lo:[0,0,1] neg_hi:[0,0,1]
    v_pk_fma_f32 v[156:157], v[22:23], v[140:141], v[156:157] neg_lo:[0,0,1] neg_hi:[0,0,1]
    v_pk_fma_f32 v[158:159], v[22:23], v[142:143], v[158:159] neg_lo:[0,0,1] neg_hi:[0,0,1]
    v_mfma_f32_16x16x32_bf16 v[188:191], a[36:39], v[168:171], v[188:191]
    v_pk_fma_f32 v[160:161], v[22:23], v[144:145], v[160:161] neg_lo:[0,0,1] neg_hi:[0,0,1]
    v_pk_fma_f32 v[162:163], v[22:23], v[146:147], v[162:163] neg_lo:[0,0,1] neg_hi:[0,0,1]
    v_pk_fma_f32 v[164:165], v[22:23], v[148:149], v[164:165] neg_lo:[0,0,1] neg_hi:[0,0,1]
    v_pk_fma_f32 v[166:167], v[22:23], v[150:151], v[166:167] neg_lo:[0,0,1] neg_hi:[0,0,1]
    v_mfma_f32_16x16x32_bf16 v[192:195], a[64:67], v[172:175], v[192:195]
    v_cvt_pk_bf16_f32 v176, v152, v153
    v_cvt_pk_bf16_f32 v177, v154, v155
    v_cvt_pk_bf16_f32 v178, v156, v157
    v_cvt_pk_bf16_f32 v179, v158, v159
    v_mfma_f32_16x16x32_bf16 v[196:199], a[92:95], v[172:175], v[196:199]
    v_cvt_pk_bf16_f32 v180, v160, v161
    v_cvt_pk_bf16_f32 v181, v162, v163
    v_cvt_pk_bf16_f32 v182, v164, v165
    v_cvt_pk_bf16_f32 v183, v166, v167
    v_mfma_f32_16x16x32_bf16 v[184:187], a[12:15], v[176:179], v[184:187]
    v_pk_fma_f32 v[136:137], v[22:23], v[152:153], v[136:137] neg_lo:[0,0,1] neg_hi:[0,0,1]
    v_pk_fma_f32 v[138:139], v[22:23], v[154:155], v[138:139] neg_lo:[0,0,1] neg_hi:[0,0,1]
    v_pk_fma_f32 v[140:141], v[22:23], v[156:157], v[140:141] neg_lo:[0,0,1] neg_hi:[0,0,1]
    v_pk_fma_f32 v[142:143], v[22:23], v[158:159], v[142:143] neg_lo:[0,0,1] neg_hi:[0,0,1]
    v_mfma_f32_16x16x32_bf16 v[188:191], a[40:43], v[176:179], v[188:191]
    v_pk_fma_f32 v[144:145], v[22:23], v[160:161], v[144:145] neg_lo:[0,0,1] neg_hi:[0,0,1]
    v_pk_fma_f32 v[146:147], v[22:23], v[162:163], v[146:147] neg_lo:[0,0,1] neg_hi:[0,0,1]
    v_pk_fma_f32 v[148:149], v[22:23], v[164:165], v[148:149] neg_lo:[0,0,1] neg_hi:[0,0,1]
    v_pk_fma_f32 v[150:151], v[22:23], v[166:167], v[150:151] neg_lo:[0,0,1] neg_hi:[0,0,1]
    v_mfma_f32_16x16x32_bf16 v[192:195], a[68:71], v[180:183], v[192:195]
    v_cvt_pk_bf16_f32 v168, v136, v137
    v_cvt_pk_bf16_f32 v169, v138, v139
    v_cvt_pk_bf16_f32 v170, v140, v141
    v_cvt_pk_bf16_f32 v171, v142, v143
    v_mfma_f32_16x16x32_bf16 v[196:199], a[96:99], v[180:183], v[196:199]
    v_cvt_pk_bf16_f32 v172, v144, v145
    v_cvt_pk_bf16_f32 v173, v146, v147
    v_cvt_pk_bf16_f32 v174, v148, v149
    v_cvt_pk_bf16_f32 v175, v150, v151
    v_mfma_f32_16x16x32_bf16 v[184:187], a[16:19], v[168:171], v[184:187]
    v_pk_fma_f32 v[152:153], v[22:23], v[136:137], v[152:153] neg_lo:[0,0,1] neg_hi:[0,0,1]
    v_pk_fma_f32 v[154:155], v[22:23], v[138:139], v[154:155] neg_lo:[0,0,1] neg_hi:[0,0,1]
    v_pk_fma_f32 v[156:157], v[22:23], v[140:141], v[156:157] neg_lo:[0,0,1] neg_hi:[0,0,1]
    v_pk_fma_f32 v[158:159], v[22:23], v[142:143], v[158:159] neg_lo:[0,0,1] neg_hi:[0,0,1]
    v_mfma_f32_16x16x32_bf16 v[188:191], a[44:47], v[168:171], v[188:191]
    v_pk_fma_f32 v[160:161], v[22:23], v[144:145], v[160:161] neg_lo:[0,0,1] neg_hi:[0,0,1]
    v_pk_fma_f32 v[162:163], v[22:23], v[146:147], v[162:163] neg_lo:[0,0,1] neg_hi:[0,0,1]
    v_pk_fma_f32 v[164:165], v[22:23], v[148:149], v[164:165] neg_lo:[0,0,1] neg_hi:[0,0,1]
    v_pk_fma_f32 v[166:167], v[22:23], v[150:151], v[166:167] neg_lo:[0,0,1] neg_hi:[0,0,1]
    v_mfma_f32_16x16x32_bf16 v[192:195], a[72:75], v[172:175], v[192:195]
    v_cvt_pk_bf16_f32 v176, v152, v153
    v_cvt_pk_bf16_f32 v177, v154, v155
    v_cvt_pk_bf16_f32 v178, v156, v157
    v_cvt_pk_bf16_f32 v179, v158, v159
    v_mfma_f32_16x16x32_bf16 v[196:199], a[100:103], v[172:175], v[196:199]
    v_cvt_pk_bf16_f32 v180, v160, v161
    v_cvt_pk_bf16_f32 v181, v162, v163
    v_cvt_pk_bf16_f32 v182, v164, v165
    v_cvt_pk_bf16_f32 v183, v166, v167
    v_mfma_f32_16x16x32_bf16 v[184:187], a[20:23], v[176:179], v[184:187]
    v_pk_fma_f32 v[136:137], v[22:23], v[152:153], v[136:137] neg_lo:[0,0,1] neg_hi:[0,0,1]
    v_pk_fma_f32 v[138:139], v[22:23], v[154:155], v[138:139] neg_lo:[0,0,1] neg_hi:[0,0,1]
    v_pk_fma_f32 v[140:141], v[22:23], v[156:157], v[140:141] neg_lo:[0,0,1] neg_hi:[0,0,1]
    v_pk_fma_f32 v[142:143], v[22:23], v[158:159], v[142:143] neg_lo:[0,0,1] neg_hi:[0,0,1]
    v_mfma_f32_16x16x32_bf16 v[188:191], a[48:51], v[176:179], v[188:191]
    v_pk_fma_f32 v[144:145], v[22:23], v[160:161], v[144:145] neg_lo:[0,0,1] neg_hi:[0,0,1]
    v_pk_fma_f32 v[146:147], v[22:23], v[162:163], v[146:147] neg_lo:[0,0,1] neg_hi:[0,0,1]
    v_pk_fma_f32 v[148:149], v[22:23], v[164:165], v[148:149] neg_lo:[0,0,1] neg_hi:[0,0,1]
    v_pk_fma_f32 v[150:151], v[22:23], v[166:167], v[150:151] neg_lo:[0,0,1] neg_hi:[0,0,1]
    v_mfma_f32_16x16x32_bf16 v[192:195], a[76:79], v[180:183], v[192:195]
    v_cvt_pk_bf16_f32 v168, v136, v137
    v_cvt_pk_bf16_f32 v169, v138, v139
    v_cvt_pk_bf16_f32 v170, v140, v141
    v_cvt_pk_bf16_f32 v171, v142, v143
    v_mfma_f32_16x16x32_bf16 v[196:199], a[104:107], v[180:183], v[196:199]
    v_cvt_pk_bf16_f32 v172, v144, v145
    v_cvt_pk_bf16_f32 v173, v146, v147
    v_cvt_pk_bf16_f32 v174, v148, v149
    v_cvt_pk_bf16_f32 v175, v150, v151
    v_mfma_f32_16x16x32_bf16 v[184:187], a[24:27], v[168:171], v[184:187]
    v_mfma_f32_16x16x32_bf16 v[188:191], a[52:55], v[168:171], v[188:191]
    v_mfma_f32_16x16x32_bf16 v[192:195], a[80:83], v[172:175], v[192:195]
    v_mfma_f32_16x16x32_bf16 v[196:199], a[108:111], v[172:175], v[196:199]
    s_lshr_b32 s34, s32, 1
    s_lshl_b32 s34, s34, 13
    s_and_b32 s35, s32, 1
    s_lshl_b32 s35, s35, 6
    s_add_u32 s34, s34, s35
    s_add_u32 s35, s34, 1048576
    s_add_u32 s32, s32, 1
    v_cvt_pk_bf16_f32 v200, v184, v185
    v_cvt_pk_bf16_f32 v201, v186, v187
    v_cvt_pk_bf16_f32 v202, v188, v189
    v_cvt_pk_bf16_f32 v203, v190, v191
    v_cvt_pk_bf16_f32 v204, v192, v193
    v_cvt_pk_bf16_f32 v205, v194, v195
    v_cvt_pk_bf16_f32 v206, v196, v197
    v_cvt_pk_bf16_f32 v207, v198, v199
    v_mfma_f32_16x16x32_bf16 v[208:211], v[200:203], v[112:115], 0
    v_mfma_f32_16x16x32_bf16 v[212:215], v[200:203], v[120:123], 0
    v_mfma_f32_16x16x32_bf16 v[216:219], v[200:203], v[116:119], 0
    v_mfma_f32_16x16x32_bf16 v[220:223], v[200:203], v[124:127], 0
    v_mfma_f32_16x16x32_bf16 v[208:211], v[204:207], v[128:131], v[208:211]
    v_mfma_f32_16x16x32_bf16 v[212:215], v[204:207], v[112:115], v[212:215]
    v_mfma_f32_16x16x32_bf16 v[216:219], v[204:207], v[132:135], v[216:219]
    v_mfma_f32_16x16x32_bf16 v[220:223], v[204:207], v[116:119], v[220:223]
    s_nop 4
    v_cvt_pk_bf16_f32 v224, v208, v209
    v_cvt_pk_bf16_f32 v225, v210, v211
    v_cvt_pk_bf16_f32 v226, v212, v213
    v_cvt_pk_bf16_f32 v227, v214, v215
    buffer_store_dwordx4 v[224:227], v19, s[20:23], s34 offen
    v_cvt_pk_bf16_f32 v228, v216, v217
    v_cvt_pk_bf16_f32 v229, v218, v219
    v_cvt_pk_bf16_f32 v230, v220, v221
    v_cvt_pk_bf16_f32 v231, v222, v223
    buffer_store_dwordx4 v[228:231], v19, s[20:23], s35 offen
    s_cmp_lt_u32 s32, s33
    s_cbranch_scc1 L1_Btile
L1_end:
    s_endpgm
.text
.globl fa_p2_kernel
.p2align 8
.type fa_p2_kernel,@function
fa_p2_kernel:
    s_cmp_ge_u32 s2, 256
    s_cbranch_scc1 L2_end
    s_load_dwordx2 s[4:5], s[0:1], 16
    s_load_dwordx2 s[6:7], s[0:1], 64
    s_load_dwordx2 s[10:11], s[0:1], 80
    v_lshrrev_b32 v2, 6, v0
    v_and_b32 v1, 63, v0
    v_readfirstlane_b32 s3, v2
    s_and_b32 s24, s2, 7
    s_lshr_b32 s25, s2, 3
    s_mul_i32 s28, s25, 37
    s_lshr_b32 s28, s28, 8
    s_mul_i32 s29, s28, 7
    s_sub_u32 s27, s25, s29
    s_cmp_ge_u32 s25, 28
    s_cselect_b32 s28, s27, s28
    s_cselect_b32 s27, 7, s27
    s_lshl_b32 s26, s24, 2
    s_add_u32 s26, s26, s28
    v_lshrrev_b32 v2, 3, v1
    v_and_b32 v3, 7, v1
    v_lshrrev_b32 v9, 4, v1
    v_and_b32 v10, 15, v1
    v_and_b32 v4, 4, v2
    v_xor_b32 v4, v4, v3
    v_lshlrev_b32 v4, 4, v4
    v_lshl_add_u32 v4, v2, 7, v4
    s_lshl_b32 s28, s26, 3
    s_add_u32 s28, s28, s27
    s_lshl_b32 s28, s28, 13
    s_lshl_b32 s29, s3, 11
    s_add_u32 s28, s28, s29
    s_add_u32 s28, s28, 2097152
    s_add_u32 s29, s29, 58368
    v_and_b32 v5, 6, v2
    v_xor_b32 v5, v5, v3
    v_lshlrev_b32 v5, 4, v5
    v_mul_u32_u24 v6, 896, v2
    s_lshl_b32 s30, s27, 7
    s_mul_i32 s31, s3, 8*896
    s_add_u32 s30, s30, s31
    v_add3_u32 v5, v5, v6, s30
    s_lshl_b32 s31, s3, 10
    s_lshl_b32 s32, s26, 2
    s_add_u32 s32, s32, s3
    s_lshl_b32 s33, s32, 14
    v_lshl_add_u32 v6, v1, 4, s33
    s_waitcnt lgkmcnt(0)
    s_mov_b32 s12, s4
    s_and_b32 s13, s5, 0xffff
    s_mov_b32 s14, 0x62000
    s_mov_b32 s15, 0x20000
    s_mov_b32 s16, s6
    s_and_b32 s17, s7, 0xffff
    s_mov_b32 s18, 0x380000
    s_mov_b32 s19, 0x20000
    s_mov_b32 s20, s10
    s_and_b32 s21, s11, 0xffff
    s_mov_b32 s22, 0x1000000
    s_mov_b32 s23, 0x20000
    s_mov_b32 m0, s29
    s_nop 0
    buffer_load_dwordx4 v4, s[20:23], s28 offen lds
    buffer_load_dwordx4 v4, s[20:23], s28 offen offset:1024 lds
    s_cmp_eq_u32 s27, 7
    s_cbranch_scc1 L2_noA
    s_add_u32 m0, s31, 0
    s_mov_b32 s34, 0
    buffer_load_dwordx4 v5, s[12:15], s34 offen lds
    s_mov_b32 s34, 0
    buffer_load_dwordx4 v[64:67], v6, s[20:23], s34 offen
    s_add_u32 m0, s31, 4096
    s_mov_b32 s34, 28672
    buffer_load_dwordx4 v5, s[12:15], s34 offen lds
    s_mov_b32 s34, 1024
    buffer_load_dwordx4 v[68:71], v6, s[20:23], s34 offen
    s_add_u32 m0, s31, 8192
    s_mov_b32 s34, 57344
    buffer_load_dwordx4 v5, s[12:15], s34 offen lds
    s_mov_b32 s34, 2048
    buffer_load_dwordx4 v[72:75], v6, s[20:23], s34 offen
    s_add_u32 m0, s31, 12288
    s_mov_b32 s34, 86016
    buffer_load_dwordx4 v5, s[12:15], s34 offen lds
    s_mov_b32 s34, 3072
    buffer_load_dwordx4 v[76:79], v6, s[20:23], s34 offen
    s_add_u32 m0, s31, 16384
    s_mov_b32 s34, 114688
    buffer_load_dwordx4 v5, s[12:15], s34 offen lds
    s_mov_b32 s34, 4096
    buffer_load_dwordx4 v[80:83], v6, s[20:23], s34 offen
    s_add_u32 m0, s31, 20480
    s_mov_b32 s34, 143360
    buffer_load_dwordx4 v5, s[12:15], s34 offen lds
    s_mov_b32 s34, 5120
    buffer_load_dwordx4 v[84:87], v6, s[20:23], s34 offen
    s_add_u32 m0, s31, 24576
    s_mov_b32 s34, 172032
    buffer_load_dwordx4 v5, s[12:15], s34 offen lds
    s_mov_b32 s34, 6144
    buffer_load_dwordx4 v[88:91], v6, s[20:23], s34 offen
    s_add_u32 m0, s31, 28672
    s_mov_b32 s34, 200704
    buffer_load_dwordx4 v5, s[12:15], s34 offen lds
    s_mov_b32 s34, 7168
    buffer_load_dwordx4 v[92:95], v6, s[20:23], s34 offen
    s_add_u32 m0, s31, 32768
    s_mov_b32 s34, 229376
    buffer_load_dwordx4 v5, s[12:15], s34 offen lds
    s_mov_b32 s34, 8192
    buffer_load_dwordx4 v[96:99], v6, s[20:23], s34 offen
    s_add_u32 m0, s31, 36864
    s_mov_b32 s34, 258048
    buffer_load_dwordx4 v5, s[12:15], s34 offen lds
    s_mov_b32 s34, 9216
    buffer_load_dwordx4 v[100:103], v6, s[20:23], s34 offen
    s_add_u32 m0, s31, 40960
    s_mov_b32 s34, 286720
    buffer_load_dwordx4 v5, s[12:15], s34 offen lds
    s_mov_b32 s34, 10240
    buffer_load_dwordx4 v[104:107], v6, s[20:23], s34 offen
    s_add_u32 m0, s31, 45056
    s_mov_b32 s34, 315392
    buffer_load_dwordx4 v5, s[12:15], s34 offen lds
    s_mov_b32 s34, 11264
    buffer_load_dwordx4 v[108:111], v6, s[20:23], s34 offen
    s_add_u32 m0, s31, 49152
    s_mov_b32 s34, 344064
    buffer_load_dwordx4 v5, s[12:15], s34 offen lds
    s_mov_b32 s34, 12288
    buffer_load_dwordx4 v[112:115], v6, s[20:23], s34 offen
    s_add_u32 m0, s31, 53248
    s_mov_b32 s34, 372736
    buffer_load_dwordx4 v5, s[12:15], s34 offen lds
    s_mov_b32 s34, 13312
    buffer_load_dwordx4 v[116:119], v6, s[20:23], s34 offen
    s_cmp_lg_u32 s3, 0
    s_cbranch_scc1 L2_skipz
    s_add_u32 m0, s31, 57344
    s_mov_b32 s34, 401408
    buffer_load_dwordx4 v5, s[12:15], s34 offen lds
L2_skipz:
    s_mov_b32 s34, 14336
    buffer_load_dwordx4 v[120:123], v6, s[20:23], s34 offen
    s_mov_b32 s34, 15360
    buffer_load_dwordx4 v[124:127], v6, s[20:23], s34 offen
L2_noA:
    s_lshl_b32 s34, s3, 4
    v_add_u32 v11, s34, v10
    v_cvt_f32_u32 v12, v11
    v_mul_f32 v12, 0x3c800000, v12
    v_lshlrev_b32 v13, 2, v9
    v_cvt_f32_u32 v13, v13
    v_mul_f32 v13, v13, v12
    v_fmamk_f32 v32, v12, 0x00000000, v13
    v_fmamk_f32 v33, v12, 0x3f800000, v13
    v_fmamk_f32 v34, v12, 0x40000000, v13
    v_fmamk_f32 v35, v12, 0x40400000, v13
    v_fmamk_f32 v36, v12, 0x41800000, v13
    v_fmamk_f32 v37, v12, 0x41880000, v13
    v_fmamk_f32 v38, v12, 0x41900000, v13
    v_fmamk_f32 v39, v12, 0x41980000, v13
    v_cos_f32 v40, v32
    v_cos_f32 v41, v33
    v_cos_f32 v42, v34
    v_cos_f32 v43, v35
    v_cos_f32 v44, v36
    v_cos_f32 v45, v37
    v_cos_f32 v46, v38
    v_cos_f32 v47, v39
    v_sin_f32 v48, v32
    v_sin_f32 v49, v33
    v_sin_f32 v50, v34
    v_sin_f32 v51, v35
    v_sin_f32 v52, v36
    v_sin_f32 v53, v37
    v_sin_f32 v54, v38
    v_sin_f32 v55, v39
    v_cvt_pk_bf16_f32 v128, v40, -v48
    v_cvt_pk_bf16_f32 v129, v41, -v49
    v_cvt_pk_bf16_f32 v130, v42, -v50
    v_cvt_pk_bf16_f32 v131, v43, -v51
    v_cvt_pk_bf16_f32 v132, v44, -v52
    v_cvt_pk_bf16_f32 v133, v45, -v53
    v_cvt_pk_bf16_f32 v134, v46, -v54
    v_cvt_pk_bf16_f32 v135, v47, -v55
    v_fmamk_f32 v32, v12, 0x42000000, v13
    v_fmamk_f32 v33, v12, 0x42040000, v13
    v_fmamk_f32 v34, v12, 0x42080000, v13
    v_fmamk_f32 v35, v12, 0x420c0000, v13
    v_fmamk_f32 v36, v12, 0x42400000, v13
    v_fmamk_f32 v37, v12, 0x42440000, v13
    v_fmamk_f32 v38, v12, 0x42480000, v13
    v_fmamk_f32 v39, v12, 0x424c0000, v13
    v_cos_f32 v40, v32
    v_cos_f32 v41, v33
    v_cos_f32 v42, v34
    v_cos_f32 v43, v35
    v_cos_f32 v44, v36
    v_cos_f32 v45, v37
    v_cos_f32 v46, v38
    v_cos_f32 v47, v39
    v_sin_f32 v48, v32
    v_sin_f32 v49, v33
    v_sin_f32 v50, v34
    v_sin_f32 v51, v35
    v_sin_f32 v52, v36
    v_sin_f32 v53, v37
    v_sin_f32 v54, v38
    v_sin_f32 v55, v39
    v_cvt_pk_bf16_f32 v136, v40, -v48
    v_cvt_pk_bf16_f32 v137, v41, -v49
    v_cvt_pk_bf16_f32 v138, v42, -v50
    v_cvt_pk_bf16_f32 v139, v43, -v51
    v_cvt_pk_bf16_f32 v140, v44, -v52
    v_cvt_pk_bf16_f32 v141, v45, -v53
    v_cvt_pk_bf16_f32 v142, v46, -v54
    v_cvt_pk_bf16_f32 v143, v47, -v55
    v_bfe_u32 v14, v1, 3, 1
    v_lshl_add_u32 v14, v9, 2, v14
    v_lshlrev_b32 v14, 7, v14
    v_and_b32 v15, 1, v9
    v_lshl_add_u32 v14, v15, 6, v14
    v_and_b32 v15, 3, v1
    v_lshl_add_u32 v14, v15, 4, v14
    v_bfe_u32 v16, v1, 2, 1
    v_lshl_add_u32 v14, v16, 3, v14
    v_add_u32 v14, 58368, v14
    v_xor_b32 v17, 64, v14
    v_lshrrev_b32 v18, 2, v1
    v_bfe_u32 v19, v1, 3, 2
    v_lshlrev_b32 v19, 5, v19
    v_lshl_add_u32 v19, v18, 7, v19
    v_lshl_add_u32 v20, v15, 3, v19
    v_xor_b32 v21, 32, v20
    v_xor_b32 v22, 64, v20
    v_xor_b32 v23, 96, v20
    v_lshlrev_b32 v24, 5, v11
    v_add_u32 v24, s26, v24
    v_sub_u32 v25, 2048, v24
    v_and_b32 v25, 2047, v25
    v_mul_u32_u24 v24, 1792, v24
    v_mul_u32_u24 v25, 1792, v25
    s_lshl_b32 s34, s27, 6
    v_lshlrev_b32 v26, 3, v9
    v_add_u32 v26, s34, v26
    v_add_u32 v27, 896, v24
    v_add3_u32 v24, v27, v26, 2
    v_sub_u32 v25, v25, v26
    v_add_u32 v25, 1752, v25
    s_and_b32 s34, s32, 63
    s_lshl_b32 s34, s34, 5
    s_lshr_b32 s35, s32, 6
    s_add_u32 s34, s34, s35
    s_mul_i32 s34, s34, 1792
    s_lshl_b32 s35, s27, 7
    s_add_u32 s34, s34, s35
    v_mul_u32_u24 v28, 3584, v10
    v_and_b32 v29, 1, v9
    v_lshl_add_u32 v28, v29, 5, v28
    v_lshrrev_b32 v29, 1, v9
    v_lshl_add_u32 v28, v29, 4, v28
    v_add_u32 v28, s34, v28
    s_waitcnt vmcnt(0)
    s_barrier
    ds_read_b64_tr_b16 v[144:145], v14 offset:0
    ds_read_b64_tr_b16 v[146:147], v14 offset:256
    ds_read_b64_tr_b16 v[148:149], v14 offset:2048
    ds_read_b64_tr_b16 v[150:151], v14 offset:2304
    ds_read_b64_tr_b16 v[152:153], v14 offset:4096
    ds_read_b64_tr_b16 v[154:155], v14 offset:4352
    ds_read_b64_tr_b16 v[156:157], v14 offset:6144
    ds_read_b64_tr_b16 v[158:159], v14 offset:6400
    ds_read_b64_tr_b16 v[160:161], v17 offset:0
    ds_read_b64_tr_b16 v[162:163], v17 offset:256
    ds_read_b64_tr_b16 v[164:165], v17 offset:2048
    ds_read_b64_tr_b16 v[166:167], v17 offset:2304
    ds_read_b64_tr_b16 v[168:169], v17 offset:4096
    ds_read_b64_tr_b16 v[170:171], v17 offset:4352
    ds_read_b64_tr_b16 v[172:173], v17 offset:6144
    ds_read_b64_tr_b16 v[174:175], v17 offset:6400
    s_waitcnt lgkmcnt(0)
    v_mfma_f32_16x16x32_bf16 v[176:179], v[144:147], v[128:131], 0
    v_mfma_f32_16x16x32_bf16 v[180:183], v[160:163], v[128:131], 0
    v_mfma_f32_16x16x32_bf16 v[176:179], v[148:151], v[132:135], v[176:179]
    v_mfma_f32_16x16x32_bf16 v[180:183], v[164:167], v[132:135], v[180:183]
    v_mfma_f32_16x16x32_bf16 v[176:179], v[152:155], v[136:139], v[176:179]
    v_mfma_f32_16x16x32_bf16 v[180:183], v[168:171], v[136:139], v[180:183]
    v_mfma_f32_16x16x32_bf16 v[176:179], v[156:159], v[140:143], v[176:179]
    v_mfma_f32_16x16x32_bf16 v[180:183], v[172:175], v[140:143], v[180:183]
    s_cmp_eq_u32 s27, 7
    s_cbranch_scc1 L2_e0
    ds_read_b64_tr_b16 v[192:193], v20 offset:0
    ds_read_b64_tr_b16 v[194:195], v20 offset:2048
    ds_read_b64_tr_b16 v[196:197], v21 offset:0
    ds_read_b64_tr_b16 v[198:199], v21 offset:2048
    ds_read_b64_tr_b16 v[200:201], v22 offset:0
    ds_read_b64_tr_b16 v[202:203], v22 offset:2048
    ds_read_b64_tr_b16 v[204:205], v23 offset:0
    ds_read_b64_tr_b16 v[206:207], v23 offset:2048
    v_cvt_pk_bf16_f32 v184, v176, v177
    v_cvt_pk_bf16_f32 v185, v178, v179
    v_cvt_pk_bf16_f32 v186, v179, v178
    v_cvt_pk_bf16_f32 v187, v177, v176
    buffer_store_dwordx2 v[184:185], v24, s[16:19], 0 offen offset:0
    buffer_store_dwordx2 v[186:187], v25, s[16:19], 0 offen offset:32
    v_cvt_pk_bf16_f32 v188, v180, v181
    v_cvt_pk_bf16_f32 v189, v182, v183
    v_cvt_pk_bf16_f32 v190, v183, v182
    v_cvt_pk_bf16_f32 v191, v181, v180
    buffer_store_dwordx2 v[188:189], v24, s[16:19], 0 offen offset:32
    buffer_store_dwordx2 v[190:191], v25, s[16:19], 0 offen offset:0
    s_waitcnt lgkmcnt(0)
    ds_read_b64_tr_b16 v[208:209], v22 offset:3584
    ds_read_b64_tr_b16 v[210:211], v22 offset:5632
    ds_read_b64_tr_b16 v[212:213], v23 offset:3584
    ds_read_b64_tr_b16 v[214:215], v23 offset:5632
    v_mfma_f32_16x16x32_bf16 v[32:35], v[192:195], v[64:67], 0
    ds_read_b64_tr_b16 v[216:217], v20 offset:3584
    ds_read_b64_tr_b16 v[218:219], v20 offset:5632
    v_mfma_f32_16x16x32_bf16 v[36:39], v[196:199], v[64:67], 0
    ds_read_b64_tr_b16 v[220:221], v21 offset:3584
    ds_read_b64_tr_b16 v[222:223], v21 offset:5632
    v_mfma_f32_16x16x32_bf16 v[40:43], v[200:203], v[64:67], 0
    v_mfma_f32_16x16x32_bf16 v[44:47], v[204:207], v[64:67], 0
    s_waitcnt lgkmcnt(0)
    ds_read_b64_tr_b16 v[192:193], v20 offset:7168
    ds_read_b64_tr_b16 v[194:195], v20 offset:9216
    ds_read_b64_tr_b16 v[196:197], v21 offset:7168
    ds_read_b64_tr_b16 v[198:199], v21 offset:9216
    v_mfma_f32_16x16x32_bf16 v[32:35], v[208:211], v[68:71], v[32:35]
    ds_read_b64_tr_b16 v[200:201], v22 offset:7168
    ds_read_b64_tr_b16 v[202:203], v22 offset:9216
    v_mfma_f32_16x16x32_bf16 v[36:39], v[212:215], v[68:71], v[36:39]
    ds_read_b64_tr_b16 v[204:205], v23 offset:7168
    ds_read_b64_tr_b16 v[206:207], v23 offset:9216
    v_mfma_f32_16x16x32_bf16 v[40:43], v[216:219], v[68:71], v[40:43]
    v_mfma_f32_16x16x32_bf16 v[44:47], v[220:223], v[68:71], v[44:47]
    s_waitcnt lgkmcnt(0)
    ds_read_b64_tr_b16 v[208:209], v22 offset:10752
    ds_read_b64_tr_b16 v[210:211], v22 offset:12800
    ds_read_b64_tr_b16 v[212:213], v23 offset:10752
    ds_read_b64_tr_b16 v[214:215], v23 offset:12800
    v_mfma_f32_16x16x32_bf16 v[32:35], v[192:195], v[72:75], v[32:35]
    ds_read_b64_tr_b16 v[216:217], v20 offset:10752
    ds_read_b64_tr_b16 v[218:219], v20 offset:12800
    v_mfma_f32_16x16x32_bf16 v[36:39], v[196:199], v[72:75], v[36:39]
    ds_read_b64_tr_b16 v[220:221], v21 offset:10752
    ds_read_b64_tr_b16 v[222:223], v21 offset:12800
    v_mfma_f32_16x16x32_bf16 v[40:43], v[200:203], v[72:75], v[40:43]
    v_mfma_f32_16x16x32_bf16 v[44:47], v[204:207], v[72:75], v[44:47]
    s_waitcnt lgkmcnt(0)
    ds_read_b64_tr_b16 v[192:193], v20 offset:14336
    ds_read_b64_tr_b16 v[194:195], v20 offset:16384
    ds_read_b64_tr_b16 v[196:197], v21 offset:14336
    ds_read_b64_tr_b16 v[198:199], v21 offset:16384
    v_mfma_f32_16x16x32_bf16 v[32:35], v[208:211], v[76:79], v[32:35]
    ds_read_b64_tr_b16 v[200:201], v22 offset:14336
    ds_read_b64_tr_b16 v[202:203], v22 offset:16384
    v_mfma_f32_16x16x32_bf16 v[36:39], v[212:215], v[76:79], v[36:39]
    ds_read_b64_tr_b16 v[204:205], v23 offset:14336
    ds_read_b64_tr_b16 v[206:207], v23 offset:16384
    v_mfma_f32_16x16x32_bf16 v[40:43], v[216:219], v[76:79], v[40:43]
    v_mfma_f32_16x16x32_bf16 v[44:47], v[220:223], v[76:79], v[44:47]
    s_waitcnt lgkmcnt(0)
    ds_read_b64_tr_b16 v[208:209], v22 offset:17920
    ds_read_b64_tr_b16 v[210:211], v22 offset:19968
    ds_read_b64_tr_b16 v[212:213], v23 offset:17920
    ds_read_b64_tr_b16 v[214:215], v23 offset:19968
    v_mfma_f32_16x16x32_bf16 v[32:35], v[192:195], v[80:83], v[32:35]
    ds_read_b64_tr_b16 v[216:217], v20 offset:17920
    ds_read_b64_tr_b16 v[218:219], v20 offset:19968
    v_mfma_f32_16x16x32_bf16 v[36:39], v[196:199], v[80:83], v[36:39]
    ds_read_b64_tr_b16 v[220:221], v21 offset:17920
    ds_read_b64_tr_b16 v[222:223], v21 offset:19968
    v_mfma_f32_16x16x32_bf16 v[40:43], v[200:203], v[80:83], v[40:43]
    v_mfma_f32_16x16x32_bf16 v[44:47], v[204:207], v[80:83], v[44:47]
    s_waitcnt lgkmcnt(0)
    ds_read_b64_tr_b16 v[192:193], v20 offset:21504
    ds_read_b64_tr_b16 v[194:195], v20 offset:23552
    ds_read_b64_tr_b16 v[196:197], v21 offset:21504
    ds_read_b64_tr_b16 v[198:199], v21 offset:23552
    v_mfma_f32_16x16x32_bf16 v[32:35], v[208:211], v[84:87], v[32:35]
    ds_read_b64_tr_b16 v[200:201], v22 offset:21504
    ds_read_b64_tr_b16 v[202:203], v22 offset:23552
    v_mfma_f32_16x16x32_bf16 v[36:39], v[212:215], v[84:87], v[36:39]
    ds_read_b64_tr_b16 v[204:205], v23 offset:21504
    ds_read_b64_tr_b16 v[206:207], v23 offset:23552
    v_mfma_f32_16x16x32_bf16 v[40:43], v[216:219], v[84:87], v[40:43]
    v_mfma_f32_16x16x32_bf16 v[44:47], v[220:223], v[84:87], v[44:47]
    s_waitcnt lgkmcnt(0)
    ds_read_b64_tr_b16 v[208:209], v22 offset:25088
    ds_read_b64_tr_b16 v[210:211], v22 offset:27136
    ds_read_b64_tr_b16 v[212:213], v23 offset:25088
    ds_read_b64_tr_b16 v[214:215], v23 offset:27136
    v_mfma_f32_16x16x32_bf16 v[32:35], v[192:195], v[88:91], v[32:35]
    ds_read_b64_tr_b16 v[216:217], v20 offset:25088
    ds_read_b64_tr_b16 v[218:219], v20 offset:27136
    v_mfma_f32_16x16x32_bf16 v[36:39], v[196:199], v[88:91], v[36:39]
    ds_read_b64_tr_b16 v[220:221], v21 offset:25088
    ds_read_b64_tr_b16 v[222:223], v21 offset:27136
    v_mfma_f32_16x16x32_bf16 v[40:43], v[200:203], v[88:91], v[40:43]
    v_mfma_f32_16x16x32_bf16 v[44:47], v[204:207], v[88:91], v[44:47]
    s_waitcnt lgkmcnt(0)
    ds_read_b64_tr_b16 v[192:193], v20 offset:28672
    ds_read_b64_tr_b16 v[194:195], v20 offset:30720
    ds_read_b64_tr_b16 v[196:197], v21 offset:28672
    ds_read_b64_tr_b16 v[198:199], v21 offset:30720
    v_mfma_f32_16x16x32_bf16 v[32:35], v[208:211], v[92:95], v[32:35]
    ds_read_b64_tr_b16 v[200:201], v22 offset:28672
    ds_read_b64_tr_b16 v[202:203], v22 offset:30720
    v_mfma_f32_16x16x32_bf16 v[36:39], v[212:215], v[92:95], v[36:39]
    ds_read_b64_tr_b16 v[204:205], v23 offset:28672
    ds_read_b64_tr_b16 v[206:207], v23 offset:30720
    v_mfma_f32_16x16x32_bf16 v[40:43], v[216:219], v[92:95], v[40:43]
    v_mfma_f32_16x16x32_bf16 v[44:47], v[220:223], v[92:95], v[44:47]
    s_waitcnt lgkmcnt(0)
    ds_read_b64_tr_b16 v[208:209], v22 offset:32256
    ds_read_b64_tr_b16 v[210:211], v22 offset:34304
    ds_read_b64_tr_b16 v[212:213], v23 offset:32256
    ds_read_b64_tr_b16 v[214:215], v23 offset:34304
    v_mfma_f32_16x16x32_bf16 v[32:35], v[192:195], v[96:99], v[32:35]
    ds_read_b64_tr_b16 v[216:217], v20 offset:32256
    ds_read_b64_tr_b16 v[218:219], v20 offset:34304
    v_mfma_f32_16x16x32_bf16 v[36:39], v[196:199], v[96:99], v[36:39]
    ds_read_b64_tr_b16 v[220:221], v21 offset:32256
    ds_read_b64_tr_b16 v[222:223], v21 offset:34304
    v_mfma_f32_16x16x32_bf16 v[40:43], v[200:203], v[96:99], v[40:43]
    v_mfma_f32_16x16x32_bf16 v[44:47], v[204:207], v[96:99], v[44:47]
    s_waitcnt lgkmcnt(0)
    ds_read_b64_tr_b16 v[192:193], v20 offset:35840
    ds_read_b64_tr_b16 v[194:195], v20 offset:37888
    ds_read_b64_tr_b16 v[196:197], v21 offset:35840
    ds_read_b64_tr_b16 v[198:199], v21 offset:37888
    v_mfma_f32_16x16x32_bf16 v[32:35], v[208:211], v[100:103], v[32:35]
    ds_read_b64_tr_b16 v[200:201], v22 offset:35840
    ds_read_b64_tr_b16 v[202:203], v22 offset:37888
    v_mfma_f32_16x16x32_bf16 v[36:39], v[212:215], v[100:103], v[36:39]
    ds_read_b64_tr_b16 v[204:205], v23 offset:35840
    ds_read_b64_tr_b16 v[206:207], v23 offset:37888
    v_mfma_f32_16x16x32_bf16 v[40:43], v[216:219], v[100:103], v[40:43]
    v_mfma_f32_16x16x32_bf16 v[44:47], v[220:223], v[100:103], v[44:47]
    s_waitcnt lgkmcnt(0)
    ds_read_b64_tr_b16 v[208:209], v22 offset:39424
    ds_read_b64_tr_b16 v[210:211], v22 offset:41472
    ds_read_b64_tr_b16 v[212:213], v23 offset:39424
    ds_read_b64_tr_b16 v[214:215], v23 offset:41472
    v_mfma_f32_16x16x32_bf16 v[32:35], v[192:195], v[104:107], v[32:35]
    ds_read_b64_tr_b16 v[216:217], v20 offset:39424
    ds_read_b64_tr_b16 v[218:219], v20 offset:41472
    v_mfma_f32_16x16x32_bf16 v[36:39], v[196:199], v[104:107], v[36:39]
    ds_read_b64_tr_b16 v[220:221], v21 offset:39424
    ds_read_b64_tr_b16 v[222:223], v21 offset:41472
    v_mfma_f32_16x16x32_bf16 v[40:43], v[200:203], v[104:107], v[40:43]
    v_mfma_f32_16x16x32_bf16 v[44:47], v[204:207], v[104:107], v[44:47]
    s_waitcnt lgkmcnt(0)
    ds_read_b64_tr_b16 v[192:193], v20 offset:43008
    ds_read_b64_tr_b16 v[194:195], v20 offset:45056
    ds_read_b64_tr_b16 v[196:197], v21 offset:43008
    ds_read_b64_tr_b16 v[198:199], v21 offset:45056
    v_mfma_f32_16x16x32_bf16 v[32:35], v[208:211], v[108:111], v[32:35]
    ds_read_b64_tr_b16 v[200:201], v22 offset:43008
    ds_read_b64_tr_b16 v[202:203], v22 offset:45056
    v_mfma_f32_16x16x32_bf16 v[36:39], v[212:215], v[108:111], v[36:39]
    ds_read_b64_tr_b16 v[204:205], v23 offset:43008
    ds_read_b64_tr_b16 v[206:207], v23 offset:45056
    v_mfma_f32_16x16x32_bf16 v[40:43], v[216:219], v[108:111], v[40:43]
    v_mfma_f32_16x16x32_bf16 v[44:47], v[220:223], v[108:111], v[44:47]
    s_waitcnt lgkmcnt(0)
    ds_read_b64_tr_b16 v[208:209], v22 offset:46592
    ds_read_b64_tr_b16 v[210:211], v22 offset:48640
    ds_read_b64_tr_b16 v[212:213], v23 offset:46592
    ds_read_b64_tr_b16 v[214:215], v23 offset:48640
    v_mfma_f32_16x16x32_bf16 v[32:35], v[192:195], v[112:115], v[32:35]
    ds_read_b64_tr_b16 v[216:217], v20 offset:46592
    ds_read_b64_tr_b16 v[218:219], v20 offset:48640
    v_mfma_f32_16x16x32_bf16 v[36:39], v[196:199], v[112:115], v[36:39]
    ds_read_b64_tr_b16 v[220:221], v21 offset:46592
    ds_read_b64_tr_b16 v[222:223], v21 offset:48640
    v_mfma_f32_16x16x32_bf16 v[40:43], v[200:203], v[112:115], v[40:43]
    v_mfma_f32_16x16x32_bf16 v[44:47], v[204:207], v[112:115], v[44:47]
    s_waitcnt lgkmcnt(0)
    ds_read_b64_tr_b16 v[192:193], v20 offset:50176
    ds_read_b64_tr_b16 v[194:195], v20 offset:52224
    ds_read_b64_tr_b16 v[196:197], v21 offset:50176
    ds_read_b64_tr_b16 v[198:199], v21 offset:52224
    v_mfma_f32_16x16x32_bf16 v[32:35], v[208:211], v[116:119], v[32:35]
    ds_read_b64_tr_b16 v[200:201], v22 offset:50176
    ds_read_b64_tr_b16 v[202:203], v22 offset:52224
    v_mfma_f32_16x16x32_bf16 v[36:39], v[212:215], v[116:119], v[36:39]
    ds_read_b64_tr_b16 v[204:205], v23 offset:50176
    ds_read_b64_tr_b16 v[206:207], v23 offset:52224
    v_mfma_f32_16x16x32_bf16 v[40:43], v[216:219], v[116:119], v[40:43]
    v_mfma_f32_16x16x32_bf16 v[44:47], v[220:223], v[116:119], v[44:47]
    s_waitcnt lgkmcnt(0)
    ds_read_b64_tr_b16 v[208:209], v22 offset:53760
    ds_read_b64_tr_b16 v[210:211], v22 offset:55808
    ds_read_b64_tr_b16 v[212:213], v23 offset:53760
    ds_read_b64_tr_b16 v[214:215], v23 offset:55808
    v_mfma_f32_16x16x32_bf16 v[32:35], v[192:195], v[120:123], v[32:35]
    ds_read_b64_tr_b16 v[216:217], v20 offset:53760
    ds_read_b64_tr_b16 v[218:219], v20 offset:55808
    v_mfma_f32_16x16x32_bf16 v[36:39], v[196:199], v[120:123], v[36:39]
    ds_read_b64_tr_b16 v[220:221], v21 offset:53760
    ds_read_b64_tr_b16 v[222:223], v21 offset:55808
    v_mfma_f32_16x16x32_bf16 v[40:43], v[200:203], v[120:123], v[40:43]
    v_mfma_f32_16x16x32_bf16 v[44:47], v[204:207], v[120:123], v[44:47]
    s_waitcnt lgkmcnt(0)
    v_mfma_f32_16x16x32_bf16 v[32:35], v[208:211], v[124:127], v[32:35]
    v_mfma_f32_16x16x32_bf16 v[36:39], v[212:215], v[124:127], v[36:39]
    v_mfma_f32_16x16x32_bf16 v[40:43], v[216:219], v[124:127], v[40:43]
    v_mfma_f32_16x16x32_bf16 v[44:47], v[220:223], v[124:127], v[44:47]
    s_nop 4
    v_cvt_pk_bf16_f32 v48, v32, v33
    v_cvt_pk_bf16_f32 v49, v34, v35
    v_cvt_pk_bf16_f32 v50, v36, v37
    v_cvt_pk_bf16_f32 v51, v38, v39
    v_cvt_pk_bf16_f32 v52, v40, v41
    v_cvt_pk_bf16_f32 v53, v42, v43
    v_cvt_pk_bf16_f32 v54, v44, v45
    v_cvt_pk_bf16_f32 v55, v46, v47
    v_permlane16_swap_b32 v48, v50
    v_permlane16_swap_b32 v49, v51
    v_permlane16_swap_b32 v52, v54
    v_permlane16_swap_b32 v53, v55
    buffer_store_dwordx4 v[48:51], v28, s[16:19], 0 offen offset:0
    buffer_store_dwordx4 v[52:55], v28, s[16:19], 0 offen offset:64
    s_endpgm
L2_e0:
    s_nop 4
    v_cvt_pk_bf16_f32 v184, v177, v177
    s_mov_b64 exec, 0xffff
    buffer_store_short v184, v27, s[16:19], 0 offen
L2_end:
    s_endpgm
.section .rodata,"a"
.p2align 6
.amdhsa_kernel fa_p1_kernel
  .amdhsa_next_free_vgpr 368
  .amdhsa_next_free_sgpr 102
  .amdhsa_accum_offset 256
  .amdhsa_group_segment_fixed_size 0
  .amdhsa_kernarg_size 88
  .amdhsa_user_sgpr_count 2
  .amdhsa_user_sgpr_kernarg_segment_ptr 1
  .amdhsa_system_sgpr_workgroup_id_x 1
  .amdhsa_float_denorm_mode_32 3
.end_amdhsa_kernel
.p2align 6
.amdhsa_kernel fa_p2_kernel
  .amdhsa_next_free_vgpr 224
  .amdhsa_next_free_sgpr 102
  .amdhsa_accum_offset 224
  .amdhsa_group_segment_fixed_size 0
  .amdhsa_kernarg_size 88
  .amdhsa_user_sgpr_count 2
  .amdhsa_user_sgpr_kernarg_segment_ptr 1
  .amdhsa_system_sgpr_workgroup_id_x 1
  .amdhsa_float_denorm_mode_32 3
.end_amdhsa_kernel
```

```asm
; @launch grid=(256,1,1) block=(256,1,1) lds=163840
.amdgcn_target "amdgcn-amd-amdhsa--gfx950"
.text
.globl concat_heads__sliding_local_dilated__spectral_fnet__prompt_kernel
.p2align 8
.type concat_heads__sliding_local_dilated__spectral_fnet__prompt_kernel,@function
concat_heads__sliding_local_dilated__spectral_fnet__prompt_kernel:
    s_cmp_ge_u32 s2, 256
    s_cbranch_scc1 L_end
    s_load_dwordx2 s[12:13], s[0:1], 0
    s_load_dwordx2 s[16:17], s[0:1], 8
    s_load_dwordx2 s[32:33], s[0:1], 24
    s_load_dwordx2 s[20:21], s[0:1], 80
    s_load_dwordx2 s[24:25], s[0:1], 16
    s_load_dwordx2 s[28:29], s[0:1], 64
    s_load_dwordx2 s[36:37], s[0:1], 72
    s_getpc_b64 s[4:5]
L_pc:
    s_lshr_b32 s40, s2, 3
    v_lshrrev_b32 v2, 5, v0
    s_lshl_b32 s6, s40, 10
    v_lshl_add_u32 v2, v2, 7, s6
    v_lshrrev_b32 v3, 6, v0
    v_min_u32 v2, L_end - L_pc, v2
    v_readfirstlane_b32 s3, v3
    global_load_dword v255, v2, s[4:5]
    v_and_b32 v1, 63, v0
    v_lshrrev_b32 v252, 4, v1
    v_and_b32 v253, 15, v1
    s_cmp_ge_u32 s40, 24
    s_cbranch_scc1 L_B
    s_mov_b32 s14, 0x1c0000
    s_mov_b32 s15, 0x20000
    s_mov_b32 s18, 0x126000
    s_mov_b32 s19, 0x20000
    s_lshr_b32 s46, s2, 5
    s_and_b32 s6, s40, 3
    s_xor_b32 s54, s6, s46
    s_and_b32 s54, s54, 1
    s_and_b32 s7, s2, 1
    s_lshl2_add_u32 s47, s7, s6
    s_mul_i32 s48, s46, 88
    s_min_u32 s48, s48, 432
    s_and_b32 s6, s2, 4
    s_lshl_b32 s6, s6, 7
    s_add_u32 s48, s48, s6
    s_mul_i32 s6, s3, 24
    s_add_u32 s6, s6, s48
    s_bfe_u32 s7, s2, 0x10001
    s_lshl1_add_u32 s7, s6, s7
    s_sub_u32 s7, s7, 16
    s_mul_i32 s7, s7, 896
    s_lshr_b32 s56, s46, 2
    v_lshrrev_b32 v32, 3, v1
    v_and_b32 v33, 7, v1
    s_lshl_b32 s8, s3, 2
    v_xor_b32 v34, s8, v252
    v_xor_b32 v34, v34, v33
    v_and_b32 v34, 7, v34
    v_mul_u32_u24 v35, 1792, v32
    v_lshl_add_u32 v34, v34, 4, v35
    v_xor_b32 v35, 64, v34
    s_cmp_eq_u32 s6, 0
    s_cselect_b32 s8, 0x40000000, s7
    v_add_u32 v2, s8, v34
    s_add_u32 s8, s7, 14336
    v_add_u32 v3, s8, v35
    s_add_u32 s8, s7, 28672
    s_add_u32 s9, s56, s3
    s_cmp_eq_u32 s9, 4
    s_cselect_b32 s8, 0x40000000, s8
    v_add_u32 v4, s8, v34
    v_and_b32 v34, 8, v1
    v_lshrrev_b32 v35, 1, v1
    v_and_or_b32 v34, v35, 16, v34
    v_lshrrev_b32 v35, 2, v1
    v_and_or_b32 v34, v35, 4, v34
    v_mul_u32_u24 v34, 2688, v34
    v_min_u32 v33, 6, v33
    v_lshl_add_u32 v34, v33, 4, v34
    s_mul_i32 s8, s3, 2688
    s_mul_i32 s9, s47, 112
    s_add_u32 s8, s8, s9
    v_add_u32 v5, s8, v34
    s_mul_i32 s49, s3, 3072
    s_mul_i32 s50, s3, 1056
    s_lshl_b32 s51, s54, 7
    s_mul_i32 s52, s54, 64*2688
    s_add_u32 s53, s52, 32*2688
    s_waitcnt lgkmcnt(0)
    s_add_u32 m0, s50, 37632
    s_nop 0
    buffer_load_dwordx4 v5, s[16:19], s52 offen offset:0 lds
    s_add_u32 m0, s50, 40960
    s_nop 0
    buffer_load_dwordx4 v5, s[16:19], s52 offen offset:896 lds
    s_add_u32 m0, s49, 62976
    s_nop 0
    buffer_load_dwordx4 v2, s[12:15], s51 offen nt lds
    s_add_u32 m0, s50, 44288
    s_nop 0
    buffer_load_dwordx4 v5, s[16:19], s52 offen offset:1792 lds
    s_add_u32 m0, s49, 64000
    s_nop 0
    buffer_load_dwordx4 v3, s[12:15], s51 offen nt lds
    s_add_u32 m0, s50, 50304
    s_nop 0
    buffer_load_dwordx4 v5, s[16:19], s53 offen offset:0 lds
    s_add_u32 m0, s49, 65024
    s_nop 0
    buffer_load_dwordx4 v4, s[12:15], s51 offen nt lds
    s_add_u32 m0, s50, 53632
    s_nop 0
    buffer_load_dwordx4 v5, s[16:19], s53 offen offset:896 lds
    s_add_u32 m0, s50, 56960
    s_nop 0
    buffer_load_dwordx4 v5, s[16:19], s53 offen offset:1792 lds
    s_lshr_b32 s55, s3, 1
    s_and_b32 s11, s3, 1
    v_lshrrev_b32 v32, 5, v1
    v_lshlrev_b32 v32, 9, v32
    v_bfe_u32 v33, v1, 4, 1
    v_lshl_add_u32 v32, v33, 7, v32
    v_bfe_u32 v33, v1, 2, 2
    v_mul_u32_u24 v33, 1056, v33
    s_mul_i32 s6, s11, 56
    v_add3_u32 v32, v32, v33, s6
    v_and_b32 v33, 3, v1
    v_lshl_add_u32 v9, v33, 3, v32
    v_min_u32 v33, 2, v33
    v_lshl_add_u32 v33, v33, 3, v32
    v_add_u32 v10, 32, v33
    v_lshrrev_b32 v32, 1, v253
    v_xor_b32 v32, v32, v252
    v_lshlrev_b32 v32, 4, v32
    v_lshl_add_u32 v32, v253, 7, v32
    s_mul_i32 s6, s55, 6144
    s_add_u32 s6, s6, 25344
    v_add_u32 v11, s6, v32
    v_xor_b32 v32, 64, v32
    v_add_u32 v12, s6, v32
    s_sub_u32 s51, 128, s51
    s_sub_u32 s52, 64*2688, s52
    s_add_u32 s53, s52, 32*2688
    s_add_u32 m0, s50, 75264
    s_nop 0
    buffer_load_dwordx4 v5, s[16:19], s52 offen offset:0 lds
    s_add_u32 m0, s50, 78592
    s_nop 0
    buffer_load_dwordx4 v5, s[16:19], s52 offen offset:896 lds
    s_add_u32 m0, s49, 100608
    s_nop 0
    buffer_load_dwordx4 v2, s[12:15], s51 offen nt lds
    v_lshlrev_b32 v37, 2, v252
    v_sub_u32 v37, v253, v37
    v_mov_b32 v39, 0xff800000
    v_subrev_u32 v40, 0, v37
    v_subrev_u32 v41, 1, v37
    v_subrev_u32 v42, 2, v37
    v_subrev_u32 v43, 3, v37
    v_cmp_gt_u32 s[58:59], 8, v40
    v_cmp_gt_u32 s[60:61], 8, v41
    v_cmp_gt_u32 vcc, 8, v42
    v_cmp_gt_u32 s[62:63], 8, v43
    v_cndmask_b32 v24, v39, 0, s[58:59]
    v_cndmask_b32 v25, v39, 0, s[60:61]
    v_cndmask_b32 v26, v39, 0, vcc
    v_cndmask_b32 v27, v39, 0, s[62:63]
    v_cmp_ge_i32 s[58:59], -9, v40
    v_cmp_ge_i32 s[60:61], -9, v41
    v_cmp_ge_i32 vcc, -9, v42
    v_cmp_ge_i32 s[62:63], -9, v43
    v_cndmask_b32 v20, v39, 0, s[58:59]
    v_cndmask_b32 v21, v39, 0, s[60:61]
    v_cndmask_b32 v22, v39, 0, vcc
    v_cndmask_b32 v23, v39, 0, s[62:63]
    v_ashrrev_i32 v40, 31, v40
    v_ashrrev_i32 v41, 31, v41
    v_ashrrev_i32 v42, 31, v42
    v_ashrrev_i32 v43, 31, v43
    v_mov_b32 v38, 0xffff
    v_bfi_b32 v28, v38, v40, v41
    v_bfi_b32 v29, v38, v42, v43
    v_subrev_u32 v30, 48, v1
    v_ashrrev_i32 v30, 31, v30
    s_cmp_eq_u32 s55, 0
    s_cselect_b32 s6, 0xff800000, 0
    v_or_b32 v56, s6, v20
    v_or_b32 v57, s6, v21
    v_or_b32 v58, s6, v22
    v_or_b32 v59, s6, v23
    s_cmp_eq_u32 s48, 0
    s_cselect_b32 s6, s6, 0
    v_subrev_u32 v38, 32, v1
    v_ashrrev_i32 v38, 31, v38
    v_and_b32 v38, s6, v38
    v_or_b32 v60, v38, v24
    v_or_b32 v61, v38, v25
    v_or_b32 v62, v38, v26
    v_or_b32 v63, v38, v27
    s_add_u32 m0, s50, 81920
    s_nop 0
    buffer_load_dwordx4 v5, s[16:19], s52 offen offset:1792 lds
    s_add_u32 m0, s49, 101632
    s_nop 0
    buffer_load_dwordx4 v3, s[12:15], s51 offen nt lds
    s_add_u32 m0, s50, 87936
    s_nop 0
    buffer_load_dwordx4 v5, s[16:19], s53 offen offset:0 lds
    s_mul_i32 s6, s55, 48
    s_add_u32 s6, s6, s48
    s_and_b32 s7, s2, 2
    s_lshl_b32 s7, s7, 9
    s_add_u32 s6, s6, s7
    s_add_u32 s6, s6, 8
    s_lshl1_add_u32 s11, s47, s11
    v_add_u32 v32, s6, v253
    v_lshrrev_b32 v33, 4, v32
    v_lshlrev_b32 v33, 14, v33
    v_and_b32 v32, 15, v32
    v_lshl_add_u32 v32, v32, 4, v33
    v_lshl_add_u32 v32, v252, 8, v32
    s_lshl_b32 s7, s11, 10
    v_add_u32 v18, s7, v32
    s_cmp_eq_u32 s55, 0
    s_cselect_b32 s8, 8, 0
    s_and_b32 s9, s55, s56
    s_cselect_b32 s9, 8, 16
    v_cmp_le_u32 s[58:59], s8, v253
    v_cmp_gt_u32 s[60:61], s9, v253
    v_mov_b32 v39, 0x40000000
    v_subrev_u32 v32, 16384, v18
    v_add_u32 v33, 16384, v18
    v_cndmask_b32 v17, v39, v32, s[58:59]
    v_cndmask_b32 v19, v39, v33, s[60:61]
    s_lshl_b32 s6, s6, 3
    s_lshl2_add_u32 s6, s11, s6
    s_add_u32 s6, s6, 4194176
    s_lshr_b32 s8, s8, 3
    s_lshr_b32 s9, s9, 3
    s_add_u32 s9, s9, 4
    v_cmp_le_u32 s[58:59], s8, v1
    v_cmp_gt_u32 s[60:61], s9, v1
    v_lshl_add_u32 v32, v1, 6, s6
    s_and_b64 vcc, s[58:59], s[60:61]
    v_cndmask_b32 v248, v39, v32, vcc
    s_lshl_b32 s6, s3, 11
    s_add_u32 s6, s6, 75264
    v_lshl_add_u32 v6, v1, 4, s6
    s_lshl_b32 s6, s55, 12
    v_subrev_u32 v7, s6, v6
    s_mov_b32 s22, 0x1000000
    s_mov_b32 s23, 0x20000
    s_mov_b32 s26, 0x62000
    s_mov_b32 s27, 0x20000
    s_mov_b32 s30, 0x380000
    s_mov_b32 s31, 0x20000
    s_mov_b32 s38, 0x100
    s_mov_b32 s39, 0x20000
    s_mul_i32 s6, s40, 37
    s_lshr_b32 s6, s6, 8
    s_mul_i32 s7, s6, 7
    s_sub_u32 s41, s40, s7
    s_lshl_b32 s6, s6, 2
    s_add_u32 s6, s6, s3
    s_and_b32 s7, s2, 1
    s_lshl_b32 s7, s7, 4
    s_add_u32 s6, s6, s7
    s_and_b32 s7, s2, 4
    s_lshl_b32 s7, s7, 3
    s_add_u32 s6, s6, s7
    s_bfe_u32 s8, s2, 0x10001
    s_lshl_b32 s7, s8, 6
    s_add_u32 s42, s6, s7
    v_lshrrev_b32 v32, 3, v1
    v_and_b32 v33, 6, v32
    v_and_b32 v34, 7, v1
    v_xor_b32 v33, v33, v34
    v_mul_u32_u24 v32, 896, v32
    v_lshl_add_u32 v32, v33, 4, v32
    s_lshl_b32 s7, s41, 7
    v_add_u32 v240, s7, v32
    s_mul_i32 s44, s41, 7
    s_add_u32 s44, s44, s3
    s_mul_i32 s44, s44, 7168
    s_lshl_b32 s45, s3, 10
    s_add_u32 s45, s45, 105472
    v_lshrrev_b32 v32, 2, v1
    v_bfe_u32 v33, v1, 3, 2
    v_lshlrev_b32 v33, 5, v33
    v_lshl_add_u32 v33, v32, 7, v33
    v_and_b32 v34, 3, v1
    v_lshl_add_u32 v33, v34, 3, v33
    v_add_u32 v241, 105472, v33
    v_xor_b32 v242, 32, v241
    v_xor_b32 v243, 64, v241
    v_xor_b32 v244, 96, v241
    s_lshl_b32 s9, s42, 14
    v_lshl_add_u32 v245, v1, 4, s9
    s_lshl_b32 s9, s42, 7
    s_add_u32 s9, s9, 4194304
    v_and_b32 v32, 31, v1
    v_lshl_add_u32 v246, v32, 2, s9
    s_lshl_b32 s6, s6, 5
    s_add_u32 s6, s6, s8
    s_mul_i32 s6, s6, 1792
    s_add_u32 s6, s6, s7
    v_mul_u32_u24 v32, 3584, v253
    v_and_b32 v33, 1, v252
    v_lshl_add_u32 v32, v33, 5, v32
    v_lshrrev_b32 v33, 1, v252
    v_lshl_add_u32 v32, v33, 4, v32
    v_add_u32 v247, s6, v32
    s_add_u32 m0, s49, 102656
    s_nop 0
    buffer_load_dwordx4 v4, s[12:15], s51 offen nt lds
    s_add_u32 m0, s50, 91264
    s_nop 0
    buffer_load_dwordx4 v5, s[16:19], s53 offen offset:896 lds
    s_add_u32 m0, s50, 94592
    s_nop 0
    buffer_load_dwordx4 v5, s[16:19], s53 offen offset:1792 lds
    s_waitcnt vmcnt(9) lgkmcnt(0)
    s_barrier
    v_add_u32 v13, 37632, v9
    v_add_u32 v15, 37632, v11
    v_add_u32 v14, 37632, v10
    v_add_u32 v16, 37632, v12
    ds_read_b128 v[136:139], v15 offset:0
    ds_read_b64_tr_b16 v[160:161], v13 offset:0
    ds_read_b64_tr_b16 v[162:163], v13 offset:256
    ds_read_b128 v[140:143], v15 offset:2048
    ds_read_b64_tr_b16 v[164:165], v14 offset:0
    ds_read_b64_tr_b16 v[166:167], v14 offset:256
    ds_read_b128 v[144:147], v15 offset:4096
    ds_read_b64_tr_b16 v[168:169], v13 offset:4224
    ds_read_b64_tr_b16 v[170:171], v13 offset:4480
    ds_read_b64_tr_b16 v[172:173], v14 offset:4224
    ds_read_b64_tr_b16 v[174:175], v14 offset:4480
    ds_read_b64_tr_b16 v[176:177], v13 offset:8448
    ds_read_b64_tr_b16 v[178:179], v13 offset:8704
    ds_read_b64_tr_b16 v[180:181], v14 offset:8448
    ds_read_b64_tr_b16 v[182:183], v14 offset:8704
    s_movk_i32 s51, 256
    s_mov_b32 s52, 344064
    s_add_u32 s53, s52, 32*2688
    s_add_u32 m0, s50, 0
    s_nop 0
    buffer_load_dwordx4 v5, s[16:19], s52 offen offset:0 lds
    s_add_u32 m0, s50, 3328
    s_nop 0
    buffer_load_dwordx4 v5, s[16:19], s52 offen offset:896 lds
    s_add_u32 m0, s49, 25344
    s_nop 0
    buffer_load_dwordx4 v2, s[12:15], s51 offen nt lds
    s_add_u32 m0, s50, 6656
    s_nop 0
    buffer_load_dwordx4 v5, s[16:19], s52 offen offset:1792 lds
    s_waitcnt lgkmcnt(0)
    v_mfma_f32_16x16x32_bf16 v[64:67], v[160:163], v[136:139], 0
    ds_read_b128 v[148:151], v16 offset:0
    ds_read_b64_tr_b16 v[184:185], v13 offset:12672
    v_mfma_f32_16x16x32_bf16 v[88:91], v[160:163], v[140:143], 0
    ds_read_b64_tr_b16 v[186:187], v13 offset:12928
    ds_read_b128 v[152:155], v16 offset:2048
    v_mfma_f32_16x16x32_bf16 v[112:115], v[160:163], v[144:147], 0
    ds_read_b64_tr_b16 v[188:189], v14 offset:12672
    ds_read_b64_tr_b16 v[190:191], v14 offset:12928
    v_mfma_f32_16x16x32_bf16 v[68:71], v[164:167], v[136:139], 0
    ds_read_b128 v[156:159], v16 offset:4096
    ds_read_b64_tr_b16 v[192:193], v13 offset:16896
    v_mfma_f32_16x16x32_bf16 v[92:95], v[164:167], v[140:143], 0
    ds_read_b64_tr_b16 v[194:195], v13 offset:17152
    ds_read_b64_tr_b16 v[196:197], v14 offset:16896
    v_mfma_f32_16x16x32_bf16 v[116:119], v[164:167], v[144:147], 0
    ds_read_b64_tr_b16 v[198:199], v14 offset:17152
    ds_read_b64_tr_b16 v[200:201], v13 offset:21120
    v_mfma_f32_16x16x32_bf16 v[72:75], v[168:171], v[136:139], 0
    ds_read_b64_tr_b16 v[202:203], v13 offset:21376
    ds_read_b64_tr_b16 v[204:205], v14 offset:21120
    v_mfma_f32_16x16x32_bf16 v[96:99], v[168:171], v[140:143], 0
    ds_read_b64_tr_b16 v[206:207], v14 offset:21376
    s_add_u32 m0, s49, 26368
    v_mfma_f32_16x16x32_bf16 v[120:123], v[168:171], v[144:147], 0
    buffer_load_dwordx4 v3, s[12:15], s51 offen nt lds
    s_add_u32 m0, s50, 12672
    v_mfma_f32_16x16x32_bf16 v[76:79], v[172:175], v[136:139], 0
    buffer_load_dwordx4 v5, s[16:19], s53 offen offset:0 lds
    s_add_u32 m0, s49, 27392
    v_mfma_f32_16x16x32_bf16 v[100:103], v[172:175], v[140:143], 0
    buffer_load_dwordx4 v4, s[12:15], s51 offen nt lds
    s_add_u32 m0, s50, 16000
    v_mfma_f32_16x16x32_bf16 v[124:127], v[172:175], v[144:147], 0
    buffer_load_dwordx4 v5, s[16:19], s53 offen offset:896 lds
    s_add_u32 m0, s50, 19328
    v_mfma_f32_16x16x32_bf16 v[80:83], v[136:139], v[176:179], 0
    buffer_load_dwordx4 v5, s[16:19], s53 offen offset:1792 lds
    v_mfma_f32_16x16x32_bf16 v[104:107], v[140:143], v[176:179], 0
    v_mfma_f32_16x16x32_bf16 v[128:131], v[144:147], v[176:179], 0
    v_mfma_f32_16x16x32_bf16 v[84:87], v[136:139], v[180:183], 0
    v_mfma_f32_16x16x32_bf16 v[108:111], v[140:143], v[180:183], 0
    v_mfma_f32_16x16x32_bf16 v[132:135], v[144:147], v[180:183], 0
    s_waitcnt vmcnt(9) lgkmcnt(0)
    s_barrier
    v_mfma_f32_16x16x32_bf16 v[64:67], v[184:187], v[148:151], v[64:67]
    v_add_u32 v13, 75264, v9
    v_add_u32 v15, 75264, v11
    v_mfma_f32_16x16x32_bf16 v[88:91], v[184:187], v[152:155], v[88:91]
    v_add_u32 v14, 75264, v10
    v_add_u32 v16, 75264, v12
    v_mfma_f32_16x16x32_bf16 v[112:115], v[184:187], v[156:159], v[112:115]
    ds_read_b128 v[136:139], v15 offset:0
    ds_read_b64_tr_b16 v[160:161], v13 offset:0
    v_mfma_f32_16x16x32_bf16 v[68:71], v[188:191], v[148:151], v[68:71]
    ds_read_b64_tr_b16 v[162:163], v13 offset:256
    ds_read_b128 v[140:143], v15 offset:2048
    v_mfma_f32_16x16x32_bf16 v[92:95], v[188:191], v[152:155], v[92:95]
    ds_read_b64_tr_b16 v[164:165], v14 offset:0
    ds_read_b64_tr_b16 v[166:167], v14 offset:256
    v_mfma_f32_16x16x32_bf16 v[116:119], v[188:191], v[156:159], v[116:119]
    ds_read_b128 v[144:147], v15 offset:4096
    ds_read_b64_tr_b16 v[168:169], v13 offset:4224
    v_mfma_f32_16x16x32_bf16 v[72:75], v[192:195], v[148:151], v[72:75]
    ds_read_b64_tr_b16 v[170:171], v13 offset:4480
    ds_read_b64_tr_b16 v[172:173], v14 offset:4224
    v_mfma_f32_16x16x32_bf16 v[96:99], v[192:195], v[152:155], v[96:99]
    ds_read_b64_tr_b16 v[174:175], v14 offset:4480
    ds_read_b64_tr_b16 v[176:177], v13 offset:8448
    v_mfma_f32_16x16x32_bf16 v[120:123], v[192:195], v[156:159], v[120:123]
    ds_read_b64_tr_b16 v[178:179], v13 offset:8704
    ds_read_b64_tr_b16 v[180:181], v14 offset:8448
    v_mfma_f32_16x16x32_bf16 v[76:79], v[196:199], v[148:151], v[76:79]
    ds_read_b64_tr_b16 v[182:183], v14 offset:8704
    s_movk_i32 s51, 384
    v_mfma_f32_16x16x32_bf16 v[100:103], v[196:199], v[152:155], v[100:103]
    s_mov_b32 s52, 516096
    s_add_u32 s53, s52, 32*2688
    v_mfma_f32_16x16x32_bf16 v[124:127], v[196:199], v[156:159], v[124:127]
    s_add_u32 m0, s50, 37632
    v_mfma_f32_16x16x32_bf16 v[80:83], v[148:151], v[200:203], v[80:83]
    buffer_load_dwordx4 v5, s[16:19], s52 offen offset:0 lds
    s_add_u32 m0, s50, 40960
    v_mfma_f32_16x16x32_bf16 v[104:107], v[152:155], v[200:203], v[104:107]
    buffer_load_dwordx4 v5, s[16:19], s52 offen offset:896 lds
    s_add_u32 m0, s49, 62976
    v_mfma_f32_16x16x32_bf16 v[128:131], v[156:159], v[200:203], v[128:131]
    buffer_load_dwordx4 v2, s[12:15], s51 offen nt lds
    s_add_u32 m0, s50, 44288
    v_mfma_f32_16x16x32_bf16 v[84:87], v[148:151], v[204:207], v[84:87]
    buffer_load_dwordx4 v5, s[16:19], s52 offen offset:1792 lds
    v_mfma_f32_16x16x32_bf16 v[108:111], v[152:155], v[204:207], v[108:111]
    v_mfma_f32_16x16x32_bf16 v[132:135], v[156:159], v[204:207], v[132:135]
    s_waitcnt lgkmcnt(0)
    v_mfma_f32_16x16x32_bf16 v[64:67], v[160:163], v[136:139], v[64:67]
    ds_read_b128 v[148:151], v16 offset:0
    ds_read_b64_tr_b16 v[184:185], v13 offset:12672
    v_mfma_f32_16x16x32_bf16 v[88:91], v[160:163], v[140:143], v[88:91]
    ds_read_b64_tr_b16 v[186:187], v13 offset:12928
    ds_read_b128 v[152:155], v16 offset:2048
    v_mfma_f32_16x16x32_bf16 v[112:115], v[160:163], v[144:147], v[112:115]
    ds_read_b64_tr_b16 v[188:189], v14 offset:12672
    ds_read_b64_tr_b16 v[190:191], v14 offset:12928
    v_mfma_f32_16x16x32_bf16 v[68:71], v[164:167], v[136:139], v[68:71]
    ds_read_b128 v[156:159], v16 offset:4096
    ds_read_b64_tr_b16 v[192:193], v13 offset:16896
    v_mfma_f32_16x16x32_bf16 v[92:95], v[164:167], v[140:143], v[92:95]
    ds_read_b64_tr_b16 v[194:195], v13 offset:17152
    ds_read_b64_tr_b16 v[196:197], v14 offset:16896
    v_mfma_f32_16x16x32_bf16 v[116:119], v[164:167], v[144:147], v[116:119]
    ds_read_b64_tr_b16 v[198:199], v14 offset:17152
    ds_read_b64_tr_b16 v[200:201], v13 offset:21120
    v_mfma_f32_16x16x32_bf16 v[72:75], v[168:171], v[136:139], v[72:75]
    ds_read_b64_tr_b16 v[202:203], v13 offset:21376
    ds_read_b64_tr_b16 v[204:205], v14 offset:21120
    v_mfma_f32_16x16x32_bf16 v[96:99], v[168:171], v[140:143], v[96:99]
    ds_read_b64_tr_b16 v[206:207], v14 offset:21376
    s_add_u32 m0, s49, 64000
    v_mfma_f32_16x16x32_bf16 v[120:123], v[168:171], v[144:147], v[120:123]
    buffer_load_dwordx4 v3, s[12:15], s51 offen nt lds
    s_add_u32 m0, s50, 50304
    v_mfma_f32_16x16x32_bf16 v[76:79], v[172:175], v[136:139], v[76:79]
    buffer_load_dwordx4 v5, s[16:19], s53 offen offset:0 lds
    s_add_u32 m0, s49, 65024
    v_mfma_f32_16x16x32_bf16 v[100:103], v[172:175], v[140:143], v[100:103]
    buffer_load_dwordx4 v4, s[12:15], s51 offen nt lds
    s_add_u32 m0, s50, 53632
    v_mfma_f32_16x16x32_bf16 v[124:127], v[172:175], v[144:147], v[124:127]
    buffer_load_dwordx4 v5, s[16:19], s53 offen offset:896 lds
    s_add_u32 m0, s50, 56960
    v_mfma_f32_16x16x32_bf16 v[80:83], v[136:139], v[176:179], v[80:83]
    buffer_load_dwordx4 v5, s[16:19], s53 offen offset:1792 lds
    v_mfma_f32_16x16x32_bf16 v[104:107], v[140:143], v[176:179], v[104:107]
    v_mfma_f32_16x16x32_bf16 v[128:131], v[144:147], v[176:179], v[128:131]
    v_mfma_f32_16x16x32_bf16 v[84:87], v[136:139], v[180:183], v[84:87]
    v_mfma_f32_16x16x32_bf16 v[108:111], v[140:143], v[180:183], v[108:111]
    v_mfma_f32_16x16x32_bf16 v[132:135], v[144:147], v[180:183], v[132:135]
    s_waitcnt vmcnt(9) lgkmcnt(0)
    s_barrier
    v_mfma_f32_16x16x32_bf16 v[64:67], v[184:187], v[148:151], v[64:67]
    v_add_u32 v13, 0, v9
    v_add_u32 v15, 0, v11
    v_mfma_f32_16x16x32_bf16 v[88:91], v[184:187], v[152:155], v[88:91]
    v_add_u32 v14, 0, v10
    v_add_u32 v16, 0, v12
    v_mfma_f32_16x16x32_bf16 v[112:115], v[184:187], v[156:159], v[112:115]
    ds_read_b128 v[136:139], v15 offset:0
    ds_read_b64_tr_b16 v[160:161], v13 offset:0
    v_mfma_f32_16x16x32_bf16 v[68:71], v[188:191], v[148:151], v[68:71]
    ds_read_b64_tr_b16 v[162:163], v13 offset:256
    ds_read_b128 v[140:143], v15 offset:2048
    v_mfma_f32_16x16x32_bf16 v[92:95], v[188:191], v[152:155], v[92:95]
    ds_read_b64_tr_b16 v[164:165], v14 offset:0
    ds_read_b64_tr_b16 v[166:167], v14 offset:256
    v_mfma_f32_16x16x32_bf16 v[116:119], v[188:191], v[156:159], v[116:119]
    ds_read_b128 v[144:147], v15 offset:4096
    ds_read_b64_tr_b16 v[168:169], v13 offset:4224
    v_mfma_f32_16x16x32_bf16 v[72:75], v[192:195], v[148:151], v[72:75]
    ds_read_b64_tr_b16 v[170:171], v13 offset:4480
    ds_read_b64_tr_b16 v[172:173], v14 offset:4224
    v_mfma_f32_16x16x32_bf16 v[96:99], v[192:195], v[152:155], v[96:99]
    ds_read_b64_tr_b16 v[174:175], v14 offset:4480
    ds_read_b64_tr_b16 v[176:177], v13 offset:8448
    v_mfma_f32_16x16x32_bf16 v[120:123], v[192:195], v[156:159], v[120:123]
    ds_read_b64_tr_b16 v[178:179], v13 offset:8704
    ds_read_b64_tr_b16 v[180:181], v14 offset:8448
    v_mfma_f32_16x16x32_bf16 v[76:79], v[196:199], v[148:151], v[76:79]
    ds_read_b64_tr_b16 v[182:183], v14 offset:8704
    s_movk_i32 s51, 512
    v_mfma_f32_16x16x32_bf16 v[100:103], v[196:199], v[152:155], v[100:103]
    s_mov_b32 s52, 688128
    s_add_u32 s53, s52, 32*2688
    v_mfma_f32_16x16x32_bf16 v[124:127], v[196:199], v[156:159], v[124:127]
    s_add_u32 m0, s50, 75264
    v_mfma_f32_16x16x32_bf16 v[80:83], v[148:151], v[200:203], v[80:83]
    buffer_load_dwordx4 v5, s[16:19], s52 offen offset:0 lds
    s_add_u32 m0, s50, 78592
    v_mfma_f32_16x16x32_bf16 v[104:107], v[152:155], v[200:203], v[104:107]
    buffer_load_dwordx4 v5, s[16:19], s52 offen offset:896 lds
    s_add_u32 m0, s49, 100608
    v_mfma_f32_16x16x32_bf16 v[128:131], v[156:159], v[200:203], v[128:131]
    buffer_load_dwordx4 v2, s[12:15], s51 offen nt lds
    s_add_u32 m0, s50, 81920
    v_mfma_f32_16x16x32_bf16 v[84:87], v[148:151], v[204:207], v[84:87]
    buffer_load_dwordx4 v5, s[16:19], s52 offen offset:1792 lds
    v_mfma_f32_16x16x32_bf16 v[108:111], v[152:155], v[204:207], v[108:111]
    v_mfma_f32_16x16x32_bf16 v[132:135], v[156:159], v[204:207], v[132:135]
    s_waitcnt lgkmcnt(0)
    v_mfma_f32_16x16x32_bf16 v[64:67], v[160:163], v[136:139], v[64:67]
    ds_read_b128 v[148:151], v16 offset:0
    ds_read_b64_tr_b16 v[184:185], v13 offset:12672
    v_mfma_f32_16x16x32_bf16 v[88:91], v[160:163], v[140:143], v[88:91]
    ds_read_b64_tr_b16 v[186:187], v13 offset:12928
    ds_read_b128 v[152:155], v16 offset:2048
    v_mfma_f32_16x16x32_bf16 v[112:115], v[160:163], v[144:147], v[112:115]
    ds_read_b64_tr_b16 v[188:189], v14 offset:12672
    ds_read_b64_tr_b16 v[190:191], v14 offset:12928
    v_mfma_f32_16x16x32_bf16 v[68:71], v[164:167], v[136:139], v[68:71]
    ds_read_b128 v[156:159], v16 offset:4096
    ds_read_b64_tr_b16 v[192:193], v13 offset:16896
    v_mfma_f32_16x16x32_bf16 v[92:95], v[164:167], v[140:143], v[92:95]
    ds_read_b64_tr_b16 v[194:195], v13 offset:17152
    ds_read_b64_tr_b16 v[196:197], v14 offset:16896
    v_mfma_f32_16x16x32_bf16 v[116:119], v[164:167], v[144:147], v[116:119]
    ds_read_b64_tr_b16 v[198:199], v14 offset:17152
    ds_read_b64_tr_b16 v[200:201], v13 offset:21120
    v_mfma_f32_16x16x32_bf16 v[72:75], v[168:171], v[136:139], v[72:75]
    ds_read_b64_tr_b16 v[202:203], v13 offset:21376
    ds_read_b64_tr_b16 v[204:205], v14 offset:21120
    v_mfma_f32_16x16x32_bf16 v[96:99], v[168:171], v[140:143], v[96:99]
    ds_read_b64_tr_b16 v[206:207], v14 offset:21376
    s_add_u32 m0, s49, 101632
    v_mfma_f32_16x16x32_bf16 v[120:123], v[168:171], v[144:147], v[120:123]
    buffer_load_dwordx4 v3, s[12:15], s51 offen nt lds
    s_add_u32 m0, s50, 87936
    v_mfma_f32_16x16x32_bf16 v[76:79], v[172:175], v[136:139], v[76:79]
    buffer_load_dwordx4 v5, s[16:19], s53 offen offset:0 lds
    s_add_u32 m0, s49, 102656
    v_mfma_f32_16x16x32_bf16 v[100:103], v[172:175], v[140:143], v[100:103]
    buffer_load_dwordx4 v4, s[12:15], s51 offen nt lds
    s_add_u32 m0, s50, 91264
    v_mfma_f32_16x16x32_bf16 v[124:127], v[172:175], v[144:147], v[124:127]
    buffer_load_dwordx4 v5, s[16:19], s53 offen offset:896 lds
    s_add_u32 m0, s50, 94592
    v_mfma_f32_16x16x32_bf16 v[80:83], v[136:139], v[176:179], v[80:83]
    buffer_load_dwordx4 v5, s[16:19], s53 offen offset:1792 lds
    v_mfma_f32_16x16x32_bf16 v[104:107], v[140:143], v[176:179], v[104:107]
    v_mfma_f32_16x16x32_bf16 v[128:131], v[144:147], v[176:179], v[128:131]
    v_mfma_f32_16x16x32_bf16 v[84:87], v[136:139], v[180:183], v[84:87]
    v_mfma_f32_16x16x32_bf16 v[108:111], v[140:143], v[180:183], v[108:111]
    v_mfma_f32_16x16x32_bf16 v[132:135], v[144:147], v[180:183], v[132:135]
    s_waitcnt vmcnt(9) lgkmcnt(0)
    s_barrier
    v_mfma_f32_16x16x32_bf16 v[64:67], v[184:187], v[148:151], v[64:67]
    v_add_u32 v13, 37632, v9
    v_add_u32 v15, 37632, v11
    v_mfma_f32_16x16x32_bf16 v[88:91], v[184:187], v[152:155], v[88:91]
    v_add_u32 v14, 37632, v10
    v_add_u32 v16, 37632, v12
    v_mfma_f32_16x16x32_bf16 v[112:115], v[184:187], v[156:159], v[112:115]
    ds_read_b128 v[136:139], v15 offset:0
    ds_read_b64_tr_b16 v[160:161], v13 offset:0
    v_mfma_f32_16x16x32_bf16 v[68:71], v[188:191], v[148:151], v[68:71]
    ds_read_b64_tr_b16 v[162:163], v13 offset:256
    ds_read_b128 v[140:143], v15 offset:2048
    v_mfma_f32_16x16x32_bf16 v[92:95], v[188:191], v[152:155], v[92:95]
    ds_read_b64_tr_b16 v[164:165], v14 offset:0
    ds_read_b64_tr_b16 v[166:167], v14 offset:256
    v_mfma_f32_16x16x32_bf16 v[116:119], v[188:191], v[156:159], v[116:119]
    ds_read_b128 v[144:147], v15 offset:4096
    ds_read_b64_tr_b16 v[168:169], v13 offset:4224
    v_mfma_f32_16x16x32_bf16 v[72:75], v[192:195], v[148:151], v[72:75]
    ds_read_b64_tr_b16 v[170:171], v13 offset:4480
    ds_read_b64_tr_b16 v[172:173], v14 offset:4224
    v_mfma_f32_16x16x32_bf16 v[96:99], v[192:195], v[152:155], v[96:99]
    ds_read_b64_tr_b16 v[174:175], v14 offset:4480
    ds_read_b64_tr_b16 v[176:177], v13 offset:8448
    v_mfma_f32_16x16x32_bf16 v[120:123], v[192:195], v[156:159], v[120:123]
    ds_read_b64_tr_b16 v[178:179], v13 offset:8704
    ds_read_b64_tr_b16 v[180:181], v14 offset:8448
    v_mfma_f32_16x16x32_bf16 v[76:79], v[196:199], v[148:151], v[76:79]
    ds_read_b64_tr_b16 v[182:183], v14 offset:8704
    s_movk_i32 s51, 640
    v_mfma_f32_16x16x32_bf16 v[100:103], v[196:199], v[152:155], v[100:103]
    s_mov_b32 s52, 860160
    s_add_u32 s53, s52, 32*2688
    v_mfma_f32_16x16x32_bf16 v[124:127], v[196:199], v[156:159], v[124:127]
    s_add_u32 m0, s50, 0
    v_mfma_f32_16x16x32_bf16 v[80:83], v[148:151], v[200:203], v[80:83]
    buffer_load_dwordx4 v5, s[16:19], s52 offen offset:0 lds
    s_add_u32 m0, s50, 3328
    v_mfma_f32_16x16x32_bf16 v[104:107], v[152:155], v[200:203], v[104:107]
    buffer_load_dwordx4 v5, s[16:19], s52 offen offset:896 lds
    s_add_u32 m0, s49, 25344
    v_mfma_f32_16x16x32_bf16 v[128:131], v[156:159], v[200:203], v[128:131]
    buffer_load_dwordx4 v2, s[12:15], s51 offen nt lds
    s_add_u32 m0, s50, 6656
    v_mfma_f32_16x16x32_bf16 v[84:87], v[148:151], v[204:207], v[84:87]
    buffer_load_dwordx4 v5, s[16:19], s52 offen offset:1792 lds
    v_mfma_f32_16x16x32_bf16 v[108:111], v[152:155], v[204:207], v[108:111]
    v_mfma_f32_16x16x32_bf16 v[132:135], v[156:159], v[204:207], v[132:135]
    s_waitcnt lgkmcnt(0)
    v_mfma_f32_16x16x32_bf16 v[64:67], v[160:163], v[136:139], v[64:67]
    ds_read_b128 v[148:151], v16 offset:0
    ds_read_b64_tr_b16 v[184:185], v13 offset:12672
    v_mfma_f32_16x16x32_bf16 v[88:91], v[160:163], v[140:143], v[88:91]
    ds_read_b64_tr_b16 v[186:187], v13 offset:12928
    ds_read_b128 v[152:155], v16 offset:2048
    v_mfma_f32_16x16x32_bf16 v[112:115], v[160:163], v[144:147], v[112:115]
    ds_read_b64_tr_b16 v[188:189], v14 offset:12672
    ds_read_b64_tr_b16 v[190:191], v14 offset:12928
    v_mfma_f32_16x16x32_bf16 v[68:71], v[164:167], v[136:139], v[68:71]
    ds_read_b128 v[156:159], v16 offset:4096
    ds_read_b64_tr_b16 v[192:193], v13 offset:16896
    v_mfma_f32_16x16x32_bf16 v[92:95], v[164:167], v[140:143], v[92:95]
    ds_read_b64_tr_b16 v[194:195], v13 offset:17152
    ds_read_b64_tr_b16 v[196:197], v14 offset:16896
    v_mfma_f32_16x16x32_bf16 v[116:119], v[164:167], v[144:147], v[116:119]
    ds_read_b64_tr_b16 v[198:199], v14 offset:17152
    ds_read_b64_tr_b16 v[200:201], v13 offset:21120
    v_mfma_f32_16x16x32_bf16 v[72:75], v[168:171], v[136:139], v[72:75]
    ds_read_b64_tr_b16 v[202:203], v13 offset:21376
    ds_read_b64_tr_b16 v[204:205], v14 offset:21120
    v_mfma_f32_16x16x32_bf16 v[96:99], v[168:171], v[140:143], v[96:99]
    ds_read_b64_tr_b16 v[206:207], v14 offset:21376
    s_add_u32 m0, s49, 26368
    v_mfma_f32_16x16x32_bf16 v[120:123], v[168:171], v[144:147], v[120:123]
    buffer_load_dwordx4 v3, s[12:15], s51 offen nt lds
    s_add_u32 m0, s50, 12672
    v_mfma_f32_16x16x32_bf16 v[76:79], v[172:175], v[136:139], v[76:79]
    buffer_load_dwordx4 v5, s[16:19], s53 offen offset:0 lds
    s_add_u32 m0, s49, 27392
    v_mfma_f32_16x16x32_bf16 v[100:103], v[172:175], v[140:143], v[100:103]
    buffer_load_dwordx4 v4, s[12:15], s51 offen nt lds
    s_add_u32 m0, s50, 16000
    v_mfma_f32_16x16x32_bf16 v[124:127], v[172:175], v[144:147], v[124:127]
    buffer_load_dwordx4 v5, s[16:19], s53 offen offset:896 lds
    s_add_u32 m0, s50, 19328
    v_mfma_f32_16x16x32_bf16 v[80:83], v[136:139], v[176:179], v[80:83]
    buffer_load_dwordx4 v5, s[16:19], s53 offen offset:1792 lds
    buffer_load_dwordx2 v[250:251], off, s[36:39], 0 sc1
    v_mfma_f32_16x16x32_bf16 v[104:107], v[140:143], v[176:179], v[104:107]
    v_mfma_f32_16x16x32_bf16 v[128:131], v[144:147], v[176:179], v[128:131]
    v_mfma_f32_16x16x32_bf16 v[84:87], v[136:139], v[180:183], v[84:87]
    v_mfma_f32_16x16x32_bf16 v[108:111], v[140:143], v[180:183], v[108:111]
    v_mfma_f32_16x16x32_bf16 v[132:135], v[144:147], v[180:183], v[132:135]
    s_waitcnt vmcnt(10) lgkmcnt(0)
    s_barrier
    v_mfma_f32_16x16x32_bf16 v[64:67], v[184:187], v[148:151], v[64:67]
    v_add_u32 v13, 75264, v9
    v_add_u32 v15, 75264, v11
    v_mfma_f32_16x16x32_bf16 v[88:91], v[184:187], v[152:155], v[88:91]
    v_add_u32 v14, 75264, v10
    v_add_u32 v16, 75264, v12
    v_mfma_f32_16x16x32_bf16 v[112:115], v[184:187], v[156:159], v[112:115]
    ds_read_b128 v[136:139], v15 offset:0
    ds_read_b64_tr_b16 v[160:161], v13 offset:0
    v_mfma_f32_16x16x32_bf16 v[68:71], v[188:191], v[148:151], v[68:71]
    ds_read_b64_tr_b16 v[162:163], v13 offset:256
    ds_read_b128 v[140:143], v15 offset:2048
    v_mfma_f32_16x16x32_bf16 v[92:95], v[188:191], v[152:155], v[92:95]
    ds_read_b64_tr_b16 v[164:165], v14 offset:0
    ds_read_b64_tr_b16 v[166:167], v14 offset:256
    v_mfma_f32_16x16x32_bf16 v[116:119], v[188:191], v[156:159], v[116:119]
    ds_read_b128 v[144:147], v15 offset:4096
    ds_read_b64_tr_b16 v[168:169], v13 offset:4224
    v_mfma_f32_16x16x32_bf16 v[72:75], v[192:195], v[148:151], v[72:75]
    ds_read_b64_tr_b16 v[170:171], v13 offset:4480
    ds_read_b64_tr_b16 v[172:173], v14 offset:4224
    v_mfma_f32_16x16x32_bf16 v[96:99], v[192:195], v[152:155], v[96:99]
    ds_read_b64_tr_b16 v[174:175], v14 offset:4480
    ds_read_b64_tr_b16 v[176:177], v13 offset:8448
    v_mfma_f32_16x16x32_bf16 v[120:123], v[192:195], v[156:159], v[120:123]
    ds_read_b64_tr_b16 v[178:179], v13 offset:8704
    ds_read_b64_tr_b16 v[180:181], v14 offset:8448
    v_mfma_f32_16x16x32_bf16 v[76:79], v[196:199], v[148:151], v[76:79]
    ds_read_b64_tr_b16 v[182:183], v14 offset:8704
    s_movk_i32 s51, 768
    v_mfma_f32_16x16x32_bf16 v[100:103], v[196:199], v[152:155], v[100:103]
    s_mov_b32 s52, 1032192
    s_add_u32 s53, s52, 32*2688
    v_mfma_f32_16x16x32_bf16 v[124:127], v[196:199], v[156:159], v[124:127]
    s_add_u32 m0, s50, 37632
    v_mfma_f32_16x16x32_bf16 v[80:83], v[148:151], v[200:203], v[80:83]
    buffer_load_dwordx4 v5, s[16:19], s52 offen offset:0 lds
    s_add_u32 m0, s50, 40960
    v_mfma_f32_16x16x32_bf16 v[104:107], v[152:155], v[200:203], v[104:107]
    buffer_load_dwordx4 v5, s[16:19], s52 offen offset:896 lds
    s_add_u32 m0, s49, 62976
    v_mfma_f32_16x16x32_bf16 v[128:131], v[156:159], v[200:203], v[128:131]
    buffer_load_dwordx4 v2, s[12:15], s51 offen nt lds
    s_add_u32 m0, s50, 44288
    v_mfma_f32_16x16x32_bf16 v[84:87], v[148:151], v[204:207], v[84:87]
    buffer_load_dwordx4 v5, s[16:19], s52 offen offset:1792 lds
    v_mfma_f32_16x16x32_bf16 v[108:111], v[152:155], v[204:207], v[108:111]
    v_mfma_f32_16x16x32_bf16 v[132:135], v[156:159], v[204:207], v[132:135]
    s_waitcnt lgkmcnt(0)
    v_mfma_f32_16x16x32_bf16 v[64:67], v[160:163], v[136:139], v[64:67]
    ds_read_b128 v[148:151], v16 offset:0
    ds_read_b64_tr_b16 v[184:185], v13 offset:12672
    v_mfma_f32_16x16x32_bf16 v[88:91], v[160:163], v[140:143], v[88:91]
    ds_read_b64_tr_b16 v[186:187], v13 offset:12928
    ds_read_b128 v[152:155], v16 offset:2048
    v_mfma_f32_16x16x32_bf16 v[112:115], v[160:163], v[144:147], v[112:115]
    ds_read_b64_tr_b16 v[188:189], v14 offset:12672
    ds_read_b64_tr_b16 v[190:191], v14 offset:12928
    v_mfma_f32_16x16x32_bf16 v[68:71], v[164:167], v[136:139], v[68:71]
    ds_read_b128 v[156:159], v16 offset:4096
    ds_read_b64_tr_b16 v[192:193], v13 offset:16896
    v_mfma_f32_16x16x32_bf16 v[92:95], v[164:167], v[140:143], v[92:95]
    ds_read_b64_tr_b16 v[194:195], v13 offset:17152
    ds_read_b64_tr_b16 v[196:197], v14 offset:16896
    v_mfma_f32_16x16x32_bf16 v[116:119], v[164:167], v[144:147], v[116:119]
    ds_read_b64_tr_b16 v[198:199], v14 offset:17152
    ds_read_b64_tr_b16 v[200:201], v13 offset:21120
    v_mfma_f32_16x16x32_bf16 v[72:75], v[168:171], v[136:139], v[72:75]
    ds_read_b64_tr_b16 v[202:203], v13 offset:21376
    ds_read_b64_tr_b16 v[204:205], v14 offset:21120
    v_mfma_f32_16x16x32_bf16 v[96:99], v[168:171], v[140:143], v[96:99]
    ds_read_b64_tr_b16 v[206:207], v14 offset:21376
    s_add_u32 m0, s49, 64000
    v_mfma_f32_16x16x32_bf16 v[120:123], v[168:171], v[144:147], v[120:123]
    buffer_load_dwordx4 v3, s[12:15], s51 offen nt lds
    s_add_u32 m0, s50, 50304
    v_mfma_f32_16x16x32_bf16 v[76:79], v[172:175], v[136:139], v[76:79]
    buffer_load_dwordx4 v5, s[16:19], s53 offen offset:0 lds
    s_add_u32 m0, s49, 65024
    v_mfma_f32_16x16x32_bf16 v[100:103], v[172:175], v[140:143], v[100:103]
    buffer_load_dwordx4 v4, s[12:15], s51 offen nt lds
    s_add_u32 m0, s50, 53632
    v_mfma_f32_16x16x32_bf16 v[124:127], v[172:175], v[144:147], v[124:127]
    buffer_load_dwordx4 v5, s[16:19], s53 offen offset:896 lds
    s_add_u32 m0, s50, 56960
    v_mfma_f32_16x16x32_bf16 v[80:83], v[136:139], v[176:179], v[80:83]
    buffer_load_dwordx4 v5, s[16:19], s53 offen offset:1792 lds
    v_mfma_f32_16x16x32_bf16 v[104:107], v[140:143], v[176:179], v[104:107]
    v_mfma_f32_16x16x32_bf16 v[128:131], v[144:147], v[176:179], v[128:131]
    v_mfma_f32_16x16x32_bf16 v[84:87], v[136:139], v[180:183], v[84:87]
    v_mfma_f32_16x16x32_bf16 v[108:111], v[140:143], v[180:183], v[108:111]
    v_mfma_f32_16x16x32_bf16 v[132:135], v[144:147], v[180:183], v[132:135]
    s_waitcnt vmcnt(9) lgkmcnt(0)
    s_barrier
    v_mfma_f32_16x16x32_bf16 v[64:67], v[184:187], v[148:151], v[64:67]
    v_add_u32 v13, 0, v9
    v_add_u32 v15, 0, v11
    v_mfma_f32_16x16x32_bf16 v[88:91], v[184:187], v[152:155], v[88:91]
    v_add_u32 v14, 0, v10
    v_add_u32 v16, 0, v12
    v_mfma_f32_16x16x32_bf16 v[112:115], v[184:187], v[156:159], v[112:115]
    ds_read_b128 v[136:139], v15 offset:0
    ds_read_b64_tr_b16 v[160:161], v13 offset:0
    v_mfma_f32_16x16x32_bf16 v[68:71], v[188:191], v[148:151], v[68:71]
    ds_read_b64_tr_b16 v[162:163], v13 offset:256
    ds_read_b128 v[140:143], v15 offset:2048
    v_mfma_f32_16x16x32_bf16 v[92:95], v[188:191], v[152:155], v[92:95]
    ds_read_b64_tr_b16 v[164:165], v14 offset:0
    ds_read_b64_tr_b16 v[166:167], v14 offset:256
    v_mfma_f32_16x16x32_bf16 v[116:119], v[188:191], v[156:159], v[116:119]
    ds_read_b128 v[144:147], v15 offset:4096
    ds_read_b64_tr_b16 v[168:169], v13 offset:4224
    v_mfma_f32_16x16x32_bf16 v[72:75], v[192:195], v[148:151], v[72:75]
    ds_read_b64_tr_b16 v[170:171], v13 offset:4480
    ds_read_b64_tr_b16 v[172:173], v14 offset:4224
    v_mfma_f32_16x16x32_bf16 v[96:99], v[192:195], v[152:155], v[96:99]
    ds_read_b64_tr_b16 v[174:175], v14 offset:4480
    ds_read_b64_tr_b16 v[176:177], v13 offset:8448
    v_mfma_f32_16x16x32_bf16 v[120:123], v[192:195], v[156:159], v[120:123]
    ds_read_b64_tr_b16 v[178:179], v13 offset:8704
    ds_read_b64_tr_b16 v[180:181], v14 offset:8448
    v_mfma_f32_16x16x32_bf16 v[76:79], v[196:199], v[148:151], v[76:79]
    ds_read_b64_tr_b16 v[182:183], v14 offset:8704
    s_add_u32 s6, s44, 57344
    v_mfma_f32_16x16x32_bf16 v[100:103], v[196:199], v[152:155], v[100:103]
    s_sub_u32 s7, s6, 401408
    s_add_u32 m0, s45, 8192
    v_mfma_f32_16x16x32_bf16 v[124:127], v[196:199], v[156:159], v[124:127]
    s_min_u32 s6, s6, s7
    buffer_load_dwordx4 v240, s[24:27], s6 offen lds
    v_mfma_f32_16x16x32_bf16 v[80:83], v[148:151], v[200:203], v[80:83]
    s_add_u32 s6, s44, 86016
    s_sub_u32 s7, s6, 401408
    v_mfma_f32_16x16x32_bf16 v[104:107], v[152:155], v[200:203], v[104:107]
    s_add_u32 m0, s45, 12288
    s_min_u32 s6, s6, s7
    v_mfma_f32_16x16x32_bf16 v[128:131], v[156:159], v[200:203], v[128:131]
    buffer_load_dwordx4 v240, s[24:27], s6 offen lds
    s_add_u32 s6, s44, 114688
    v_mfma_f32_16x16x32_bf16 v[84:87], v[148:151], v[204:207], v[84:87]
    s_sub_u32 s7, s6, 401408
    s_add_u32 m0, s45, 16384
    v_mfma_f32_16x16x32_bf16 v[108:111], v[152:155], v[204:207], v[108:111]
    s_min_u32 s6, s6, s7
    buffer_load_dwordx4 v240, s[24:27], s6 offen lds
    v_mfma_f32_16x16x32_bf16 v[132:135], v[156:159], v[204:207], v[132:135]
    s_add_u32 s6, s44, 143360
    s_sub_u32 s7, s6, 401408
    s_add_u32 m0, s45, 20480
    s_min_u32 s6, s6, s7
    buffer_load_dwordx4 v240, s[24:27], s6 offen lds
    s_waitcnt lgkmcnt(0)
    v_mfma_f32_16x16x32_bf16 v[64:67], v[160:163], v[136:139], v[64:67]
    ds_read_b128 v[148:151], v16 offset:0
    ds_read_b64_tr_b16 v[184:185], v13 offset:12672
    v_mfma_f32_16x16x32_bf16 v[88:91], v[160:163], v[140:143], v[88:91]
    ds_read_b64_tr_b16 v[186:187], v13 offset:12928
    ds_read_b128 v[152:155], v16 offset:2048
    v_mfma_f32_16x16x32_bf16 v[112:115], v[160:163], v[144:147], v[112:115]
    ds_read_b64_tr_b16 v[188:189], v14 offset:12672
    ds_read_b64_tr_b16 v[190:191], v14 offset:12928
    v_mfma_f32_16x16x32_bf16 v[68:71], v[164:167], v[136:139], v[68:71]
    ds_read_b128 v[156:159], v16 offset:4096
    ds_read_b64_tr_b16 v[192:193], v13 offset:16896
    v_mfma_f32_16x16x32_bf16 v[92:95], v[164:167], v[140:143], v[92:95]
    ds_read_b64_tr_b16 v[194:195], v13 offset:17152
    ds_read_b64_tr_b16 v[196:197], v14 offset:16896
    v_mfma_f32_16x16x32_bf16 v[116:119], v[164:167], v[144:147], v[116:119]
    ds_read_b64_tr_b16 v[198:199], v14 offset:17152
    ds_read_b64_tr_b16 v[200:201], v13 offset:21120
    v_mfma_f32_16x16x32_bf16 v[72:75], v[168:171], v[136:139], v[72:75]
    ds_read_b64_tr_b16 v[202:203], v13 offset:21376
    ds_read_b64_tr_b16 v[204:205], v14 offset:21120
    v_mfma_f32_16x16x32_bf16 v[96:99], v[168:171], v[140:143], v[96:99]
    ds_read_b64_tr_b16 v[206:207], v14 offset:21376
    s_add_u32 s6, s44, 172032
    v_mfma_f32_16x16x32_bf16 v[120:123], v[168:171], v[144:147], v[120:123]
    s_sub_u32 s7, s6, 401408
    s_add_u32 m0, s45, 24576
    v_mfma_f32_16x16x32_bf16 v[76:79], v[172:175], v[136:139], v[76:79]
    s_min_u32 s6, s6, s7
    buffer_load_dwordx4 v240, s[24:27], s6 offen lds
    v_mfma_f32_16x16x32_bf16 v[100:103], v[172:175], v[140:143], v[100:103]
    s_add_u32 s6, s44, 200704
    s_sub_u32 s7, s6, 401408
    v_mfma_f32_16x16x32_bf16 v[124:127], v[172:175], v[144:147], v[124:127]
    s_add_u32 m0, s45, 28672
    s_min_u32 s6, s6, s7
    v_mfma_f32_16x16x32_bf16 v[80:83], v[136:139], v[176:179], v[80:83]
    buffer_load_dwordx4 v240, s[24:27], s6 offen lds
    s_add_u32 s6, s44, 229376
    v_mfma_f32_16x16x32_bf16 v[104:107], v[140:143], v[176:179], v[104:107]
    s_sub_u32 s7, s6, 401408
    s_add_u32 m0, s45, 32768
    v_mfma_f32_16x16x32_bf16 v[128:131], v[144:147], v[176:179], v[128:131]
    s_min_u32 s6, s6, s7
    buffer_load_dwordx4 v240, s[24:27], s6 offen lds
    v_mfma_f32_16x16x32_bf16 v[84:87], v[136:139], v[180:183], v[84:87]
    s_add_u32 s6, s44, 258048
    s_sub_u32 s7, s6, 401408
    v_mfma_f32_16x16x32_bf16 v[108:111], v[140:143], v[180:183], v[108:111]
    s_add_u32 m0, s45, 36864
    s_min_u32 s6, s6, s7
    v_mfma_f32_16x16x32_bf16 v[132:135], v[144:147], v[180:183], v[132:135]
    buffer_load_dwordx4 v240, s[24:27], s6 offen lds
    s_waitcnt vmcnt(8) lgkmcnt(0)
    s_barrier
    v_mfma_f32_16x16x32_bf16 v[64:67], v[184:187], v[148:151], v[64:67]
    v_add_u32 v13, 37632, v9
    v_add_u32 v15, 37632, v11
    v_mfma_f32_16x16x32_bf16 v[88:91], v[184:187], v[152:155], v[88:91]
    v_add_u32 v14, 37632, v10
    v_add_u32 v16, 37632, v12
    v_mfma_f32_16x16x32_bf16 v[112:115], v[184:187], v[156:159], v[112:115]
    ds_read_b128 v[136:139], v15 offset:0
    ds_read_b64_tr_b16 v[160:161], v13 offset:0
    v_mfma_f32_16x16x32_bf16 v[68:71], v[188:191], v[148:151], v[68:71]
    ds_read_b64_tr_b16 v[162:163], v13 offset:256
    ds_read_b128 v[140:143], v15 offset:2048
    v_mfma_f32_16x16x32_bf16 v[92:95], v[188:191], v[152:155], v[92:95]
    ds_read_b64_tr_b16 v[164:165], v14 offset:0
    ds_read_b64_tr_b16 v[166:167], v14 offset:256
    v_mfma_f32_16x16x32_bf16 v[116:119], v[188:191], v[156:159], v[116:119]
    ds_read_b128 v[144:147], v15 offset:4096
    ds_read_b64_tr_b16 v[168:169], v13 offset:4224
    v_mfma_f32_16x16x32_bf16 v[72:75], v[192:195], v[148:151], v[72:75]
    ds_read_b64_tr_b16 v[170:171], v13 offset:4480
    ds_read_b64_tr_b16 v[172:173], v14 offset:4224
    v_mfma_f32_16x16x32_bf16 v[96:99], v[192:195], v[152:155], v[96:99]
    ds_read_b64_tr_b16 v[174:175], v14 offset:4480
    ds_read_b64_tr_b16 v[176:177], v13 offset:8448
    v_mfma_f32_16x16x32_bf16 v[120:123], v[192:195], v[156:159], v[120:123]
    ds_read_b64_tr_b16 v[178:179], v13 offset:8704
    ds_read_b64_tr_b16 v[180:181], v14 offset:8448
    v_mfma_f32_16x16x32_bf16 v[76:79], v[196:199], v[148:151], v[76:79]
    ds_read_b64_tr_b16 v[182:183], v14 offset:8704
    s_add_u32 s6, s44, 286720
    v_mfma_f32_16x16x32_bf16 v[100:103], v[196:199], v[152:155], v[100:103]
    s_sub_u32 s7, s6, 401408
    s_add_u32 m0, s45, 40960
    v_mfma_f32_16x16x32_bf16 v[124:127], v[196:199], v[156:159], v[124:127]
    s_min_u32 s6, s6, s7
    buffer_load_dwordx4 v240, s[24:27], s6 offen lds
    v_mfma_f32_16x16x32_bf16 v[80:83], v[148:151], v[200:203], v[80:83]
    s_add_u32 s6, s44, 315392
    s_sub_u32 s7, s6, 401408
    v_mfma_f32_16x16x32_bf16 v[104:107], v[152:155], v[200:203], v[104:107]
    s_add_u32 m0, s45, 45056
    s_min_u32 s6, s6, s7
    v_mfma_f32_16x16x32_bf16 v[128:131], v[156:159], v[200:203], v[128:131]
    buffer_load_dwordx4 v240, s[24:27], s6 offen lds
    s_add_u32 s6, s44, 344064
    v_mfma_f32_16x16x32_bf16 v[84:87], v[148:151], v[204:207], v[84:87]
    s_sub_u32 s7, s6, 401408
    s_add_u32 m0, s45, 49152
    v_mfma_f32_16x16x32_bf16 v[108:111], v[152:155], v[204:207], v[108:111]
    s_min_u32 s6, s6, s7
    buffer_load_dwordx4 v240, s[24:27], s6 offen lds
    v_mfma_f32_16x16x32_bf16 v[132:135], v[156:159], v[204:207], v[132:135]
    s_add_u32 s6, s44, 372736
    s_sub_u32 s7, s6, 401408
    s_add_u32 m0, s45, 53248
    s_min_u32 s6, s6, s7
    buffer_load_dwordx4 v240, s[24:27], s6 offen lds
    s_waitcnt lgkmcnt(0)
    v_mfma_f32_16x16x32_bf16 v[64:67], v[160:163], v[136:139], v[64:67]
    ds_read_b128 v[148:151], v16 offset:0
    ds_read_b64_tr_b16 v[184:185], v13 offset:12672
    v_mfma_f32_16x16x32_bf16 v[88:91], v[160:163], v[140:143], v[88:91]
    ds_read_b64_tr_b16 v[186:187], v13 offset:12928
    ds_read_b128 v[152:155], v16 offset:2048
    v_mfma_f32_16x16x32_bf16 v[112:115], v[160:163], v[144:147], v[112:115]
    ds_read_b64_tr_b16 v[188:189], v14 offset:12672
    ds_read_b64_tr_b16 v[190:191], v14 offset:12928
    v_mfma_f32_16x16x32_bf16 v[68:71], v[164:167], v[136:139], v[68:71]
    ds_read_b128 v[156:159], v16 offset:4096
    ds_read_b64_tr_b16 v[192:193], v13 offset:16896
    v_mfma_f32_16x16x32_bf16 v[92:95], v[164:167], v[140:143], v[92:95]
    ds_read_b64_tr_b16 v[194:195], v13 offset:17152
    ds_read_b64_tr_b16 v[196:197], v14 offset:16896
    v_mfma_f32_16x16x32_bf16 v[116:119], v[164:167], v[144:147], v[116:119]
    ds_read_b64_tr_b16 v[198:199], v14 offset:17152
    ds_read_b64_tr_b16 v[200:201], v13 offset:21120
    v_mfma_f32_16x16x32_bf16 v[72:75], v[168:171], v[136:139], v[72:75]
    ds_read_b64_tr_b16 v[202:203], v13 offset:21376
    ds_read_b64_tr_b16 v[204:205], v14 offset:21120
    v_mfma_f32_16x16x32_bf16 v[96:99], v[168:171], v[140:143], v[96:99]
    ds_read_b64_tr_b16 v[206:207], v14 offset:21376
    s_mov_b32 m0, 162816
    v_mfma_f32_16x16x32_bf16 v[120:123], v[168:171], v[144:147], v[120:123]
    s_mov_b32 s6, 0x40000000
    buffer_load_dwordx4 v240, s[24:27], s6 offen lds
    v_mfma_f32_16x16x32_bf16 v[76:79], v[172:175], v[136:139], v[76:79]
    s_add_u32 s6, s44, 0
    s_sub_u32 s7, s6, 401408
    v_mfma_f32_16x16x32_bf16 v[100:103], v[172:175], v[140:143], v[100:103]
    s_add_u32 m0, s45, 0
    s_min_u32 s6, s6, s7
    v_mfma_f32_16x16x32_bf16 v[124:127], v[172:175], v[144:147], v[124:127]
    buffer_load_dwordx4 v240, s[24:27], s6 offen lds
    s_add_u32 s6, s44, 28672
    v_mfma_f32_16x16x32_bf16 v[80:83], v[136:139], v[176:179], v[80:83]
    s_sub_u32 s7, s6, 401408
    s_add_u32 m0, s45, 4096
    v_mfma_f32_16x16x32_bf16 v[104:107], v[140:143], v[176:179], v[104:107]
    s_min_u32 s6, s6, s7
    buffer_load_dwordx4 v240, s[24:27], s6 offen lds
    v_mfma_f32_16x16x32_bf16 v[128:131], v[144:147], v[176:179], v[128:131]
    v_mfma_f32_16x16x32_bf16 v[84:87], v[136:139], v[180:183], v[84:87]
    v_mfma_f32_16x16x32_bf16 v[108:111], v[140:143], v[180:183], v[108:111]
    v_mfma_f32_16x16x32_bf16 v[132:135], v[144:147], v[180:183], v[132:135]
    s_waitcnt lgkmcnt(0)
    v_mfma_f32_16x16x32_bf16 v[120:123], v[192:195], v[156:159], v[120:123]
    v_mfma_f32_16x16x32_bf16 v[124:127], v[196:199], v[156:159], v[124:127]
    v_mfma_f32_16x16x32_bf16 v[128:131], v[156:159], v[200:203], v[128:131]
    v_mfma_f32_16x16x32_bf16 v[132:135], v[156:159], v[204:207], v[132:135]
    v_mfma_f32_16x16x32_bf16 v[112:115], v[184:187], v[156:159], v[112:115]
    v_mfma_f32_16x16x32_bf16 v[116:119], v[188:191], v[156:159], v[116:119]
    v_mfma_f32_16x16x32_bf16 v[88:91], v[184:187], v[152:155], v[88:91]
    v_mfma_f32_16x16x32_bf16 v[92:95], v[188:191], v[152:155], v[92:95]
    v_mfma_f32_16x16x32_bf16 v[96:99], v[192:195], v[152:155], v[96:99]
    v_cvt_pk_bf16_f32 v220, v120, v121
    v_cvt_pk_bf16_f32 v221, v122, v123
    v_mfma_f32_16x16x32_bf16 v[100:103], v[196:199], v[152:155], v[100:103]
    v_cvt_pk_bf16_f32 v222, v124, v125
    v_cvt_pk_bf16_f32 v223, v126, v127
    v_mfma_f32_16x16x32_bf16 v[104:107], v[152:155], v[200:203], v[104:107]
    v_cvt_pk_bf16_f32 v230, v128, v129
    v_cvt_pk_bf16_f32 v231, v130, v131
    v_mfma_f32_16x16x32_bf16 v[108:111], v[152:155], v[204:207], v[108:111]
    v_cvt_pk_bf16_f32 v238, v132, v133
    v_cvt_pk_bf16_f32 v239, v134, v135
    v_mfma_f32_16x16x32_bf16 v[64:67], v[184:187], v[148:151], v[64:67]
    ds_write_b128 v6, v[220:223]
    ds_write_b64 v6, v[230:231] offset:1024
    v_mfma_f32_16x16x32_bf16 v[68:71], v[188:191], v[148:151], v[68:71]
    ds_write_b64 v6, v[238:239] offset:1032
    v_cvt_pk_bf16_f32 v52, v112, v113
    v_mfma_f32_16x16x32_bf16 v[72:75], v[192:195], v[148:151], v[72:75]
    v_cvt_pk_bf16_f32 v53, v114, v115
    v_cvt_pk_bf16_f32 v54, v116, v117
    v_mfma_f32_16x16x32_bf16 v[76:79], v[196:199], v[148:151], v[76:79]
    v_cvt_pk_bf16_f32 v55, v118, v119
    v_and_b32 v54, v30, v54
    v_mfma_f32_16x16x32_bf16 v[80:83], v[148:151], v[200:203], v[80:83]
    v_and_b32 v55, v30, v55
    v_mfma_f32_16x16x32_bf16 v[84:87], v[148:151], v[204:207], v[84:87]
    v_cvt_pk_bf16_f32 v216, v96, v97
    v_cvt_pk_bf16_f32 v217, v98, v99
    v_cvt_pk_bf16_f32 v218, v100, v101
    v_cvt_pk_bf16_f32 v219, v102, v103
    v_cvt_pk_bf16_f32 v48, v88, v89
    v_cvt_pk_bf16_f32 v49, v90, v91
    v_cvt_pk_bf16_f32 v50, v92, v93
    v_cvt_pk_bf16_f32 v51, v94, v95
    v_and_b32 v50, v30, v50
    v_and_b32 v51, v30, v51
    s_waitcnt lgkmcnt(0)
    s_barrier
    ds_read_b128 v[208:211], v7
    ds_read_b64 v[224:225], v7 offset:1024
    ds_read_b64 v[232:233], v7 offset:1032
    v_mfma_f32_16x16x32_bf16 v[152:155], v[216:219], v[52:55], v[20:23]
    v_mfma_f32_16x16x32_bf16 v[156:159], v[220:223], v[52:55], v[24:27]
    v_mfma_f32_16x16x32_bf16 v[148:151], v[216:219], v[48:51], v[24:27]
    v_cvt_pk_bf16_f32 v212, v72, v73
    v_cvt_pk_bf16_f32 v213, v74, v75
    v_cvt_pk_bf16_f32 v214, v76, v77
    v_cvt_pk_bf16_f32 v215, v78, v79
    v_cvt_pk_bf16_f32 v44, v64, v65
    v_cvt_pk_bf16_f32 v45, v66, v67
    v_cvt_pk_bf16_f32 v46, v68, v69
    v_cvt_pk_bf16_f32 v47, v70, v71
    v_and_b32 v46, v30, v46
    v_and_b32 v47, v30, v47
    v_mfma_f32_16x16x32_bf16 v[144:147], v[212:215], v[48:51], v[20:23]
    s_mov_b32 s8, 0x3e8b97f6
    v_mfma_f32_16x16x32_bf16 v[140:143], v[212:215], v[44:47], v[60:63]
    s_waitcnt lgkmcnt(0)
    v_mfma_f32_16x16x32_bf16 v[136:139], v[208:211], v[44:47], v[56:59]
    v_cvt_pk_bf16_f32 v228, v104, v105
    v_cvt_pk_bf16_f32 v229, v106, v107
    v_cvt_pk_bf16_f32 v236, v108, v109
    v_cvt_pk_bf16_f32 v237, v110, v111
    v_cvt_pk_bf16_f32 v226, v80, v81
    v_cvt_pk_bf16_f32 v227, v82, v83
    v_cvt_pk_bf16_f32 v234, v84, v85
    v_cvt_pk_bf16_f32 v235, v86, v87
    v_max_f32 v152, v152, v156
    v_max_f32 v153, v153, v157
    v_max_f32 v154, v154, v158
    v_max_f32 v155, v155, v159
    v_max_f32 v144, v144, v148
    v_max_f32 v145, v145, v149
    v_max_f32 v146, v146, v150
    v_max_f32 v147, v147, v151
    v_max_f32 v136, v136, v140
    v_max_f32 v137, v137, v141
    v_max_f32 v138, v138, v142
    v_max_f32 v139, v139, v143
    v_max3_f32 v106, v152, v153, v154
    v_max3_f32 v105, v144, v145, v146
    v_max3_f32 v104, v136, v137, v138
    v_max_f32 v98, v106, v155
    v_max_f32 v102, v106, v155
    v_max_f32 v97, v105, v147
    v_max_f32 v101, v105, v147
    v_max_f32 v96, v104, v139
    v_max_f32 v100, v104, v139
    v_permlane32_swap_b32 v98, v102
    v_permlane32_swap_b32 v97, v101
    v_permlane32_swap_b32 v96, v100
    v_max_f32 v110, v98, v102
    v_max_f32 v98, v98, v102
    v_max_f32 v109, v97, v101
    v_max_f32 v97, v97, v101
    v_max_f32 v108, v96, v100
    v_max_f32 v96, v96, v100
    v_permlane16_swap_b32 v98, v110
    v_permlane16_swap_b32 v97, v109
    v_permlane16_swap_b32 v96, v108
    v_max_f32 v98, v98, v110
    v_max_f32 v97, v97, v109
    v_max_f32 v96, v96, v108
    v_mul_f32 v98, s8, v98
    v_mul_f32 v97, s8, v97
    v_mul_f32 v96, s8, v96
    v_fma_f32 v152, v152, s8, -v98
    v_fma_f32 v153, v153, s8, -v98
    v_fma_f32 v154, v154, s8, -v98
    v_fma_f32 v155, v155, s8, -v98
    v_fma_f32 v144, v144, s8, -v97
    v_fma_f32 v145, v145, s8, -v97
    v_fma_f32 v146, v146, s8, -v97
    v_fma_f32 v147, v147, s8, -v97
    v_fma_f32 v136, v136, s8, -v96
    v_fma_f32 v137, v137, s8, -v96
    v_fma_f32 v138, v138, s8, -v96
    v_fma_f32 v139, v139, s8, -v96
    v_exp_f32 v152, v152
    v_exp_f32 v153, v153
    v_exp_f32 v154, v154
    v_exp_f32 v155, v155
    v_exp_f32 v144, v144
    v_exp_f32 v145, v145
    v_exp_f32 v146, v146
    v_exp_f32 v147, v147
    v_exp_f32 v136, v136
    v_exp_f32 v137, v137
    v_exp_f32 v138, v138
    v_exp_f32 v139, v139
    v_pk_add_f32 v[156:157], v[152:153], v[154:155]
    v_pk_add_f32 v[148:149], v[144:145], v[146:147]
    v_pk_add_f32 v[140:141], v[136:137], v[138:139]
    v_add_f32 v106, v156, v157
    v_add_f32 v102, v156, v157
    v_add_f32 v105, v148, v149
    v_add_f32 v101, v148, v149
    v_add_f32 v104, v140, v141
    v_add_f32 v100, v140, v141
    v_permlane32_swap_b32 v106, v102
    v_permlane32_swap_b32 v105, v101
    v_permlane32_swap_b32 v104, v100
    v_add_f32 v110, v106, v102
    v_add_f32 v106, v106, v102
    v_add_f32 v109, v105, v101
    v_add_f32 v105, v105, v101
    v_add_f32 v108, v104, v100
    v_add_f32 v104, v104, v100
    v_permlane16_swap_b32 v106, v110
    v_permlane16_swap_b32 v105, v109
    v_permlane16_swap_b32 v104, v108
    v_add_f32 v106, v106, v110
    v_add_f32 v105, v105, v109
    v_add_f32 v104, v104, v108
    v_rcp_f32 v116, v106
    v_rcp_f32 v114, v105
    v_rcp_f32 v112, v104
    v_pk_mul_f32 v[152:153], v[152:153], v[116:117] op_sel_hi:[1,0]
    v_pk_mul_f32 v[154:155], v[154:155], v[116:117] op_sel_hi:[1,0]
    v_pk_mul_f32 v[144:145], v[144:145], v[114:115] op_sel_hi:[1,0]
    v_pk_mul_f32 v[146:147], v[146:147], v[114:115] op_sel_hi:[1,0]
    v_pk_mul_f32 v[136:137], v[136:137], v[112:113] op_sel_hi:[1,0]
    v_pk_mul_f32 v[138:139], v[138:139], v[112:113] op_sel_hi:[1,0]
    v_cvt_pk_bf16_f32 v156, v152, v153
    v_cvt_pk_bf16_f32 v157, v154, v155
    v_cvt_pk_bf16_f32 v148, v144, v145
    v_cvt_pk_bf16_f32 v149, v146, v147
    v_cvt_pk_bf16_f32 v140, v136, v137
    v_cvt_pk_bf16_f32 v141, v138, v139
    v_and_b32 v72, v28, v156
    v_bfi_b32 v74, v28, 0, v156
    v_and_b32 v73, v29, v157
    v_bfi_b32 v75, v29, 0, v157
    v_and_b32 v68, v28, v148
    v_bfi_b32 v70, v28, 0, v148
    v_and_b32 v69, v29, v149
    v_bfi_b32 v71, v29, 0, v149
    v_mfma_f32_16x16x32_bf16 v[176:179], v[228:231], v[72:75], 0
    v_mfma_f32_16x16x32_bf16 v[180:183], v[236:239], v[72:75], 0
    v_and_b32 v64, v28, v140
    v_bfi_b32 v66, v28, 0, v140
    v_and_b32 v65, v29, v141
    v_bfi_b32 v67, v29, 0, v141
    v_mfma_f32_16x16x32_bf16 v[168:171], v[226:229], v[68:71], 0
    v_mfma_f32_16x16x32_bf16 v[172:175], v[234:237], v[68:71], 0
    v_mfma_f32_16x16x32_bf16 v[160:163], v[224:227], v[64:67], 0
    v_mfma_f32_16x16x32_bf16 v[164:167], v[232:235], v[64:67], 0
    v_cvt_pk_bf16_f32 v192, v176, v177
    v_cvt_pk_bf16_f32 v193, v178, v179
    v_cvt_pk_bf16_f32 v194, v180, v181
    v_cvt_pk_bf16_f32 v195, v182, v183
    v_and_b32 v194, v30, v194
    v_and_b32 v195, v30, v195
    buffer_store_dwordx4 v[192:195], v19, s[20:23], 0 offen sc1
    v_cvt_pk_bf16_f32 v188, v168, v169
    v_cvt_pk_bf16_f32 v189, v170, v171
    v_cvt_pk_bf16_f32 v190, v172, v173
    v_cvt_pk_bf16_f32 v191, v174, v175
    v_and_b32 v190, v30, v190
    v_and_b32 v191, v30, v191
    buffer_store_dwordx4 v[188:191], v18, s[20:23], 0 offen sc1
    v_cvt_pk_bf16_f32 v184, v160, v161
    v_cvt_pk_bf16_f32 v185, v162, v163
    v_cvt_pk_bf16_f32 v186, v164, v165
    v_cvt_pk_bf16_f32 v187, v166, v167
    v_and_b32 v186, v30, v186
    v_and_b32 v187, v30, v187
    buffer_store_dwordx4 v[184:187], v17, s[20:23], 0 offen sc1
    s_waitcnt vmcnt(3)
    s_mov_b32 s10, 65536
L_ncA:
    v_readfirstlane_b32 s6, v251
    s_sub_u32 s10, s10, 1
    s_cselect_b32 s6, 1, s6
    s_cmp_lg_u32 s6, 0
    s_cbranch_scc1 L_ndA
    buffer_load_dwordx2 v[250:251], off, s[36:39], 0 sc1
    s_waitcnt vmcnt(0)
    s_branch L_ncA
L_ndA:
L_P2:
    s_barrier
    ds_read_b64_tr_b16 a[0:1], v241 offset:0
    ds_read_b64_tr_b16 a[2:3], v241 offset:2048
    ds_read_b64_tr_b16 a[4:5], v242 offset:0
    ds_read_b64_tr_b16 a[6:7], v242 offset:2048
    ds_read_b64_tr_b16 a[8:9], v243 offset:0
    ds_read_b64_tr_b16 a[10:11], v243 offset:2048
    ds_read_b64_tr_b16 a[12:13], v244 offset:0
    ds_read_b64_tr_b16 a[14:15], v244 offset:2048
    ds_read_b64_tr_b16 a[16:17], v243 offset:3584
    ds_read_b64_tr_b16 a[18:19], v243 offset:5632
    ds_read_b64_tr_b16 a[20:21], v244 offset:3584
    ds_read_b64_tr_b16 a[22:23], v244 offset:5632
    ds_read_b64_tr_b16 a[24:25], v241 offset:3584
    ds_read_b64_tr_b16 a[26:27], v241 offset:5632
    ds_read_b64_tr_b16 a[28:29], v242 offset:3584
    ds_read_b64_tr_b16 a[30:31], v242 offset:5632
    ds_read_b64_tr_b16 a[32:33], v241 offset:7168
    ds_read_b64_tr_b16 a[34:35], v241 offset:9216
    ds_read_b64_tr_b16 a[36:37], v242 offset:7168
    ds_read_b64_tr_b16 a[38:39], v242 offset:9216
    ds_read_b64_tr_b16 a[40:41], v243 offset:7168
    ds_read_b64_tr_b16 a[42:43], v243 offset:9216
    ds_read_b64_tr_b16 a[44:45], v244 offset:7168
    ds_read_b64_tr_b16 a[46:47], v244 offset:9216
    ds_read_b64_tr_b16 a[48:49], v243 offset:10752
    ds_read_b64_tr_b16 a[50:51], v243 offset:12800
    ds_read_b64_tr_b16 a[52:53], v244 offset:10752
    ds_read_b64_tr_b16 a[54:55], v244 offset:12800
    ds_read_b64_tr_b16 a[56:57], v241 offset:10752
    ds_read_b64_tr_b16 a[58:59], v241 offset:12800
    ds_read_b64_tr_b16 a[60:61], v242 offset:10752
    ds_read_b64_tr_b16 a[62:63], v242 offset:12800
    ds_read_b64_tr_b16 a[64:65], v241 offset:14336
    ds_read_b64_tr_b16 a[66:67], v241 offset:16384
    ds_read_b64_tr_b16 a[68:69], v242 offset:14336
    ds_read_b64_tr_b16 a[70:71], v242 offset:16384
    ds_read_b64_tr_b16 a[72:73], v243 offset:14336
    ds_read_b64_tr_b16 a[74:75], v243 offset:16384
    ds_read_b64_tr_b16 a[76:77], v244 offset:14336
    ds_read_b64_tr_b16 a[78:79], v244 offset:16384
    ds_read_b64_tr_b16 a[80:81], v243 offset:17920
    ds_read_b64_tr_b16 a[82:83], v243 offset:19968
    ds_read_b64_tr_b16 a[84:85], v244 offset:17920
    ds_read_b64_tr_b16 a[86:87], v244 offset:19968
    ds_read_b64_tr_b16 a[88:89], v241 offset:17920
    ds_read_b64_tr_b16 a[90:91], v241 offset:19968
    ds_read_b64_tr_b16 a[92:93], v242 offset:17920
    ds_read_b64_tr_b16 a[94:95], v242 offset:19968
    s_waitcnt vmcnt(0)
    buffer_store_dword v250, v248, s[20:23], 0 offen sc1
    ds_read_b64_tr_b16 a[96:97], v241 offset:21504
    ds_read_b64_tr_b16 a[98:99], v241 offset:23552
    ds_read_b64_tr_b16 a[100:101], v242 offset:21504
    ds_read_b64_tr_b16 a[102:103], v242 offset:23552
    ds_read_b64_tr_b16 a[104:105], v243 offset:21504
    ds_read_b64_tr_b16 a[106:107], v243 offset:23552
    ds_read_b64_tr_b16 a[108:109], v244 offset:21504
    ds_read_b64_tr_b16 a[110:111], v244 offset:23552
    ds_read_b64_tr_b16 a[112:113], v243 offset:25088
    ds_read_b64_tr_b16 a[114:115], v243 offset:27136
    ds_read_b64_tr_b16 a[116:117], v244 offset:25088
    ds_read_b64_tr_b16 a[118:119], v244 offset:27136
    ds_read_b64_tr_b16 a[120:121], v241 offset:25088
    ds_read_b64_tr_b16 a[122:123], v241 offset:27136
    ds_read_b64_tr_b16 a[124:125], v242 offset:25088
    ds_read_b64_tr_b16 a[126:127], v242 offset:27136
    ds_read_b64_tr_b16 a[128:129], v241 offset:28672
    ds_read_b64_tr_b16 a[130:131], v241 offset:30720
    ds_read_b64_tr_b16 a[132:133], v242 offset:28672
    ds_read_b64_tr_b16 a[134:135], v242 offset:30720
    ds_read_b64_tr_b16 a[136:137], v243 offset:28672
    ds_read_b64_tr_b16 a[138:139], v243 offset:30720
    ds_read_b64_tr_b16 a[140:141], v244 offset:28672
    ds_read_b64_tr_b16 a[142:143], v244 offset:30720
    ds_read_b64_tr_b16 a[144:145], v243 offset:32256
    ds_read_b64_tr_b16 a[146:147], v243 offset:34304
    ds_read_b64_tr_b16 a[148:149], v244 offset:32256
    ds_read_b64_tr_b16 a[150:151], v244 offset:34304
    ds_read_b64_tr_b16 a[152:153], v241 offset:32256
    ds_read_b64_tr_b16 a[154:155], v241 offset:34304
    ds_read_b64_tr_b16 a[156:157], v242 offset:32256
    ds_read_b64_tr_b16 a[158:159], v242 offset:34304
    ds_read_b64_tr_b16 a[160:161], v241 offset:35840
    ds_read_b64_tr_b16 a[162:163], v241 offset:37888
    ds_read_b64_tr_b16 a[164:165], v242 offset:35840
    ds_read_b64_tr_b16 a[166:167], v242 offset:37888
    ds_read_b64_tr_b16 a[168:169], v243 offset:35840
    ds_read_b64_tr_b16 a[170:171], v243 offset:37888
    ds_read_b64_tr_b16 a[172:173], v244 offset:35840
    ds_read_b64_tr_b16 a[174:175], v244 offset:37888
    ds_read_b64_tr_b16 a[176:177], v243 offset:39424
    ds_read_b64_tr_b16 a[178:179], v243 offset:41472
    ds_read_b64_tr_b16 a[180:181], v244 offset:39424
    ds_read_b64_tr_b16 a[182:183], v244 offset:41472
    ds_read_b64_tr_b16 a[184:185], v241 offset:39424
    ds_read_b64_tr_b16 a[186:187], v241 offset:41472
    ds_read_b64_tr_b16 a[188:189], v242 offset:39424
    ds_read_b64_tr_b16 a[190:191], v242 offset:41472
    ds_read_b64_tr_b16 a[192:193], v241 offset:43008
    ds_read_b64_tr_b16 a[194:195], v241 offset:45056
    ds_read_b64_tr_b16 a[196:197], v242 offset:43008
    ds_read_b64_tr_b16 a[198:199], v242 offset:45056
    ds_read_b64_tr_b16 a[200:201], v243 offset:43008
    ds_read_b64_tr_b16 a[202:203], v243 offset:45056
    ds_read_b64_tr_b16 a[204:205], v244 offset:43008
    ds_read_b64_tr_b16 a[206:207], v244 offset:45056
    ds_read_b64_tr_b16 a[208:209], v243 offset:46592
    ds_read_b64_tr_b16 a[210:211], v243 offset:48640
    ds_read_b64_tr_b16 a[212:213], v244 offset:46592
    ds_read_b64_tr_b16 a[214:215], v244 offset:48640
    ds_read_b64_tr_b16 a[216:217], v241 offset:46592
    ds_read_b64_tr_b16 a[218:219], v241 offset:48640
    ds_read_b64_tr_b16 a[220:221], v242 offset:46592
    ds_read_b64_tr_b16 a[222:223], v242 offset:48640
    ds_read_b64_tr_b16 a[224:225], v241 offset:50176
    ds_read_b64_tr_b16 a[226:227], v241 offset:52224
    ds_read_b64_tr_b16 a[228:229], v242 offset:50176
    ds_read_b64_tr_b16 a[230:231], v242 offset:52224
    ds_read_b64_tr_b16 a[232:233], v243 offset:50176
    ds_read_b64_tr_b16 a[234:235], v243 offset:52224
    ds_read_b64_tr_b16 a[236:237], v244 offset:50176
    ds_read_b64_tr_b16 a[238:239], v244 offset:52224
    ds_read_b64_tr_b16 a[240:241], v243 offset:53760
    ds_read_b64_tr_b16 a[242:243], v243 offset:55808
    ds_read_b64_tr_b16 a[244:245], v244 offset:53760
    ds_read_b64_tr_b16 a[246:247], v244 offset:55808
    ds_read_b64_tr_b16 a[248:249], v241 offset:53760
    ds_read_b64_tr_b16 a[250:251], v241 offset:55808
    ds_read_b64_tr_b16 a[252:253], v242 offset:53760
    ds_read_b64_tr_b16 a[254:255], v242 offset:55808
    s_mov_b32 s10, 65536
L_plP:
    buffer_load_dword v32, v246, s[20:23], 0 offen sc1
    s_sub_u32 s10, s10, 1
    s_cbranch_scc1 L_pdP
    s_waitcnt vmcnt(0)
    v_cmp_ne_u32 vcc, v32, v250
    s_cbranch_vccnz L_plP
L_pdP:
    s_lshl_b32 s6, s41, 11
    s_and_b32 s7, s6, 0x3fff
    s_add_u32 s6, s6, 1024
    buffer_load_dwordx4 v[64:67], v245, s[20:23], s7 offen sc1
    s_and_b32 s7, s6, 0x3fff
    s_add_u32 s6, s6, 1024
    buffer_load_dwordx4 v[68:71], v245, s[20:23], s7 offen sc1
    s_and_b32 s7, s6, 0x3fff
    s_add_u32 s6, s6, 1024
    buffer_load_dwordx4 v[72:75], v245, s[20:23], s7 offen sc1
    s_and_b32 s7, s6, 0x3fff
    s_add_u32 s6, s6, 1024
    buffer_load_dwordx4 v[76:79], v245, s[20:23], s7 offen sc1
    s_and_b32 s7, s6, 0x3fff
    s_add_u32 s6, s6, 1024
    buffer_load_dwordx4 v[80:83], v245, s[20:23], s7 offen sc1
    s_and_b32 s7, s6, 0x3fff
    s_add_u32 s6, s6, 1024
    buffer_load_dwordx4 v[84:87], v245, s[20:23], s7 offen sc1
    s_and_b32 s7, s6, 0x3fff
    s_add_u32 s6, s6, 1024
    buffer_load_dwordx4 v[88:91], v245, s[20:23], s7 offen sc1
    s_and_b32 s7, s6, 0x3fff
    s_add_u32 s6, s6, 1024
    buffer_load_dwordx4 v[92:95], v245, s[20:23], s7 offen sc1
    s_and_b32 s7, s6, 0x3fff
    s_add_u32 s6, s6, 1024
    buffer_load_dwordx4 v[96:99], v245, s[20:23], s7 offen sc1
    s_and_b32 s7, s6, 0x3fff
    s_add_u32 s6, s6, 1024
    buffer_load_dwordx4 v[100:103], v245, s[20:23], s7 offen sc1
    s_and_b32 s7, s6, 0x3fff
    s_add_u32 s6, s6, 1024
    buffer_load_dwordx4 v[104:107], v245, s[20:23], s7 offen sc1
    s_and_b32 s7, s6, 0x3fff
    s_add_u32 s6, s6, 1024
    buffer_load_dwordx4 v[108:111], v245, s[20:23], s7 offen sc1
    s_and_b32 s7, s6, 0x3fff
    s_add_u32 s6, s6, 1024
    buffer_load_dwordx4 v[112:115], v245, s[20:23], s7 offen sc1
    s_and_b32 s7, s6, 0x3fff
    s_add_u32 s6, s6, 1024
    buffer_load_dwordx4 v[116:119], v245, s[20:23], s7 offen sc1
    s_and_b32 s7, s6, 0x3fff
    s_add_u32 s6, s6, 1024
    buffer_load_dwordx4 v[120:123], v245, s[20:23], s7 offen sc1
    s_and_b32 s7, s6, 0x3fff
    s_add_u32 s6, s6, 1024
    buffer_load_dwordx4 v[124:127], v245, s[20:23], s7 offen sc1
    s_waitcnt lgkmcnt(0)
    s_waitcnt vmcnt(15)
    v_mfma_f32_16x16x32_bf16 v[32:35], a[0:3], v[64:67], 0
    v_mfma_f32_16x16x32_bf16 v[36:39], a[4:7], v[64:67], 0
    v_mfma_f32_16x16x32_bf16 v[40:43], a[8:11], v[64:67], 0
    v_mfma_f32_16x16x32_bf16 v[44:47], a[12:15], v[64:67], 0
    s_waitcnt vmcnt(14)
    v_mfma_f32_16x16x32_bf16 v[32:35], a[16:19], v[68:71], v[32:35]
    v_mfma_f32_16x16x32_bf16 v[36:39], a[20:23], v[68:71], v[36:39]
    v_mfma_f32_16x16x32_bf16 v[40:43], a[24:27], v[68:71], v[40:43]
    v_mfma_f32_16x16x32_bf16 v[44:47], a[28:31], v[68:71], v[44:47]
    s_waitcnt vmcnt(13)
    v_mfma_f32_16x16x32_bf16 v[32:35], a[32:35], v[72:75], v[32:35]
    v_mfma_f32_16x16x32_bf16 v[36:39], a[36:39], v[72:75], v[36:39]
    v_mfma_f32_16x16x32_bf16 v[40:43], a[40:43], v[72:75], v[40:43]
    v_mfma_f32_16x16x32_bf16 v[44:47], a[44:47], v[72:75], v[44:47]
    s_waitcnt vmcnt(12)
    v_mfma_f32_16x16x32_bf16 v[32:35], a[48:51], v[76:79], v[32:35]
    v_mfma_f32_16x16x32_bf16 v[36:39], a[52:55], v[76:79], v[36:39]
    v_mfma_f32_16x16x32_bf16 v[40:43], a[56:59], v[76:79], v[40:43]
    v_mfma_f32_16x16x32_bf16 v[44:47], a[60:63], v[76:79], v[44:47]
    s_waitcnt vmcnt(11)
    v_mfma_f32_16x16x32_bf16 v[32:35], a[64:67], v[80:83], v[32:35]
    v_mfma_f32_16x16x32_bf16 v[36:39], a[68:71], v[80:83], v[36:39]
    v_mfma_f32_16x16x32_bf16 v[40:43], a[72:75], v[80:83], v[40:43]
    v_mfma_f32_16x16x32_bf16 v[44:47], a[76:79], v[80:83], v[44:47]
    s_waitcnt vmcnt(10)
    v_mfma_f32_16x16x32_bf16 v[32:35], a[80:83], v[84:87], v[32:35]
    v_mfma_f32_16x16x32_bf16 v[36:39], a[84:87], v[84:87], v[36:39]
    v_mfma_f32_16x16x32_bf16 v[40:43], a[88:91], v[84:87], v[40:43]
    v_mfma_f32_16x16x32_bf16 v[44:47], a[92:95], v[84:87], v[44:47]
    s_waitcnt vmcnt(9)
    v_mfma_f32_16x16x32_bf16 v[32:35], a[96:99], v[88:91], v[32:35]
    v_mfma_f32_16x16x32_bf16 v[36:39], a[100:103], v[88:91], v[36:39]
    v_mfma_f32_16x16x32_bf16 v[40:43], a[104:107], v[88:91], v[40:43]
    v_mfma_f32_16x16x32_bf16 v[44:47], a[108:111], v[88:91], v[44:47]
    s_waitcnt vmcnt(8)
    v_mfma_f32_16x16x32_bf16 v[32:35], a[112:115], v[92:95], v[32:35]
    v_mfma_f32_16x16x32_bf16 v[36:39], a[116:119], v[92:95], v[36:39]
    v_mfma_f32_16x16x32_bf16 v[40:43], a[120:123], v[92:95], v[40:43]
    v_mfma_f32_16x16x32_bf16 v[44:47], a[124:127], v[92:95], v[44:47]
    s_waitcnt vmcnt(7)
    v_mfma_f32_16x16x32_bf16 v[32:35], a[128:131], v[96:99], v[32:35]
    v_mfma_f32_16x16x32_bf16 v[36:39], a[132:135], v[96:99], v[36:39]
    v_mfma_f32_16x16x32_bf16 v[40:43], a[136:139], v[96:99], v[40:43]
    v_mfma_f32_16x16x32_bf16 v[44:47], a[140:143], v[96:99], v[44:47]
    s_waitcnt vmcnt(6)
    v_mfma_f32_16x16x32_bf16 v[32:35], a[144:147], v[100:103], v[32:35]
    v_mfma_f32_16x16x32_bf16 v[36:39], a[148:151], v[100:103], v[36:39]
    v_mfma_f32_16x16x32_bf16 v[40:43], a[152:155], v[100:103], v[40:43]
    v_mfma_f32_16x16x32_bf16 v[44:47], a[156:159], v[100:103], v[44:47]
    s_waitcnt vmcnt(5)
    v_mfma_f32_16x16x32_bf16 v[32:35], a[160:163], v[104:107], v[32:35]
    v_mfma_f32_16x16x32_bf16 v[36:39], a[164:167], v[104:107], v[36:39]
    v_mfma_f32_16x16x32_bf16 v[40:43], a[168:171], v[104:107], v[40:43]
    v_mfma_f32_16x16x32_bf16 v[44:47], a[172:175], v[104:107], v[44:47]
    s_waitcnt vmcnt(4)
    v_mfma_f32_16x16x32_bf16 v[32:35], a[176:179], v[108:111], v[32:35]
    v_mfma_f32_16x16x32_bf16 v[36:39], a[180:183], v[108:111], v[36:39]
    v_mfma_f32_16x16x32_bf16 v[40:43], a[184:187], v[108:111], v[40:43]
    v_mfma_f32_16x16x32_bf16 v[44:47], a[188:191], v[108:111], v[44:47]
    s_waitcnt vmcnt(3)
    v_mfma_f32_16x16x32_bf16 v[32:35], a[192:195], v[112:115], v[32:35]
    v_mfma_f32_16x16x32_bf16 v[36:39], a[196:199], v[112:115], v[36:39]
    v_mfma_f32_16x16x32_bf16 v[40:43], a[200:203], v[112:115], v[40:43]
    v_mfma_f32_16x16x32_bf16 v[44:47], a[204:207], v[112:115], v[44:47]
    s_waitcnt vmcnt(2)
    v_mfma_f32_16x16x32_bf16 v[32:35], a[208:211], v[116:119], v[32:35]
    v_mfma_f32_16x16x32_bf16 v[36:39], a[212:215], v[116:119], v[36:39]
    v_mfma_f32_16x16x32_bf16 v[40:43], a[216:219], v[116:119], v[40:43]
    v_mfma_f32_16x16x32_bf16 v[44:47], a[220:223], v[116:119], v[44:47]
    s_waitcnt vmcnt(1)
    v_mfma_f32_16x16x32_bf16 v[32:35], a[224:227], v[120:123], v[32:35]
    v_mfma_f32_16x16x32_bf16 v[36:39], a[228:231], v[120:123], v[36:39]
    v_mfma_f32_16x16x32_bf16 v[40:43], a[232:235], v[120:123], v[40:43]
    v_mfma_f32_16x16x32_bf16 v[44:47], a[236:239], v[120:123], v[44:47]
    s_waitcnt vmcnt(0)
    v_mfma_f32_16x16x32_bf16 v[32:35], a[240:243], v[124:127], v[32:35]
    v_mfma_f32_16x16x32_bf16 v[36:39], a[244:247], v[124:127], v[36:39]
    v_mfma_f32_16x16x32_bf16 v[40:43], a[248:251], v[124:127], v[40:43]
    v_mfma_f32_16x16x32_bf16 v[44:47], a[252:255], v[124:127], v[44:47]
    s_nop 4
    v_cvt_pk_bf16_f32 v48, v32, v33
    v_cvt_pk_bf16_f32 v49, v34, v35
    v_cvt_pk_bf16_f32 v50, v36, v37
    v_cvt_pk_bf16_f32 v51, v38, v39
    v_cvt_pk_bf16_f32 v52, v40, v41
    v_cvt_pk_bf16_f32 v53, v42, v43
    v_cvt_pk_bf16_f32 v54, v44, v45
    v_cvt_pk_bf16_f32 v55, v46, v47
    v_permlane16_swap_b32 v48, v50
    v_permlane16_swap_b32 v49, v51
    buffer_store_dwordx4 v[48:51], v247, s[28:31], 0 offen offset:0 sc1
    v_permlane16_swap_b32 v52, v54
    v_permlane16_swap_b32 v53, v55
    buffer_store_dwordx4 v[52:55], v247, s[28:31], 0 offen offset:64 sc1
    s_endpgm
L_B:
    s_mov_b32 s34, 0x1c0000
    s_mov_b32 s35, 0x20000
    s_mov_b32 s14, 0x1c0000
    s_mov_b32 s15, 0x20000
    s_mov_b32 s18, 0x126000
    s_mov_b32 s19, 0x20000
    s_and_b32 s6, s2, 7
    s_lshl3_add_u32 s46, s6, s40
    s_sub_u32 s46, s46, 24
    s_lshl_b32 s6, s3, 9
    s_add_u32 s6, s6, s46
    s_mul_i32 s6, s6, 896
    v_mul_u32_u24 v2, 64*896, v252
    v_add_u32 v2, s6, v2
    v_lshlrev_b32 v3, 4, v253
    v_sub_u32 v4, v2, v3
    v_add_u32 v4, 432, v4
    v_add_u32 v2, v2, v3
    v_subrev_u32 v5, 1, v253
    v_cmp_gt_u32 vcc, 14, v253
    v_cmp_gt_u32 s[58:59], 14, v5
    v_mov_b32 v8, 0x40000000
    s_mov_b32 s7, 229376
    v_cndmask_b32 v2, v8, v2, vcc
    v_cndmask_b32 v3, v8, v4, vcc
    v_cndmask_b32 v4, v8, v4, s[58:59]
    s_waitcnt lgkmcnt(0)
    buffer_load_dwordx4 v[192:195], v2, s[32:35], 0 offen nt
    buffer_load_dwordx4 v[200:203], v3, s[32:35], 0 offen nt
    buffer_load_dwordx4 v[196:199], v2, s[32:35], 0 offen offset:448 nt
    buffer_load_dwordx4 v[204:207], v3, s[32:35], 0 offen offset:448 nt
    buffer_load_ushort v208, v4, s[32:35], 0 offen offset:16 nt
    buffer_load_ushort v209, v4, s[32:35], 0 offen offset:464 nt
    buffer_load_dwordx4 v[212:215], v2, s[32:35], s7 offen nt
    buffer_load_dwordx4 v[220:223], v3, s[32:35], s7 offen nt
    buffer_load_dwordx4 v[216:219], v2, s[32:35], s7 offen offset:448 nt
    buffer_load_dwordx4 v[224:227], v3, s[32:35], s7 offen offset:448 nt
    buffer_load_ushort v228, v4, s[32:35], s7 offen offset:16 nt
    buffer_load_ushort v229, v4, s[32:35], s7 offen offset:464 nt
    s_add_u32 s4, s20, 4210688
    s_addc_u32 s5, s21, 0
    s_load_dword s57, s[4:5], 0
    s_sub_u32 s6, s40, 24
    s_lshl2_add_u32 s47, s6, s3
    s_mul_i32 s6, s47, 17
    v_add_u32 v5, s6, v1
    s_and_b32 s6, s2, 4
    s_lshl_b32 s6, s6, 8
    s_bfe_u32 s8, s2, 0x10001
    s_add_u32 s6, s6, s8
    s_sub_u32 s6, s6, 16
    v_lshl_add_u32 v6, v5, 1, s6
    v_max_i32 v6, s8, v6
    v_mul_u32_u24 v6, 896, v6
    v_cmp_gt_u32 vcc, 520, v5
    v_mul_u32_u24 v7, 43, v1
    v_lshrrev_b32 v7, 9, v7
    v_cndmask_b32 v6, v8, v6, vcc
    v_mul_u32_u24 v9, 12, v7
    v_sub_u32 v9, v1, v9
    s_lshl_b32 s6, s47, 1
    v_add_u32 v7, s6, v7
    v_mul_u32_u24 v7, 2688, v7
    v_lshrrev_b32 v10, 2, v9
    v_mul_u32_u24 v10, 384, v10
    v_lshl_add_u32 v9, v9, 7, v10
    s_and_b32 s6, s2, 1
    s_mul_i32 s6, s6, 384
    v_add3_u32 v7, v7, v9, s6
    s_mov_b64 exec, 0x1ffff
    s_mov_b32 s6, 344064
    buffer_load_dword v255, v6, s[12:15], 0 offen offset:256 nt
    s_mov_b64 exec, 0xffffff
    buffer_load_dword v255, v7, s[16:19], s6 offen
    s_mov_b64 exec, -1
    s_lshl_b32 s6, s3, 6
    v_lshl_add_u32 v11, v253, 1, s6
    v_cvt_f32_u32 v11, v11
    v_lshlrev_b32 v12, 5, v252
    v_cvt_f32_u32 v12, v12
    v_add_f32 v13, 0x00000000, v11
    v_mul_f32 v13, 0x3b124925, v13
    v_mul_f32 v32, v12, v13
    v_add_f32 v14, v13, v13
    v_fract_f32 v32, v32
    v_cos_f32 v16, v14
    v_add_f32 v33, v32, v13
    v_add_f32 v34, v32, v14
    v_add_f32 v35, v33, v14
    v_add_f32 v16, v16, v16
    v_cos_f32 v36, v32
    v_cos_f32 v37, v33
    v_cos_f32 v38, v34
    v_cos_f32 v39, v35
    v_sin_f32 v40, v32
    v_sin_f32 v41, v33
    v_sin_f32 v42, v34
    v_sin_f32 v43, v35
    v_cvt_pk_bf16_f32 v64, v36, v37
    v_cvt_pk_bf16_f32 v80, v40, v41
    v_pk_fma_f32 v[36:37], v[16:17], v[38:39], v[36:37] op_sel_hi:[0,1,1] neg_lo:[0,0,1] neg_hi:[0,0,1]
    v_pk_fma_f32 v[40:41], v[16:17], v[42:43], v[40:41] op_sel_hi:[0,1,1] neg_lo:[0,0,1] neg_hi:[0,0,1]
    v_cvt_pk_bf16_f32 v65, v38, v39
    v_cvt_pk_bf16_f32 v81, v42, v43
    v_pk_fma_f32 v[38:39], v[16:17], v[36:37], v[38:39] op_sel_hi:[0,1,1] neg_lo:[0,0,1] neg_hi:[0,0,1]
    v_pk_fma_f32 v[42:43], v[16:17], v[40:41], v[42:43] op_sel_hi:[0,1,1] neg_lo:[0,0,1] neg_hi:[0,0,1]
    v_cvt_pk_bf16_f32 v66, v36, v37
    v_cvt_pk_bf16_f32 v82, v40, v41
    v_pk_fma_f32 v[36:37], v[16:17], v[38:39], v[36:37] op_sel_hi:[0,1,1] neg_lo:[0,0,1] neg_hi:[0,0,1]
    v_pk_fma_f32 v[40:41], v[16:17], v[42:43], v[40:41] op_sel_hi:[0,1,1] neg_lo:[0,0,1] neg_hi:[0,0,1]
    v_cvt_pk_bf16_f32 v67, v38, v39
    v_cvt_pk_bf16_f32 v83, v42, v43
    v_pk_fma_f32 v[38:39], v[16:17], v[36:37], v[38:39] op_sel_hi:[0,1,1] neg_lo:[0,0,1] neg_hi:[0,0,1]
    v_pk_fma_f32 v[42:43], v[16:17], v[40:41], v[42:43] op_sel_hi:[0,1,1] neg_lo:[0,0,1] neg_hi:[0,0,1]
    v_cvt_pk_bf16_f32 v68, v36, v37
    v_cvt_pk_bf16_f32 v84, v40, v41
    v_pk_fma_f32 v[36:37], v[16:17], v[38:39], v[36:37] op_sel_hi:[0,1,1] neg_lo:[0,0,1] neg_hi:[0,0,1]
    v_pk_fma_f32 v[40:41], v[16:17], v[42:43], v[40:41] op_sel_hi:[0,1,1] neg_lo:[0,0,1] neg_hi:[0,0,1]
    v_cvt_pk_bf16_f32 v69, v38, v39
    v_cvt_pk_bf16_f32 v85, v42, v43
    v_pk_fma_f32 v[38:39], v[16:17], v[36:37], v[38:39] op_sel_hi:[0,1,1] neg_lo:[0,0,1] neg_hi:[0,0,1]
    v_pk_fma_f32 v[42:43], v[16:17], v[40:41], v[42:43] op_sel_hi:[0,1,1] neg_lo:[0,0,1] neg_hi:[0,0,1]
    v_cvt_pk_bf16_f32 v70, v36, v37
    v_cvt_pk_bf16_f32 v86, v40, v41
    v_pk_fma_f32 v[36:37], v[16:17], v[38:39], v[36:37] op_sel_hi:[0,1,1] neg_lo:[0,0,1] neg_hi:[0,0,1]
    v_pk_fma_f32 v[40:41], v[16:17], v[42:43], v[40:41] op_sel_hi:[0,1,1] neg_lo:[0,0,1] neg_hi:[0,0,1]
    v_cvt_pk_bf16_f32 v71, v38, v39
    v_cvt_pk_bf16_f32 v87, v42, v43
    v_pk_fma_f32 v[38:39], v[16:17], v[36:37], v[38:39] op_sel_hi:[0,1,1] neg_lo:[0,0,1] neg_hi:[0,0,1]
    v_pk_fma_f32 v[42:43], v[16:17], v[40:41], v[42:43] op_sel_hi:[0,1,1] neg_lo:[0,0,1] neg_hi:[0,0,1]
    v_cvt_pk_bf16_f32 v72, v36, v37
    v_cvt_pk_bf16_f32 v88, v40, v41
    v_pk_fma_f32 v[36:37], v[16:17], v[38:39], v[36:37] op_sel_hi:[0,1,1] neg_lo:[0,0,1] neg_hi:[0,0,1]
    v_pk_fma_f32 v[40:41], v[16:17], v[42:43], v[40:41] op_sel_hi:[0,1,1] neg_lo:[0,0,1] neg_hi:[0,0,1]
    v_cvt_pk_bf16_f32 v73, v38, v39
    v_cvt_pk_bf16_f32 v89, v42, v43
    v_pk_fma_f32 v[38:39], v[16:17], v[36:37], v[38:39] op_sel_hi:[0,1,1] neg_lo:[0,0,1] neg_hi:[0,0,1]
    v_pk_fma_f32 v[42:43], v[16:17], v[40:41], v[42:43] op_sel_hi:[0,1,1] neg_lo:[0,0,1] neg_hi:[0,0,1]
    v_cvt_pk_bf16_f32 v74, v36, v37
    v_cvt_pk_bf16_f32 v90, v40, v41
    v_pk_fma_f32 v[36:37], v[16:17], v[38:39], v[36:37] op_sel_hi:[0,1,1] neg_lo:[0,0,1] neg_hi:[0,0,1]
    v_pk_fma_f32 v[40:41], v[16:17], v[42:43], v[40:41] op_sel_hi:[0,1,1] neg_lo:[0,0,1] neg_hi:[0,0,1]
    v_cvt_pk_bf16_f32 v75, v38, v39
    v_cvt_pk_bf16_f32 v91, v42, v43
    v_pk_fma_f32 v[38:39], v[16:17], v[36:37], v[38:39] op_sel_hi:[0,1,1] neg_lo:[0,0,1] neg_hi:[0,0,1]
    v_pk_fma_f32 v[42:43], v[16:17], v[40:41], v[42:43] op_sel_hi:[0,1,1] neg_lo:[0,0,1] neg_hi:[0,0,1]
    v_cvt_pk_bf16_f32 v76, v36, v37
    v_cvt_pk_bf16_f32 v92, v40, v41
    v_pk_fma_f32 v[36:37], v[16:17], v[38:39], v[36:37] op_sel_hi:[0,1,1] neg_lo:[0,0,1] neg_hi:[0,0,1]
    v_pk_fma_f32 v[40:41], v[16:17], v[42:43], v[40:41] op_sel_hi:[0,1,1] neg_lo:[0,0,1] neg_hi:[0,0,1]
    v_cvt_pk_bf16_f32 v77, v38, v39
    v_cvt_pk_bf16_f32 v93, v42, v43
    v_pk_fma_f32 v[38:39], v[16:17], v[36:37], v[38:39] op_sel_hi:[0,1,1] neg_lo:[0,0,1] neg_hi:[0,0,1]
    v_pk_fma_f32 v[42:43], v[16:17], v[40:41], v[42:43] op_sel_hi:[0,1,1] neg_lo:[0,0,1] neg_hi:[0,0,1]
    v_cvt_pk_bf16_f32 v78, v36, v37
    v_cvt_pk_bf16_f32 v94, v40, v41
    v_cvt_pk_bf16_f32 v79, v38, v39
    v_cvt_pk_bf16_f32 v95, v42, v43
    s_mov_b64 exec, 0x1ffff
    s_mov_b32 s6, 516096
    buffer_load_dword v255, v6, s[12:15], 0 offen offset:384 nt
    s_mov_b64 exec, 0xffffff
    buffer_load_dword v255, v7, s[16:19], s6 offen
    s_mov_b64 exec, -1
    v_add_f32 v13, 0x3f800000, v11
    v_mul_f32 v13, 0x3b124925, v13
    v_mul_f32 v32, v12, v13
    v_add_f32 v14, v13, v13
    v_fract_f32 v32, v32
    v_cos_f32 v16, v14
    v_add_f32 v33, v32, v13
    v_add_f32 v34, v32, v14
    v_add_f32 v35, v33, v14
    v_add_f32 v16, v16, v16
    v_cos_f32 v36, v32
    v_cos_f32 v37, v33
    v_cos_f32 v38, v34
    v_cos_f32 v39, v35
    v_sin_f32 v40, v32
    v_sin_f32 v41, v33
    v_sin_f32 v42, v34
    v_sin_f32 v43, v35
    v_cvt_pk_bf16_f32 v96, v36, v37
    v_cvt_pk_bf16_f32 v112, v40, v41
    v_pk_fma_f32 v[36:37], v[16:17], v[38:39], v[36:37] op_sel_hi:[0,1,1] neg_lo:[0,0,1] neg_hi:[0,0,1]
    v_pk_fma_f32 v[40:41], v[16:17], v[42:43], v[40:41] op_sel_hi:[0,1,1] neg_lo:[0,0,1] neg_hi:[0,0,1]
    v_cvt_pk_bf16_f32 v97, v38, v39
    v_cvt_pk_bf16_f32 v113, v42, v43
    v_pk_fma_f32 v[38:39], v[16:17], v[36:37], v[38:39] op_sel_hi:[0,1,1] neg_lo:[0,0,1] neg_hi:[0,0,1]
    v_pk_fma_f32 v[42:43], v[16:17], v[40:41], v[42:43] op_sel_hi:[0,1,1] neg_lo:[0,0,1] neg_hi:[0,0,1]
    v_cvt_pk_bf16_f32 v98, v36, v37
    v_cvt_pk_bf16_f32 v114, v40, v41
    v_pk_fma_f32 v[36:37], v[16:17], v[38:39], v[36:37] op_sel_hi:[0,1,1] neg_lo:[0,0,1] neg_hi:[0,0,1]
    v_pk_fma_f32 v[40:41], v[16:17], v[42:43], v[40:41] op_sel_hi:[0,1,1] neg_lo:[0,0,1] neg_hi:[0,0,1]
    v_cvt_pk_bf16_f32 v99, v38, v39
    v_cvt_pk_bf16_f32 v115, v42, v43
    v_pk_fma_f32 v[38:39], v[16:17], v[36:37], v[38:39] op_sel_hi:[0,1,1] neg_lo:[0,0,1] neg_hi:[0,0,1]
    v_pk_fma_f32 v[42:43], v[16:17], v[40:41], v[42:43] op_sel_hi:[0,1,1] neg_lo:[0,0,1] neg_hi:[0,0,1]
    v_cvt_pk_bf16_f32 v100, v36, v37
    v_cvt_pk_bf16_f32 v116, v40, v41
    v_pk_fma_f32 v[36:37], v[16:17], v[38:39], v[36:37] op_sel_hi:[0,1,1] neg_lo:[0,0,1] neg_hi:[0,0,1]
    v_pk_fma_f32 v[40:41], v[16:17], v[42:43], v[40:41] op_sel_hi:[0,1,1] neg_lo:[0,0,1] neg_hi:[0,0,1]
    v_cvt_pk_bf16_f32 v101, v38, v39
    v_cvt_pk_bf16_f32 v117, v42, v43
    v_pk_fma_f32 v[38:39], v[16:17], v[36:37], v[38:39] op_sel_hi:[0,1,1] neg_lo:[0,0,1] neg_hi:[0,0,1]
    v_pk_fma_f32 v[42:43], v[16:17], v[40:41], v[42:43] op_sel_hi:[0,1,1] neg_lo:[0,0,1] neg_hi:[0,0,1]
    v_cvt_pk_bf16_f32 v102, v36, v37
    v_cvt_pk_bf16_f32 v118, v40, v41
    v_pk_fma_f32 v[36:37], v[16:17], v[38:39], v[36:37] op_sel_hi:[0,1,1] neg_lo:[0,0,1] neg_hi:[0,0,1]
    v_pk_fma_f32 v[40:41], v[16:17], v[42:43], v[40:41] op_sel_hi:[0,1,1] neg_lo:[0,0,1] neg_hi:[0,0,1]
    v_cvt_pk_bf16_f32 v103, v38, v39
    v_cvt_pk_bf16_f32 v119, v42, v43
    v_pk_fma_f32 v[38:39], v[16:17], v[36:37], v[38:39] op_sel_hi:[0,1,1] neg_lo:[0,0,1] neg_hi:[0,0,1]
    v_pk_fma_f32 v[42:43], v[16:17], v[40:41], v[42:43] op_sel_hi:[0,1,1] neg_lo:[0,0,1] neg_hi:[0,0,1]
    v_cvt_pk_bf16_f32 v104, v36, v37
    v_cvt_pk_bf16_f32 v120, v40, v41
    v_pk_fma_f32 v[36:37], v[16:17], v[38:39], v[36:37] op_sel_hi:[0,1,1] neg_lo:[0,0,1] neg_hi:[0,0,1]
    v_pk_fma_f32 v[40:41], v[16:17], v[42:43], v[40:41] op_sel_hi:[0,1,1] neg_lo:[0,0,1] neg_hi:[0,0,1]
    v_cvt_pk_bf16_f32 v105, v38, v39
    v_cvt_pk_bf16_f32 v121, v42, v43
    v_pk_fma_f32 v[38:39], v[16:17], v[36:37], v[38:39] op_sel_hi:[0,1,1] neg_lo:[0,0,1] neg_hi:[0,0,1]
    v_pk_fma_f32 v[42:43], v[16:17], v[40:41], v[42:43] op_sel_hi:[0,1,1] neg_lo:[0,0,1] neg_hi:[0,0,1]
    v_cvt_pk_bf16_f32 v106, v36, v37
    v_cvt_pk_bf16_f32 v122, v40, v41
    v_pk_fma_f32 v[36:37], v[16:17], v[38:39], v[36:37] op_sel_hi:[0,1,1] neg_lo:[0,0,1] neg_hi:[0,0,1]
    v_pk_fma_f32 v[40:41], v[16:17], v[42:43], v[40:41] op_sel_hi:[0,1,1] neg_lo:[0,0,1] neg_hi:[0,0,1]
    v_cvt_pk_bf16_f32 v107, v38, v39
    v_cvt_pk_bf16_f32 v123, v42, v43
    v_pk_fma_f32 v[38:39], v[16:17], v[36:37], v[38:39] op_sel_hi:[0,1,1] neg_lo:[0,0,1] neg_hi:[0,0,1]
    v_pk_fma_f32 v[42:43], v[16:17], v[40:41], v[42:43] op_sel_hi:[0,1,1] neg_lo:[0,0,1] neg_hi:[0,0,1]
    v_cvt_pk_bf16_f32 v108, v36, v37
    v_cvt_pk_bf16_f32 v124, v40, v41
    v_pk_fma_f32 v[36:37], v[16:17], v[38:39], v[36:37] op_sel_hi:[0,1,1] neg_lo:[0,0,1] neg_hi:[0,0,1]
    v_pk_fma_f32 v[40:41], v[16:17], v[42:43], v[40:41] op_sel_hi:[0,1,1] neg_lo:[0,0,1] neg_hi:[0,0,1]
    v_cvt_pk_bf16_f32 v109, v38, v39
    v_cvt_pk_bf16_f32 v125, v42, v43
    v_pk_fma_f32 v[38:39], v[16:17], v[36:37], v[38:39] op_sel_hi:[0,1,1] neg_lo:[0,0,1] neg_hi:[0,0,1]
    v_pk_fma_f32 v[42:43], v[16:17], v[40:41], v[42:43] op_sel_hi:[0,1,1] neg_lo:[0,0,1] neg_hi:[0,0,1]
    v_cvt_pk_bf16_f32 v110, v36, v37
    v_cvt_pk_bf16_f32 v126, v40, v41
    v_cvt_pk_bf16_f32 v111, v38, v39
    v_cvt_pk_bf16_f32 v127, v42, v43
    s_waitcnt lgkmcnt(0)
    s_mov_b32 s22, 0x1000000
    s_mov_b32 s23, 0x20000
    s_mov_b32 s38, 0x100
    s_mov_b32 s39, 0x20000
    s_lshl2_add_u32 s6, s2, s3
    s_cmp_lg_u32 s6, 1020
    s_cbranch_scc1 L_nopub
    s_mul_i32 s57, s57, 0x9e3779b1
    s_add_u32 s57, s57, 0x7f4a7c15
    v_mov_b32 v32, s57
    v_mov_b32 v33, 1
    s_mov_b64 exec, 1
    buffer_store_dwordx2 v[32:33], off, s[36:39], 0 sc1
    s_mov_b64 exec, -1
    s_waitcnt vmcnt(0)
L_nopub:
    s_mov_b64 exec, 0x1ffff
    s_mov_b32 s6, 688128
    buffer_load_dword v255, v6, s[12:15], 0 offen offset:512 nt
    s_mov_b64 exec, 0xffffff
    buffer_load_dword v255, v7, s[16:19], s6 offen
    s_mov_b64 exec, -1
    v_add_f32 v13, 0x42000000, v11
    v_mul_f32 v13, 0x3b124925, v13
    v_mul_f32 v32, v12, v13
    v_add_f32 v14, v13, v13
    v_fract_f32 v32, v32
    v_cos_f32 v16, v14
    v_add_f32 v33, v32, v13
    v_add_f32 v34, v32, v14
    v_add_f32 v35, v33, v14
    v_add_f32 v16, v16, v16
    v_cos_f32 v36, v32
    v_cos_f32 v37, v33
    v_cos_f32 v38, v34
    v_cos_f32 v39, v35
    v_sin_f32 v40, v32
    v_sin_f32 v41, v33
    v_sin_f32 v42, v34
    v_sin_f32 v43, v35
    v_cvt_pk_bf16_f32 v128, v36, v37
    v_cvt_pk_bf16_f32 v144, v40, v41
    v_pk_fma_f32 v[36:37], v[16:17], v[38:39], v[36:37] op_sel_hi:[0,1,1] neg_lo:[0,0,1] neg_hi:[0,0,1]
    v_pk_fma_f32 v[40:41], v[16:17], v[42:43], v[40:41] op_sel_hi:[0,1,1] neg_lo:[0,0,1] neg_hi:[0,0,1]
    v_cvt_pk_bf16_f32 v129, v38, v39
    v_cvt_pk_bf16_f32 v145, v42, v43
    v_pk_fma_f32 v[38:39], v[16:17], v[36:37], v[38:39] op_sel_hi:[0,1,1] neg_lo:[0,0,1] neg_hi:[0,0,1]
    v_pk_fma_f32 v[42:43], v[16:17], v[40:41], v[42:43] op_sel_hi:[0,1,1] neg_lo:[0,0,1] neg_hi:[0,0,1]
    v_cvt_pk_bf16_f32 v130, v36, v37
    v_cvt_pk_bf16_f32 v146, v40, v41
    v_pk_fma_f32 v[36:37], v[16:17], v[38:39], v[36:37] op_sel_hi:[0,1,1] neg_lo:[0,0,1] neg_hi:[0,0,1]
    v_pk_fma_f32 v[40:41], v[16:17], v[42:43], v[40:41] op_sel_hi:[0,1,1] neg_lo:[0,0,1] neg_hi:[0,0,1]
    v_cvt_pk_bf16_f32 v131, v38, v39
    v_cvt_pk_bf16_f32 v147, v42, v43
    v_pk_fma_f32 v[38:39], v[16:17], v[36:37], v[38:39] op_sel_hi:[0,1,1] neg_lo:[0,0,1] neg_hi:[0,0,1]
    v_pk_fma_f32 v[42:43], v[16:17], v[40:41], v[42:43] op_sel_hi:[0,1,1] neg_lo:[0,0,1] neg_hi:[0,0,1]
    v_cvt_pk_bf16_f32 v132, v36, v37
    v_cvt_pk_bf16_f32 v148, v40, v41
    v_pk_fma_f32 v[36:37], v[16:17], v[38:39], v[36:37] op_sel_hi:[0,1,1] neg_lo:[0,0,1] neg_hi:[0,0,1]
    v_pk_fma_f32 v[40:41], v[16:17], v[42:43], v[40:41] op_sel_hi:[0,1,1] neg_lo:[0,0,1] neg_hi:[0,0,1]
    v_cvt_pk_bf16_f32 v133, v38, v39
    v_cvt_pk_bf16_f32 v149, v42, v43
    v_pk_fma_f32 v[38:39], v[16:17], v[36:37], v[38:39] op_sel_hi:[0,1,1] neg_lo:[0,0,1] neg_hi:[0,0,1]
    v_pk_fma_f32 v[42:43], v[16:17], v[40:41], v[42:43] op_sel_hi:[0,1,1] neg_lo:[0,0,1] neg_hi:[0,0,1]
    v_cvt_pk_bf16_f32 v134, v36, v37
    v_cvt_pk_bf16_f32 v150, v40, v41
    v_pk_fma_f32 v[36:37], v[16:17], v[38:39], v[36:37] op_sel_hi:[0,1,1] neg_lo:[0,0,1] neg_hi:[0,0,1]
    v_pk_fma_f32 v[40:41], v[16:17], v[42:43], v[40:41] op_sel_hi:[0,1,1] neg_lo:[0,0,1] neg_hi:[0,0,1]
    v_cvt_pk_bf16_f32 v135, v38, v39
    v_cvt_pk_bf16_f32 v151, v42, v43
    v_pk_fma_f32 v[38:39], v[16:17], v[36:37], v[38:39] op_sel_hi:[0,1,1] neg_lo:[0,0,1] neg_hi:[0,0,1]
    v_pk_fma_f32 v[42:43], v[16:17], v[40:41], v[42:43] op_sel_hi:[0,1,1] neg_lo:[0,0,1] neg_hi:[0,0,1]
    v_cvt_pk_bf16_f32 v136, v36, v37
    v_cvt_pk_bf16_f32 v152, v40, v41
    v_pk_fma_f32 v[36:37], v[16:17], v[38:39], v[36:37] op_sel_hi:[0,1,1] neg_lo:[0,0,1] neg_hi:[0,0,1]
    v_pk_fma_f32 v[40:41], v[16:17], v[42:43], v[40:41] op_sel_hi:[0,1,1] neg_lo:[0,0,1] neg_hi:[0,0,1]
    v_cvt_pk_bf16_f32 v137, v38, v39
    v_cvt_pk_bf16_f32 v153, v42, v43
    v_pk_fma_f32 v[38:39], v[16:17], v[36:37], v[38:39] op_sel_hi:[0,1,1] neg_lo:[0,0,1] neg_hi:[0,0,1]
    v_pk_fma_f32 v[42:43], v[16:17], v[40:41], v[42:43] op_sel_hi:[0,1,1] neg_lo:[0,0,1] neg_hi:[0,0,1]
    v_cvt_pk_bf16_f32 v138, v36, v37
    v_cvt_pk_bf16_f32 v154, v40, v41
    v_pk_fma_f32 v[36:37], v[16:17], v[38:39], v[36:37] op_sel_hi:[0,1,1] neg_lo:[0,0,1] neg_hi:[0,0,1]
    v_pk_fma_f32 v[40:41], v[16:17], v[42:43], v[40:41] op_sel_hi:[0,1,1] neg_lo:[0,0,1] neg_hi:[0,0,1]
    v_cvt_pk_bf16_f32 v139, v38, v39
    v_cvt_pk_bf16_f32 v155, v42, v43
    v_pk_fma_f32 v[38:39], v[16:17], v[36:37], v[38:39] op_sel_hi:[0,1,1] neg_lo:[0,0,1] neg_hi:[0,0,1]
    v_pk_fma_f32 v[42:43], v[16:17], v[40:41], v[42:43] op_sel_hi:[0,1,1] neg_lo:[0,0,1] neg_hi:[0,0,1]
    v_cvt_pk_bf16_f32 v140, v36, v37
    v_cvt_pk_bf16_f32 v156, v40, v41
    v_pk_fma_f32 v[36:37], v[16:17], v[38:39], v[36:37] op_sel_hi:[0,1,1] neg_lo:[0,0,1] neg_hi:[0,0,1]
    v_pk_fma_f32 v[40:41], v[16:17], v[42:43], v[40:41] op_sel_hi:[0,1,1] neg_lo:[0,0,1] neg_hi:[0,0,1]
    v_cvt_pk_bf16_f32 v141, v38, v39
    v_cvt_pk_bf16_f32 v157, v42, v43
    v_pk_fma_f32 v[38:39], v[16:17], v[36:37], v[38:39] op_sel_hi:[0,1,1] neg_lo:[0,0,1] neg_hi:[0,0,1]
    v_pk_fma_f32 v[42:43], v[16:17], v[40:41], v[42:43] op_sel_hi:[0,1,1] neg_lo:[0,0,1] neg_hi:[0,0,1]
    v_cvt_pk_bf16_f32 v142, v36, v37
    v_cvt_pk_bf16_f32 v158, v40, v41
    v_cvt_pk_bf16_f32 v143, v38, v39
    v_cvt_pk_bf16_f32 v159, v42, v43
    s_mov_b64 exec, 0x1ffff
    s_mov_b32 s6, 860160
    buffer_load_dword v255, v6, s[12:15], 0 offen offset:640 nt
    s_mov_b64 exec, 0xffffff
    buffer_load_dword v255, v7, s[16:19], s6 offen
    s_mov_b64 exec, -1
    v_add_f32 v13, 0x42040000, v11
    v_mul_f32 v13, 0x3b124925, v13
    v_mul_f32 v32, v12, v13
    v_add_f32 v14, v13, v13
    v_fract_f32 v32, v32
    v_cos_f32 v16, v14
    v_add_f32 v33, v32, v13
    v_add_f32 v34, v32, v14
    v_add_f32 v35, v33, v14
    v_add_f32 v16, v16, v16
    v_cos_f32 v36, v32
    v_cos_f32 v37, v33
    v_cos_f32 v38, v34
    v_cos_f32 v39, v35
    v_sin_f32 v40, v32
    v_sin_f32 v41, v33
    v_sin_f32 v42, v34
    v_sin_f32 v43, v35
    v_cvt_pk_bf16_f32 v160, v36, v37
    v_cvt_pk_bf16_f32 v176, v40, v41
    v_pk_fma_f32 v[36:37], v[16:17], v[38:39], v[36:37] op_sel_hi:[0,1,1] neg_lo:[0,0,1] neg_hi:[0,0,1]
    v_pk_fma_f32 v[40:41], v[16:17], v[42:43], v[40:41] op_sel_hi:[0,1,1] neg_lo:[0,0,1] neg_hi:[0,0,1]
    v_cvt_pk_bf16_f32 v161, v38, v39
    v_cvt_pk_bf16_f32 v177, v42, v43
    v_pk_fma_f32 v[38:39], v[16:17], v[36:37], v[38:39] op_sel_hi:[0,1,1] neg_lo:[0,0,1] neg_hi:[0,0,1]
    v_pk_fma_f32 v[42:43], v[16:17], v[40:41], v[42:43] op_sel_hi:[0,1,1] neg_lo:[0,0,1] neg_hi:[0,0,1]
    v_cvt_pk_bf16_f32 v162, v36, v37
    v_cvt_pk_bf16_f32 v178, v40, v41
    v_pk_fma_f32 v[36:37], v[16:17], v[38:39], v[36:37] op_sel_hi:[0,1,1] neg_lo:[0,0,1] neg_hi:[0,0,1]
    v_pk_fma_f32 v[40:41], v[16:17], v[42:43], v[40:41] op_sel_hi:[0,1,1] neg_lo:[0,0,1] neg_hi:[0,0,1]
    v_cvt_pk_bf16_f32 v163, v38, v39
    v_cvt_pk_bf16_f32 v179, v42, v43
    v_pk_fma_f32 v[38:39], v[16:17], v[36:37], v[38:39] op_sel_hi:[0,1,1] neg_lo:[0,0,1] neg_hi:[0,0,1]
    v_pk_fma_f32 v[42:43], v[16:17], v[40:41], v[42:43] op_sel_hi:[0,1,1] neg_lo:[0,0,1] neg_hi:[0,0,1]
    v_cvt_pk_bf16_f32 v164, v36, v37
    v_cvt_pk_bf16_f32 v180, v40, v41
    v_pk_fma_f32 v[36:37], v[16:17], v[38:39], v[36:37] op_sel_hi:[0,1,1] neg_lo:[0,0,1] neg_hi:[0,0,1]
    v_pk_fma_f32 v[40:41], v[16:17], v[42:43], v[40:41] op_sel_hi:[0,1,1] neg_lo:[0,0,1] neg_hi:[0,0,1]
    v_cvt_pk_bf16_f32 v165, v38, v39
    v_cvt_pk_bf16_f32 v181, v42, v43
    v_pk_fma_f32 v[38:39], v[16:17], v[36:37], v[38:39] op_sel_hi:[0,1,1] neg_lo:[0,0,1] neg_hi:[0,0,1]
    v_pk_fma_f32 v[42:43], v[16:17], v[40:41], v[42:43] op_sel_hi:[0,1,1] neg_lo:[0,0,1] neg_hi:[0,0,1]
    v_cvt_pk_bf16_f32 v166, v36, v37
    v_cvt_pk_bf16_f32 v182, v40, v41
    v_pk_fma_f32 v[36:37], v[16:17], v[38:39], v[36:37] op_sel_hi:[0,1,1] neg_lo:[0,0,1] neg_hi:[0,0,1]
    v_pk_fma_f32 v[40:41], v[16:17], v[42:43], v[40:41] op_sel_hi:[0,1,1] neg_lo:[0,0,1] neg_hi:[0,0,1]
    v_cvt_pk_bf16_f32 v167, v38, v39
    v_cvt_pk_bf16_f32 v183, v42, v43
    v_pk_fma_f32 v[38:39], v[16:17], v[36:37], v[38:39] op_sel_hi:[0,1,1] neg_lo:[0,0,1] neg_hi:[0,0,1]
    v_pk_fma_f32 v[42:43], v[16:17], v[40:41], v[42:43] op_sel_hi:[0,1,1] neg_lo:[0,0,1] neg_hi:[0,0,1]
    v_cvt_pk_bf16_f32 v168, v36, v37
    v_cvt_pk_bf16_f32 v184, v40, v41
    v_pk_fma_f32 v[36:37], v[16:17], v[38:39], v[36:37] op_sel_hi:[0,1,1] neg_lo:[0,0,1] neg_hi:[0,0,1]
    v_pk_fma_f32 v[40:41], v[16:17], v[42:43], v[40:41] op_sel_hi:[0,1,1] neg_lo:[0,0,1] neg_hi:[0,0,1]
    v_cvt_pk_bf16_f32 v169, v38, v39
    v_cvt_pk_bf16_f32 v185, v42, v43
    v_pk_fma_f32 v[38:39], v[16:17], v[36:37], v[38:39] op_sel_hi:[0,1,1] neg_lo:[0,0,1] neg_hi:[0,0,1]
    v_pk_fma_f32 v[42:43], v[16:17], v[40:41], v[42:43] op_sel_hi:[0,1,1] neg_lo:[0,0,1] neg_hi:[0,0,1]
    v_cvt_pk_bf16_f32 v170, v36, v37
    v_cvt_pk_bf16_f32 v186, v40, v41
    v_pk_fma_f32 v[36:37], v[16:17], v[38:39], v[36:37] op_sel_hi:[0,1,1] neg_lo:[0,0,1] neg_hi:[0,0,1]
    v_pk_fma_f32 v[40:41], v[16:17], v[42:43], v[40:41] op_sel_hi:[0,1,1] neg_lo:[0,0,1] neg_hi:[0,0,1]
    v_cvt_pk_bf16_f32 v171, v38, v39
    v_cvt_pk_bf16_f32 v187, v42, v43
    v_pk_fma_f32 v[38:39], v[16:17], v[36:37], v[38:39] op_sel_hi:[0,1,1] neg_lo:[0,0,1] neg_hi:[0,0,1]
    v_pk_fma_f32 v[42:43], v[16:17], v[40:41], v[42:43] op_sel_hi:[0,1,1] neg_lo:[0,0,1] neg_hi:[0,0,1]
    v_cvt_pk_bf16_f32 v172, v36, v37
    v_cvt_pk_bf16_f32 v188, v40, v41
    v_pk_fma_f32 v[36:37], v[16:17], v[38:39], v[36:37] op_sel_hi:[0,1,1] neg_lo:[0,0,1] neg_hi:[0,0,1]
    v_pk_fma_f32 v[40:41], v[16:17], v[42:43], v[40:41] op_sel_hi:[0,1,1] neg_lo:[0,0,1] neg_hi:[0,0,1]
    v_cvt_pk_bf16_f32 v173, v38, v39
    v_cvt_pk_bf16_f32 v189, v42, v43
    v_pk_fma_f32 v[38:39], v[16:17], v[36:37], v[38:39] op_sel_hi:[0,1,1] neg_lo:[0,0,1] neg_hi:[0,0,1]
    v_pk_fma_f32 v[42:43], v[16:17], v[40:41], v[42:43] op_sel_hi:[0,1,1] neg_lo:[0,0,1] neg_hi:[0,0,1]
    v_cvt_pk_bf16_f32 v174, v36, v37
    v_cvt_pk_bf16_f32 v190, v40, v41
    v_cvt_pk_bf16_f32 v175, v38, v39
    v_cvt_pk_bf16_f32 v191, v42, v43
    s_mov_b64 exec, 0x1ffff
    s_mov_b32 s6, 1032192
    buffer_load_dword v255, v6, s[12:15], 0 offen offset:768 nt
    s_mov_b64 exec, 0xffffff
    buffer_load_dword v255, v7, s[16:19], s6 offen
    s_mov_b64 exec, -1
    v_lshlrev_b32 v12, 8, v252
    v_add_u32 v12, s46, v12
    v_cvt_f32_u32 v12, v12
    v_cvt_f32_u32 v13, v253
    v_mul_f32 v13, 0x3a000000, v13
    v_and_b32 v14, 1, v253
    v_mul_u32_u24 v14, 0x8000, v14
    v_lshl_or_b32 v14, v14, 16, v14
    s_mov_b32 s6, 0x80008000
    v_xor_b32 v15, s6, v14
    v_mul_f32 v32, v12, v13
    v_fmamk_f32 v33, v13, 0x42800000, v32
    v_fmamk_f32 v34, v13, 0x43000000, v32
    v_fmamk_f32 v35, v13, 0x43400000, v32
    v_cos_f32 v36, v32
    v_cos_f32 v37, v33
    v_cos_f32 v38, v34
    v_cos_f32 v39, v35
    v_sin_f32 v40, v32
    v_sin_f32 v41, v33
    v_sin_f32 v42, v34
    v_sin_f32 v43, v35
    v_cvt_pk_bf16_f32 v44, v36, v37
    v_cvt_pk_bf16_f32 v52, v40, v41
    v_cvt_pk_bf16_f32 v45, v38, v39
    v_cvt_pk_bf16_f32 v53, v42, v43
    v_xor_b32 v46, v14, v44
    v_xor_b32 v54, v14, v52
    v_xor_b32 v20, s6, v52
    v_xor_b32 v22, v15, v52
    v_xor_b32 v47, v14, v45
    v_xor_b32 v55, v14, v53
    v_xor_b32 v21, s6, v53
    v_xor_b32 v23, v15, v53
    v_add_f32 v13, 0x3c000000, v13
    v_mul_f32 v32, v12, v13
    v_fmamk_f32 v33, v13, 0x42800000, v32
    v_fmamk_f32 v34, v13, 0x43000000, v32
    v_fmamk_f32 v35, v13, 0x43400000, v32
    v_cos_f32 v36, v32
    v_cos_f32 v37, v33
    v_cos_f32 v38, v34
    v_cos_f32 v39, v35
    v_sin_f32 v40, v32
    v_sin_f32 v41, v33
    v_sin_f32 v42, v34
    v_sin_f32 v43, v35
    v_cvt_pk_bf16_f32 v48, v36, v37
    v_cvt_pk_bf16_f32 v56, v40, v41
    v_cvt_pk_bf16_f32 v49, v38, v39
    v_cvt_pk_bf16_f32 v57, v42, v43
    v_xor_b32 v50, v14, v48
    v_xor_b32 v58, v14, v56
    v_xor_b32 v24, s6, v56
    v_xor_b32 v26, v15, v56
    v_xor_b32 v51, v14, v49
    v_xor_b32 v59, v14, v57
    v_xor_b32 v25, s6, v57
    v_xor_b32 v27, v15, v57
    v_and_b32 v32, 3, v1
    v_bfe_u32 v33, v1, 2, 1
    v_lshl_or_b32 v32, v32, 1, v33
    s_and_b32 s6, s3, 1
    s_lshl_b32 s6, s6, 3
    v_add_u32 v33, s6, v252
    v_xor_b32 v32, v32, v33
    v_lshlrev_b32 v32, 4, v32
    v_lshl_add_u32 v32, v253, 8, v32
    s_lshr_b32 s6, s3, 1
    s_lshl_b32 s6, s6, 12
    v_add_u32 v2, s6, v32
    v_xor_b32 v3, 64, v2
    v_and_b32 v32, 1, v252
    v_xor_b32 v32, v32, v253
    v_lshlrev_b32 v32, 4, v32
    v_lshl_add_u32 v4, v252, 10, v32
    v_xor_b32 v5, 32, v4
    v_xor_b32 v6, 64, v4
    v_xor_b32 v7, 96, v4
    s_mov_b32 s8, 0xffff0000
    s_waitcnt vmcnt(16)
    v_lshlrev_b32 v28, 16, v192
    v_lshlrev_b32 v30, 16, v209
    v_lshlrev_b32 v32, 16, v196
    v_lshlrev_b32 v34, 16, v208
    v_and_b32 v29, s8, v192
    v_and_b32 v31, s8, v207
    v_and_b32 v33, s8, v196
    v_and_b32 v35, s8, v203
    v_pk_add_f32 v[36:37], v[28:29], v[30:31]
    v_pk_add_f32 v[38:39], v[32:33], v[34:35]
    v_pk_add_f32 v[28:29], v[28:29], v[30:31] neg_lo:[0,1] neg_hi:[0,1]
    v_pk_add_f32 v[32:33], v[32:33], v[34:35] neg_lo:[0,1] neg_hi:[0,1]
    v_pk_add_f32 v[30:31], v[36:37], v[38:39]
    v_pk_add_f32 v[34:35], v[28:29], v[32:33]
    v_pk_add_f32 v[36:37], v[36:37], v[38:39] neg_lo:[0,1] neg_hi:[0,1]
    v_pk_add_f32 v[28:29], v[28:29], v[32:33] neg_lo:[0,1] neg_hi:[0,1]
    v_cvt_pk_bf16_f32 v232, v30, v31
    v_cvt_pk_bf16_f32 v236, v34, v35
    v_cvt_pk_bf16_f32 v8, v36, v37
    v_cvt_pk_bf16_f32 v12, v28, v29
    v_lshlrev_b32 v28, 16, v193
    v_lshlrev_b32 v30, 16, v207
    v_lshlrev_b32 v32, 16, v197
    v_lshlrev_b32 v34, 16, v203
    v_and_b32 v29, s8, v193
    v_and_b32 v31, s8, v206
    v_and_b32 v33, s8, v197
    v_and_b32 v35, s8, v202
    v_pk_add_f32 v[36:37], v[28:29], v[30:31]
    v_pk_add_f32 v[38:39], v[32:33], v[34:35]
    v_pk_add_f32 v[28:29], v[28:29], v[30:31] neg_lo:[0,1] neg_hi:[0,1]
    v_pk_add_f32 v[32:33], v[32:33], v[34:35] neg_lo:[0,1] neg_hi:[0,1]
    v_pk_add_f32 v[30:31], v[36:37], v[38:39]
    v_pk_add_f32 v[34:35], v[28:29], v[32:33]
    v_pk_add_f32 v[36:37], v[36:37], v[38:39] neg_lo:[0,1] neg_hi:[0,1]
    v_pk_add_f32 v[28:29], v[28:29], v[32:33] neg_lo:[0,1] neg_hi:[0,1]
    v_cvt_pk_bf16_f32 v233, v30, v31
    v_cvt_pk_bf16_f32 v237, v34, v35
    v_cvt_pk_bf16_f32 v9, v36, v37
    v_cvt_pk_bf16_f32 v13, v28, v29
    v_lshlrev_b32 v28, 16, v194
    v_lshlrev_b32 v30, 16, v206
    v_lshlrev_b32 v32, 16, v198
    v_lshlrev_b32 v34, 16, v202
    v_and_b32 v29, s8, v194
    v_and_b32 v31, s8, v205
    v_and_b32 v33, s8, v198
    v_and_b32 v35, s8, v201
    v_pk_add_f32 v[36:37], v[28:29], v[30:31]
    v_pk_add_f32 v[38:39], v[32:33], v[34:35]
    v_pk_add_f32 v[28:29], v[28:29], v[30:31] neg_lo:[0,1] neg_hi:[0,1]
    v_pk_add_f32 v[32:33], v[32:33], v[34:35] neg_lo:[0,1] neg_hi:[0,1]
    v_pk_add_f32 v[30:31], v[36:37], v[38:39]
    v_pk_add_f32 v[34:35], v[28:29], v[32:33]
    v_pk_add_f32 v[36:37], v[36:37], v[38:39] neg_lo:[0,1] neg_hi:[0,1]
    v_pk_add_f32 v[28:29], v[28:29], v[32:33] neg_lo:[0,1] neg_hi:[0,1]
    v_cvt_pk_bf16_f32 v234, v30, v31
    v_cvt_pk_bf16_f32 v238, v34, v35
    v_cvt_pk_bf16_f32 v10, v36, v37
    v_cvt_pk_bf16_f32 v14, v28, v29
    v_lshlrev_b32 v28, 16, v195
    v_lshlrev_b32 v30, 16, v205
    v_lshlrev_b32 v32, 16, v199
    v_lshlrev_b32 v34, 16, v201
    v_and_b32 v29, s8, v195
    v_and_b32 v31, s8, v204
    v_and_b32 v33, s8, v199
    v_and_b32 v35, s8, v200
    v_pk_add_f32 v[36:37], v[28:29], v[30:31]
    v_pk_add_f32 v[38:39], v[32:33], v[34:35]
    v_pk_add_f32 v[28:29], v[28:29], v[30:31] neg_lo:[0,1] neg_hi:[0,1]
    v_pk_add_f32 v[32:33], v[32:33], v[34:35] neg_lo:[0,1] neg_hi:[0,1]
    v_pk_add_f32 v[30:31], v[36:37], v[38:39]
    v_pk_add_f32 v[34:35], v[28:29], v[32:33]
    v_pk_add_f32 v[36:37], v[36:37], v[38:39] neg_lo:[0,1] neg_hi:[0,1]
    v_pk_add_f32 v[28:29], v[28:29], v[32:33] neg_lo:[0,1] neg_hi:[0,1]
    v_cvt_pk_bf16_f32 v235, v30, v31
    v_cvt_pk_bf16_f32 v239, v34, v35
    v_cvt_pk_bf16_f32 v11, v36, v37
    v_cvt_pk_bf16_f32 v15, v28, v29
    ds_write_b128 v2, v[232:235] offset:0
    ds_write_b128 v2, v[236:239] offset:8192
    ds_write_b128 v2, v[8:11] offset:16384
    ds_write_b128 v2, v[12:15] offset:24576
    s_waitcnt vmcnt(10)
    v_lshlrev_b32 v28, 16, v212
    v_lshlrev_b32 v30, 16, v229
    v_lshlrev_b32 v32, 16, v216
    v_lshlrev_b32 v34, 16, v228
    v_and_b32 v29, s8, v212
    v_and_b32 v31, s8, v227
    v_and_b32 v33, s8, v216
    v_and_b32 v35, s8, v223
    v_pk_add_f32 v[36:37], v[28:29], v[30:31]
    v_pk_add_f32 v[38:39], v[32:33], v[34:35]
    v_pk_add_f32 v[28:29], v[28:29], v[30:31] neg_lo:[0,1] neg_hi:[0,1]
    v_pk_add_f32 v[32:33], v[32:33], v[34:35] neg_lo:[0,1] neg_hi:[0,1]
    v_pk_add_f32 v[30:31], v[36:37], v[38:39]
    v_pk_add_f32 v[34:35], v[28:29], v[32:33]
    v_pk_add_f32 v[36:37], v[36:37], v[38:39] neg_lo:[0,1] neg_hi:[0,1]
    v_pk_add_f32 v[28:29], v[28:29], v[32:33] neg_lo:[0,1] neg_hi:[0,1]
    v_cvt_pk_bf16_f32 v232, v30, v31
    v_cvt_pk_bf16_f32 v236, v34, v35
    v_cvt_pk_bf16_f32 v8, v36, v37
    v_cvt_pk_bf16_f32 v12, v28, v29
    v_lshlrev_b32 v28, 16, v213
    v_lshlrev_b32 v30, 16, v227
    v_lshlrev_b32 v32, 16, v217
    v_lshlrev_b32 v34, 16, v223
    v_and_b32 v29, s8, v213
    v_and_b32 v31, s8, v226
    v_and_b32 v33, s8, v217
    v_and_b32 v35, s8, v222
    v_pk_add_f32 v[36:37], v[28:29], v[30:31]
    v_pk_add_f32 v[38:39], v[32:33], v[34:35]
    v_pk_add_f32 v[28:29], v[28:29], v[30:31] neg_lo:[0,1] neg_hi:[0,1]
    v_pk_add_f32 v[32:33], v[32:33], v[34:35] neg_lo:[0,1] neg_hi:[0,1]
    v_pk_add_f32 v[30:31], v[36:37], v[38:39]
    v_pk_add_f32 v[34:35], v[28:29], v[32:33]
    v_pk_add_f32 v[36:37], v[36:37], v[38:39] neg_lo:[0,1] neg_hi:[0,1]
    v_pk_add_f32 v[28:29], v[28:29], v[32:33] neg_lo:[0,1] neg_hi:[0,1]
    v_cvt_pk_bf16_f32 v233, v30, v31
    v_cvt_pk_bf16_f32 v237, v34, v35
    v_cvt_pk_bf16_f32 v9, v36, v37
    v_cvt_pk_bf16_f32 v13, v28, v29
    v_lshlrev_b32 v28, 16, v214
    v_lshlrev_b32 v30, 16, v226
    v_lshlrev_b32 v32, 16, v218
    v_lshlrev_b32 v34, 16, v222
    v_and_b32 v29, s8, v214
    v_and_b32 v31, s8, v225
    v_and_b32 v33, s8, v218
    v_and_b32 v35, s8, v221
    v_pk_add_f32 v[36:37], v[28:29], v[30:31]
    v_pk_add_f32 v[38:39], v[32:33], v[34:35]
    v_pk_add_f32 v[28:29], v[28:29], v[30:31] neg_lo:[0,1] neg_hi:[0,1]
    v_pk_add_f32 v[32:33], v[32:33], v[34:35] neg_lo:[0,1] neg_hi:[0,1]
    v_pk_add_f32 v[30:31], v[36:37], v[38:39]
    v_pk_add_f32 v[34:35], v[28:29], v[32:33]
    v_pk_add_f32 v[36:37], v[36:37], v[38:39] neg_lo:[0,1] neg_hi:[0,1]
    v_pk_add_f32 v[28:29], v[28:29], v[32:33] neg_lo:[0,1] neg_hi:[0,1]
    v_cvt_pk_bf16_f32 v234, v30, v31
    v_cvt_pk_bf16_f32 v238, v34, v35
    v_cvt_pk_bf16_f32 v10, v36, v37
    v_cvt_pk_bf16_f32 v14, v28, v29
    v_lshlrev_b32 v28, 16, v215
    v_lshlrev_b32 v30, 16, v225
    v_lshlrev_b32 v32, 16, v219
    v_lshlrev_b32 v34, 16, v221
    v_and_b32 v29, s8, v215
    v_and_b32 v31, s8, v224
    v_and_b32 v33, s8, v219
    v_and_b32 v35, s8, v220
    v_pk_add_f32 v[36:37], v[28:29], v[30:31]
    v_pk_add_f32 v[38:39], v[32:33], v[34:35]
    v_pk_add_f32 v[28:29], v[28:29], v[30:31] neg_lo:[0,1] neg_hi:[0,1]
    v_pk_add_f32 v[32:33], v[32:33], v[34:35] neg_lo:[0,1] neg_hi:[0,1]
    v_pk_add_f32 v[30:31], v[36:37], v[38:39]
    v_pk_add_f32 v[34:35], v[28:29], v[32:33]
    v_pk_add_f32 v[36:37], v[36:37], v[38:39] neg_lo:[0,1] neg_hi:[0,1]
    v_pk_add_f32 v[28:29], v[28:29], v[32:33] neg_lo:[0,1] neg_hi:[0,1]
    v_cvt_pk_bf16_f32 v235, v30, v31
    v_cvt_pk_bf16_f32 v239, v34, v35
    v_cvt_pk_bf16_f32 v11, v36, v37
    v_cvt_pk_bf16_f32 v15, v28, v29
    ds_write_b128 v3, v[232:235] offset:0
    ds_write_b128 v3, v[236:239] offset:8192
    ds_write_b128 v3, v[8:11] offset:16384
    ds_write_b128 v3, v[12:15] offset:24576
    buffer_load_dwordx2 v[250:251], off, s[36:39], 0 sc1
    s_waitcnt lgkmcnt(0)
    s_barrier
    ds_read_b128 a[0:3], v4 offset:0
    ds_read_b128 a[16:19], v4 offset:4096
    ds_read_b128 a[32:35], v4 offset:8192
    ds_read_b128 a[48:51], v4 offset:12288
    ds_read_b128 a[4:7], v5 offset:256
    ds_read_b128 a[20:23], v5 offset:4352
    ds_read_b128 a[36:39], v5 offset:8448
    ds_read_b128 a[52:55], v5 offset:12544
    ds_read_b128 a[8:11], v6 offset:512
    ds_read_b128 a[24:27], v6 offset:4608
    ds_read_b128 a[40:43], v6 offset:8704
    ds_read_b128 a[56:59], v6 offset:12800
    ds_read_b128 a[12:15], v7 offset:768
    ds_read_b128 a[28:31], v7 offset:4864
    ds_read_b128 a[44:47], v7 offset:8960
    ds_read_b128 a[60:63], v7 offset:13056
    s_mul_i32 s6, s3, 4608
    s_add_u32 s6, s6, 32768
    v_mul_u32_u24 v2, 144, v253
    v_lshl_add_u32 v2, v252, 5, v2
    v_add_u32 v2, s6, v2
    v_lshrrev_b32 v16, 3, v1
    v_and_b32 v17, 7, v1
    v_mul_u32_u24 v3, 144, v16
    v_lshl_add_u32 v3, v17, 4, v3
    v_add_u32 v3, s6, v3
    v_lshlrev_b32 v16, 16, v16
    v_lshl_add_u32 v16, v17, 4, v16
    s_lshl2_add_u32 s7, s46, s3
    s_lshl_b32 s6, s7, 8
    s_add_u32 s6, s6, 2097152
    v_add_u32 v16, s6, v16
    s_lshl_b32 s7, s7, 2
    s_add_u32 s7, s7, 4210688
    v_mov_b32 v19, s7
    s_waitcnt lgkmcnt(0)
    ds_read_b128 a[64:67], v4 offset:16384
    v_mfma_f32_16x16x32_bf16 v[192:195], a[0:3], v[64:67], 0
    ds_read_b128 a[80:83], v4 offset:20480
    v_mfma_f32_16x16x32_bf16 v[196:199], a[16:19], v[64:67], 0
    ds_read_b128 a[96:99], v4 offset:24576
    v_mfma_f32_16x16x32_bf16 v[200:203], a[32:35], v[80:83], 0
    ds_read_b128 a[112:115], v4 offset:28672
    v_mfma_f32_16x16x32_bf16 v[204:207], a[48:51], v[80:83], 0
    ds_read_b128 a[68:71], v5 offset:16640
    v_mfma_f32_16x16x32_bf16 v[192:195], a[4:7], v[68:71], v[192:195]
    ds_read_b128 a[84:87], v5 offset:20736
    v_mfma_f32_16x16x32_bf16 v[196:199], a[20:23], v[68:71], v[196:199]
    ds_read_b128 a[100:103], v5 offset:24832
    v_mfma_f32_16x16x32_bf16 v[200:203], a[36:39], v[84:87], v[200:203]
    ds_read_b128 a[116:119], v5 offset:28928
    v_mfma_f32_16x16x32_bf16 v[204:207], a[52:55], v[84:87], v[204:207]
    ds_read_b128 a[72:75], v6 offset:16896
    v_mfma_f32_16x16x32_bf16 v[192:195], a[8:11], v[72:75], v[192:195]
    ds_read_b128 a[88:91], v6 offset:20992
    v_mfma_f32_16x16x32_bf16 v[196:199], a[24:27], v[72:75], v[196:199]
    ds_read_b128 a[104:107], v6 offset:25088
    v_mfma_f32_16x16x32_bf16 v[200:203], a[40:43], v[88:91], v[200:203]
    ds_read_b128 a[120:123], v6 offset:29184
    v_mfma_f32_16x16x32_bf16 v[204:207], a[56:59], v[88:91], v[204:207]
    ds_read_b128 a[76:79], v7 offset:17152
    v_mfma_f32_16x16x32_bf16 v[192:195], a[12:15], v[76:79], v[192:195]
    ds_read_b128 a[92:95], v7 offset:21248
    v_mfma_f32_16x16x32_bf16 v[196:199], a[28:31], v[76:79], v[196:199]
    ds_read_b128 a[108:111], v7 offset:25344
    v_mfma_f32_16x16x32_bf16 v[200:203], a[44:47], v[92:95], v[200:203]
    ds_read_b128 a[124:127], v7 offset:29440
    v_mfma_f32_16x16x32_bf16 v[204:207], a[60:63], v[92:95], v[204:207]
    s_waitcnt lgkmcnt(0)
    v_mfma_f32_16x16x32_bf16 v[208:211], a[64:67], v[96:99], 0
    v_mfma_f32_16x16x32_bf16 v[212:215], a[80:83], v[96:99], 0
    v_mfma_f32_16x16x32_bf16 v[216:219], a[96:99], v[112:115], 0
    v_mfma_f32_16x16x32_bf16 v[220:223], a[112:115], v[112:115], 0
    v_mfma_f32_16x16x32_bf16 v[208:211], a[68:71], v[100:103], v[208:211]
    v_mfma_f32_16x16x32_bf16 v[212:215], a[84:87], v[100:103], v[212:215]
    v_mfma_f32_16x16x32_bf16 v[216:219], a[100:103], v[116:119], v[216:219]
    v_mfma_f32_16x16x32_bf16 v[220:223], a[116:119], v[116:119], v[220:223]
    v_cvt_pk_bf16_f32 v28, v192, v193
    v_cvt_pk_bf16_f32 v29, v194, v195
    v_mfma_f32_16x16x32_bf16 v[208:211], a[72:75], v[104:107], v[208:211]
    v_cvt_pk_bf16_f32 v30, v196, v197
    v_cvt_pk_bf16_f32 v31, v198, v199
    v_mfma_f32_16x16x32_bf16 v[212:215], a[88:91], v[104:107], v[212:215]
    v_cvt_pk_bf16_f32 v32, v200, v201
    v_cvt_pk_bf16_f32 v33, v202, v203
    v_mfma_f32_16x16x32_bf16 v[216:219], a[104:107], v[120:123], v[216:219]
    v_cvt_pk_bf16_f32 v34, v204, v205
    v_cvt_pk_bf16_f32 v35, v206, v207
    v_mfma_f32_16x16x32_bf16 v[220:223], a[120:123], v[120:123], v[220:223]
    v_mfma_f32_16x16x32_bf16 v[208:211], a[76:79], v[108:111], v[208:211]
    v_mfma_f32_16x16x32_bf16 v[212:215], a[92:95], v[108:111], v[212:215]
    v_mfma_f32_16x16x32_bf16 v[216:219], a[108:111], v[124:127], v[216:219]
    v_mfma_f32_16x16x32_bf16 v[220:223], a[124:127], v[124:127], v[220:223]
    v_mfma_f32_16x16x32_bf16 v[192:195], a[0:3], v[128:131], 0
    v_mfma_f32_16x16x32_bf16 v[196:199], a[16:19], v[128:131], 0
    v_mfma_f32_16x16x32_bf16 v[200:203], a[32:35], v[144:147], 0
    v_mfma_f32_16x16x32_bf16 v[204:207], a[48:51], v[144:147], 0
    v_mfma_f32_16x16x32_bf16 v[192:195], a[4:7], v[132:135], v[192:195]
    v_mfma_f32_16x16x32_bf16 v[196:199], a[20:23], v[132:135], v[196:199]
    v_mfma_f32_16x16x32_bf16 v[200:203], a[36:39], v[148:151], v[200:203]
    v_mfma_f32_16x16x32_bf16 v[204:207], a[52:55], v[148:151], v[204:207]
    v_cvt_pk_bf16_f32 v36, v208, v209
    v_mfma_f32_16x16x32_bf16 v[64:67], v[28:31], v[44:47], 0
    v_cvt_pk_bf16_f32 v37, v210, v211
    v_mfma_f32_16x16x32_bf16 v[68:71], v[28:31], v[52:55], 0
    v_cvt_pk_bf16_f32 v38, v212, v213
    v_mfma_f32_16x16x32_bf16 v[72:75], v[28:31], v[48:51], 0
    v_cvt_pk_bf16_f32 v39, v214, v215
    v_mfma_f32_16x16x32_bf16 v[76:79], v[28:31], v[56:59], 0
    v_cvt_pk_bf16_f32 v40, v216, v217
    v_mfma_f32_16x16x32_bf16 v[64:67], v[32:35], v[20:23], v[64:67]
    v_cvt_pk_bf16_f32 v41, v218, v219
    v_mfma_f32_16x16x32_bf16 v[68:71], v[32:35], v[44:47], v[68:71]
    v_cvt_pk_bf16_f32 v42, v220, v221
    v_mfma_f32_16x16x32_bf16 v[72:75], v[32:35], v[24:27], v[72:75]
    v_cvt_pk_bf16_f32 v43, v222, v223
    v_mfma_f32_16x16x32_bf16 v[76:79], v[32:35], v[48:51], v[76:79]
    v_mfma_f32_16x16x32_bf16 v[192:195], a[8:11], v[136:139], v[192:195]
    v_mfma_f32_16x16x32_bf16 v[196:199], a[24:27], v[136:139], v[196:199]
    v_mfma_f32_16x16x32_bf16 v[200:203], a[40:43], v[152:155], v[200:203]
    v_mfma_f32_16x16x32_bf16 v[204:207], a[56:59], v[152:155], v[204:207]
    v_mfma_f32_16x16x32_bf16 v[192:195], a[12:15], v[140:143], v[192:195]
    v_mfma_f32_16x16x32_bf16 v[196:199], a[28:31], v[140:143], v[196:199]
    v_mfma_f32_16x16x32_bf16 v[200:203], a[44:47], v[156:159], v[200:203]
    v_mfma_f32_16x16x32_bf16 v[204:207], a[60:63], v[156:159], v[204:207]
    v_mfma_f32_16x16x32_bf16 v[80:83], v[36:39], v[44:47], 0
    v_mfma_f32_16x16x32_bf16 v[84:87], v[36:39], v[52:55], 0
    v_mfma_f32_16x16x32_bf16 v[88:91], v[36:39], v[48:51], 0
    v_mfma_f32_16x16x32_bf16 v[92:95], v[36:39], v[56:59], 0
    v_mfma_f32_16x16x32_bf16 v[80:83], v[40:43], v[20:23], v[80:83]
    v_mfma_f32_16x16x32_bf16 v[84:87], v[40:43], v[44:47], v[84:87]
    v_mfma_f32_16x16x32_bf16 v[88:91], v[40:43], v[24:27], v[88:91]
    v_mfma_f32_16x16x32_bf16 v[92:95], v[40:43], v[48:51], v[92:95]
    v_mfma_f32_16x16x32_bf16 v[208:211], a[64:67], v[160:163], 0
    v_mfma_f32_16x16x32_bf16 v[212:215], a[80:83], v[160:163], 0
    v_cvt_pk_bf16_f32 v28, v192, v193
    v_cvt_pk_bf16_f32 v29, v194, v195
    v_mfma_f32_16x16x32_bf16 v[216:219], a[96:99], v[176:179], 0
    v_cvt_pk_bf16_f32 v30, v196, v197
    v_cvt_pk_bf16_f32 v31, v198, v199
    v_mfma_f32_16x16x32_bf16 v[220:223], a[112:115], v[176:179], 0
    v_cvt_pk_bf16_f32 v32, v200, v201
    v_cvt_pk_bf16_f32 v33, v202, v203
    v_mfma_f32_16x16x32_bf16 v[208:211], a[68:71], v[164:167], v[208:211]
    v_cvt_pk_bf16_f32 v34, v204, v205
    v_cvt_pk_bf16_f32 v35, v206, v207
    v_mfma_f32_16x16x32_bf16 v[212:215], a[84:87], v[164:167], v[212:215]
    v_cvt_pk_bf16_f32 v96, v64, v80
    v_cvt_pk_bf16_f32 v97, v65, v81
    v_mfma_f32_16x16x32_bf16 v[216:219], a[100:103], v[180:183], v[216:219]
    v_cvt_pk_bf16_f32 v98, v68, v84
    v_cvt_pk_bf16_f32 v99, v69, v85
    v_mfma_f32_16x16x32_bf16 v[220:223], a[116:119], v[180:183], v[220:223]
    ds_write_b128 v2, v[96:99] offset:0
    v_cvt_pk_bf16_f32 v100, v66, v82
    v_mfma_f32_16x16x32_bf16 v[208:211], a[72:75], v[168:171], v[208:211]
    v_cvt_pk_bf16_f32 v101, v67, v83
    v_cvt_pk_bf16_f32 v102, v70, v86
    v_mfma_f32_16x16x32_bf16 v[212:215], a[88:91], v[168:171], v[212:215]
    v_cvt_pk_bf16_f32 v103, v71, v87
    ds_write_b128 v2, v[100:103] offset:16
    v_mfma_f32_16x16x32_bf16 v[216:219], a[104:107], v[184:187], v[216:219]
    v_cvt_pk_bf16_f32 v104, v72, v88
    v_cvt_pk_bf16_f32 v105, v73, v89
    v_mfma_f32_16x16x32_bf16 v[220:223], a[120:123], v[184:187], v[220:223]
    v_cvt_pk_bf16_f32 v106, v76, v92
    v_cvt_pk_bf16_f32 v107, v77, v93
    v_mfma_f32_16x16x32_bf16 v[208:211], a[76:79], v[172:175], v[208:211]
    ds_write_b128 v2, v[104:107] offset:2304
    v_cvt_pk_bf16_f32 v108, v74, v90
    v_mfma_f32_16x16x32_bf16 v[212:215], a[92:95], v[172:175], v[212:215]
    v_cvt_pk_bf16_f32 v109, v75, v91
    v_cvt_pk_bf16_f32 v110, v78, v94
    v_mfma_f32_16x16x32_bf16 v[216:219], a[108:111], v[188:191], v[216:219]
    v_cvt_pk_bf16_f32 v111, v79, v95
    ds_write_b128 v2, v[108:111] offset:2320
    v_mfma_f32_16x16x32_bf16 v[220:223], a[124:127], v[188:191], v[220:223]
    s_waitcnt lgkmcnt(0)
    v_mfma_f32_16x16x32_bf16 v[64:67], v[28:31], v[44:47], 0
    v_mfma_f32_16x16x32_bf16 v[68:71], v[28:31], v[52:55], 0
    ds_read_b128 v[112:115], v3 offset:0
    ds_read_b128 v[116:119], v3 offset:1152
    v_mfma_f32_16x16x32_bf16 v[72:75], v[28:31], v[48:51], 0
    ds_read_b128 v[120:123], v3 offset:2304
    ds_read_b128 v[124:127], v3 offset:3456
    v_mfma_f32_16x16x32_bf16 v[76:79], v[28:31], v[56:59], 0
    v_cvt_pk_bf16_f32 v36, v208, v209
    v_cvt_pk_bf16_f32 v37, v210, v211
    v_mfma_f32_16x16x32_bf16 v[64:67], v[32:35], v[20:23], v[64:67]
    v_cvt_pk_bf16_f32 v38, v212, v213
    v_cvt_pk_bf16_f32 v39, v214, v215
    v_mfma_f32_16x16x32_bf16 v[68:71], v[32:35], v[44:47], v[68:71]
    v_cvt_pk_bf16_f32 v40, v216, v217
    v_cvt_pk_bf16_f32 v41, v218, v219
    v_mfma_f32_16x16x32_bf16 v[72:75], v[32:35], v[24:27], v[72:75]
    v_cvt_pk_bf16_f32 v42, v220, v221
    v_cvt_pk_bf16_f32 v43, v222, v223
    v_mfma_f32_16x16x32_bf16 v[76:79], v[32:35], v[48:51], v[76:79]
    s_waitcnt lgkmcnt(0)
    v_mfma_f32_16x16x32_bf16 v[80:83], v[36:39], v[44:47], 0
    v_mfma_f32_16x16x32_bf16 v[84:87], v[36:39], v[52:55], 0
    s_mov_b32 s6, 0
    buffer_store_dwordx4 v[112:115], v16, s[20:23], s6 offen offset:0 sc1
    v_mfma_f32_16x16x32_bf16 v[88:91], v[36:39], v[48:51], 0
    s_mov_b32 s6, 524288
    buffer_store_dwordx4 v[116:119], v16, s[20:23], s6 offen offset:0 sc1
    v_mfma_f32_16x16x32_bf16 v[92:95], v[36:39], v[56:59], 0
    s_mov_b32 s6, 1048576
    buffer_store_dwordx4 v[120:123], v16, s[20:23], s6 offen offset:0 sc1
    v_mfma_f32_16x16x32_bf16 v[80:83], v[40:43], v[20:23], v[80:83]
    s_mov_b32 s6, 1572864
    buffer_store_dwordx4 v[124:127], v16, s[20:23], s6 offen offset:0 sc1
    v_mfma_f32_16x16x32_bf16 v[84:87], v[40:43], v[44:47], v[84:87]
    v_mfma_f32_16x16x32_bf16 v[88:91], v[40:43], v[24:27], v[88:91]
    v_mfma_f32_16x16x32_bf16 v[92:95], v[40:43], v[48:51], v[92:95]
    s_nop 2
    v_cvt_pk_bf16_f32 v96, v64, v80
    v_cvt_pk_bf16_f32 v97, v65, v81
    s_nop 0
    v_cvt_pk_bf16_f32 v98, v68, v84
    v_cvt_pk_bf16_f32 v99, v69, v85
    ds_write_b128 v2, v[96:99] offset:0
    v_cvt_pk_bf16_f32 v100, v66, v82
    v_cvt_pk_bf16_f32 v101, v67, v83
    v_cvt_pk_bf16_f32 v102, v70, v86
    v_cvt_pk_bf16_f32 v103, v71, v87
    ds_write_b128 v2, v[100:103] offset:16
    v_cvt_pk_bf16_f32 v104, v72, v88
    v_cvt_pk_bf16_f32 v105, v73, v89
    v_cvt_pk_bf16_f32 v106, v76, v92
    v_cvt_pk_bf16_f32 v107, v77, v93
    ds_write_b128 v2, v[104:107] offset:2304
    v_cvt_pk_bf16_f32 v108, v74, v90
    v_cvt_pk_bf16_f32 v109, v75, v91
    v_cvt_pk_bf16_f32 v110, v78, v94
    v_cvt_pk_bf16_f32 v111, v79, v95
    ds_write_b128 v2, v[108:111] offset:2320
    s_waitcnt lgkmcnt(0)
    ds_read_b128 v[112:115], v3 offset:0
    ds_read_b128 v[116:119], v3 offset:1152
    ds_read_b128 v[120:123], v3 offset:2304
    ds_read_b128 v[124:127], v3 offset:3456
    s_waitcnt lgkmcnt(0)
    s_mov_b32 s6, 0
    buffer_store_dwordx4 v[112:115], v16, s[20:23], s6 offen offset:128 sc1
    s_mov_b32 s6, 524288
    buffer_store_dwordx4 v[116:119], v16, s[20:23], s6 offen offset:128 sc1
    s_mov_b32 s6, 1048576
    buffer_store_dwordx4 v[120:123], v16, s[20:23], s6 offen offset:128 sc1
    s_mov_b32 s6, 1572864
    buffer_store_dwordx4 v[124:127], v16, s[20:23], s6 offen offset:128 sc1
    s_cmp_ge_u32 s40, 28
    s_cbranch_scc1 L_B2
    s_mov_b32 s22, 0x1000000
    s_mov_b32 s23, 0x20000
    s_mov_b32 s26, 0x62000
    s_mov_b32 s27, 0x20000
    s_mov_b32 s30, 0x380000
    s_mov_b32 s31, 0x20000
    s_mov_b32 s38, 0x100
    s_mov_b32 s39, 0x20000
    s_mul_i32 s6, s40, 37
    s_lshr_b32 s6, s6, 8
    s_mul_i32 s7, s6, 7
    s_sub_u32 s41, s40, s7
    s_lshl_b32 s6, s6, 2
    s_add_u32 s6, s6, s3
    s_and_b32 s7, s2, 1
    s_lshl_b32 s7, s7, 4
    s_add_u32 s6, s6, s7
    s_and_b32 s7, s2, 4
    s_lshl_b32 s7, s7, 3
    s_add_u32 s6, s6, s7
    s_bfe_u32 s8, s2, 0x10001
    s_lshl_b32 s7, s8, 6
    s_add_u32 s42, s6, s7
    v_lshrrev_b32 v32, 3, v1
    v_and_b32 v33, 6, v32
    v_and_b32 v34, 7, v1
    v_xor_b32 v33, v33, v34
    v_mul_u32_u24 v32, 896, v32
    v_lshl_add_u32 v32, v33, 4, v32
    s_lshl_b32 s7, s41, 7
    v_add_u32 v240, s7, v32
    s_mul_i32 s44, s41, 7
    s_add_u32 s44, s44, s3
    s_mul_i32 s44, s44, 7168
    s_lshl_b32 s45, s3, 10
    s_add_u32 s45, s45, 105472
    v_lshrrev_b32 v32, 2, v1
    v_bfe_u32 v33, v1, 3, 2
    v_lshlrev_b32 v33, 5, v33
    v_lshl_add_u32 v33, v32, 7, v33
    v_and_b32 v34, 3, v1
    v_lshl_add_u32 v33, v34, 3, v33
    v_add_u32 v241, 105472, v33
    v_xor_b32 v242, 32, v241
    v_xor_b32 v243, 64, v241
    v_xor_b32 v244, 96, v241
    s_lshl_b32 s9, s42, 14
    v_lshl_add_u32 v245, v1, 4, s9
    s_lshl_b32 s9, s42, 7
    s_add_u32 s9, s9, 4194304
    v_and_b32 v32, 31, v1
    v_lshl_add_u32 v246, v32, 2, s9
    s_lshl_b32 s6, s6, 5
    s_add_u32 s6, s6, s8
    s_mul_i32 s6, s6, 1792
    s_add_u32 s6, s6, s7
    v_mul_u32_u24 v32, 3584, v253
    v_and_b32 v33, 1, v252
    v_lshl_add_u32 v32, v33, 5, v32
    v_lshrrev_b32 v33, 1, v252
    v_lshl_add_u32 v32, v33, 4, v32
    v_add_u32 v247, s6, v32
    v_mov_b32 v248, 0x40000000
    s_add_u32 s6, s44, 0
    s_sub_u32 s7, s6, 401408
    s_add_u32 m0, s45, 0
    s_min_u32 s6, s6, s7
    buffer_load_dwordx4 v240, s[24:27], s6 offen lds
    s_add_u32 s6, s44, 28672
    s_sub_u32 s7, s6, 401408
    s_add_u32 m0, s45, 4096
    s_min_u32 s6, s6, s7
    buffer_load_dwordx4 v240, s[24:27], s6 offen lds
    s_add_u32 s6, s44, 57344
    s_sub_u32 s7, s6, 401408
    s_add_u32 m0, s45, 8192
    s_min_u32 s6, s6, s7
    buffer_load_dwordx4 v240, s[24:27], s6 offen lds
    s_add_u32 s6, s44, 86016
    s_sub_u32 s7, s6, 401408
    s_add_u32 m0, s45, 12288
    s_min_u32 s6, s6, s7
    buffer_load_dwordx4 v240, s[24:27], s6 offen lds
    s_waitcnt vmcnt(4)
    s_mov_b32 s10, 65536
L_ncP:
    v_readfirstlane_b32 s6, v251
    s_sub_u32 s10, s10, 1
    s_cselect_b32 s6, 1, s6
    s_cmp_lg_u32 s6, 0
    s_cbranch_scc1 L_ndP
    buffer_load_dwordx2 v[250:251], off, s[36:39], 0 sc1
    s_waitcnt vmcnt(0)
    s_branch L_ncP
L_ndP:
    s_mov_b64 exec, 1
    buffer_store_dword v250, v19, s[20:23], 0 offen sc1
    s_mov_b64 exec, -1
    s_add_u32 s6, s44, 114688
    s_sub_u32 s7, s6, 401408
    s_add_u32 m0, s45, 16384
    s_min_u32 s6, s6, s7
    buffer_load_dwordx4 v240, s[24:27], s6 offen lds
    s_add_u32 s6, s44, 143360
    s_sub_u32 s7, s6, 401408
    s_add_u32 m0, s45, 20480
    s_min_u32 s6, s6, s7
    buffer_load_dwordx4 v240, s[24:27], s6 offen lds
    s_add_u32 s6, s44, 172032
    s_sub_u32 s7, s6, 401408
    s_add_u32 m0, s45, 24576
    s_min_u32 s6, s6, s7
    buffer_load_dwordx4 v240, s[24:27], s6 offen lds
    s_add_u32 s6, s44, 200704
    s_sub_u32 s7, s6, 401408
    s_add_u32 m0, s45, 28672
    s_min_u32 s6, s6, s7
    buffer_load_dwordx4 v240, s[24:27], s6 offen lds
    s_add_u32 s6, s44, 229376
    s_sub_u32 s7, s6, 401408
    s_add_u32 m0, s45, 32768
    s_min_u32 s6, s6, s7
    buffer_load_dwordx4 v240, s[24:27], s6 offen lds
    s_add_u32 s6, s44, 258048
    s_sub_u32 s7, s6, 401408
    s_add_u32 m0, s45, 36864
    s_min_u32 s6, s6, s7
    buffer_load_dwordx4 v240, s[24:27], s6 offen lds
    s_add_u32 s6, s44, 286720
    s_sub_u32 s7, s6, 401408
    s_add_u32 m0, s45, 40960
    s_min_u32 s6, s6, s7
    buffer_load_dwordx4 v240, s[24:27], s6 offen lds
    s_add_u32 s6, s44, 315392
    s_sub_u32 s7, s6, 401408
    s_add_u32 m0, s45, 45056
    s_min_u32 s6, s6, s7
    buffer_load_dwordx4 v240, s[24:27], s6 offen lds
    s_add_u32 s6, s44, 344064
    s_sub_u32 s7, s6, 401408
    s_add_u32 m0, s45, 49152
    s_min_u32 s6, s6, s7
    buffer_load_dwordx4 v240, s[24:27], s6 offen lds
    s_add_u32 s6, s44, 372736
    s_sub_u32 s7, s6, 401408
    s_add_u32 m0, s45, 53248
    s_min_u32 s6, s6, s7
    buffer_load_dwordx4 v240, s[24:27], s6 offen lds
    s_mov_b32 m0, 162816
    s_mov_b32 s6, 0x40000000
    buffer_load_dwordx4 v240, s[24:27], s6 offen lds
    s_waitcnt vmcnt(0)
    s_branch L_P2
L_B2:
    s_mov_b32 s26, 0x62000
    s_mov_b32 s27, 0x20000
    s_mov_b32 s30, 0x380000
    s_mov_b32 s31, 0x20000
    s_sub_u32 s6, s47, 16
    s_mul_i32 s6, s6, 28*896
    v_mul_u32_u24 v32, 86, v1
    v_lshrrev_b32 v32, 8, v32
    v_mul_u32_u24 v32, 512, v32
    v_lshl_add_u32 v32, v1, 7, v32
    s_add_u32 s7, s6, 14*896
    s_bfm_b64 exec, 42, 0
    buffer_load_dword v255, v32, s[24:27], s6 offen
    buffer_load_dword v255, v32, s[24:27], s7 offen
    s_mov_b64 exec, -1
    s_and_b32 s6, s2, 7
    s_lshl2_add_u32 s48, s6, s40
    s_sub_u32 s48, s48, 28
    s_lshl_b32 s6, s3, 4
    v_add_u32 v11, s6, v253
    v_cvt_f32_u32 v12, v11
    v_mul_f32 v12, 0x3c800000, v12
    v_lshlrev_b32 v13, 2, v252
    v_cvt_f32_u32 v13, v13
    v_mul_f32 v13, v13, v12
    v_fmamk_f32 v32, v12, 0x00000000, v13
    v_fmamk_f32 v33, v12, 0x3f800000, v13
    v_fmamk_f32 v34, v12, 0x40000000, v13
    v_fmamk_f32 v35, v12, 0x40400000, v13
    v_fmamk_f32 v36, v12, 0x41800000, v13
    v_fmamk_f32 v37, v12, 0x41880000, v13
    v_fmamk_f32 v38, v12, 0x41900000, v13
    v_fmamk_f32 v39, v12, 0x41980000, v13
    v_cos_f32 v40, v32
    v_cos_f32 v41, v33
    v_cos_f32 v42, v34
    v_cos_f32 v43, v35
    v_cos_f32 v44, v36
    v_cos_f32 v45, v37
    v_cos_f32 v46, v38
    v_cos_f32 v47, v39
    v_sin_f32 v48, v32
    v_sin_f32 v49, v33
    v_sin_f32 v50, v34
    v_sin_f32 v51, v35
    v_sin_f32 v52, v36
    v_sin_f32 v53, v37
    v_sin_f32 v54, v38
    v_sin_f32 v55, v39
    v_cvt_pk_bf16_f32 v64, v40, -v48
    v_cvt_pk_bf16_f32 v65, v41, -v49
    v_cvt_pk_bf16_f32 v66, v42, -v50
    v_cvt_pk_bf16_f32 v67, v43, -v51
    v_cvt_pk_bf16_f32 v68, v44, -v52
    v_cvt_pk_bf16_f32 v69, v45, -v53
    v_cvt_pk_bf16_f32 v70, v46, -v54
    v_cvt_pk_bf16_f32 v71, v47, -v55
    v_fmamk_f32 v32, v12, 0x42000000, v13
    v_fmamk_f32 v33, v12, 0x42040000, v13
    v_fmamk_f32 v34, v12, 0x42080000, v13
    v_fmamk_f32 v35, v12, 0x420c0000, v13
    v_fmamk_f32 v36, v12, 0x42400000, v13
    v_fmamk_f32 v37, v12, 0x42440000, v13
    v_fmamk_f32 v38, v12, 0x42480000, v13
    v_fmamk_f32 v39, v12, 0x424c0000, v13
    v_cos_f32 v40, v32
    v_cos_f32 v41, v33
    v_cos_f32 v42, v34
    v_cos_f32 v43, v35
    v_cos_f32 v44, v36
    v_cos_f32 v45, v37
    v_cos_f32 v46, v38
    v_cos_f32 v47, v39
    v_sin_f32 v48, v32
    v_sin_f32 v49, v33
    v_sin_f32 v50, v34
    v_sin_f32 v51, v35
    v_sin_f32 v52, v36
    v_sin_f32 v53, v37
    v_sin_f32 v54, v38
    v_sin_f32 v55, v39
    v_cvt_pk_bf16_f32 v72, v40, -v48
    v_cvt_pk_bf16_f32 v73, v41, -v49
    v_cvt_pk_bf16_f32 v74, v42, -v50
    v_cvt_pk_bf16_f32 v75, v43, -v51
    v_cvt_pk_bf16_f32 v76, v44, -v52
    v_cvt_pk_bf16_f32 v77, v45, -v53
    v_cvt_pk_bf16_f32 v78, v46, -v54
    v_cvt_pk_bf16_f32 v79, v47, -v55
    s_waitcnt vmcnt(2)
    s_mov_b32 s10, 65536
L_ncB:
    v_readfirstlane_b32 s6, v251
    s_sub_u32 s10, s10, 1
    s_cselect_b32 s6, 1, s6
    s_cmp_lg_u32 s6, 0
    s_cbranch_scc1 L_ndB
    buffer_load_dwordx2 v[250:251], off, s[36:39], 0 sc1
    s_waitcnt vmcnt(0)
    s_branch L_ncB
L_ndB:
    s_mov_b64 exec, 1
    buffer_store_dword v250, v19, s[20:23], 0 offen sc1
    s_mov_b64 exec, -1
    v_lshrrev_b32 v32, 3, v1
    v_and_b32 v33, 4, v32
    v_and_b32 v34, 7, v1
    v_xor_b32 v33, v33, v34
    v_lshlrev_b32 v33, 4, v33
    v_lshl_add_u32 v33, v32, 10, v33
    s_lshl2_add_u32 s6, s48, s3
    s_lshl_b32 s6, s6, 14
    s_add_u32 s6, s6, 2097152
    v_add_u32 v2, s6, v33
    s_lshl_b32 s6, s3, 8
    s_add_u32 s6, s6, 4210688
    v_lshl_add_u32 v3, v1, 2, s6
    s_lshl_b32 s11, s3, 11
    s_add_u32 s11, s11, 65536
    s_movk_i32 s9, 0x2000
    v_bfe_u32 v4, v1, 3, 1
    v_lshl_add_u32 v4, v252, 2, v4
    v_lshlrev_b32 v4, 7, v4
    v_and_b32 v32, 1, v252
    v_lshl_add_u32 v4, v32, 6, v4
    v_and_b32 v32, 3, v1
    v_lshl_add_u32 v4, v32, 4, v4
    v_bfe_u32 v33, v1, 2, 1
    v_lshl_add_u32 v4, v33, 3, v4
    v_add_u32 v4, 65536, v4
    v_xor_b32 v5, 64, v4
    s_mul_i32 s6, s3, 15872
    s_add_u32 s6, s6, 32
    v_mul_u32_u24 v6, 496, v253
    v_add_u32 v6, s6, v6
    v_lshlrev_b32 v33, 3, v252
    v_sub_u32 v7, v6, v33
    v_add_u32 v6, v6, v33
    v_lshrrev_b32 v33, 2, v1
    v_mul_u32_u24 v8, 496, v33
    v_lshl_add_u32 v8, v32, 4, v8
    v_add_u32 v8, s6, v8
    s_lshl_b32 s6, s3, 9
    s_add_u32 s6, s6, s48
    v_lshl_add_u32 v9, v33, 5, s6
    v_sub_u32 v10, 2048, v9
    v_and_b32 v10, 2047, v10
    v_mul_u32_u24 v9, 1792, v9
    v_mul_u32_u24 v10, 1792, v10
    v_lshl_add_u32 v9, v32, 4, v9
    v_lshl_add_u32 v10, v32, 4, v10
    s_barrier
    s_mov_b32 s10, 65536
L_plB:
    buffer_load_dword v32, v3, s[20:23], 0 offen sc1
    s_sub_u32 s10, s10, 1
    s_cbranch_scc1 L_pdB
    s_waitcnt vmcnt(0)
    v_cmp_ne_u32 vcc, v32, v250
    s_cbranch_vccnz L_plB
L_pdB:
    s_add_u32 m0, s11, 0
    s_nop 0
    buffer_load_dwordx4 v2, s[20:23], 0 offen offset:0 sc1 lds
    s_add_u32 m0, s11, 1024
    s_nop 0
    buffer_load_dwordx4 v2, s[20:23], s9 offen offset:0 sc1 lds
    s_add_u32 m0, s11, 8064
    s_nop 0
    buffer_load_dwordx4 v2, s[20:23], 0 offen offset:128 sc1 lds
    s_add_u32 m0, s11, 9088
    s_nop 0
    buffer_load_dwordx4 v2, s[20:23], s9 offen offset:128 sc1 lds
    s_add_u32 m0, s11, 16128
    s_nop 0
    buffer_load_dwordx4 v2, s[20:23], 0 offen offset:256 sc1 lds
    s_add_u32 m0, s11, 17152
    s_nop 0
    buffer_load_dwordx4 v2, s[20:23], s9 offen offset:256 sc1 lds
    s_add_u32 m0, s11, 24192
    s_nop 0
    buffer_load_dwordx4 v2, s[20:23], 0 offen offset:384 sc1 lds
    s_add_u32 m0, s11, 25216
    s_nop 0
    buffer_load_dwordx4 v2, s[20:23], s9 offen offset:384 sc1 lds
    s_add_u32 m0, s11, 32256
    s_nop 0
    buffer_load_dwordx4 v2, s[20:23], 0 offen offset:512 sc1 lds
    s_add_u32 m0, s11, 33280
    s_nop 0
    buffer_load_dwordx4 v2, s[20:23], s9 offen offset:512 sc1 lds
    s_add_u32 m0, s11, 40320
    s_nop 0
    buffer_load_dwordx4 v2, s[20:23], 0 offen offset:640 sc1 lds
    s_add_u32 m0, s11, 41344
    s_nop 0
    buffer_load_dwordx4 v2, s[20:23], s9 offen offset:640 sc1 lds
    s_add_u32 m0, s11, 48384
    s_nop 0
    buffer_load_dwordx4 v2, s[20:23], 0 offen offset:768 sc1 lds
    s_add_u32 m0, s11, 49408
    s_nop 0
    buffer_load_dwordx4 v2, s[20:23], s9 offen offset:768 sc1 lds
    s_add_u32 m0, s11, 56448
    s_nop 0
    buffer_load_dwordx4 v2, s[20:23], 0 offen offset:896 sc1 lds
    s_add_u32 m0, s11, 57472
    s_nop 0
    buffer_load_dwordx4 v2, s[20:23], s9 offen offset:896 sc1 lds
    s_waitcnt vmcnt(12)
    s_barrier
    ds_read_b64_tr_b16 v[96:97], v4 offset:0
    ds_read_b64_tr_b16 v[98:99], v4 offset:256
    ds_read_b64_tr_b16 v[100:101], v4 offset:2048
    ds_read_b64_tr_b16 v[102:103], v4 offset:2304
    ds_read_b64_tr_b16 v[104:105], v4 offset:4096
    ds_read_b64_tr_b16 v[106:107], v4 offset:4352
    ds_read_b64_tr_b16 v[108:109], v4 offset:6144
    ds_read_b64_tr_b16 v[110:111], v4 offset:6400
    ds_read_b64_tr_b16 v[112:113], v5 offset:0
    ds_read_b64_tr_b16 v[114:115], v5 offset:256
    ds_read_b64_tr_b16 v[116:117], v5 offset:2048
    ds_read_b64_tr_b16 v[118:119], v5 offset:2304
    ds_read_b64_tr_b16 v[120:121], v5 offset:4096
    ds_read_b64_tr_b16 v[122:123], v5 offset:4352
    ds_read_b64_tr_b16 v[124:125], v5 offset:6144
    ds_read_b64_tr_b16 v[126:127], v5 offset:6400
    s_waitcnt lgkmcnt(0)
    ds_read_b64_tr_b16 v[128:129], v4 offset:8192
    ds_read_b64_tr_b16 v[130:131], v4 offset:8448
    v_mfma_f32_16x16x32_bf16 v[32:35], v[96:99], v[64:67], 0
    ds_read_b64_tr_b16 v[132:133], v4 offset:10240
    ds_read_b64_tr_b16 v[134:135], v4 offset:10496
    v_mfma_f32_16x16x32_bf16 v[36:39], v[112:115], v[64:67], 0
    ds_read_b64_tr_b16 v[136:137], v4 offset:12288
    ds_read_b64_tr_b16 v[138:139], v4 offset:12544
    v_mfma_f32_16x16x32_bf16 v[32:35], v[100:103], v[68:71], v[32:35]
    ds_read_b64_tr_b16 v[140:141], v4 offset:14336
    ds_read_b64_tr_b16 v[142:143], v4 offset:14592
    v_mfma_f32_16x16x32_bf16 v[36:39], v[116:119], v[68:71], v[36:39]
    ds_read_b64_tr_b16 v[144:145], v5 offset:8192
    ds_read_b64_tr_b16 v[146:147], v5 offset:8448
    v_mfma_f32_16x16x32_bf16 v[32:35], v[104:107], v[72:75], v[32:35]
    ds_read_b64_tr_b16 v[148:149], v5 offset:10240
    ds_read_b64_tr_b16 v[150:151], v5 offset:10496
    v_mfma_f32_16x16x32_bf16 v[36:39], v[120:123], v[72:75], v[36:39]
    ds_read_b64_tr_b16 v[152:153], v5 offset:12288
    ds_read_b64_tr_b16 v[154:155], v5 offset:12544
    v_mfma_f32_16x16x32_bf16 v[32:35], v[108:111], v[76:79], v[32:35]
    ds_read_b64_tr_b16 v[156:157], v5 offset:14336
    ds_read_b64_tr_b16 v[158:159], v5 offset:14592
    v_mfma_f32_16x16x32_bf16 v[36:39], v[124:127], v[76:79], v[36:39]
    s_waitcnt lgkmcnt(0)
    v_mfma_f32_16x16x32_bf16 v[40:43], v[128:131], v[64:67], 0
    v_mfma_f32_16x16x32_bf16 v[44:47], v[144:147], v[64:67], 0
    v_mfma_f32_16x16x32_bf16 v[40:43], v[132:135], v[68:71], v[40:43]
    v_mfma_f32_16x16x32_bf16 v[44:47], v[148:151], v[68:71], v[44:47]
    v_mfma_f32_16x16x32_bf16 v[40:43], v[136:139], v[72:75], v[40:43]
    v_mfma_f32_16x16x32_bf16 v[44:47], v[152:155], v[72:75], v[44:47]
    v_mfma_f32_16x16x32_bf16 v[40:43], v[140:143], v[76:79], v[40:43]
    v_mfma_f32_16x16x32_bf16 v[44:47], v[156:159], v[76:79], v[44:47]
    v_cvt_pk_bf16_f32 v48, v32, v33
    v_cvt_pk_bf16_f32 v49, v34, v35
    v_cvt_pk_bf16_f32 v50, v34, v33
    ds_write_b64 v6, v[48:49] offset:0
    ds_write_b16 v7, v48 offset:8384
    ds_write_b32 v7, v50 offset:8380
    ds_write_b16_d16_hi v7, v49 offset:8378
    v_cvt_pk_bf16_f32 v52, v36, v37
    v_cvt_pk_bf16_f32 v53, v38, v39
    v_cvt_pk_bf16_f32 v54, v38, v37
    ds_write_b64 v6, v[52:53] offset:32
    ds_write_b16 v7, v52 offset:8352
    ds_write_b32 v7, v54 offset:8348
    ds_write_b16_d16_hi v7, v53 offset:8346
    v_cvt_pk_bf16_f32 v56, v40, v41
    v_cvt_pk_bf16_f32 v57, v42, v43
    v_cvt_pk_bf16_f32 v58, v42, v41
    ds_write_b64 v6, v[56:57] offset:64
    ds_write_b16 v7, v56 offset:8320
    ds_write_b32 v7, v58 offset:8316
    ds_write_b16_d16_hi v7, v57 offset:8314
    v_cvt_pk_bf16_f32 v60, v44, v45
    v_cvt_pk_bf16_f32 v61, v46, v47
    v_cvt_pk_bf16_f32 v62, v46, v45
    ds_write_b64 v6, v[60:61] offset:96
    ds_write_b16 v7, v60 offset:8288
    ds_write_b32 v7, v62 offset:8284
    ds_write_b16_d16_hi v7, v61 offset:8282
    s_waitcnt lgkmcnt(0)
    ds_read_b128 v[160:163], v8 offset:0
    ds_read_b128 v[164:167], v8 offset:64
    ds_read_b128 v[168:171], v8 offset:8320
    s_waitcnt lgkmcnt(0)
    buffer_store_dwordx4 v[160:163], v9, s[28:31], 0 offen offset:896 sc1
    buffer_store_dwordx4 v[164:167], v9, s[28:31], 0 offen offset:960 sc1
    buffer_store_dwordx4 v[168:171], v10, s[28:31], 0 offen offset:1728 sc1
    s_waitcnt vmcnt(11)
    s_barrier
    ds_read_b64_tr_b16 v[96:97], v4 offset:16384
    ds_read_b64_tr_b16 v[98:99], v4 offset:16640
    ds_read_b64_tr_b16 v[100:101], v4 offset:18432
    ds_read_b64_tr_b16 v[102:103], v4 offset:18688
    ds_read_b64_tr_b16 v[104:105], v4 offset:20480
    ds_read_b64_tr_b16 v[106:107], v4 offset:20736
    ds_read_b64_tr_b16 v[108:109], v4 offset:22528
    ds_read_b64_tr_b16 v[110:111], v4 offset:22784
    ds_read_b64_tr_b16 v[112:113], v5 offset:16384
    ds_read_b64_tr_b16 v[114:115], v5 offset:16640
    ds_read_b64_tr_b16 v[116:117], v5 offset:18432
    ds_read_b64_tr_b16 v[118:119], v5 offset:18688
    ds_read_b64_tr_b16 v[120:121], v5 offset:20480
    ds_read_b64_tr_b16 v[122:123], v5 offset:20736
    ds_read_b64_tr_b16 v[124:125], v5 offset:22528
    ds_read_b64_tr_b16 v[126:127], v5 offset:22784
    s_waitcnt lgkmcnt(0)
    ds_read_b64_tr_b16 v[128:129], v4 offset:24576
    ds_read_b64_tr_b16 v[130:131], v4 offset:24832
    v_mfma_f32_16x16x32_bf16 v[32:35], v[96:99], v[64:67], 0
    ds_read_b64_tr_b16 v[132:133], v4 offset:26624
    ds_read_b64_tr_b16 v[134:135], v4 offset:26880
    v_mfma_f32_16x16x32_bf16 v[36:39], v[112:115], v[64:67], 0
    ds_read_b64_tr_b16 v[136:137], v4 offset:28672
    ds_read_b64_tr_b16 v[138:139], v4 offset:28928
    v_mfma_f32_16x16x32_bf16 v[32:35], v[100:103], v[68:71], v[32:35]
    ds_read_b64_tr_b16 v[140:141], v4 offset:30720
    ds_read_b64_tr_b16 v[142:143], v4 offset:30976
    v_mfma_f32_16x16x32_bf16 v[36:39], v[116:119], v[68:71], v[36:39]
    ds_read_b64_tr_b16 v[144:145], v5 offset:24576
    ds_read_b64_tr_b16 v[146:147], v5 offset:24832
    v_mfma_f32_16x16x32_bf16 v[32:35], v[104:107], v[72:75], v[32:35]
    ds_read_b64_tr_b16 v[148:149], v5 offset:26624
    ds_read_b64_tr_b16 v[150:151], v5 offset:26880
    v_mfma_f32_16x16x32_bf16 v[36:39], v[120:123], v[72:75], v[36:39]
    ds_read_b64_tr_b16 v[152:153], v5 offset:28672
    ds_read_b64_tr_b16 v[154:155], v5 offset:28928
    v_mfma_f32_16x16x32_bf16 v[32:35], v[108:111], v[76:79], v[32:35]
    ds_read_b64_tr_b16 v[156:157], v5 offset:30720
    ds_read_b64_tr_b16 v[158:159], v5 offset:30976
    v_mfma_f32_16x16x32_bf16 v[36:39], v[124:127], v[76:79], v[36:39]
    s_waitcnt lgkmcnt(0)
    v_mfma_f32_16x16x32_bf16 v[40:43], v[128:131], v[64:67], 0
    v_mfma_f32_16x16x32_bf16 v[44:47], v[144:147], v[64:67], 0
    v_mfma_f32_16x16x32_bf16 v[40:43], v[132:135], v[68:71], v[40:43]
    v_mfma_f32_16x16x32_bf16 v[44:47], v[148:151], v[68:71], v[44:47]
    v_mfma_f32_16x16x32_bf16 v[40:43], v[136:139], v[72:75], v[40:43]
    v_mfma_f32_16x16x32_bf16 v[44:47], v[152:155], v[72:75], v[44:47]
    v_mfma_f32_16x16x32_bf16 v[40:43], v[140:143], v[76:79], v[40:43]
    v_mfma_f32_16x16x32_bf16 v[44:47], v[156:159], v[76:79], v[44:47]
    v_cvt_pk_bf16_f32 v48, v32, v33
    v_cvt_pk_bf16_f32 v49, v34, v35
    v_cvt_pk_bf16_f32 v50, v34, v33
    ds_write_b64 v6, v[48:49] offset:128
    ds_write_b16 v7, v48 offset:8256
    ds_write_b32 v7, v50 offset:8252
    ds_write_b16_d16_hi v7, v49 offset:8250
    v_cvt_pk_bf16_f32 v52, v36, v37
    v_cvt_pk_bf16_f32 v53, v38, v39
    v_cvt_pk_bf16_f32 v54, v38, v37
    ds_write_b64 v6, v[52:53] offset:160
    ds_write_b16 v7, v52 offset:8224
    ds_write_b32 v7, v54 offset:8220
    ds_write_b16_d16_hi v7, v53 offset:8218
    v_cvt_pk_bf16_f32 v56, v40, v41
    v_cvt_pk_bf16_f32 v57, v42, v43
    v_cvt_pk_bf16_f32 v58, v42, v41
    ds_write_b64 v6, v[56:57] offset:192
    ds_write_b16 v7, v56 offset:8192
    ds_write_b32 v7, v58 offset:8188
    ds_write_b16_d16_hi v7, v57 offset:8186
    v_cvt_pk_bf16_f32 v60, v44, v45
    v_cvt_pk_bf16_f32 v61, v46, v47
    v_cvt_pk_bf16_f32 v62, v46, v45
    ds_write_b64 v6, v[60:61] offset:224
    ds_write_b16 v7, v60 offset:8160
    ds_write_b32 v7, v62 offset:8156
    ds_write_b16_d16_hi v7, v61 offset:8154
    s_waitcnt lgkmcnt(0)
    ds_read_b128 v[176:179], v8 offset:128
    ds_read_b128 v[180:183], v8 offset:192
    ds_read_b128 v[184:187], v8 offset:8256
    ds_read_b128 v[188:191], v8 offset:8192
    s_waitcnt lgkmcnt(0)
    buffer_store_dwordx4 v[176:179], v9, s[28:31], 0 offen offset:1024 sc1
    buffer_store_dwordx4 v[180:183], v9, s[28:31], 0 offen offset:1088 sc1
    buffer_store_dwordx4 v[184:187], v10, s[28:31], 0 offen offset:1664 sc1
    buffer_store_dwordx4 v[188:191], v10, s[28:31], 0 offen offset:1600 sc1
    s_waitcnt vmcnt(11)
    s_barrier
    ds_read_b64_tr_b16 v[96:97], v4 offset:32768
    ds_read_b64_tr_b16 v[98:99], v4 offset:33024
    ds_read_b64_tr_b16 v[100:101], v4 offset:34816
    ds_read_b64_tr_b16 v[102:103], v4 offset:35072
    ds_read_b64_tr_b16 v[104:105], v4 offset:36864
    ds_read_b64_tr_b16 v[106:107], v4 offset:37120
    ds_read_b64_tr_b16 v[108:109], v4 offset:38912
    ds_read_b64_tr_b16 v[110:111], v4 offset:39168
    ds_read_b64_tr_b16 v[112:113], v5 offset:32768
    ds_read_b64_tr_b16 v[114:115], v5 offset:33024
    ds_read_b64_tr_b16 v[116:117], v5 offset:34816
    ds_read_b64_tr_b16 v[118:119], v5 offset:35072
    ds_read_b64_tr_b16 v[120:121], v5 offset:36864
    ds_read_b64_tr_b16 v[122:123], v5 offset:37120
    ds_read_b64_tr_b16 v[124:125], v5 offset:38912
    ds_read_b64_tr_b16 v[126:127], v5 offset:39168
    s_waitcnt lgkmcnt(0)
    ds_read_b64_tr_b16 v[128:129], v4 offset:40960
    ds_read_b64_tr_b16 v[130:131], v4 offset:41216
    v_mfma_f32_16x16x32_bf16 v[32:35], v[96:99], v[64:67], 0
    ds_read_b64_tr_b16 v[132:133], v4 offset:43008
    ds_read_b64_tr_b16 v[134:135], v4 offset:43264
    v_mfma_f32_16x16x32_bf16 v[36:39], v[112:115], v[64:67], 0
    ds_read_b64_tr_b16 v[136:137], v4 offset:45056
    ds_read_b64_tr_b16 v[138:139], v4 offset:45312
    v_mfma_f32_16x16x32_bf16 v[32:35], v[100:103], v[68:71], v[32:35]
    ds_read_b64_tr_b16 v[140:141], v4 offset:47104
    ds_read_b64_tr_b16 v[142:143], v4 offset:47360
    v_mfma_f32_16x16x32_bf16 v[36:39], v[116:119], v[68:71], v[36:39]
    ds_read_b64_tr_b16 v[144:145], v5 offset:40960
    ds_read_b64_tr_b16 v[146:147], v5 offset:41216
    v_mfma_f32_16x16x32_bf16 v[32:35], v[104:107], v[72:75], v[32:35]
    ds_read_b64_tr_b16 v[148:149], v5 offset:43008
    ds_read_b64_tr_b16 v[150:151], v5 offset:43264
    v_mfma_f32_16x16x32_bf16 v[36:39], v[120:123], v[72:75], v[36:39]
    ds_read_b64_tr_b16 v[152:153], v5 offset:45056
    ds_read_b64_tr_b16 v[154:155], v5 offset:45312
    v_mfma_f32_16x16x32_bf16 v[32:35], v[108:111], v[76:79], v[32:35]
    ds_read_b64_tr_b16 v[156:157], v5 offset:47104
    ds_read_b64_tr_b16 v[158:159], v5 offset:47360
    v_mfma_f32_16x16x32_bf16 v[36:39], v[124:127], v[76:79], v[36:39]
    s_waitcnt lgkmcnt(0)
    v_mfma_f32_16x16x32_bf16 v[40:43], v[128:131], v[64:67], 0
    v_mfma_f32_16x16x32_bf16 v[44:47], v[144:147], v[64:67], 0
    v_mfma_f32_16x16x32_bf16 v[40:43], v[132:135], v[68:71], v[40:43]
    v_mfma_f32_16x16x32_bf16 v[44:47], v[148:151], v[68:71], v[44:47]
    v_mfma_f32_16x16x32_bf16 v[40:43], v[136:139], v[72:75], v[40:43]
    v_mfma_f32_16x16x32_bf16 v[44:47], v[152:155], v[72:75], v[44:47]
    v_mfma_f32_16x16x32_bf16 v[40:43], v[140:143], v[76:79], v[40:43]
    v_mfma_f32_16x16x32_bf16 v[44:47], v[156:159], v[76:79], v[44:47]
    v_cvt_pk_bf16_f32 v48, v32, v33
    v_cvt_pk_bf16_f32 v49, v34, v35
    v_cvt_pk_bf16_f32 v50, v34, v33
    ds_write_b64 v6, v[48:49] offset:256
    ds_write_b16 v7, v48 offset:8128
    ds_write_b32 v7, v50 offset:8124
    ds_write_b16_d16_hi v7, v49 offset:8122
    v_cvt_pk_bf16_f32 v52, v36, v37
    v_cvt_pk_bf16_f32 v53, v38, v39
    v_cvt_pk_bf16_f32 v54, v38, v37
    ds_write_b64 v6, v[52:53] offset:288
    ds_write_b16 v7, v52 offset:8096
    ds_write_b32 v7, v54 offset:8092
    ds_write_b16_d16_hi v7, v53 offset:8090
    v_cvt_pk_bf16_f32 v56, v40, v41
    v_cvt_pk_bf16_f32 v57, v42, v43
    v_cvt_pk_bf16_f32 v58, v42, v41
    ds_write_b64 v6, v[56:57] offset:320
    ds_write_b16 v7, v56 offset:8064
    ds_write_b32 v7, v58 offset:8060
    ds_write_b16_d16_hi v7, v57 offset:8058
    v_cvt_pk_bf16_f32 v60, v44, v45
    v_cvt_pk_bf16_f32 v61, v46, v47
    v_cvt_pk_bf16_f32 v62, v46, v45
    ds_write_b64 v6, v[60:61] offset:352
    ds_write_b16 v7, v60 offset:8032
    ds_write_b32 v7, v62 offset:8028
    ds_write_b16_d16_hi v7, v61 offset:8026
    s_waitcnt lgkmcnt(0)
    ds_read_b128 v[192:195], v8 offset:256
    ds_read_b128 v[196:199], v8 offset:320
    ds_read_b128 v[200:203], v8 offset:8128
    ds_read_b128 v[204:207], v8 offset:8064
    s_waitcnt lgkmcnt(0)
    buffer_store_dwordx4 v[192:195], v9, s[28:31], 0 offen offset:1152 sc1
    buffer_store_dwordx4 v[196:199], v9, s[28:31], 0 offen offset:1216 sc1
    buffer_store_dwordx4 v[200:203], v10, s[28:31], 0 offen offset:1536 sc1
    buffer_store_dwordx4 v[204:207], v10, s[28:31], 0 offen offset:1472 sc1
    s_waitcnt vmcnt(11)
    s_barrier
    ds_read_b64_tr_b16 v[96:97], v4 offset:49152
    ds_read_b64_tr_b16 v[98:99], v4 offset:49408
    ds_read_b64_tr_b16 v[100:101], v4 offset:51200
    ds_read_b64_tr_b16 v[102:103], v4 offset:51456
    ds_read_b64_tr_b16 v[104:105], v4 offset:53248
    ds_read_b64_tr_b16 v[106:107], v4 offset:53504
    ds_read_b64_tr_b16 v[108:109], v4 offset:55296
    ds_read_b64_tr_b16 v[110:111], v4 offset:55552
    ds_read_b64_tr_b16 v[112:113], v5 offset:49152
    ds_read_b64_tr_b16 v[114:115], v5 offset:49408
    ds_read_b64_tr_b16 v[116:117], v5 offset:51200
    ds_read_b64_tr_b16 v[118:119], v5 offset:51456
    ds_read_b64_tr_b16 v[120:121], v5 offset:53248
    ds_read_b64_tr_b16 v[122:123], v5 offset:53504
    ds_read_b64_tr_b16 v[124:125], v5 offset:55296
    ds_read_b64_tr_b16 v[126:127], v5 offset:55552
    s_waitcnt lgkmcnt(0)
    ds_read_b64_tr_b16 v[128:129], v4 offset:57344
    ds_read_b64_tr_b16 v[130:131], v4 offset:57600
    v_mfma_f32_16x16x32_bf16 v[32:35], v[96:99], v[64:67], 0
    ds_read_b64_tr_b16 v[132:133], v4 offset:59392
    ds_read_b64_tr_b16 v[134:135], v4 offset:59648
    v_mfma_f32_16x16x32_bf16 v[36:39], v[112:115], v[64:67], 0
    ds_read_b64_tr_b16 v[136:137], v4 offset:61440
    ds_read_b64_tr_b16 v[138:139], v4 offset:61696
    v_mfma_f32_16x16x32_bf16 v[32:35], v[100:103], v[68:71], v[32:35]
    ds_read_b64_tr_b16 v[140:141], v4 offset:63488
    ds_read_b64_tr_b16 v[142:143], v4 offset:63744
    v_mfma_f32_16x16x32_bf16 v[36:39], v[116:119], v[68:71], v[36:39]
    v_mfma_f32_16x16x32_bf16 v[32:35], v[104:107], v[72:75], v[32:35]
    v_mfma_f32_16x16x32_bf16 v[36:39], v[120:123], v[72:75], v[36:39]
    v_mfma_f32_16x16x32_bf16 v[32:35], v[108:111], v[76:79], v[32:35]
    v_mfma_f32_16x16x32_bf16 v[36:39], v[124:127], v[76:79], v[36:39]
    s_waitcnt lgkmcnt(0)
    v_mfma_f32_16x16x32_bf16 v[40:43], v[128:131], v[64:67], 0
    v_mfma_f32_16x16x32_bf16 v[40:43], v[132:135], v[68:71], v[40:43]
    v_mfma_f32_16x16x32_bf16 v[40:43], v[136:139], v[72:75], v[40:43]
    v_mfma_f32_16x16x32_bf16 v[40:43], v[140:143], v[76:79], v[40:43]
    s_nop 1
    v_cvt_pk_bf16_f32 v48, v32, v33
    v_cvt_pk_bf16_f32 v49, v34, v35
    v_cvt_pk_bf16_f32 v50, v34, v33
    ds_write_b64 v6, v[48:49] offset:384
    ds_write_b16 v7, v48 offset:8000
    ds_write_b32 v7, v50 offset:7996
    ds_write_b16_d16_hi v7, v49 offset:7994
    v_cvt_pk_bf16_f32 v52, v36, v37
    v_cvt_pk_bf16_f32 v53, v38, v39
    v_cvt_pk_bf16_f32 v54, v38, v37
    ds_write_b64 v6, v[52:53] offset:416
    ds_write_b16 v7, v52 offset:7968
    ds_write_b32 v7, v54 offset:7964
    ds_write_b16_d16_hi v7, v53 offset:7962
    v_cvt_pk_bf16_f32 v56, v40, v41
    ds_write_b16 v7, v56 offset:7936
    s_waitcnt lgkmcnt(0)
    ds_read_b128 v[208:211], v8 offset:384
    ds_read_b128 v[212:215], v8 offset:8000
    ds_read_b128 v[216:219], v8 offset:7936
    s_waitcnt lgkmcnt(0)
    buffer_store_dwordx4 v[208:211], v9, s[28:31], 0 offen offset:1280 sc1
    buffer_store_dwordx4 v[212:215], v10, s[28:31], 0 offen offset:1408 sc1
    buffer_store_dwordx4 v[216:219], v10, s[28:31], 0 offen offset:1344 sc1
L_end:
    s_endpgm
.section .rodata,"a"
.p2align 6
.amdhsa_kernel concat_heads__sliding_local_dilated__spectral_fnet__prompt_kernel
  .amdhsa_next_free_vgpr 512
  .amdhsa_next_free_sgpr 102
  .amdhsa_accum_offset 256
  .amdhsa_group_segment_fixed_size 0
  .amdhsa_kernarg_size 88
  .amdhsa_user_sgpr_count 2
  .amdhsa_user_sgpr_kernarg_segment_ptr 1
  .amdhsa_system_sgpr_workgroup_id_x 1
  .amdhsa_float_denorm_mode_32 3
.end_amdhsa_kernel
```

```asm
; @launch grid=(256,1,1) block=(256,1,1) lds=163840
.amdgcn_target "amdgcn-amd-amdhsa--gfx950"
.text
.p2align 12
.fill 0x340, 4, 0xbf800000
.text
.globl concat_heads__sliding_local_dilated__spectral_fnet__prompt_kernel
.p2align 8
.type concat_heads__sliding_local_dilated__spectral_fnet__prompt_kernel,@function
concat_heads__sliding_local_dilated__spectral_fnet__prompt_kernel:
    s_load_dwordx2 s[16:17], s[0:1], 8
    s_load_dwordx2 s[20:21], s[0:1], 80
    s_cmpk_ge_u32 s2, 256
    s_cbranch_scc1 L_end
    s_lshr_b32 s40, s2, 3
    s_getpc_b64 s[4:5]
L_pc:
    v_lshrrev_b32 v2, 5, v0
    v_lshrrev_b32 v3, 6, v0
    v_lshl_add_u32 v2, s40, 3, v2
    v_min_u32 v2, (L_end - L_pc) / 128, v2
    v_lshlrev_b32 v2, 7, v2
    v_readfirstlane_b32 s3, v3
    global_load_dword v255, v2, s[4:5]
    s_load_dwordx2 s[12:13], s[0:1], 0
    s_load_dwordx2 s[32:33], s[0:1], 24
    s_load_dwordx2 s[24:25], s[0:1], 16
    s_load_dwordx2 s[28:29], s[0:1], 64
    v_and_b32 v1, 63, v0
    s_and_b32 s9, s2, 7
    s_lshl_b32 s57, s9, 3
    s_min_u32 s100, s9, 6
    v_lshrrev_b32 v252, 4, v1
    v_and_b32 v253, 15, v1
    s_lshr_b32 s44, s2, 6
    s_cmp_lg_u32 s44, 3
    s_cbranch_scc1 L_A
    s_mov_b32 s34, 0x1c0000
    s_mov_b32 s35, 0x20000
    s_add_u32 s46, s57, s40
    s_sub_u32 s46, s46, 24
    s_lshl_b32 s6, s3, 9
    s_add_u32 s6, s6, s46
    s_mul_i32 s6, s6, 896
    v_mul_u32_u24 v2, 64*896, v252
    v_add_u32 v2, s6, v2
    v_cmp_gt_u32 vcc, 14, v253
    v_lshlrev_b32 v3, 4, v253
    s_mov_b32 s48, 229376
    v_cndmask_b32 v4, 2.0, v2, vcc
    v_add_u32 v2, v4, v3
    v_sub_u32 v3, v4, v3
    v_add_u32 v3, 432, v3
    s_waitcnt lgkmcnt(0)
    buffer_load_dwordx4 v[192:195], v2, s[32:35], 0 offen
    buffer_load_dwordx4 v[200:203], v3, s[32:35], 0 offen
    buffer_load_dwordx4 v[196:199], v2, s[32:35], 0 offen offset:448
    buffer_load_dwordx4 v[204:207], v3, s[32:35], 0 offen offset:448
    buffer_load_dwordx4 v[208:211], v2, s[32:35], s48 offen
    buffer_load_dwordx4 v[216:219], v3, s[32:35], s48 offen
    buffer_load_dwordx4 v[212:215], v2, s[32:35], s48 offen offset:448
    buffer_load_dwordx4 v[220:223], v3, s[32:35], s48 offen offset:448
    s_mov_b64 exec, 0
    s_cmp_eq_u32 s3, 1
    s_cbranch_scc1 L_padB1
    s_branch L_B
L_A:
    s_mov_b32 s14, 0x1c0000
    s_mov_b32 s15, 0x20000
    s_and_b32 s47, s40, 7
    s_mul_i32 s48, s44, 88
    s_and_b32 s6, s2, 6
    s_lshl_b32 s6, s6, 7
    s_add_u32 s48, s48, s6
    s_lshr_b32 s56, s44, 1
    s_and_b32 s7, s2, 1
    s_cmp_lg_u32 s47, 7
    s_cbranch_scc1 L_G
    s_lshl1_add_u32 s6, s48, s7
    s_cmp_eq_u32 s3, 3
    s_cselect_b32 s6, 0x100000, s6
    v_and_b32 v4, -2, v0
    v_add_u32 v4, s6, v4
    v_subrev_u32 v4, 16, v4 clamp
    v_and_b32 v5, 1, v0
    v_add_u32 v5, s100, v5
    v_add_u32 v5, 1, v5
    v_subrev_u32 v6, 7, v5
    v_min_u32 v5, v5, v6
    v_mad_u32_u24 v7, v4, 7, v5
    v_lshlrev_b32 v7, 7, v7
    s_waitcnt lgkmcnt(0)
    buffer_load_dword v255, v7, s[12:15], 0 offen
    s_branch L_S
L_G:
    s_mov_b32 s18, 0x126000
    s_mov_b32 s19, 0x20000
    v_and_b32 v34, 8, v1
    v_lshrrev_b32 v35, 1, v1
    v_and_or_b32 v34, v35, 16, v34
    v_lshrrev_b32 v35, 2, v1
    v_and_or_b32 v34, v35, 4, v34
    v_add_u32 v34, s3, v34
    v_mul_u32_u24 v34, 2688, v34
    v_and_b32 v33, 7, v1
    v_lshl_add_u32 v34, v33, 4, v34
    v_lshl_add_u32 v5, s47, 7, v34
    s_mul_i32 s50, s3, 1056
    s_mul_i32 s52, s100, 64*2688
    s_lshl_b32 s51, s100, 7
    s_add_u32 s53, s52, 32*2688
    s_add_u32 s100, s100, 1
    s_sub_u32 s10, s100, 7
    s_min_u32 s100, s100, s10
    s_mul_i32 s6, s3, 24
    s_add_u32 s6, s6, s48
    s_lshl1_add_u32 s7, s6, s7
    s_sub_u32 s7, s7, 16
    s_mul_i32 s7, s7, 896
    v_lshrrev_b32 v32, 3, v1
    s_lshl_b32 s8, s3, 2
    v_xor_b32 v34, s8, v252
    v_xor_b32 v34, v34, v33
    v_and_b32 v34, 7, v34
    v_mul_u32_u24 v35, 1792, v32
    v_lshl_add_u32 v34, v34, 4, v35
    v_xor_b32 v35, 64, v34
    s_cmp_eq_u32 s6, 0
    s_cselect_b32 s8, 0x40000000, s7
    v_add_u32 v2, s8, v34
    s_add_u32 s8, s7, 14336
    v_add_u32 v3, s8, v35
    s_add_u32 s8, s7, 28672
    s_add_u32 s9, s56, s3
    s_cmp_eq_u32 s9, 4
    s_cselect_b32 s8, 0x40000000, s8
    v_add_u32 v4, s8, v34
    s_mul_i32 s49, s3, 3072
    s_waitcnt lgkmcnt(0)
    s_add_u32 m0, s50, 37632
    s_and_b32 s11, s3, 1
    buffer_load_dwordx4 v5, s[16:19], s52 offen offset:0 lds
    s_lshl1_add_u32 s6, s47, s11
    s_add_u32 m0, s50, 40960
    s_lshl_b32 s6, s6, 4
    buffer_load_dwordx4 v5, s[16:19], s52 offen offset:896 lds
    s_add_u32 s6, s6, L_tab - L_pc
    s_add_u32 m0, s49, 62976
    s_load_dwordx4 s[32:35], s[4:5], s6
    buffer_load_dwordx4 v2, s[12:15], s51 offen lds
    s_add_u32 s6, s57, 5259264
    s_add_u32 m0, s50, 44288
    s_load_dword s36, s[20:21], s6
    buffer_load_dwordx4 v5, s[16:19], s52 offen offset:1792 lds
    s_lshr_b32 s55, s3, 1
    s_add_u32 m0, s49, 64000
    s_mov_b32 s22, 0x1000000
    buffer_load_dwordx4 v3, s[12:15], s51 offen lds
    s_mov_b32 s23, 0x20000
    s_mov_b32 s26, 0x62000
    s_mov_b32 s27, 0x20000
    s_mov_b32 s30, 0x380000
    s_mov_b32 s31, 0x20000
    s_mul_i32 s6, s40, 37
    s_lshr_b32 s6, s6, 8
    s_mul_i32 s7, s6, 7
    s_sub_u32 s41, s40, s7
    s_add_u32 m0, s50, 50304
    s_lshr_b32 s7, s57, 3
    buffer_load_dwordx4 v5, s[16:19], s53 offen offset:0 lds
    s_add_u32 s41, s41, s7
    s_sub_u32 s7, s41, 7
    s_min_u32 s41, s41, s7
    s_lshl_b32 s6, s6, 2
    s_add_u32 s6, s6, s3
    v_bfe_u32 v32, v1, 1, 1
    v_lshl_add_u32 v32, s6, 1, v32
    v_mul_u32_u24 v33, 47, v32
    v_lshrrev_b32 v33, 9, v33
    s_add_u32 m0, s49, 65024
    v_mul_u32_u24 v34, 11, v33
    buffer_load_dwordx4 v4, s[12:15], s51 offen lds
    v_sub_u32 v32, v32, v34
    v_add_u32 v32, 3, v32
    v_and_b32 v32, 8, v32
    v_lshl_add_u32 v32, v33, 10, v32
    v_and_b32 v33, 1, v1
    v_lshl_add_u32 v32, v33, 2, v32
    v_bfe_u32 v33, v1, 2, 3
    v_lshl_add_u32 v32, v33, 7, v32
    s_mul_i32 s7, s57, 17920
    s_add_u32 m0, s50, 53632
    s_add_u32 s7, s7, 6429696
    buffer_load_dwordx4 v5, s[16:19], s53 offen offset:896 lds
    v_add_u32 v246, s7, v32
    s_and_b32 s7, s2, 6
    s_lshl3_add_u32 s6, s7, s6
    s_and_b32 s8, s2, 1
    s_lshl_b32 s7, s8, 6
    s_add_u32 s42, s6, s7
    v_lshrrev_b32 v32, 3, v1
    v_and_b32 v33, 6, v32
    v_and_b32 v34, 7, v1
    s_add_u32 m0, s50, 56960
    v_xor_b32 v33, v33, v34
    buffer_load_dwordx4 v5, s[16:19], s53 offen offset:1792 lds
    v_lshrrev_b32 v32, 3, v0
    v_mul_u32_u24 v32, 896, v32
    v_lshl_add_u32 v32, v33, 4, v32
    s_lshl_b32 s7, s41, 7
    v_add_u32 v240, s7, v32
    v_mov_b32 v34, 0
    v_mov_b32 v35, 0
    v_lshlrev_b32 v32, 3, v1
    v_add_u32 v32, 162816, v32
    s_mul_i32 s59, s100, 64*2688
    s_lshl_b32 s58, s100, 7
    s_add_u32 s60, s59, 32*2688
    s_add_u32 s100, s100, 1
    s_sub_u32 s10, s100, 7
    s_min_u32 s100, s100, s10
    s_add_u32 m0, s50, 75264
    ds_write_b64 v32, v[34:35]
    buffer_load_dwordx4 v5, s[16:19], s59 offen offset:0 lds
    s_lshl_b32 s45, s3, 10
    s_add_u32 s45, s45, 105472
    v_lshrrev_b32 v32, 2, v1
    v_bfe_u32 v33, v1, 3, 2
    v_lshlrev_b32 v33, 5, v33
    v_lshl_add_u32 v33, v32, 7, v33
    v_and_b32 v34, 3, v1
    v_lshl_add_u32 v33, v34, 3, v33
    v_add_u32 v241, 105472, v33
    s_add_u32 m0, s50, 78592
    v_xor_b32 v242, 32, v241
    buffer_load_dwordx4 v5, s[16:19], s59 offen offset:896 lds
    v_xor_b32 v243, 64, v241
    v_xor_b32 v244, 96, v241
    s_lshl_b32 s9, s42, 14
    v_lshl_add_u32 v245, v1, 4, s9
    s_lshl_b32 s6, s6, 5
    s_add_u32 s6, s6, s8
    s_mul_i32 s6, s6, 1792
    s_add_u32 s6, s6, s7
    v_mul_u32_u24 v32, 3584, v253
    s_add_u32 m0, s49, 100608
    v_and_b32 v33, 1, v252
    buffer_load_dwordx4 v2, s[12:15], s58 offen lds
    v_lshl_add_u32 v32, v33, 5, v32
    v_lshrrev_b32 v33, 1, v252
    v_lshl_add_u32 v32, v33, 4, v32
    v_add_u32 v247, s6, v32
    s_cmp_eq_u32 s55, 0
    s_cselect_b32 s54, 0xff800000, 0
    s_cmp_eq_u32 s48, 0
    s_cselect_b32 s61, s54, 0
    s_mul_i32 s6, s55, 48
    s_add_u32 s6, s6, s48
    s_and_b32 s7, s2, 1
    s_lshl_b32 s7, s7, 10
    s_add_u32 s6, s6, s7
    s_add_u32 s6, s6, 8
    s_waitcnt lgkmcnt(0)
    s_and_b32 s11, s34, 15
    v_add_u32 v32, s6, v253
    v_lshrrev_b32 v33, 4, v32
    v_lshlrev_b32 v33, 14, v33
    v_and_b32 v32, 15, v32
    v_lshl_add_u32 v32, v32, 4, v33
    v_lshl_add_u32 v32, v252, 8, v32
    s_lshl_b32 s7, s11, 10
    v_add_u32 v18, s7, v32
    s_cmp_eq_u32 s55, 0
    s_cselect_b32 s8, 8, 0
    s_and_b32 s9, s55, s56
    s_cselect_b32 s9, 8, 16
    v_cmp_le_u32 s[4:5], s8, v253
    v_cmp_gt_u32 s[62:63], s9, v253
    v_subrev_u32 v32, 16384, v18
    v_add_u32 v33, 16384, v18
    v_cndmask_b32 v17, 2.0, v32, s[4:5]
    v_cndmask_b32 v19, 2.0, v33, s[62:63]
    s_mul_i32 s9, s57, 17920
    s_lshl_b32 s7, s40, 7
    s_add_u32 s6, s9, s7
    s_lshl2_add_u32 s6, s3, s6
    s_add_u32 s6, s6, 6429696
    v_mov_b32 v248, s6
    v_and_b32 v32, 4, v1
    v_add_u32 v32, 16, v32
    v_bfe_u32 v32, s34, v32, 4
    v_and_b32 v33, 3, v1
    v_lshlrev_b32 v34, 2, v33
    v_lshl_add_u32 v32, v32, 7, v34
    s_lshl_b32 s6, s44, 10
    s_add_u32 s6, s6, s9
    s_add_u32 s6, s6, 6429712
    v_add_u32 v40, s6, v32
    s_mul_i32 s6, s44, 46080
    s_add_u32 s9, s9, s6
    s_add_u32 s9, s9, 6291456
    s_lshl_b32 s38, s55, 10
    s_lshl_b32 s39, s55, 3
    v_lshl_add_u32 v42, v253, 4, s9
    v_lshl_add_u32 v43, v252, 2, v33
    v_lshl_add_u32 v43, v43, 4, s9
    v_lshrrev_b32 v35, 2, v253
    s_bfe_u32 s6, s34, 0x40008
    s_sub_u32 s6, 4, s6
    v_cmp_le_u32 s[62:63], s6, v252
    v_cmp_le_u32 s[64:65], s6, v35
    s_movk_i32 s8, 2304
    v_lshlrev_b32 v32, 3, v252
    v_bfe_u32 v32, s33, v32, 8
    v_mad_u32_u24 v32, v32, s8, v42
    v_cndmask_b32 v36, 2.0, v32, s[62:63]
    v_lshlrev_b32 v32, 3, v35
    v_bfe_u32 v32, s33, v32, 8
    v_mad_u32_u24 v32, v32, s8, v43
    v_cndmask_b32 v37, 2.0, v32, s[64:65]
    s_bfe_u32 s6, s34, 0x4000c
    s_bitcmp1_b32 s34, 4
    s_cselect_b32 s7, 2, 4
    s_cselect_b32 s9, -1, 1
    s_add_u32 s6, s6, s7
    v_mul_i32_i24 v32, s9, v252
    v_add_u32 v32, s6, v32
    v_cmp_ne_u32 vcc, 3, v252
    v_mad_u32_u24 v32, v32, s8, v42
    s_nop 0
    v_cndmask_b32 v38, 2.0, v32, vcc
    v_mul_i32_i24 v32, s9, v35
    v_add_u32 v32, s6, v32
    v_cmp_ne_u32 vcc, 3, v35
    v_mad_u32_u24 v32, v32, s8, v43
    s_nop 0
    v_cndmask_b32 v39, 2.0, v32, vcc
    s_mul_i32 s36, s36, 0x9e3779b1
    s_add_u32 s36, s36, 0x7f4a7c15
    v_mov_b32 v250, s36
    s_getreg_b32 s7, hwreg(HW_REG_XCC_ID, 0, 3)
    s_add_u32 m0, s50, 81920
    s_mul_i32 s8, s57, 17920
    buffer_load_dwordx4 v5, s[16:19], s59 offen offset:1792 lds
    s_lshl_b32 s7, s7, 7
    s_add_u32 s8, s8, s7
    s_add_u32 s8, s8, 6432768
    v_and_b32 v41, 31, v1
    v_lshl_add_u32 v41, v41, 2, s8
    s_lshl2_add_u32 s37, s40, s8
    v_lshrrev_b32 v32, 5, v1
    v_lshlrev_b32 v32, 9, v32
    v_bfe_u32 v33, v1, 4, 1
    s_add_u32 m0, s49, 101632
    v_lshl_add_u32 v32, v33, 7, v32
    buffer_load_dwordx4 v3, s[12:15], s58 offen lds
    s_movk_i32 s6, 1056
    v_mad_u32_u24 v32, v35, s6, v32
    v_bfe_u32 v33, s32, v34, 4
    v_lshl_add_u32 v9, v33, 3, v32
    v_add_u32 v34, 16, v34
    v_bfe_u32 v33, s32, v34, 4
    v_lshl_add_u32 v10, v33, 3, v32
    v_lshrrev_b32 v32, 1, v253
    v_xor_b32 v32, v32, v252
    s_mul_i32 s52, s100, 64*2688
    s_lshl_b32 s51, s100, 7
    s_add_u32 s53, s52, 32*2688
    s_add_u32 s100, s100, 1
    s_sub_u32 s10, s100, 7
    s_min_u32 s100, s100, s10
    s_add_u32 m0, s50, 87936
    v_lshlrev_b32 v32, 4, v32
    buffer_load_dwordx4 v5, s[16:19], s60 offen offset:0 lds
    v_lshl_add_u32 v32, v253, 7, v32
    s_mul_i32 s6, s55, 6144
    s_add_u32 s6, s6, 25344
    v_add_u32 v11, s6, v32
    v_xor_b32 v32, 64, v32
    v_add_u32 v12, s6, v32
    v_add_u32 v13, 37632, v9
    v_add_u32 v15, 37632, v11
    v_add_u32 v14, 37632, v10
    s_add_u32 m0, s49, 102656
    v_add_u32 v16, 37632, v12
    buffer_load_dwordx4 v4, s[12:15], s58 offen lds
    s_lshl_b32 s6, s3, 11
    s_add_u32 s6, s6, 75264
    v_lshl_add_u32 v6, v1, 4, s6
    s_lshl_b32 s6, s55, 12
    v_subrev_u32 v7, s6, v6
    v_lshlrev_b32 v208, 2, v252
    v_sub_u32 v208, v253, v208
    v_mov_b32 v209, 0xff800000
    v_subrev_u32 v212, 0, v208
    s_add_u32 m0, s50, 91264
    v_subrev_u32 v213, 1, v208
    buffer_load_dwordx4 v5, s[16:19], s60 offen offset:896 lds
    v_subrev_u32 v214, 2, v208
    v_subrev_u32 v215, 3, v208
    v_cmp_gt_u32 s[4:5], 8, v212
    v_cmp_gt_u32 s[46:47], 8, v213
    v_cmp_gt_u32 vcc, 8, v214
    v_cmp_gt_u32 s[98:99], 8, v215
    v_cndmask_b32 v24, v209, 0, s[4:5]
    v_cndmask_b32 v25, v209, 0, s[46:47]
    v_cndmask_b32 v26, v209, 0, vcc
    s_add_u32 m0, s50, 94592
    v_cndmask_b32 v27, v209, 0, s[98:99]
    buffer_load_dwordx4 v5, s[16:19], s60 offen offset:1792 lds
    v_cmp_ge_i32 s[4:5], -9, v212
    v_cmp_ge_i32 s[46:47], -9, v213
    v_cmp_ge_i32 vcc, -9, v214
    v_cmp_ge_i32 s[98:99], -9, v215
    v_cndmask_b32 v20, v209, 0, s[4:5]
    v_cndmask_b32 v21, v209, 0, s[46:47]
    v_cndmask_b32 v22, v209, 0, vcc
    v_cndmask_b32 v23, v209, 0, s[98:99]
    v_ashrrev_i32 v212, 31, v212
    v_ashrrev_i32 v213, 31, v213
    v_ashrrev_i32 v214, 31, v214
    v_ashrrev_i32 v215, 31, v215
    v_mov_b32 v208, 0xffff
    v_bfi_b32 v28, v208, v212, v213
    v_bfi_b32 v29, v208, v214, v215
    v_mov_b32 v30, 0x3e8b97f6
    v_or_b32 v56, s54, v20
    v_or_b32 v57, s54, v21
    v_or_b32 v58, s54, v22
    v_or_b32 v59, s54, v23
    v_subrev_u32 v208, 32, v1
    v_ashrrev_i32 v208, 31, v208
    v_and_b32 v208, s61, v208
    v_or_b32 v60, v208, v24
    v_or_b32 v61, v208, v25
    v_or_b32 v62, v208, v26
    v_or_b32 v63, v208, v27
    v_mov_b32 v32, 0x3f803f80
    v_mov_b32 v33, 0x3f803f80
    v_mov_b32 v34, 0x3f803f80
    v_mov_b32 v35, 0x3f803f80
    s_mov_b64 exec, 0
    s_cmp_eq_u32 s3, 1
    s_cbranch_scc1 L_padA1
    s_cmp_eq_u32 s3, 2
    s_cbranch_scc1 L_padA2
L_back:
    s_mov_b64 exec, -1
    s_waitcnt vmcnt(9) lgkmcnt(0)
    s_barrier
    buffer_store_dword v250, off, s[20:23], s37
    ds_read_b128 v[136:139], v15 offset:0
    ds_read_b64_tr_b16 v[160:161], v13 offset:0
    ds_read_b64_tr_b16 v[162:163], v13 offset:256
    ds_read_b128 v[140:143], v15 offset:2048
    s_add_u32 m0, s50, 0
    ds_read_b128 v[144:147], v15 offset:4096
    buffer_load_dwordx4 v5, s[16:19], s52 offen offset:0 lds
    ds_read_b64_tr_b16 v[164:165], v14 offset:0
    ds_read_b64_tr_b16 v[166:167], v14 offset:256
    ds_read_b64_tr_b16 v[168:169], v13 offset:4224
    s_add_u32 m0, s50, 3328
    ds_read_b64_tr_b16 v[170:171], v13 offset:4480
    buffer_load_dwordx4 v5, s[16:19], s52 offen offset:896 lds
    ds_read_b64_tr_b16 v[172:173], v14 offset:4224
    ds_read_b64_tr_b16 v[174:175], v14 offset:4480
    ds_read_b64_tr_b16 v[176:177], v13 offset:8448
    s_add_u32 m0, s49, 25344
    ds_read_b64_tr_b16 v[178:179], v13 offset:8704
    buffer_load_dwordx4 v2, s[12:15], s51 offen lds
    ds_read_b64_tr_b16 v[180:181], v14 offset:8448
    ds_read_b64_tr_b16 v[182:183], v14 offset:8704
    s_waitcnt lgkmcnt(12)
    v_mfma_f32_16x16x32_bf16 v[64:67], v[160:163], v[136:139], 0
    ds_read_b128 v[148:151], v16 offset:0
    s_add_u32 m0, s50, 6656
    s_waitcnt lgkmcnt(12)
    v_mfma_f32_16x16x32_bf16 v[88:91], v[160:163], v[140:143], 0
    ds_read_b64_tr_b16 v[184:185], v13 offset:12672
    buffer_load_dwordx4 v5, s[16:19], s52 offen offset:1792 lds
    s_waitcnt lgkmcnt(12)
    v_mfma_f32_16x16x32_bf16 v[112:115], v[160:163], v[144:147], 0
    ds_read_b64_tr_b16 v[186:187], v13 offset:12928
    s_add_u32 m0, s49, 26368
    s_waitcnt lgkmcnt(11)
    v_mfma_f32_16x16x32_bf16 v[68:71], v[164:167], v[136:139], 0
    ds_read_b128 v[152:155], v16 offset:2048
    buffer_load_dwordx4 v3, s[12:15], s51 offen lds
    v_mfma_f32_16x16x32_bf16 v[92:95], v[164:167], v[140:143], 0
    ds_read_b128 v[156:159], v16 offset:4096
    s_mul_i32 s59, s100, 64*2688
    v_mfma_f32_16x16x32_bf16 v[116:119], v[164:167], v[144:147], 0
    ds_read_b64_tr_b16 v[188:189], v14 offset:12672
    s_add_u32 m0, s50, 12672
    s_waitcnt lgkmcnt(12)
    v_mfma_f32_16x16x32_bf16 v[72:75], v[168:171], v[136:139], 0
    ds_read_b64_tr_b16 v[190:191], v14 offset:12928
    buffer_load_dwordx4 v5, s[16:19], s53 offen offset:0 lds
    v_mfma_f32_16x16x32_bf16 v[96:99], v[168:171], v[140:143], 0
    ds_read_b64_tr_b16 v[192:193], v13 offset:16896
    s_lshl_b32 s58, s100, 7
    v_mfma_f32_16x16x32_bf16 v[120:123], v[168:171], v[144:147], 0
    ds_read_b64_tr_b16 v[194:195], v13 offset:17152
    s_add_u32 m0, s49, 27392
    s_waitcnt lgkmcnt(13)
    v_mfma_f32_16x16x32_bf16 v[76:79], v[172:175], v[136:139], 0
    ds_read_b64_tr_b16 v[196:197], v14 offset:16896
    buffer_load_dwordx4 v4, s[12:15], s51 offen lds
    v_mfma_f32_16x16x32_bf16 v[100:103], v[172:175], v[140:143], 0
    ds_read_b64_tr_b16 v[198:199], v14 offset:17152
    s_add_u32 s60, s59, 32*2688
    v_mfma_f32_16x16x32_bf16 v[124:127], v[172:175], v[144:147], 0
    ds_read_b64_tr_b16 v[200:201], v13 offset:21120
    s_add_u32 m0, s50, 16000
    s_waitcnt lgkmcnt(14)
    v_mfma_f32_16x16x32_bf16 v[80:83], v[136:139], v[176:179], 0
    ds_read_b64_tr_b16 v[202:203], v13 offset:21376
    buffer_load_dwordx4 v5, s[16:19], s53 offen offset:896 lds
    v_mfma_f32_16x16x32_bf16 v[104:107], v[140:143], v[176:179], 0
    ds_read_b64_tr_b16 v[204:205], v14 offset:21120
    s_add_u32 s100, s100, 1
    v_mfma_f32_16x16x32_bf16 v[128:131], v[144:147], v[176:179], 0
    ds_read_b64_tr_b16 v[206:207], v14 offset:21376
    s_add_u32 m0, s50, 19328
    s_waitcnt lgkmcnt(15)
    v_mfma_f32_16x16x32_bf16 v[84:87], v[136:139], v[180:183], 0
    buffer_load_dwordx4 v5, s[16:19], s53 offen offset:1792 lds
    v_add_u32 v13, 75264, v9
    v_mfma_f32_16x16x32_bf16 v[108:111], v[140:143], v[180:183], 0
    v_add_u32 v15, 75264, v11
    v_add_u32 v14, 75264, v10
    v_mfma_f32_16x16x32_bf16 v[132:135], v[144:147], v[180:183], 0
    v_add_u32 v16, 75264, v12
    s_sub_u32 s10, s100, 7
    s_min_u32 s100, s100, s10
    s_waitcnt vmcnt(10) lgkmcnt(0)
    s_barrier
    v_mfma_f32_16x16x32_bf16 v[64:67], v[184:187], v[148:151], v[64:67]
    ds_read_b128 v[136:139], v15 offset:0
    s_add_u32 m0, s50, 37632
    v_mfma_f32_16x16x32_bf16 v[88:91], v[184:187], v[152:155], v[88:91]
    ds_read_b64_tr_b16 v[160:161], v13 offset:0
    buffer_load_dwordx4 v5, s[16:19], s59 offen offset:0 lds
    v_mfma_f32_16x16x32_bf16 v[112:115], v[184:187], v[156:159], v[112:115]
    ds_read_b64_tr_b16 v[162:163], v13 offset:256
    s_mul_i32 s52, s100, 64*2688
    v_mfma_f32_16x16x32_bf16 v[68:71], v[188:191], v[148:151], v[68:71]
    ds_read_b128 v[140:143], v15 offset:2048
    s_add_u32 m0, s50, 40960
    v_mfma_f32_16x16x32_bf16 v[92:95], v[188:191], v[152:155], v[92:95]
    ds_read_b128 v[144:147], v15 offset:4096
    buffer_load_dwordx4 v5, s[16:19], s59 offen offset:896 lds
    v_mfma_f32_16x16x32_bf16 v[116:119], v[188:191], v[156:159], v[116:119]
    ds_read_b64_tr_b16 v[164:165], v14 offset:0
    s_lshl_b32 s51, s100, 7
    v_mfma_f32_16x16x32_bf16 v[72:75], v[192:195], v[148:151], v[72:75]
    ds_read_b64_tr_b16 v[166:167], v14 offset:256
    s_add_u32 s53, s52, 32*2688
    v_mfma_f32_16x16x32_bf16 v[96:99], v[192:195], v[152:155], v[96:99]
    ds_read_b64_tr_b16 v[168:169], v13 offset:4224
    s_add_u32 m0, s49, 62976
    v_mfma_f32_16x16x32_bf16 v[120:123], v[192:195], v[156:159], v[120:123]
    ds_read_b64_tr_b16 v[170:171], v13 offset:4480
    buffer_load_dwordx4 v2, s[12:15], s58 offen lds
    v_mfma_f32_16x16x32_bf16 v[76:79], v[196:199], v[148:151], v[76:79]
    ds_read_b64_tr_b16 v[172:173], v14 offset:4224
    s_add_u32 s100, s100, 1
    v_mfma_f32_16x16x32_bf16 v[100:103], v[196:199], v[152:155], v[100:103]
    ds_read_b64_tr_b16 v[174:175], v14 offset:4480
    s_sub_u32 s10, s100, 7
    v_mfma_f32_16x16x32_bf16 v[124:127], v[196:199], v[156:159], v[124:127]
    ds_read_b64_tr_b16 v[176:177], v13 offset:8448
    s_add_u32 m0, s50, 44288
    v_mfma_f32_16x16x32_bf16 v[80:83], v[148:151], v[200:203], v[80:83]
    ds_read_b64_tr_b16 v[178:179], v13 offset:8704
    buffer_load_dwordx4 v5, s[16:19], s59 offen offset:1792 lds
    v_mfma_f32_16x16x32_bf16 v[104:107], v[152:155], v[200:203], v[104:107]
    ds_read_b64_tr_b16 v[180:181], v14 offset:8448
    s_min_u32 s100, s100, s10
    v_mfma_f32_16x16x32_bf16 v[128:131], v[156:159], v[200:203], v[128:131]
    ds_read_b64_tr_b16 v[182:183], v14 offset:8704
    v_mfma_f32_16x16x32_bf16 v[84:87], v[148:151], v[204:207], v[84:87]
    s_add_u32 m0, s49, 64000
    v_mfma_f32_16x16x32_bf16 v[108:111], v[152:155], v[204:207], v[108:111]
    buffer_load_dwordx4 v3, s[12:15], s58 offen lds
    v_mfma_f32_16x16x32_bf16 v[132:135], v[156:159], v[204:207], v[132:135]
    s_waitcnt lgkmcnt(0)
    v_mfma_f32_16x16x32_bf16 v[64:67], v[160:163], v[136:139], v[64:67]
    ds_read_b128 v[148:151], v16 offset:0
    v_mfma_f32_16x16x32_bf16 v[88:91], v[160:163], v[140:143], v[88:91]
    ds_read_b64_tr_b16 v[184:185], v13 offset:12672
    s_add_u32 m0, s50, 50304
    v_mfma_f32_16x16x32_bf16 v[112:115], v[160:163], v[144:147], v[112:115]
    ds_read_b64_tr_b16 v[186:187], v13 offset:12928
    buffer_load_dwordx4 v5, s[16:19], s60 offen offset:0 lds
    v_mfma_f32_16x16x32_bf16 v[68:71], v[164:167], v[136:139], v[68:71]
    ds_read_b128 v[152:155], v16 offset:2048
    v_mfma_f32_16x16x32_bf16 v[92:95], v[164:167], v[140:143], v[92:95]
    ds_read_b128 v[156:159], v16 offset:4096
    v_mfma_f32_16x16x32_bf16 v[116:119], v[164:167], v[144:147], v[116:119]
    ds_read_b64_tr_b16 v[188:189], v14 offset:12672
    s_add_u32 m0, s49, 65024
    v_mfma_f32_16x16x32_bf16 v[72:75], v[168:171], v[136:139], v[72:75]
    ds_read_b64_tr_b16 v[190:191], v14 offset:12928
    buffer_load_dwordx4 v4, s[12:15], s58 offen lds
    v_mfma_f32_16x16x32_bf16 v[96:99], v[168:171], v[140:143], v[96:99]
    ds_read_b64_tr_b16 v[192:193], v13 offset:16896
    v_mfma_f32_16x16x32_bf16 v[120:123], v[168:171], v[144:147], v[120:123]
    ds_read_b64_tr_b16 v[194:195], v13 offset:17152
    v_mfma_f32_16x16x32_bf16 v[76:79], v[172:175], v[136:139], v[76:79]
    ds_read_b64_tr_b16 v[196:197], v14 offset:16896
    s_add_u32 m0, s50, 53632
    v_mfma_f32_16x16x32_bf16 v[100:103], v[172:175], v[140:143], v[100:103]
    ds_read_b64_tr_b16 v[198:199], v14 offset:17152
    buffer_load_dwordx4 v5, s[16:19], s60 offen offset:896 lds
    v_mfma_f32_16x16x32_bf16 v[124:127], v[172:175], v[144:147], v[124:127]
    ds_read_b64_tr_b16 v[200:201], v13 offset:21120
    v_mfma_f32_16x16x32_bf16 v[80:83], v[136:139], v[176:179], v[80:83]
    ds_read_b64_tr_b16 v[202:203], v13 offset:21376
    v_mfma_f32_16x16x32_bf16 v[104:107], v[140:143], v[176:179], v[104:107]
    ds_read_b64_tr_b16 v[204:205], v14 offset:21120
    s_add_u32 m0, s50, 56960
    v_mfma_f32_16x16x32_bf16 v[128:131], v[144:147], v[176:179], v[128:131]
    ds_read_b64_tr_b16 v[206:207], v14 offset:21376
    buffer_load_dwordx4 v5, s[16:19], s60 offen offset:1792 lds
    v_mfma_f32_16x16x32_bf16 v[84:87], v[136:139], v[180:183], v[84:87]
    v_add_u32 v13, 0, v9
    v_add_u32 v15, 0, v11
    v_mfma_f32_16x16x32_bf16 v[108:111], v[140:143], v[180:183], v[108:111]
    v_add_u32 v14, 0, v10
    v_add_u32 v16, 0, v12
    v_mfma_f32_16x16x32_bf16 v[132:135], v[144:147], v[180:183], v[132:135]
    s_waitcnt vmcnt(9) lgkmcnt(0)
    s_barrier
    v_mfma_f32_16x16x32_bf16 v[64:67], v[184:187], v[148:151], v[64:67]
    ds_read_b128 v[136:139], v15 offset:0
    s_add_u32 m0, s50, 75264
    v_mfma_f32_16x16x32_bf16 v[88:91], v[184:187], v[152:155], v[88:91]
    ds_read_b64_tr_b16 v[160:161], v13 offset:0
    buffer_load_dwordx4 v5, s[16:19], s52 offen offset:0 lds
    v_mfma_f32_16x16x32_bf16 v[112:115], v[184:187], v[156:159], v[112:115]
    ds_read_b64_tr_b16 v[162:163], v13 offset:256
    s_mul_i32 s59, s100, 64*2688
    v_mfma_f32_16x16x32_bf16 v[68:71], v[188:191], v[148:151], v[68:71]
    ds_read_b128 v[140:143], v15 offset:2048
    s_lshl_b32 s58, s100, 7
    v_mfma_f32_16x16x32_bf16 v[92:95], v[188:191], v[152:155], v[92:95]
    ds_read_b128 v[144:147], v15 offset:4096
    s_add_u32 m0, s50, 78592
    v_mfma_f32_16x16x32_bf16 v[116:119], v[188:191], v[156:159], v[116:119]
    ds_read_b64_tr_b16 v[164:165], v14 offset:0
    buffer_load_dwordx4 v5, s[16:19], s52 offen offset:896 lds
    v_mfma_f32_16x16x32_bf16 v[72:75], v[192:195], v[148:151], v[72:75]
    ds_read_b64_tr_b16 v[166:167], v14 offset:256
    s_add_u32 s60, s59, 32*2688
    v_mfma_f32_16x16x32_bf16 v[96:99], v[192:195], v[152:155], v[96:99]
    ds_read_b64_tr_b16 v[168:169], v13 offset:4224
    s_add_u32 s100, s100, 1
    v_mfma_f32_16x16x32_bf16 v[120:123], v[192:195], v[156:159], v[120:123]
    ds_read_b64_tr_b16 v[170:171], v13 offset:4480
    s_add_u32 m0, s49, 100608
L_padA1:
    s_cbranch_execz L_back
    v_mfma_f32_16x16x32_bf16 v[76:79], v[196:199], v[148:151], v[76:79]
    ds_read_b64_tr_b16 v[172:173], v14 offset:4224
    buffer_load_dwordx4 v2, s[12:15], s51 offen lds
    v_mfma_f32_16x16x32_bf16 v[100:103], v[196:199], v[152:155], v[100:103]
    ds_read_b64_tr_b16 v[174:175], v14 offset:4480
    s_sub_u32 s10, s100, 7
    v_mfma_f32_16x16x32_bf16 v[124:127], v[196:199], v[156:159], v[124:127]
    ds_read_b64_tr_b16 v[176:177], v13 offset:8448
    s_min_u32 s100, s100, s10
    v_mfma_f32_16x16x32_bf16 v[80:83], v[148:151], v[200:203], v[80:83]
    ds_read_b64_tr_b16 v[178:179], v13 offset:8704
    s_add_u32 m0, s50, 81920
    v_mfma_f32_16x16x32_bf16 v[104:107], v[152:155], v[200:203], v[104:107]
    ds_read_b64_tr_b16 v[180:181], v14 offset:8448
    buffer_load_dwordx4 v5, s[16:19], s52 offen offset:1792 lds
    v_mfma_f32_16x16x32_bf16 v[128:131], v[156:159], v[200:203], v[128:131]
    ds_read_b64_tr_b16 v[182:183], v14 offset:8704
    v_mfma_f32_16x16x32_bf16 v[84:87], v[148:151], v[204:207], v[84:87]
    v_mfma_f32_16x16x32_bf16 v[108:111], v[152:155], v[204:207], v[108:111]
    s_add_u32 m0, s49, 101632
    v_mfma_f32_16x16x32_bf16 v[132:135], v[156:159], v[204:207], v[132:135]
    s_waitcnt lgkmcnt(0)
    buffer_load_dwordx4 v3, s[12:15], s51 offen lds
    v_mfma_f32_16x16x32_bf16 v[64:67], v[160:163], v[136:139], v[64:67]
    ds_read_b128 v[148:151], v16 offset:0
    v_mfma_f32_16x16x32_bf16 v[88:91], v[160:163], v[140:143], v[88:91]
    ds_read_b64_tr_b16 v[184:185], v13 offset:12672
    v_mfma_f32_16x16x32_bf16 v[112:115], v[160:163], v[144:147], v[112:115]
    ds_read_b64_tr_b16 v[186:187], v13 offset:12928
    v_mfma_f32_16x16x32_bf16 v[68:71], v[164:167], v[136:139], v[68:71]
    ds_read_b128 v[152:155], v16 offset:2048
    s_add_u32 m0, s50, 87936
    v_mfma_f32_16x16x32_bf16 v[92:95], v[164:167], v[140:143], v[92:95]
    ds_read_b128 v[156:159], v16 offset:4096
    buffer_load_dwordx4 v5, s[16:19], s53 offen offset:0 lds
    v_mfma_f32_16x16x32_bf16 v[116:119], v[164:167], v[144:147], v[116:119]
    ds_read_b64_tr_b16 v[188:189], v14 offset:12672
    v_mfma_f32_16x16x32_bf16 v[72:75], v[168:171], v[136:139], v[72:75]
    ds_read_b64_tr_b16 v[190:191], v14 offset:12928
    v_mfma_f32_16x16x32_bf16 v[96:99], v[168:171], v[140:143], v[96:99]
    ds_read_b64_tr_b16 v[192:193], v13 offset:16896
    s_add_u32 m0, s49, 102656
    v_mfma_f32_16x16x32_bf16 v[120:123], v[168:171], v[144:147], v[120:123]
    ds_read_b64_tr_b16 v[194:195], v13 offset:17152
    buffer_load_dwordx4 v4, s[12:15], s51 offen lds
    v_mfma_f32_16x16x32_bf16 v[76:79], v[172:175], v[136:139], v[76:79]
    ds_read_b64_tr_b16 v[196:197], v14 offset:16896
    v_mfma_f32_16x16x32_bf16 v[100:103], v[172:175], v[140:143], v[100:103]
    ds_read_b64_tr_b16 v[198:199], v14 offset:17152
    v_mfma_f32_16x16x32_bf16 v[124:127], v[172:175], v[144:147], v[124:127]
    ds_read_b64_tr_b16 v[200:201], v13 offset:21120
    s_add_u32 m0, s50, 91264
    v_mfma_f32_16x16x32_bf16 v[80:83], v[136:139], v[176:179], v[80:83]
    ds_read_b64_tr_b16 v[202:203], v13 offset:21376
    buffer_load_dwordx4 v5, s[16:19], s53 offen offset:896 lds
    v_mfma_f32_16x16x32_bf16 v[104:107], v[140:143], v[176:179], v[104:107]
    ds_read_b64_tr_b16 v[204:205], v14 offset:21120
    v_mfma_f32_16x16x32_bf16 v[128:131], v[144:147], v[176:179], v[128:131]
    ds_read_b64_tr_b16 v[206:207], v14 offset:21376
    v_mfma_f32_16x16x32_bf16 v[84:87], v[136:139], v[180:183], v[84:87]
    s_add_u32 m0, s50, 94592
    v_add_u32 v13, 37632, v9
    v_mfma_f32_16x16x32_bf16 v[108:111], v[140:143], v[180:183], v[108:111]
    buffer_load_dwordx4 v5, s[16:19], s53 offen offset:1792 lds
    v_add_u32 v15, 37632, v11
    v_mfma_f32_16x16x32_bf16 v[132:135], v[144:147], v[180:183], v[132:135]
    s_waitcnt lgkmcnt(0)
    v_add_u32 v14, 37632, v10
    v_mfma_f32_16x16x32_bf16 v[64:67], v[184:187], v[148:151], v[64:67]
    v_add_u32 v16, 37632, v12
    v_mfma_f32_16x16x32_bf16 v[88:91], v[184:187], v[152:155], v[88:91]
    v_mfma_f32_16x16x32_bf16 v[112:115], v[184:187], v[156:159], v[112:115]
    s_waitcnt vmcnt(9) lgkmcnt(0)
    s_barrier
    v_mfma_f32_16x16x32_bf16 v[68:71], v[188:191], v[148:151], v[68:71]
    ds_read_b128 v[136:139], v15 offset:0
    ds_read_b64_tr_b16 v[160:161], v13 offset:0
    v_mfma_f32_16x16x32_bf16 v[92:95], v[188:191], v[152:155], v[92:95]
    ds_read_b64_tr_b16 v[162:163], v13 offset:256
    s_add_u32 m0, s50, 0
    v_mfma_f32_16x16x32_bf16 v[116:119], v[188:191], v[156:159], v[116:119]
    ds_read_b128 v[140:143], v15 offset:2048
    buffer_load_dwordx4 v5, s[16:19], s59 offen offset:0 lds
    v_mfma_f32_16x16x32_bf16 v[72:75], v[192:195], v[148:151], v[72:75]
    ds_read_b128 v[144:147], v15 offset:4096
    s_mul_i32 s52, s100, 64*2688
    v_mfma_f32_16x16x32_bf16 v[96:99], v[192:195], v[152:155], v[96:99]
    ds_read_b64_tr_b16 v[164:165], v14 offset:0
    ds_read_b64_tr_b16 v[166:167], v14 offset:256
    v_mfma_f32_16x16x32_bf16 v[120:123], v[192:195], v[156:159], v[120:123]
    ds_read_b64_tr_b16 v[168:169], v13 offset:4224
    s_add_u32 m0, s50, 3328
    v_mfma_f32_16x16x32_bf16 v[76:79], v[196:199], v[148:151], v[76:79]
    ds_read_b64_tr_b16 v[170:171], v13 offset:4480
    buffer_load_dwordx4 v5, s[16:19], s59 offen offset:896 lds
    v_mfma_f32_16x16x32_bf16 v[100:103], v[196:199], v[152:155], v[100:103]
    ds_read_b64_tr_b16 v[172:173], v14 offset:4224
    s_lshl_b32 s51, s100, 7
    v_mfma_f32_16x16x32_bf16 v[124:127], v[196:199], v[156:159], v[124:127]
    ds_read_b64_tr_b16 v[174:175], v14 offset:4480
    ds_read_b64_tr_b16 v[176:177], v13 offset:8448
    v_mfma_f32_16x16x32_bf16 v[80:83], v[148:151], v[200:203], v[80:83]
    ds_read_b64_tr_b16 v[178:179], v13 offset:8704
    s_add_u32 s53, s52, 32*2688
    v_mfma_f32_16x16x32_bf16 v[104:107], v[152:155], v[200:203], v[104:107]
    ds_read_b64_tr_b16 v[180:181], v14 offset:8448
    s_add_u32 m0, s49, 25344
    v_mfma_f32_16x16x32_bf16 v[128:131], v[156:159], v[200:203], v[128:131]
    ds_read_b64_tr_b16 v[182:183], v14 offset:8704
    buffer_load_dwordx4 v2, s[12:15], s58 offen lds
    v_mfma_f32_16x16x32_bf16 v[84:87], v[148:151], v[204:207], v[84:87]
    v_mfma_f32_16x16x32_bf16 v[108:111], v[152:155], v[204:207], v[108:111]
    v_mfma_f32_16x16x32_bf16 v[132:135], v[156:159], v[204:207], v[132:135]
    s_waitcnt lgkmcnt(0)
    s_add_u32 m0, s50, 6656
    v_mfma_f32_16x16x32_bf16 v[64:67], v[160:163], v[136:139], v[64:67]
    ds_read_b128 v[148:151], v16 offset:0
    buffer_load_dwordx4 v5, s[16:19], s59 offen offset:1792 lds
    v_mfma_f32_16x16x32_bf16 v[88:91], v[160:163], v[140:143], v[88:91]
    ds_read_b64_tr_b16 v[184:185], v13 offset:12672
    v_mfma_f32_16x16x32_bf16 v[112:115], v[160:163], v[144:147], v[112:115]
    ds_read_b64_tr_b16 v[186:187], v13 offset:12928
    v_mfma_f32_16x16x32_bf16 v[68:71], v[164:167], v[136:139], v[68:71]
    ds_read_b128 v[152:155], v16 offset:2048
    s_add_u32 m0, s49, 26368
    v_mfma_f32_16x16x32_bf16 v[92:95], v[164:167], v[140:143], v[92:95]
    ds_read_b128 v[156:159], v16 offset:4096
    buffer_load_dwordx4 v3, s[12:15], s58 offen lds
    v_mfma_f32_16x16x32_bf16 v[116:119], v[164:167], v[144:147], v[116:119]
    ds_read_b64_tr_b16 v[188:189], v14 offset:12672
    v_mfma_f32_16x16x32_bf16 v[72:75], v[168:171], v[136:139], v[72:75]
    ds_read_b64_tr_b16 v[190:191], v14 offset:12928
    v_mfma_f32_16x16x32_bf16 v[96:99], v[168:171], v[140:143], v[96:99]
    ds_read_b64_tr_b16 v[192:193], v13 offset:16896
    s_add_u32 m0, s50, 12672
    v_mfma_f32_16x16x32_bf16 v[120:123], v[168:171], v[144:147], v[120:123]
    ds_read_b64_tr_b16 v[194:195], v13 offset:17152
    buffer_load_dwordx4 v5, s[16:19], s60 offen offset:0 lds
    v_mfma_f32_16x16x32_bf16 v[76:79], v[172:175], v[136:139], v[76:79]
    ds_read_b64_tr_b16 v[196:197], v14 offset:16896
    v_mfma_f32_16x16x32_bf16 v[100:103], v[172:175], v[140:143], v[100:103]
    ds_read_b64_tr_b16 v[198:199], v14 offset:17152
    v_mfma_f32_16x16x32_bf16 v[124:127], v[172:175], v[144:147], v[124:127]
    ds_read_b64_tr_b16 v[200:201], v13 offset:21120
    s_add_u32 m0, s49, 27392
    v_mfma_f32_16x16x32_bf16 v[80:83], v[136:139], v[176:179], v[80:83]
    ds_read_b64_tr_b16 v[202:203], v13 offset:21376
    buffer_load_dwordx4 v4, s[12:15], s58 offen lds
    v_mfma_f32_16x16x32_bf16 v[104:107], v[140:143], v[176:179], v[104:107]
    ds_read_b64_tr_b16 v[204:205], v14 offset:21120
    v_mfma_f32_16x16x32_bf16 v[128:131], v[144:147], v[176:179], v[128:131]
    ds_read_b64_tr_b16 v[206:207], v14 offset:21376
    v_mfma_f32_16x16x32_bf16 v[84:87], v[136:139], v[180:183], v[84:87]
    s_add_u32 m0, s50, 16000
    v_add_u32 v13, 75264, v9
    v_mfma_f32_16x16x32_bf16 v[108:111], v[140:143], v[180:183], v[108:111]
    buffer_load_dwordx4 v5, s[16:19], s60 offen offset:896 lds
    v_add_u32 v15, 75264, v11
    v_mfma_f32_16x16x32_bf16 v[132:135], v[144:147], v[180:183], v[132:135]
    s_waitcnt lgkmcnt(0)
    v_add_u32 v14, 75264, v10
    v_mfma_f32_16x16x32_bf16 v[64:67], v[184:187], v[148:151], v[64:67]
    v_add_u32 v16, 75264, v12
    v_mfma_f32_16x16x32_bf16 v[88:91], v[184:187], v[152:155], v[88:91]
    s_add_u32 m0, s50, 19328
    v_mfma_f32_16x16x32_bf16 v[112:115], v[184:187], v[156:159], v[112:115]
    buffer_load_dwordx4 v5, s[16:19], s60 offen offset:1792 lds
    v_mfma_f32_16x16x32_bf16 v[68:71], v[188:191], v[148:151], v[68:71]
    v_mfma_f32_16x16x32_bf16 v[92:95], v[188:191], v[152:155], v[92:95]
    v_mfma_f32_16x16x32_bf16 v[116:119], v[188:191], v[156:159], v[116:119]
    s_waitcnt vmcnt(9) lgkmcnt(0)
    s_barrier
    v_mfma_f32_16x16x32_bf16 v[72:75], v[192:195], v[148:151], v[72:75]
    ds_read_b128 v[136:139], v15 offset:0
    ds_read_b64_tr_b16 v[160:161], v13 offset:0
    v_mfma_f32_16x16x32_bf16 v[96:99], v[192:195], v[152:155], v[96:99]
    ds_read_b64_tr_b16 v[162:163], v13 offset:256
    ds_read_b128 v[140:143], v15 offset:2048
    v_mfma_f32_16x16x32_bf16 v[120:123], v[192:195], v[156:159], v[120:123]
    ds_read_b128 v[144:147], v15 offset:4096
    s_add_u32 m0, s50, 37632
    v_mfma_f32_16x16x32_bf16 v[76:79], v[196:199], v[148:151], v[76:79]
    ds_read_b64_tr_b16 v[164:165], v14 offset:0
    ds_read_b64_tr_b16 v[166:167], v14 offset:256
    v_mfma_f32_16x16x32_bf16 v[100:103], v[196:199], v[152:155], v[100:103]
    ds_read_b64_tr_b16 v[168:169], v13 offset:4224
    ds_read_b64_tr_b16 v[170:171], v13 offset:4480
    v_mfma_f32_16x16x32_bf16 v[124:127], v[196:199], v[156:159], v[124:127]
    ds_read_b64_tr_b16 v[172:173], v14 offset:4224
    buffer_load_dwordx4 v5, s[16:19], s52 offen offset:0 lds
    v_mfma_f32_16x16x32_bf16 v[80:83], v[148:151], v[200:203], v[80:83]
    ds_read_b64_tr_b16 v[174:175], v14 offset:4480
    ds_read_b64_tr_b16 v[176:177], v13 offset:8448
    v_mfma_f32_16x16x32_bf16 v[104:107], v[152:155], v[200:203], v[104:107]
    ds_read_b64_tr_b16 v[178:179], v13 offset:8704
    ds_read_b64_tr_b16 v[180:181], v14 offset:8448
    v_mfma_f32_16x16x32_bf16 v[128:131], v[156:159], v[200:203], v[128:131]
    ds_read_b64_tr_b16 v[182:183], v14 offset:8704
    v_mfma_f32_16x16x32_bf16 v[84:87], v[148:151], v[204:207], v[84:87]
    s_add_u32 m0, s50, 40960
    v_mfma_f32_16x16x32_bf16 v[108:111], v[152:155], v[204:207], v[108:111]
    buffer_load_dwordx4 v5, s[16:19], s52 offen offset:896 lds
    v_mfma_f32_16x16x32_bf16 v[132:135], v[156:159], v[204:207], v[132:135]
    s_waitcnt lgkmcnt(0)
    v_mfma_f32_16x16x32_bf16 v[64:67], v[160:163], v[136:139], v[64:67]
    ds_read_b128 v[148:151], v16 offset:0
    v_mfma_f32_16x16x32_bf16 v[88:91], v[160:163], v[140:143], v[88:91]
    ds_read_b64_tr_b16 v[184:185], v13 offset:12672
    s_add_u32 m0, s49, 62976
    v_mfma_f32_16x16x32_bf16 v[112:115], v[160:163], v[144:147], v[112:115]
    ds_read_b64_tr_b16 v[186:187], v13 offset:12928
    buffer_load_dwordx4 v2, s[12:15], s51 offen lds
    v_mfma_f32_16x16x32_bf16 v[68:71], v[164:167], v[136:139], v[68:71]
    ds_read_b128 v[152:155], v16 offset:2048
    v_mfma_f32_16x16x32_bf16 v[92:95], v[164:167], v[140:143], v[92:95]
    ds_read_b128 v[156:159], v16 offset:4096
    s_add_u32 m0, s50, 44288
    v_mfma_f32_16x16x32_bf16 v[116:119], v[164:167], v[144:147], v[116:119]
    ds_read_b64_tr_b16 v[188:189], v14 offset:12672
    buffer_load_dwordx4 v5, s[16:19], s52 offen offset:1792 lds
    v_mfma_f32_16x16x32_bf16 v[72:75], v[168:171], v[136:139], v[72:75]
    ds_read_b64_tr_b16 v[190:191], v14 offset:12928
    v_mfma_f32_16x16x32_bf16 v[96:99], v[168:171], v[140:143], v[96:99]
    ds_read_b64_tr_b16 v[192:193], v13 offset:16896
    v_mfma_f32_16x16x32_bf16 v[120:123], v[168:171], v[144:147], v[120:123]
    ds_read_b64_tr_b16 v[194:195], v13 offset:17152
    s_add_u32 m0, s49, 64000
    v_mfma_f32_16x16x32_bf16 v[76:79], v[172:175], v[136:139], v[76:79]
    ds_read_b64_tr_b16 v[196:197], v14 offset:16896
    buffer_load_dwordx4 v3, s[12:15], s51 offen lds
    v_mfma_f32_16x16x32_bf16 v[100:103], v[172:175], v[140:143], v[100:103]
    ds_read_b64_tr_b16 v[198:199], v14 offset:17152
    v_mfma_f32_16x16x32_bf16 v[124:127], v[172:175], v[144:147], v[124:127]
    ds_read_b64_tr_b16 v[200:201], v13 offset:21120
    s_add_u32 m0, s50, 50304
    v_mfma_f32_16x16x32_bf16 v[80:83], v[136:139], v[176:179], v[80:83]
    ds_read_b64_tr_b16 v[202:203], v13 offset:21376
    buffer_load_dwordx4 v5, s[16:19], s53 offen offset:0 lds
    v_mfma_f32_16x16x32_bf16 v[104:107], v[140:143], v[176:179], v[104:107]
    ds_read_b64_tr_b16 v[204:205], v14 offset:21120
    v_mfma_f32_16x16x32_bf16 v[128:131], v[144:147], v[176:179], v[128:131]
    ds_read_b64_tr_b16 v[206:207], v14 offset:21376
    v_mfma_f32_16x16x32_bf16 v[84:87], v[136:139], v[180:183], v[84:87]
    s_add_u32 m0, s49, 65024
    v_add_u32 v13, 0, v9
    v_mfma_f32_16x16x32_bf16 v[108:111], v[140:143], v[180:183], v[108:111]
    buffer_load_dwordx4 v4, s[12:15], s51 offen lds
    v_add_u32 v15, 0, v11
    v_mfma_f32_16x16x32_bf16 v[132:135], v[144:147], v[180:183], v[132:135]
    s_waitcnt lgkmcnt(0)
    v_add_u32 v14, 0, v10
    v_mfma_f32_16x16x32_bf16 v[64:67], v[184:187], v[148:151], v[64:67]
    s_add_u32 m0, s50, 53632
    v_add_u32 v16, 0, v12
    v_mfma_f32_16x16x32_bf16 v[88:91], v[184:187], v[152:155], v[88:91]
    buffer_load_dwordx4 v5, s[16:19], s53 offen offset:896 lds
    v_mfma_f32_16x16x32_bf16 v[112:115], v[184:187], v[156:159], v[112:115]
    v_mfma_f32_16x16x32_bf16 v[68:71], v[188:191], v[148:151], v[68:71]
    v_mfma_f32_16x16x32_bf16 v[92:95], v[188:191], v[152:155], v[92:95]
    s_add_u32 m0, s50, 56960
    v_mfma_f32_16x16x32_bf16 v[116:119], v[188:191], v[156:159], v[116:119]
    buffer_load_dwordx4 v5, s[16:19], s53 offen offset:1792 lds
    v_mfma_f32_16x16x32_bf16 v[72:75], v[192:195], v[148:151], v[72:75]
    v_mfma_f32_16x16x32_bf16 v[96:99], v[192:195], v[152:155], v[96:99]
    v_mfma_f32_16x16x32_bf16 v[120:123], v[192:195], v[156:159], v[120:123]
    buffer_load_dword v43, v41, s[20:23], 0 offen sc1
    s_waitcnt vmcnt(10) lgkmcnt(0)
    s_barrier
    v_mfma_f32_16x16x32_bf16 v[76:79], v[196:199], v[148:151], v[76:79]
    ds_read_b128 v[136:139], v15 offset:0
    ds_read_b64_tr_b16 v[160:161], v13 offset:0
    ds_read_b64_tr_b16 v[162:163], v13 offset:256
    v_mfma_f32_16x16x32_bf16 v[100:103], v[196:199], v[152:155], v[100:103]
    ds_read_b128 v[140:143], v15 offset:2048
    ds_read_b128 v[144:147], v15 offset:4096
    v_mfma_f32_16x16x32_bf16 v[124:127], v[196:199], v[156:159], v[124:127]
    ds_read_b64_tr_b16 v[164:165], v14 offset:0
    ds_read_b64_tr_b16 v[166:167], v14 offset:256
    ds_read_b64_tr_b16 v[168:169], v13 offset:4224
    v_mfma_f32_16x16x32_bf16 v[80:83], v[148:151], v[200:203], v[80:83]
    ds_read_b64_tr_b16 v[170:171], v13 offset:4480
    ds_read_b64_tr_b16 v[172:173], v14 offset:4224
    v_mfma_f32_16x16x32_bf16 v[104:107], v[152:155], v[200:203], v[104:107]
    ds_read_b64_tr_b16 v[174:175], v14 offset:4480
    ds_read_b64_tr_b16 v[176:177], v13 offset:8448
    ds_read_b64_tr_b16 v[178:179], v13 offset:8704
    v_mfma_f32_16x16x32_bf16 v[128:131], v[156:159], v[200:203], v[128:131]
    ds_read_b64_tr_b16 v[180:181], v14 offset:8448
    ds_read_b64_tr_b16 v[182:183], v14 offset:8704
    v_mfma_f32_16x16x32_bf16 v[84:87], v[148:151], v[204:207], v[84:87]
    s_add_u32 m0, s45, 0
    v_lshlrev_b32 v5, 10, v252
    v_mfma_f32_16x16x32_bf16 v[108:111], v[152:155], v[204:207], v[108:111]
    s_mov_b32 s6, 0
    v_sub_u32 v2, v241, v5
    v_mfma_f32_16x16x32_bf16 v[132:135], v[156:159], v[204:207], v[132:135]
    s_waitcnt lgkmcnt(0)
    buffer_load_dwordx4 v240, s[24:27], s6 offen lds
    s_add_u32 m0, s45, 4096
    v_mfma_f32_16x16x32_bf16 v[64:67], v[160:163], v[136:139], v[64:67]
    ds_read_b128 v[148:151], v16 offset:0
    s_mov_b32 s6, 28672
    v_mfma_f32_16x16x32_bf16 v[88:91], v[160:163], v[140:143], v[88:91]
    ds_read_b64_tr_b16 v[184:185], v13 offset:12672
    buffer_load_dwordx4 v240, s[24:27], s6 offen lds
    v_mfma_f32_16x16x32_bf16 v[112:115], v[160:163], v[144:147], v[112:115]
    ds_read_b64_tr_b16 v[186:187], v13 offset:12928
    s_add_u32 m0, s45, 8192
    v_mfma_f32_16x16x32_bf16 v[68:71], v[164:167], v[136:139], v[68:71]
    ds_read_b128 v[152:155], v16 offset:2048
    s_mov_b32 s6, 57344
    v_mfma_f32_16x16x32_bf16 v[92:95], v[164:167], v[140:143], v[92:95]
    ds_read_b128 v[156:159], v16 offset:4096
    buffer_load_dwordx4 v240, s[24:27], s6 offen lds
    v_mfma_f32_16x16x32_bf16 v[116:119], v[164:167], v[144:147], v[116:119]
    ds_read_b64_tr_b16 v[188:189], v14 offset:12672
    s_add_u32 m0, s45, 12288
    v_mfma_f32_16x16x32_bf16 v[72:75], v[168:171], v[136:139], v[72:75]
    ds_read_b64_tr_b16 v[190:191], v14 offset:12928
    s_mov_b32 s6, 86016
    v_mfma_f32_16x16x32_bf16 v[96:99], v[168:171], v[140:143], v[96:99]
    ds_read_b64_tr_b16 v[192:193], v13 offset:16896
    buffer_load_dwordx4 v240, s[24:27], s6 offen lds
    v_mfma_f32_16x16x32_bf16 v[120:123], v[168:171], v[144:147], v[120:123]
    ds_read_b64_tr_b16 v[194:195], v13 offset:17152
    s_add_u32 m0, s45, 16384
    v_mfma_f32_16x16x32_bf16 v[76:79], v[172:175], v[136:139], v[76:79]
    ds_read_b64_tr_b16 v[196:197], v14 offset:16896
    s_mov_b32 s6, 114688
    v_mfma_f32_16x16x32_bf16 v[100:103], v[172:175], v[140:143], v[100:103]
    ds_read_b64_tr_b16 v[198:199], v14 offset:17152
    buffer_load_dwordx4 v240, s[24:27], s6 offen lds
    v_mfma_f32_16x16x32_bf16 v[124:127], v[172:175], v[144:147], v[124:127]
    ds_read_b64_tr_b16 v[200:201], v13 offset:21120
    s_add_u32 m0, s45, 20480
    v_mfma_f32_16x16x32_bf16 v[80:83], v[136:139], v[176:179], v[80:83]
    ds_read_b64_tr_b16 v[202:203], v13 offset:21376
    s_mov_b32 s6, 143360
    v_mfma_f32_16x16x32_bf16 v[104:107], v[140:143], v[176:179], v[104:107]
    ds_read_b64_tr_b16 v[204:205], v14 offset:21120
    buffer_load_dwordx4 v240, s[24:27], s6 offen lds
    v_mfma_f32_16x16x32_bf16 v[128:131], v[144:147], v[176:179], v[128:131]
    ds_read_b64_tr_b16 v[206:207], v14 offset:21376
    s_add_u32 m0, s45, 24576
    v_mfma_f32_16x16x32_bf16 v[84:87], v[136:139], v[180:183], v[84:87]
    s_mov_b32 s6, 172032
    v_add_u32 v13, 37632, v9
    v_mfma_f32_16x16x32_bf16 v[108:111], v[140:143], v[180:183], v[108:111]
    buffer_load_dwordx4 v240, s[24:27], s6 offen lds
    v_add_u32 v15, 37632, v11
    v_mfma_f32_16x16x32_bf16 v[132:135], v[144:147], v[180:183], v[132:135]
    s_waitcnt lgkmcnt(0)
    s_add_u32 m0, s45, 28672
    v_mfma_f32_16x16x32_bf16 v[64:67], v[184:187], v[148:151], v[64:67]
    s_mov_b32 s6, 200704
    v_add_u32 v14, 37632, v10
    v_mfma_f32_16x16x32_bf16 v[88:91], v[184:187], v[152:155], v[88:91]
    buffer_load_dwordx4 v240, s[24:27], s6 offen lds
    v_add_u32 v16, 37632, v12
    v_mfma_f32_16x16x32_bf16 v[112:115], v[184:187], v[156:159], v[112:115]
    s_add_u32 m0, s45, 32768
    v_sub_u32 v3, v242, v5
    v_mfma_f32_16x16x32_bf16 v[68:71], v[188:191], v[148:151], v[68:71]
    s_mov_b32 s6, 229376
    v_sub_u32 v4, v243, v5
    v_mfma_f32_16x16x32_bf16 v[92:95], v[188:191], v[152:155], v[92:95]
    buffer_load_dwordx4 v240, s[24:27], s6 offen lds
    v_sub_u32 v5, v244, v5
    v_mfma_f32_16x16x32_bf16 v[116:119], v[188:191], v[156:159], v[116:119]
    s_add_u32 m0, s45, 36864
    s_movk_i32 s58, 4096
    v_mfma_f32_16x16x32_bf16 v[72:75], v[192:195], v[148:151], v[72:75]
    s_mov_b32 s6, 258048
    s_movk_i32 s59, 8192
    v_mfma_f32_16x16x32_bf16 v[96:99], v[192:195], v[152:155], v[96:99]
    buffer_load_dwordx4 v240, s[24:27], s6 offen lds
    s_movk_i32 s60, 12288
    v_mfma_f32_16x16x32_bf16 v[120:123], v[192:195], v[156:159], v[120:123]
    s_waitcnt vmcnt(10) lgkmcnt(0)
    s_barrier
    ds_read_b128 v[144:147], v15 offset:4096
    ds_read_b64_tr_b16 v[164:165], v14 offset:0
    v_mfma_f32_16x16x32_bf16 v[76:79], v[196:199], v[148:151], v[76:79]
    ds_read_b64_tr_b16 v[166:167], v14 offset:256
    ds_read_b128 v[140:143], v15 offset:2048
    v_mfma_f32_16x16x32_bf16 v[100:103], v[196:199], v[152:155], v[100:103]
    ds_read_b128 v[136:139], v15 offset:0
    ds_read_b64_tr_b16 v[172:173], v14 offset:4224
    v_mfma_f32_16x16x32_bf16 v[124:127], v[196:199], v[156:159], v[124:127]
    ds_read_b64_tr_b16 v[174:175], v14 offset:4480
    ds_read_b64_tr_b16 v[180:181], v14 offset:8448
    v_mfma_f32_16x16x32_bf16 v[80:83], v[148:151], v[200:203], v[80:83]
    ds_read_b64_tr_b16 v[182:183], v14 offset:8704
    ds_read_b64_tr_b16 v[168:169], v13 offset:4224
    v_mfma_f32_16x16x32_bf16 v[104:107], v[152:155], v[200:203], v[104:107]
    ds_read_b64_tr_b16 v[170:171], v13 offset:4480
    ds_read_b64_tr_b16 v[176:177], v13 offset:8448
    v_mfma_f32_16x16x32_bf16 v[128:131], v[156:159], v[200:203], v[128:131]
    ds_read_b64_tr_b16 v[178:179], v13 offset:8704
    ds_read_b64_tr_b16 v[160:161], v13 offset:0
    v_mfma_f32_16x16x32_bf16 v[84:87], v[148:151], v[204:207], v[84:87]
    ds_read_b64_tr_b16 v[162:163], v13 offset:256
    v_mfma_f32_16x16x32_bf16 v[108:111], v[152:155], v[204:207], v[108:111]
    v_mfma_f32_16x16x32_bf16 v[132:135], v[156:159], v[204:207], v[132:135]
    ds_read_b128 v[156:159], v16 offset:4096
    s_add_u32 m0, s45, 40960
    s_waitcnt lgkmcnt(13)
    v_mfma_f32_16x16x32_bf16 v[116:119], v[164:167], v[144:147], v[116:119]
    ds_read_b64_tr_b16 v[188:189], v14 offset:12672
    s_mov_b32 s6, 286720
    s_waitcnt lgkmcnt(13)
    v_mfma_f32_16x16x32_bf16 v[92:95], v[164:167], v[140:143], v[92:95]
    ds_read_b64_tr_b16 v[190:191], v14 offset:12928
    buffer_load_dwordx4 v240, s[24:27], s6 offen lds
    s_waitcnt lgkmcnt(13)
    v_mfma_f32_16x16x32_bf16 v[68:71], v[164:167], v[136:139], v[68:71]
    ds_read_b64_tr_b16 v[196:197], v14 offset:16896
    s_waitcnt lgkmcnt(12)
    v_mfma_f32_16x16x32_bf16 v[124:127], v[172:175], v[144:147], v[124:127]
    ds_read_b64_tr_b16 v[198:199], v14 offset:17152
    s_add_u32 m0, s45, 45056
    v_mfma_f32_16x16x32_bf16 v[100:103], v[172:175], v[140:143], v[100:103]
    ds_read_b128 v[152:155], v16 offset:2048
    s_mov_b32 s6, 315392
    v_mfma_f32_16x16x32_bf16 v[76:79], v[172:175], v[136:139], v[76:79]
    ds_read_b128 v[148:151], v16 offset:0
    buffer_load_dwordx4 v240, s[24:27], s6 offen lds
    s_waitcnt lgkmcnt(13)
    v_mfma_f32_16x16x32_bf16 v[132:135], v[144:147], v[180:183], v[132:135]
    ds_read_b64_tr_b16 v[204:205], v14 offset:21120
    v_mfma_f32_16x16x32_bf16 v[108:111], v[140:143], v[180:183], v[108:111]
    ds_read_b64_tr_b16 v[206:207], v14 offset:21376
    s_add_u32 m0, s45, 49152
    v_mfma_f32_16x16x32_bf16 v[84:87], v[136:139], v[180:183], v[84:87]
    ds_read_b64_tr_b16 v[192:193], v13 offset:16896
    s_mov_b32 s6, 344064
    s_waitcnt lgkmcnt(7)
    v_mfma_f32_16x16x32_bf16 v[116:119], v[188:191], v[156:159], v[116:119]
    ds_read_b64_tr_b16 v[194:195], v13 offset:17152
    buffer_load_dwordx4 v240, s[24:27], s6 offen lds
    s_waitcnt lgkmcnt(6)
    v_mfma_f32_16x16x32_bf16 v[124:127], v[196:199], v[156:159], v[124:127]
    ds_read_b64_tr_b16 v[200:201], v13 offset:21120
    s_waitcnt lgkmcnt(6)
    v_mfma_f32_16x16x32_bf16 v[92:95], v[188:191], v[152:155], v[92:95]
    ds_read_b64_tr_b16 v[202:203], v13 offset:21376
    s_add_u32 m0, s45, 53248
    v_mfma_f32_16x16x32_bf16 v[100:103], v[196:199], v[152:155], v[100:103]
    ds_read_b64_tr_b16 v[184:185], v13 offset:12672
    s_mov_b32 s6, 372736
    s_waitcnt lgkmcnt(7)
    v_mfma_f32_16x16x32_bf16 v[68:71], v[188:191], v[148:151], v[68:71]
    ds_read_b64_tr_b16 v[186:187], v13 offset:12928
    buffer_load_dwordx4 v240, s[24:27], s6 offen lds
    v_mfma_f32_16x16x32_bf16 v[76:79], v[196:199], v[148:151], v[76:79]
    v_cmp_ne_u32 vcc, v43, v250
    s_waitcnt lgkmcnt(6)
    v_mfma_f32_16x16x32_bf16 v[132:135], v[156:159], v[204:207], v[132:135]
    v_mfma_f32_16x16x32_bf16 v[108:111], v[152:155], v[204:207], v[108:111]
    s_or_b32 s43, vcc_lo, vcc_hi
    v_mfma_f32_16x16x32_bf16 v[84:87], v[148:151], v[204:207], v[84:87]
    v_cvt_pk_bf16_f32 v218, v116, v117
    v_cvt_pk_bf16_f32 v219, v118, v119
    v_cvt_pk_bf16_f32 v216, v124, v125
    v_mfma_f32_16x16x32_bf16 v[120:123], v[168:171], v[144:147], v[120:123]
    v_cvt_pk_bf16_f32 v217, v126, v127
    buffer_store_dwordx4 v[216:219], v36, s[20:23], s38 offen offset:512
    v_cvt_pk_bf16_f32 v214, v92, v93
    v_mfma_f32_16x16x32_bf16 v[96:99], v[168:171], v[140:143], v[96:99]
    v_cvt_pk_bf16_f32 v215, v94, v95
    v_cvt_pk_bf16_f32 v212, v100, v101
    v_cvt_pk_bf16_f32 v213, v102, v103
    v_mfma_f32_16x16x32_bf16 v[72:75], v[168:171], v[136:139], v[72:75]
    buffer_store_dwordx4 v[212:215], v36, s[20:23], s38 offen offset:256
    v_cvt_pk_bf16_f32 v210, v68, v69
    v_cvt_pk_bf16_f32 v211, v70, v71
    v_mfma_f32_16x16x32_bf16 v[128:131], v[144:147], v[176:179], v[128:131]
    v_cvt_pk_bf16_f32 v208, v76, v77
    v_cvt_pk_bf16_f32 v209, v78, v79
    buffer_store_dwordx4 v[208:211], v36, s[20:23], s38 offen offset:0
    v_mfma_f32_16x16x32_bf16 v[104:107], v[140:143], v[176:179], v[104:107]
    v_cvt_pk_bf16_f32 v238, v132, v133
    v_cvt_pk_bf16_f32 v239, v134, v135
    v_cvt_pk_bf16_f32 v236, v108, v109
    v_mfma_f32_16x16x32_bf16 v[80:83], v[136:139], v[176:179], v[80:83]
    v_cvt_pk_bf16_f32 v237, v110, v111
    buffer_store_dwordx4 v[236:239], v37, s[20:23], s38 offen offset:768
    v_cvt_pk_bf16_f32 v234, v84, v85
    v_mfma_f32_16x16x32_bf16 v[112:115], v[160:163], v[144:147], v[112:115]
    v_cvt_pk_bf16_f32 v235, v86, v87
    buffer_store_dwordx2 v[234:235], v37, s[20:23], s39 offen offset:2048
    v_mfma_f32_16x16x32_bf16 v[88:91], v[160:163], v[140:143], v[88:91]
    ds_write_b64 v6, v[216:217] offset:0
    ds_write_b64 v6, v[238:239] offset:1032
    v_mfma_f32_16x16x32_bf16 v[64:67], v[160:163], v[136:139], v[64:67]
    s_waitcnt lgkmcnt(6)
    v_mfma_f32_16x16x32_bf16 v[120:123], v[192:195], v[156:159], v[120:123]
    s_waitcnt lgkmcnt(4)
    v_mfma_f32_16x16x32_bf16 v[128:131], v[156:159], v[200:203], v[128:131]
    s_waitcnt lgkmcnt(2)
    v_mfma_f32_16x16x32_bf16 v[112:115], v[184:187], v[156:159], v[112:115]
    v_mfma_f32_16x16x32_bf16 v[96:99], v[192:195], v[152:155], v[96:99]
    v_mfma_f32_16x16x32_bf16 v[104:107], v[152:155], v[200:203], v[104:107]
    s_nop 1
    v_cvt_pk_bf16_f32 v52, v120, v121
    v_cvt_pk_bf16_f32 v53, v122, v123
    v_mfma_f32_16x16x32_bf16 v[88:91], v[184:187], v[152:155], v[88:91]
    v_cvt_pk_bf16_f32 v230, v128, v129
    v_cvt_pk_bf16_f32 v231, v130, v131
    v_mfma_f32_16x16x32_bf16 v[72:75], v[192:195], v[148:151], v[72:75]
    ds_write_b64 v6, v[52:53] offset:8
    ds_write_b64 v6, v[230:231] offset:1024
    v_mfma_f32_16x16x32_bf16 v[80:83], v[148:151], v[200:203], v[80:83]
    v_cvt_pk_bf16_f32 v54, v112, v113
    v_cvt_pk_bf16_f32 v55, v114, v115
    v_mfma_f32_16x16x32_bf16 v[64:67], v[184:187], v[148:151], v[64:67]
    v_cvt_pk_bf16_f32 v48, v96, v97
    v_cvt_pk_bf16_f32 v49, v98, v99
    v_cvt_pk_bf16_f32 v228, v104, v105
    v_cvt_pk_bf16_f32 v229, v106, v107
    v_cvt_pk_bf16_f32 v50, v88, v89
    v_cvt_pk_bf16_f32 v51, v90, v91
    s_cmp_lg_u32 s43, 0
    s_waitcnt vmcnt(0)
    s_cbranch_scc1 L_rsX
L_rfX:
    buffer_store_dword v250, v248, s[20:23], 0 offen offset:16
L_rdX:
    s_waitcnt lgkmcnt(0)
    s_barrier
    ds_read_b128 v[220:223], v7
    ds_read_b64 v[224:225], v7 offset:1024
    ds_read_b64 v[232:233], v7 offset:1032
    v_cvt_pk_bf16_f32 v44, v72, v73
    v_cvt_pk_bf16_f32 v45, v74, v75
    v_cvt_pk_bf16_f32 v46, v64, v65
    v_cvt_pk_bf16_f32 v47, v66, v67
    v_cvt_pk_bf16_f32 v226, v80, v81
    v_cvt_pk_bf16_f32 v227, v82, v83
    v_mfma_f32_16x16x16_bf16 v[164:167], v[52:53], v[54:55], v[24:27]
    v_mfma_f32_16x16x16_bf16 v[160:163], v[48:49], v[54:55], v[20:23]
L_padA2:
    s_cbranch_execz L_back
    v_mfma_f32_16x16x16_bf16 v[172:175], v[48:49], v[50:51], v[24:27]
    v_mfma_f32_16x16x16_bf16 v[168:171], v[44:45], v[50:51], v[20:23]
    v_mfma_f32_16x16x16_bf16 v[188:191], v[44:45], v[46:47], v[60:63]
    s_waitcnt lgkmcnt(2)
    v_mfma_f32_16x16x16_bf16 v[184:187], v[222:223], v[46:47], v[56:59]
    s_bitcmp1_b32 s34, 9
    s_waitcnt lgkmcnt(0)
    s_cbranch_scc1 L_get
    s_mov_b64 exec, s[62:63]
    v_mov_b32 v218, 0
    v_mov_b32 v219, 0
    v_mov_b32 v214, 0
    v_mov_b32 v215, 0
    v_mov_b32 v210, 0
    v_mov_b32 v211, 0
    s_mov_b64 exec, s[64:65]
    v_mov_b32 v232, 0
    v_mov_b32 v233, 0
    v_mov_b32 v234, 0
    v_mov_b32 v235, 0
    v_mov_b32 v236, 0
    v_mov_b32 v237, 0
    v_mov_b32 v238, 0
    v_mov_b32 v239, 0
    s_mov_b64 exec, -1
    s_branch L_imp
L_get:
    ds_read_b64_tr_b16 a[0:1], v241 offset:0
    ds_read_b64_tr_b16 a[2:3], v241 offset:2048
    ds_read_b64_tr_b16 a[4:5], v242 offset:0
    ds_read_b64_tr_b16 a[6:7], v242 offset:2048
    ds_read_b64_tr_b16 a[8:9], v243 offset:0
    ds_read_b64_tr_b16 a[10:11], v243 offset:2048
    ds_read_b64_tr_b16 a[12:13], v244 offset:0
    ds_read_b64_tr_b16 a[14:15], v244 offset:2048
    s_mov_b32 s10, 65536
L_plX:
    buffer_load_dword v42, v40, s[20:23], 0 offen sc1
    s_sub_u32 s10, s10, 1
    s_cbranch_scc1 L_pdX
    s_waitcnt vmcnt(0)
    v_cmp_ne_u32 vcc, v42, v250
    s_nop 0
    s_and_b64 exec, exec, vcc
    s_cbranch_scc1 L_plX
L_pdX:
    s_mov_b64 exec, -1
    s_cmp_lg_u32 s43, 0
    s_cbranch_scc1 L_asX
L_adX:
    s_mov_b64 exec, s[62:63]
    buffer_load_dwordx4 v[216:219], v38, s[20:23], s38 offen offset:512 sc1
    buffer_load_dwordx4 v[212:215], v38, s[20:23], s38 offen offset:256 sc1
    buffer_load_dwordx4 v[208:211], v38, s[20:23], s38 offen offset:0 sc1
    buffer_load_dwordx2 v[220:221], v38, s[20:23], 0 offen offset:512 sc1
    s_mov_b64 exec, s[64:65]
    buffer_load_dwordx4 v[236:239], v39, s[20:23], s38 offen offset:768 sc1
    buffer_load_dwordx2 v[234:235], v39, s[20:23], s39 offen offset:2048 sc1
    buffer_load_dwordx2 v[232:233], v39, s[20:23], 0 offen offset:776 sc1
    s_mov_b64 exec, -1
    ds_read_b64_tr_b16 a[16:17], v243 offset:3584
    ds_read_b64_tr_b16 a[18:19], v243 offset:5632
    ds_read_b64_tr_b16 a[20:21], v244 offset:3584
    ds_read_b64_tr_b16 a[22:23], v244 offset:5632
    ds_read_b64_tr_b16 a[24:25], v241 offset:3584
    ds_read_b64_tr_b16 a[26:27], v241 offset:5632
    ds_read_b64_tr_b16 a[28:29], v242 offset:3584
    ds_read_b64_tr_b16 a[30:31], v242 offset:5632
    ds_read_b64_tr_b16 a[112:113], v243 offset:25088
    ds_read_b64_tr_b16 a[114:115], v243 offset:27136
    ds_read_b64_tr_b16 a[116:117], v244 offset:25088
    ds_read_b64_tr_b16 a[118:119], v244 offset:27136
    ds_read_b64_tr_b16 a[120:121], v241 offset:25088
    ds_read_b64_tr_b16 a[122:123], v241 offset:27136
    ds_read_b64_tr_b16 a[124:125], v242 offset:25088
    ds_read_b64_tr_b16 a[126:127], v242 offset:27136
    ds_read_b64_tr_b16 a[128:129], v241 offset:28672
    ds_read_b64_tr_b16 a[130:131], v241 offset:30720
    ds_read_b64_tr_b16 a[132:133], v242 offset:28672
    ds_read_b64_tr_b16 a[134:135], v242 offset:30720
    ds_read_b64_tr_b16 a[136:137], v243 offset:28672
    ds_read_b64_tr_b16 a[138:139], v243 offset:30720
    ds_read_b64_tr_b16 a[140:141], v244 offset:28672
    ds_read_b64_tr_b16 a[142:143], v244 offset:30720
    ds_read_b64_tr_b16 a[224:225], v241 offset:50176
    ds_read_b64_tr_b16 a[226:227], v241 offset:52224
    ds_read_b64_tr_b16 a[228:229], v242 offset:50176
    ds_read_b64_tr_b16 a[230:231], v242 offset:52224
    ds_read_b64_tr_b16 a[232:233], v243 offset:50176
    ds_read_b64_tr_b16 a[234:235], v243 offset:52224
    ds_read_b64_tr_b16 a[236:237], v244 offset:50176
    ds_read_b64_tr_b16 a[238:239], v244 offset:52224
    s_branch L_imp
L_Sget:
    s_mov_b32 s10, 65536
L_plS:
    buffer_load_dword v42, v40, s[20:23], 0 offen sc1
    s_sub_u32 s10, s10, 1
    s_cbranch_scc1 L_pdS
    s_waitcnt vmcnt(0)
    v_cmp_ne_u32 vcc, v42, v250
    s_nop 0
    s_and_b64 exec, exec, vcc
    s_cbranch_scc1 L_plS
L_pdS:
    s_mov_b64 exec, -1
    s_cmp_lg_u32 s43, 0
    s_cbranch_scc1 L_asS
L_adS:
    buffer_load_dwordx4 v[52:55], v36, s[20:23], s38 offen offset:512 sc1
    buffer_load_dwordx4 v[216:219], v38, s[20:23], s38 offen offset:512 sc1
    buffer_load_dwordx4 v[48:51], v36, s[20:23], s38 offen offset:256 sc1
    buffer_load_dwordx4 v[212:215], v38, s[20:23], s38 offen offset:256 sc1
    buffer_load_dwordx4 v[44:47], v36, s[20:23], s38 offen offset:0 sc1
    buffer_load_dwordx4 v[208:211], v38, s[20:23], s38 offen offset:0 sc1
    buffer_load_dwordx2 v[222:223], v36, s[20:23], 0 offen offset:512 sc1
    buffer_load_dwordx2 v[220:221], v38, s[20:23], 0 offen offset:512 sc1
    s_waitcnt vmcnt(7)
    v_mfma_f32_16x16x16_bf16 v[164:167], v[52:53], v[54:55], v[24:27]
    buffer_load_dwordx4 v[228:231], v37, s[20:23], s38 offen offset:768 sc1
    s_waitcnt vmcnt(7)
    v_mfma_f32_16x16x16_bf16 v[164:167], v[216:217], v[218:219], v[164:167]
    s_waitcnt vmcnt(6)
    v_mfma_f32_16x16x16_bf16 v[160:163], v[48:49], v[54:55], v[20:23]
    buffer_load_dwordx2 v[226:227], v37, s[20:23], s39 offen offset:2048 sc1
    s_waitcnt vmcnt(6)
    v_mfma_f32_16x16x16_bf16 v[160:163], v[212:213], v[218:219], v[160:163]
    v_mfma_f32_16x16x16_bf16 v[172:175], v[48:49], v[50:51], v[24:27]
    buffer_load_dwordx2 v[224:225], v37, s[20:23], 0 offen offset:776 sc1
    v_mfma_f32_16x16x16_bf16 v[172:175], v[212:213], v[214:215], v[172:175]
    s_waitcnt vmcnt(6)
    v_mfma_f32_16x16x16_bf16 v[168:171], v[44:45], v[50:51], v[20:23]
    buffer_load_dwordx4 v[236:239], v39, s[20:23], s38 offen offset:768 sc1
    s_waitcnt vmcnt(6)
    v_mfma_f32_16x16x16_bf16 v[168:171], v[208:209], v[214:215], v[168:171]
    v_mfma_f32_16x16x16_bf16 v[188:191], v[44:45], v[46:47], v[60:63]
    buffer_load_dwordx2 v[234:235], v39, s[20:23], s39 offen offset:2048 sc1
    v_mfma_f32_16x16x16_bf16 v[188:191], v[208:209], v[210:211], v[188:191]
    s_waitcnt vmcnt(6)
    v_mfma_f32_16x16x16_bf16 v[184:187], v[222:223], v[46:47], v[56:59]
    buffer_load_dwordx2 v[232:233], v39, s[20:23], 0 offen offset:776 sc1
    s_waitcnt vmcnt(6)
    v_mfma_f32_16x16x16_bf16 v[184:187], v[220:221], v[210:211], v[184:187]
    s_branch L_sm
L_imp:
    s_waitcnt vmcnt(6)
    v_mfma_f32_16x16x16_bf16 v[164:167], v[216:217], v[218:219], v[164:167]
    s_waitcnt vmcnt(5)
    v_mfma_f32_16x16x16_bf16 v[160:163], v[212:213], v[218:219], v[160:163]
    v_mfma_f32_16x16x16_bf16 v[172:175], v[212:213], v[214:215], v[172:175]
    s_waitcnt vmcnt(4)
    v_mfma_f32_16x16x16_bf16 v[168:171], v[208:209], v[214:215], v[168:171]
    v_mfma_f32_16x16x16_bf16 v[188:191], v[208:209], v[210:211], v[188:191]
    s_waitcnt vmcnt(3)
    v_mfma_f32_16x16x16_bf16 v[184:187], v[220:221], v[210:211], v[184:187]
L_sm:
    s_nop 1
    v_max_f32 v160, v160, v164
    v_max_f32 v161, v161, v165
    v_max_f32 v162, v162, v166
    v_max_f32 v163, v163, v167
    v_max_f32 v168, v168, v172
    v_max_f32 v169, v169, v173
    v_max_f32 v170, v170, v174
    v_max_f32 v171, v171, v175
    v_max_f32 v184, v184, v188
    v_max_f32 v185, v185, v189
    v_max_f32 v186, v186, v190
    v_max_f32 v187, v187, v191
    v_max3_f32 v75, v160, v161, v162
    v_max3_f32 v74, v168, v169, v170
    v_max3_f32 v73, v184, v185, v186
    v_max_f32 v68, v75, v163
    v_max_f32 v72, v75, v163
    v_max_f32 v66, v74, v171
    v_max_f32 v71, v74, v171
    v_max_f32 v64, v73, v187
    v_max_f32 v70, v73, v187
    v_permlane32_swap_b32 v68, v72
    v_permlane32_swap_b32 v66, v71
    v_permlane32_swap_b32 v64, v70
    v_max_f32 v75, v68, v72
    v_max_f32 v68, v68, v72
    v_max_f32 v74, v66, v71
    v_max_f32 v66, v66, v71
    v_max_f32 v73, v64, v70
    v_max_f32 v64, v64, v70
    v_permlane16_swap_b32 v68, v75
    v_permlane16_swap_b32 v66, v74
    v_permlane16_swap_b32 v64, v73
    v_max_f32 v68, v68, v75
    v_max_f32 v66, v66, v74
    v_max_f32 v64, v64, v73
    v_mul_f32 v68, v30, v68
    v_mul_f32 v66, v30, v66
    v_mul_f32 v64, v30, v64
    v_pk_fma_f32 v[160:161], v[160:161], v[30:31], v[68:69] op_sel_hi:[1,0,0] neg_lo:[0,0,1] neg_hi:[0,0,1]
    v_pk_fma_f32 v[162:163], v[162:163], v[30:31], v[68:69] op_sel_hi:[1,0,0] neg_lo:[0,0,1] neg_hi:[0,0,1]
    v_pk_fma_f32 v[168:169], v[168:169], v[30:31], v[66:67] op_sel_hi:[1,0,0] neg_lo:[0,0,1] neg_hi:[0,0,1]
    v_pk_fma_f32 v[170:171], v[170:171], v[30:31], v[66:67] op_sel_hi:[1,0,0] neg_lo:[0,0,1] neg_hi:[0,0,1]
    v_pk_fma_f32 v[184:185], v[184:185], v[30:31], v[64:65] op_sel_hi:[1,0,0] neg_lo:[0,0,1] neg_hi:[0,0,1]
    v_pk_fma_f32 v[186:187], v[186:187], v[30:31], v[64:65] op_sel_hi:[1,0,0] neg_lo:[0,0,1] neg_hi:[0,0,1]
    buffer_load_dword v42, v246, s[20:23], 0 offen sc1
    v_exp_f32 v160, v160
    v_exp_f32 v161, v161
    v_exp_f32 v162, v162
    v_exp_f32 v163, v163
    v_exp_f32 v168, v168
    v_exp_f32 v169, v169
    v_exp_f32 v170, v170
    v_exp_f32 v171, v171
    v_cvt_pk_bf16_f32 v164, v160, v161
    v_cvt_pk_bf16_f32 v165, v162, v163
    v_and_b32 v96, v28, v164
    v_and_b32 v97, v29, v165
    v_bfi_b32 v98, v28, 0, v164
    v_bfi_b32 v99, v29, 0, v165
    v_exp_f32 v184, v184
    v_exp_f32 v185, v185
    v_mfma_f32_16x16x32_bf16 v[120:123], v[32:35], v[96:99], 0
    v_exp_f32 v186, v186
    v_exp_f32 v187, v187
    s_waitcnt vmcnt(3)
    v_mfma_f32_16x16x32_bf16 v[156:159], v[236:239], v[96:99], 0
    v_cvt_pk_bf16_f32 v172, v168, v169
    v_cvt_pk_bf16_f32 v173, v170, v171
    v_mfma_f32_16x16x32_bf16 v[152:155], v[228:231], v[96:99], 0
    v_and_b32 v92, v28, v172
    v_and_b32 v93, v29, v173
    v_bfi_b32 v94, v28, 0, v172
    v_bfi_b32 v95, v29, 0, v173
    v_cvt_pk_bf16_f32 v188, v184, v185
    v_cvt_pk_bf16_f32 v189, v186, v187
    v_mfma_f32_16x16x32_bf16 v[116:119], v[32:35], v[92:95], 0
    v_and_b32 v88, v28, v188
    v_and_b32 v89, v29, v189
    s_waitcnt vmcnt(2)
    v_mfma_f32_16x16x32_bf16 v[148:151], v[234:237], v[92:95], 0
    v_bfi_b32 v90, v28, 0, v188
    v_bfi_b32 v91, v29, 0, v189
    v_mfma_f32_16x16x32_bf16 v[144:147], v[226:229], v[92:95], 0
    v_rcp_f32 v68, v120
    v_mfma_f32_16x16x32_bf16 v[112:115], v[32:35], v[88:91], 0
    s_waitcnt vmcnt(1)
    v_mfma_f32_16x16x32_bf16 v[140:143], v[232:235], v[88:91], 0
    v_mfma_f32_16x16x32_bf16 v[136:139], v[224:227], v[88:91], 0
    v_pk_mul_f32 v[152:153], v[152:153], v[68:69] op_sel_hi:[1,0]
    v_pk_mul_f32 v[154:155], v[154:155], v[68:69] op_sel_hi:[1,0]
    v_pk_mul_f32 v[156:157], v[156:157], v[68:69] op_sel_hi:[1,0]
    v_pk_mul_f32 v[158:159], v[158:159], v[68:69] op_sel_hi:[1,0]
    v_rcp_f32 v66, v116
    v_cvt_pk_bf16_f32 v200, v152, v153
    v_cvt_pk_bf16_f32 v201, v154, v155
    v_cvt_pk_bf16_f32 v202, v156, v157
    v_cvt_pk_bf16_f32 v203, v158, v159
    buffer_store_dwordx4 v[200:203], v19, s[20:23], 0 offen
    v_pk_mul_f32 v[144:145], v[144:145], v[66:67] op_sel_hi:[1,0]
    v_pk_mul_f32 v[146:147], v[146:147], v[66:67] op_sel_hi:[1,0]
    v_pk_mul_f32 v[148:149], v[148:149], v[66:67] op_sel_hi:[1,0]
    v_pk_mul_f32 v[150:151], v[150:151], v[66:67] op_sel_hi:[1,0]
    v_rcp_f32 v64, v112
    v_cvt_pk_bf16_f32 v196, v144, v145
    v_cvt_pk_bf16_f32 v197, v146, v147
    v_cvt_pk_bf16_f32 v198, v148, v149
    v_cvt_pk_bf16_f32 v199, v150, v151
    buffer_store_dwordx4 v[196:199], v18, s[20:23], 0 offen
    v_pk_mul_f32 v[136:137], v[136:137], v[64:65] op_sel_hi:[1,0]
    v_pk_mul_f32 v[138:139], v[138:139], v[64:65] op_sel_hi:[1,0]
    v_pk_mul_f32 v[140:141], v[140:141], v[64:65] op_sel_hi:[1,0]
    v_pk_mul_f32 v[142:143], v[142:143], v[64:65] op_sel_hi:[1,0]
    v_cvt_pk_bf16_f32 v192, v136, v137
    v_cvt_pk_bf16_f32 v193, v138, v139
    v_cvt_pk_bf16_f32 v194, v140, v141
    v_cvt_pk_bf16_f32 v195, v142, v143
    buffer_store_dwordx4 v[192:195], v17, s[20:23], 0 offen
    s_waitcnt vmcnt(3)
    v_cmp_ne_u32 vcc, v42, v250
    s_and_b32 s11, s34, 0x600
    s_cselect_b32 s6, s43, 1
    s_and_b32 s7, vcc_lo, 0xf5af5af
    s_or_b32 s6, s6, s7
    s_cbranch_scc0 L_late
L_P2:
    s_cmp_lg_u32 s11, 0
    s_cbranch_scc1 L_nord0
    ds_read_b64_tr_b16 a[0:1], v241 offset:0
    ds_read_b64_tr_b16 a[2:3], v241 offset:2048
    ds_read_b64_tr_b16 a[4:5], v242 offset:0
    ds_read_b64_tr_b16 a[6:7], v242 offset:2048
    ds_read_b64_tr_b16 a[8:9], v243 offset:0
    ds_read_b64_tr_b16 a[10:11], v243 offset:2048
    ds_read_b64_tr_b16 a[12:13], v244 offset:0
    ds_read_b64_tr_b16 a[14:15], v244 offset:2048
L_nord0:
    s_cmp_lg_u32 s43, 0
    s_waitcnt vmcnt(0)
    s_cbranch_scc1 L_rsO
L_rfO:
    buffer_store_dword v250, v248, s[20:23], 0 offen offset:0
L_rdO:
    s_cmp_lg_u32 s11, 0
    s_cbranch_scc1 L_nord
    ds_read_b64_tr_b16 a[16:17], v243 offset:3584
    ds_read_b64_tr_b16 a[18:19], v243 offset:5632
    ds_read_b64_tr_b16 a[20:21], v244 offset:3584
    ds_read_b64_tr_b16 a[22:23], v244 offset:5632
    ds_read_b64_tr_b16 a[24:25], v241 offset:3584
    ds_read_b64_tr_b16 a[26:27], v241 offset:5632
    ds_read_b64_tr_b16 a[28:29], v242 offset:3584
    ds_read_b64_tr_b16 a[30:31], v242 offset:5632
    ds_read_b64_tr_b16 a[112:113], v243 offset:25088
    ds_read_b64_tr_b16 a[114:115], v243 offset:27136
    ds_read_b64_tr_b16 a[116:117], v244 offset:25088
    ds_read_b64_tr_b16 a[118:119], v244 offset:27136
    ds_read_b64_tr_b16 a[120:121], v241 offset:25088
    ds_read_b64_tr_b16 a[122:123], v241 offset:27136
    ds_read_b64_tr_b16 a[124:125], v242 offset:25088
    ds_read_b64_tr_b16 a[126:127], v242 offset:27136
    ds_read_b64_tr_b16 a[128:129], v241 offset:28672
    ds_read_b64_tr_b16 a[130:131], v241 offset:30720
    ds_read_b64_tr_b16 a[132:133], v242 offset:28672
    ds_read_b64_tr_b16 a[134:135], v242 offset:30720
    ds_read_b64_tr_b16 a[136:137], v243 offset:28672
    ds_read_b64_tr_b16 a[138:139], v243 offset:30720
    ds_read_b64_tr_b16 a[140:141], v244 offset:28672
    ds_read_b64_tr_b16 a[142:143], v244 offset:30720
    ds_read_b64_tr_b16 a[224:225], v241 offset:50176
    ds_read_b64_tr_b16 a[226:227], v241 offset:52224
    ds_read_b64_tr_b16 a[228:229], v242 offset:50176
    ds_read_b64_tr_b16 a[230:231], v242 offset:52224
    ds_read_b64_tr_b16 a[232:233], v243 offset:50176
    ds_read_b64_tr_b16 a[234:235], v243 offset:52224
    ds_read_b64_tr_b16 a[236:237], v244 offset:50176
    ds_read_b64_tr_b16 a[238:239], v244 offset:52224
L_nord:
    s_cmp_lg_u32 s43, 0
    s_cselect_b32 exec_lo, -1, 0xf5af5af
    s_mov_b32 exec_hi, 0
    s_mov_b32 s10, 65536
L_plP:
    buffer_load_dword v42, v246, s[20:23], 0 offen sc1
    s_sub_u32 s10, s10, 1
    s_cbranch_scc1 L_pdP
    s_waitcnt vmcnt(0)
    v_cmp_ne_u32 vcc, v42, v250
    s_nop 0
    s_and_b64 exec, exec, vcc
    s_cbranch_scc1 L_plP
L_pdP:
    s_mov_b64 exec, -1
    s_cmp_lg_u32 s43, 0
    s_cbranch_scc1 L_asP
L_adP:
    buffer_load_dwordx4 v[64:67], v245, s[20:23], 0 offen offset:0 sc1
    buffer_load_dwordx4 v[68:71], v245, s[20:23], 0 offen offset:1024 sc1
    buffer_load_dwordx4 v[72:75], v245, s[20:23], s58 offen offset:3072 sc1
    buffer_load_dwordx4 v[76:79], v245, s[20:23], s59 offen offset:0 sc1
    s_branch L_join
L_late:
    buffer_load_dwordx4 v[64:67], v245, s[20:23], 0 offen offset:0 sc1
    buffer_load_dwordx4 v[68:71], v245, s[20:23], 0 offen offset:1024 sc1
    buffer_load_dwordx4 v[72:75], v245, s[20:23], s58 offen offset:3072 sc1
    buffer_load_dwordx4 v[76:79], v245, s[20:23], s59 offen offset:0 sc1
    s_waitcnt vmcnt(4)
    buffer_store_dword v250, v248, s[20:23], 0 offen
L_join:
    buffer_load_dword v28, v246, s[20:23], 0 offen sc1
    ds_read_b64_tr_b16 a[240:241], v243 offset:53760
    ds_read_b64_tr_b16 a[242:243], v243 offset:55808
    ds_read_b64_tr_b16 a[244:245], v244 offset:53760
    ds_read_b64_tr_b16 a[246:247], v244 offset:55808
    ds_read_b64_tr_b16 a[248:249], v241 offset:53760
    ds_read_b64_tr_b16 a[250:251], v241 offset:55808
    ds_read_b64_tr_b16 a[252:253], v242 offset:53760
    ds_read_b64_tr_b16 a[254:255], v242 offset:55808
    buffer_load_dwordx4 v[80:83], v245, s[20:23], s60 offen offset:2048 sc1
    ds_read_b64_tr_b16 a[48:49], v243 offset:10752
    ds_read_b64_tr_b16 a[50:51], v243 offset:12800
    ds_read_b64_tr_b16 a[52:53], v244 offset:10752
    ds_read_b64_tr_b16 a[54:55], v244 offset:12800
    ds_read_b64_tr_b16 a[56:57], v241 offset:10752
    ds_read_b64_tr_b16 a[58:59], v241 offset:12800
    ds_read_b64_tr_b16 a[60:61], v242 offset:10752
    ds_read_b64_tr_b16 a[62:63], v242 offset:12800
    buffer_load_dwordx4 v[84:87], v245, s[20:23], s60 offen offset:3072 sc1
    ds_read_b64_tr_b16 a[80:81], v243 offset:17920
    ds_read_b64_tr_b16 a[82:83], v243 offset:19968
    ds_read_b64_tr_b16 a[84:85], v244 offset:17920
    ds_read_b64_tr_b16 a[86:87], v244 offset:19968
    ds_read_b64_tr_b16 a[88:89], v241 offset:17920
    ds_read_b64_tr_b16 a[90:91], v241 offset:19968
    ds_read_b64_tr_b16 a[92:93], v242 offset:17920
    ds_read_b64_tr_b16 a[94:95], v242 offset:19968
    ds_read_b64_tr_b16 a[160:161], v241 offset:35840
    ds_read_b64_tr_b16 a[162:163], v241 offset:37888
    ds_read_b64_tr_b16 a[164:165], v242 offset:35840
    ds_read_b64_tr_b16 a[166:167], v242 offset:37888
    ds_read_b64_tr_b16 a[168:169], v243 offset:35840
    ds_read_b64_tr_b16 a[170:171], v243 offset:37888
    ds_read_b64_tr_b16 a[172:173], v244 offset:35840
    ds_read_b64_tr_b16 a[174:175], v244 offset:37888
    s_waitcnt lgkmcnt(15)
    s_waitcnt vmcnt(6)
    v_mfma_f32_16x16x32_bf16 v[32:35], a[0:3], v[64:67], 0
    ds_read_b64_tr_b16 a[192:193], v241 offset:43008
    buffer_load_dwordx4 v[88:91], v245, s[20:23], 0 offen offset:3072 sc1
    v_mfma_f32_16x16x32_bf16 v[36:39], a[4:7], v[64:67], 0
    ds_read_b64_tr_b16 a[194:195], v241 offset:45056
    v_mfma_f32_16x16x32_bf16 v[40:43], a[8:11], v[64:67], 0
    ds_read_b64_tr_b16 a[196:197], v242 offset:43008
    v_mfma_f32_16x16x32_bf16 v[44:47], a[12:15], v[64:67], 0
    ds_read_b64_tr_b16 a[198:199], v242 offset:45056
    s_waitcnt vmcnt(6)
    v_mfma_f32_16x16x32_bf16 v[32:35], a[16:19], v[68:71], v[32:35]
    ds_read_b64_tr_b16 a[200:201], v243 offset:43008
    buffer_load_dwordx4 v[92:95], v245, s[20:23], s58 offen offset:1024 sc1
    v_mfma_f32_16x16x32_bf16 v[36:39], a[20:23], v[68:71], v[36:39]
    ds_read_b64_tr_b16 a[202:203], v243 offset:45056
    v_mfma_f32_16x16x32_bf16 v[40:43], a[24:27], v[68:71], v[40:43]
    ds_read_b64_tr_b16 a[204:205], v244 offset:43008
    v_mfma_f32_16x16x32_bf16 v[44:47], a[28:31], v[68:71], v[44:47]
    ds_read_b64_tr_b16 a[206:207], v244 offset:45056
    s_waitcnt vmcnt(6)
    v_mfma_f32_16x16x32_bf16 v[32:35], a[112:115], v[72:75], v[32:35]
    ds_read_b64_tr_b16 a[32:33], v2 offset:10240
    buffer_load_dwordx4 v[96:99], v245, s[20:23], s59 offen offset:2048 sc1
    v_mfma_f32_16x16x32_bf16 v[36:39], a[116:119], v[72:75], v[36:39]
    ds_read_b64_tr_b16 a[34:35], v2 offset:8192
    v_mfma_f32_16x16x32_bf16 v[40:43], a[120:123], v[72:75], v[40:43]
    ds_read_b64_tr_b16 a[36:37], v3 offset:10240
    v_mfma_f32_16x16x32_bf16 v[44:47], a[124:127], v[72:75], v[44:47]
    ds_read_b64_tr_b16 a[38:39], v3 offset:8192
    s_waitcnt vmcnt(6)
    v_mfma_f32_16x16x32_bf16 v[32:35], a[128:131], v[76:79], v[32:35]
    ds_read_b64_tr_b16 a[40:41], v4 offset:10240
    buffer_load_dwordx4 v[100:103], v245, s[20:23], s60 offen offset:0 sc1
    v_mfma_f32_16x16x32_bf16 v[36:39], a[132:135], v[76:79], v[36:39]
    ds_read_b64_tr_b16 a[42:43], v4 offset:8192
    v_mfma_f32_16x16x32_bf16 v[40:43], a[136:139], v[76:79], v[40:43]
    ds_read_b64_tr_b16 a[44:45], v5 offset:10240
    v_mfma_f32_16x16x32_bf16 v[44:47], a[140:143], v[76:79], v[44:47]
    ds_read_b64_tr_b16 a[46:47], v5 offset:8192
    s_waitcnt vmcnt(6)
    v_cmp_ne_u32 vcc, v28, v250
    s_nop 0
    s_and_b32 exec_lo, vcc_lo, 0xa50a50
    s_mov_b32 exec_hi, 0
    s_cbranch_scc0 L_pdQ
    s_mov_b32 s10, 65536
L_plQ:
    buffer_load_dword v28, v246, s[20:23], 0 offen sc1
    s_sub_u32 s10, s10, 1
    s_cbranch_scc1 L_pdQ
    s_waitcnt vmcnt(0)
    v_cmp_ne_u32 vcc, v28, v250
    s_nop 0
    s_and_b64 exec, exec, vcc
    s_cbranch_scc1 L_plQ
L_pdQ:
    s_mov_b64 exec, -1
    buffer_load_dwordx4 v[104:107], v245, s[20:23], 0 offen offset:2048 sc1
    s_waitcnt vmcnt(6)
    v_mfma_f32_16x16x32_bf16 v[32:35], a[224:227], v[80:83], v[32:35]
    ds_read_b64_tr_b16 a[96:97], v241 offset:21504
    buffer_load_dwordx4 v[108:111], v245, s[20:23], s58 offen offset:2048 sc1
    v_mfma_f32_16x16x32_bf16 v[36:39], a[228:231], v[80:83], v[36:39]
    ds_read_b64_tr_b16 a[98:99], v241 offset:23552
    v_mfma_f32_16x16x32_bf16 v[40:43], a[232:235], v[80:83], v[40:43]
    ds_read_b64_tr_b16 a[100:101], v242 offset:21504
    v_mfma_f32_16x16x32_bf16 v[44:47], a[236:239], v[80:83], v[44:47]
    ds_read_b64_tr_b16 a[102:103], v242 offset:23552
    s_waitcnt vmcnt(6)
    v_mfma_f32_16x16x32_bf16 v[32:35], a[240:243], v[84:87], v[32:35]
    ds_read_b64_tr_b16 a[104:105], v243 offset:21504
    buffer_load_dword v29, v246, s[20:23], 0 offen sc1
    v_mfma_f32_16x16x32_bf16 v[36:39], a[244:247], v[84:87], v[36:39]
    ds_read_b64_tr_b16 a[106:107], v243 offset:23552
    v_mfma_f32_16x16x32_bf16 v[40:43], a[248:251], v[84:87], v[40:43]
    ds_read_b64_tr_b16 a[108:109], v244 offset:21504
    v_mfma_f32_16x16x32_bf16 v[44:47], a[252:255], v[84:87], v[44:47]
    ds_read_b64_tr_b16 a[110:111], v244 offset:23552
    s_waitcnt vmcnt(6)
    v_mfma_f32_16x16x32_bf16 v[32:35], a[48:51], v[88:91], v[32:35]
    ds_read_b64_tr_b16 a[144:145], v4 offset:35328
    buffer_load_dwordx4 v[112:115], v245, s[20:23], s59 offen offset:1024 sc1
    v_mfma_f32_16x16x32_bf16 v[36:39], a[52:55], v[88:91], v[36:39]
    ds_read_b64_tr_b16 a[146:147], v4 offset:33280
    v_mfma_f32_16x16x32_bf16 v[40:43], a[56:59], v[88:91], v[40:43]
    ds_read_b64_tr_b16 a[148:149], v5 offset:35328
    v_mfma_f32_16x16x32_bf16 v[44:47], a[60:63], v[88:91], v[44:47]
    ds_read_b64_tr_b16 a[150:151], v5 offset:33280
    s_waitcnt lgkmcnt(15) vmcnt(6)
    v_mfma_f32_16x16x32_bf16 v[32:35], a[80:83], v[92:95], v[32:35]
    ds_read_b64_tr_b16 a[152:153], v2 offset:35328
    buffer_load_dwordx4 v[116:119], v245, s[20:23], s60 offen offset:1024 sc1
    v_mfma_f32_16x16x32_bf16 v[36:39], a[84:87], v[92:95], v[36:39]
    ds_read_b64_tr_b16 a[154:155], v2 offset:33280
    v_mfma_f32_16x16x32_bf16 v[40:43], a[88:91], v[92:95], v[40:43]
    ds_read_b64_tr_b16 a[156:157], v3 offset:35328
    v_mfma_f32_16x16x32_bf16 v[44:47], a[92:95], v[92:95], v[44:47]
    ds_read_b64_tr_b16 a[158:159], v3 offset:33280
    s_waitcnt vmcnt(6)
    v_mfma_f32_16x16x32_bf16 v[32:35], a[160:163], v[96:99], v[32:35]
    ds_read_b64_tr_b16 a[208:209], v243 offset:46592
    v_mfma_f32_16x16x32_bf16 v[36:39], a[164:167], v[96:99], v[36:39]
    ds_read_b64_tr_b16 a[210:211], v243 offset:48640
    v_mfma_f32_16x16x32_bf16 v[40:43], a[168:171], v[96:99], v[40:43]
    ds_read_b64_tr_b16 a[212:213], v244 offset:46592
    v_mfma_f32_16x16x32_bf16 v[44:47], a[172:175], v[96:99], v[44:47]
    ds_read_b64_tr_b16 a[214:215], v244 offset:48640
    s_waitcnt vmcnt(5)
    v_mfma_f32_16x16x32_bf16 v[32:35], a[192:195], v[100:103], v[32:35]
    ds_read_b64_tr_b16 a[216:217], v241 offset:46592
    v_mfma_f32_16x16x32_bf16 v[36:39], a[196:199], v[100:103], v[36:39]
    ds_read_b64_tr_b16 a[218:219], v241 offset:48640
    v_mfma_f32_16x16x32_bf16 v[40:43], a[200:203], v[100:103], v[40:43]
    ds_read_b64_tr_b16 a[220:221], v242 offset:46592
    v_mfma_f32_16x16x32_bf16 v[44:47], a[204:207], v[100:103], v[44:47]
    ds_read_b64_tr_b16 a[222:223], v242 offset:48640
    s_waitcnt vmcnt(4)
    v_mfma_f32_16x16x32_bf16 v[32:35], a[32:35], v[104:107], v[32:35]
    ds_read_b64_tr_b16 a[64:65], v241 offset:14336
    v_mfma_f32_16x16x32_bf16 v[36:39], a[36:39], v[104:107], v[36:39]
    ds_read_b64_tr_b16 a[66:67], v241 offset:16384
    s_waitcnt lgkmcnt(15)
    v_mfma_f32_16x16x32_bf16 v[40:43], a[40:43], v[104:107], v[40:43]
    ds_read_b64_tr_b16 a[68:69], v242 offset:14336
    v_mfma_f32_16x16x32_bf16 v[44:47], a[44:47], v[104:107], v[44:47]
    ds_read_b64_tr_b16 a[70:71], v242 offset:16384
    s_waitcnt vmcnt(2)
    v_cmp_ne_u32 vcc, v29, v250
    s_nop 0
    s_and_b32 exec_lo, vcc_lo, 0xf0000000
    s_mov_b32 exec_hi, 0
    s_cbranch_scc0 L_pdW
    s_mov_b32 s10, 65536
L_plW:
    buffer_load_dword v29, v246, s[20:23], 0 offen sc1
    s_sub_u32 s10, s10, 1
    s_cbranch_scc1 L_pdW
    s_waitcnt vmcnt(0)
    v_cmp_ne_u32 vcc, v29, v250
    s_nop 0
    s_and_b64 exec, exec, vcc
    s_cbranch_scc1 L_plW
L_pdW:
    s_mov_b64 exec, -1
    buffer_load_dwordx4 v[120:123], v245, s[20:23], s58 offen offset:0 sc1
    buffer_load_dwordx4 v[124:127], v245, s[20:23], s59 offen offset:3072 sc1
    v_mfma_f32_16x16x32_bf16 v[32:35], a[96:99], v[108:111], v[32:35]
    ds_read_b64_tr_b16 a[72:73], v243 offset:14336
    v_mfma_f32_16x16x32_bf16 v[36:39], a[100:103], v[108:111], v[36:39]
    ds_read_b64_tr_b16 a[74:75], v243 offset:16384
    v_mfma_f32_16x16x32_bf16 v[40:43], a[104:107], v[108:111], v[40:43]
    ds_read_b64_tr_b16 a[76:77], v244 offset:14336
    v_mfma_f32_16x16x32_bf16 v[44:47], a[108:111], v[108:111], v[44:47]
    ds_read_b64_tr_b16 a[78:79], v244 offset:16384
    s_waitcnt vmcnt(3)
    v_mfma_f32_16x16x32_bf16 v[32:35], a[144:147], v[112:115], v[32:35]
    ds_read_b64_tr_b16 a[176:177], v243 offset:39424
    s_waitcnt lgkmcnt(15)
    v_mfma_f32_16x16x32_bf16 v[36:39], a[148:151], v[112:115], v[36:39]
    ds_read_b64_tr_b16 a[178:179], v243 offset:41472
    v_mfma_f32_16x16x32_bf16 v[40:43], a[152:155], v[112:115], v[40:43]
    ds_read_b64_tr_b16 a[180:181], v244 offset:39424
    v_mfma_f32_16x16x32_bf16 v[44:47], a[156:159], v[112:115], v[44:47]
    ds_read_b64_tr_b16 a[182:183], v244 offset:41472
    s_waitcnt vmcnt(2)
    v_mfma_f32_16x16x32_bf16 v[32:35], a[208:211], v[116:119], v[32:35]
    ds_read_b64_tr_b16 a[184:185], v241 offset:39424
    s_waitcnt lgkmcnt(15)
    v_mfma_f32_16x16x32_bf16 v[36:39], a[212:215], v[116:119], v[36:39]
    ds_read_b64_tr_b16 a[186:187], v241 offset:41472
    v_mfma_f32_16x16x32_bf16 v[40:43], a[216:219], v[116:119], v[40:43]
    ds_read_b64_tr_b16 a[188:189], v242 offset:39424
    s_waitcnt lgkmcnt(15)
    v_mfma_f32_16x16x32_bf16 v[44:47], a[220:223], v[116:119], v[44:47]
    ds_read_b64_tr_b16 a[190:191], v242 offset:41472
    s_waitcnt lgkmcnt(14) vmcnt(1)
    v_mfma_f32_16x16x32_bf16 v[32:35], a[64:67], v[120:123], v[32:35]
    s_waitcnt lgkmcnt(12)
    v_mfma_f32_16x16x32_bf16 v[36:39], a[68:71], v[120:123], v[36:39]
    s_waitcnt lgkmcnt(10)
    v_mfma_f32_16x16x32_bf16 v[40:43], a[72:75], v[120:123], v[40:43]
    s_waitcnt lgkmcnt(8)
    v_mfma_f32_16x16x32_bf16 v[44:47], a[76:79], v[120:123], v[44:47]
    s_waitcnt lgkmcnt(6) vmcnt(0)
    v_mfma_f32_16x16x32_bf16 v[32:35], a[176:179], v[124:127], v[32:35]
    s_waitcnt lgkmcnt(4)
    v_mfma_f32_16x16x32_bf16 v[36:39], a[180:183], v[124:127], v[36:39]
    s_waitcnt lgkmcnt(2)
    v_mfma_f32_16x16x32_bf16 v[40:43], a[184:187], v[124:127], v[40:43]
    s_waitcnt lgkmcnt(0)
    v_mfma_f32_16x16x32_bf16 v[44:47], a[188:191], v[124:127], v[44:47]
    s_nop 1
    v_cvt_pk_bf16_f32 v48, v32, v33
    v_cvt_pk_bf16_f32 v49, v34, v35
    v_cvt_pk_bf16_f32 v50, v36, v37
    v_cvt_pk_bf16_f32 v51, v38, v39
    v_cvt_pk_bf16_f32 v52, v40, v41
    v_cvt_pk_bf16_f32 v53, v42, v43
    v_cvt_pk_bf16_f32 v54, v44, v45
    v_cvt_pk_bf16_f32 v55, v46, v47
    v_permlane16_swap_b32 v48, v50
    v_permlane16_swap_b32 v49, v51
    buffer_store_dwordx4 v[48:51], v247, s[28:31], 0 offen offset:0 sc1
    v_permlane16_swap_b32 v52, v54
    v_permlane16_swap_b32 v53, v55
    buffer_store_dwordx4 v[52:55], v247, s[28:31], 0 offen offset:64 sc1
    s_endpgm
L_rsX:
    s_mov_b32 s10, 40
L_plRX:
    buffer_load_dword v42, v41, s[20:23], 0 offen sc1
    s_sub_u32 s10, s10, 1
    s_cbranch_scc1 L_pdRX
    s_waitcnt vmcnt(0)
    v_cmp_ne_u32 vcc, v42, v250
    s_nop 0
    s_and_b64 exec, exec, vcc
    s_cbranch_scc1 L_plRX
L_pdRX:
    s_or_b32 s43, exec_lo, exec_hi
    s_mov_b64 exec, -1
    s_cmp_eq_u32 s43, 0
    s_cbranch_scc1 L_rfX
    buffer_wbl2 sc1
    s_waitcnt vmcnt(0)
    buffer_store_dword v250, v248, s[20:23], 0 offen offset:16 sc1
    s_branch L_rdX
L_rsO:
    buffer_wbl2 sc1
    s_waitcnt vmcnt(0)
    buffer_store_dword v250, v248, s[20:23], 0 offen offset:0 sc1
    s_branch L_rdO
L_asX:
    buffer_inv sc1
    s_waitcnt vmcnt(0)
    s_branch L_adX
L_asP:
    buffer_inv sc1
    s_waitcnt vmcnt(0)
    s_branch L_adP
L_asS:
    buffer_inv sc1
    s_waitcnt vmcnt(0)
    s_branch L_adS
.type L_tab,@object
L_tab:
    .long 0xf6543210, 0x01000000, 0x00000100, 0
    .long 0xedcba987, 0x00000000, 0x00000101, 0
    .long 0xfed01234, 0x05040300, 0x00000312, 0
    .long 0xcba98765, 0x02000000, 0x00000103, 0
    .long 0x29876543, 0x08000000, 0x00000105, 0
    .long 0x10fedcba, 0x07060000, 0x00333206, 0
    .long 0x07654321, 0x09000000, 0x00000107, 0
    .long 0xfedcba98, 0x0a000000, 0x00000108, 0
    .long 0xfe012345, 0x0d0c0000, 0x0033a219, 0
    .long 0xdcba9876, 0x0b000000, 0x0000010a, 0
    .long 0x3a987654, 0x11000000, 0x0000010c, 0
    .long 0x210fedcb, 0x100f0e00, 0x0066d30d, 0
    .long 0x18765432, 0x13000000, 0x0000010e, 0
    .long 0x0fedcba9, 0x12000000, 0x0000010f, 0
    .long 0x00000000, 0x00000000, 0x00212404, 0
    .long 0x00000000, 0x00000000, 0x0054b40b, 0
.size L_tab, 256
L_S:
    v_add_u32 v5, 2, v5
    v_subrev_u32 v6, 7, v5
    v_min_u32 v5, v5, v6
    v_mad_u32_u24 v7, v4, 7, v5
    v_lshlrev_b32 v7, 7, v7
    buffer_load_dword v255, v7, s[12:15], 0 offen
    s_and_b32 s11, s3, 1
    s_lshl1_add_u32 s6, s47, s11
    s_lshl_b32 s6, s6, 4
    s_add_u32 s6, s6, L_tab - L_pc
    s_load_dwordx4 s[32:35], s[4:5], s6
    s_add_u32 s6, s57, 5259264
    s_load_dword s36, s[20:21], s6
    s_lshr_b32 s55, s3, 1
    s_mov_b32 s22, 0x1000000
    s_mov_b32 s23, 0x20000
    s_mov_b32 s26, 0x62000
    s_mov_b32 s27, 0x20000
    s_mov_b32 s30, 0x380000
    s_mov_b32 s31, 0x20000
    s_mul_i32 s6, s40, 37
    s_lshr_b32 s6, s6, 8
    s_mul_i32 s7, s6, 7
    s_sub_u32 s41, s40, s7
    s_lshr_b32 s7, s57, 3
    s_add_u32 s41, s41, s7
    s_sub_u32 s7, s41, 7
    s_min_u32 s41, s41, s7
    s_lshl_b32 s6, s6, 2
    s_add_u32 s6, s6, s3
    v_bfe_u32 v32, v1, 1, 1
    v_lshl_add_u32 v32, s6, 1, v32
    v_mul_u32_u24 v33, 47, v32
    v_lshrrev_b32 v33, 9, v33
    v_mul_u32_u24 v34, 11, v33
    v_sub_u32 v32, v32, v34
    v_add_u32 v32, 3, v32
    v_and_b32 v32, 8, v32
    v_lshl_add_u32 v32, v33, 10, v32
    v_and_b32 v33, 1, v1
    v_lshl_add_u32 v32, v33, 2, v32
    v_bfe_u32 v33, v1, 2, 3
    v_lshl_add_u32 v32, v33, 7, v32
    s_mul_i32 s7, s57, 17920
    s_add_u32 s7, s7, 6429696
    v_add_u32 v246, s7, v32
    s_and_b32 s7, s2, 6
    s_lshl3_add_u32 s6, s7, s6
    s_and_b32 s8, s2, 1
    s_lshl_b32 s7, s8, 6
    s_add_u32 s42, s6, s7
    v_lshrrev_b32 v32, 3, v1
    v_and_b32 v33, 6, v32
    v_and_b32 v34, 7, v1
    v_xor_b32 v33, v33, v34
    v_lshrrev_b32 v32, 3, v0
    v_mul_u32_u24 v32, 896, v32
    v_lshl_add_u32 v32, v33, 4, v32
    s_lshl_b32 s7, s41, 7
    v_add_u32 v240, s7, v32
    v_mov_b32 v34, 0
    v_mov_b32 v35, 0
    v_lshlrev_b32 v32, 3, v1
    v_add_u32 v32, 162816, v32
    ds_write_b64 v32, v[34:35]
    s_lshl_b32 s45, s3, 10
    s_add_u32 s45, s45, 105472
    v_lshrrev_b32 v32, 2, v1
    v_bfe_u32 v33, v1, 3, 2
    v_lshlrev_b32 v33, 5, v33
    v_lshl_add_u32 v33, v32, 7, v33
    v_and_b32 v34, 3, v1
    v_lshl_add_u32 v33, v34, 3, v33
    v_add_u32 v241, 105472, v33
    v_xor_b32 v242, 32, v241
    v_xor_b32 v243, 64, v241
    v_xor_b32 v244, 96, v241
    s_lshl_b32 s9, s42, 14
    v_lshl_add_u32 v245, v1, 4, s9
    s_lshl_b32 s6, s6, 5
    s_add_u32 s6, s6, s8
    s_mul_i32 s6, s6, 1792
    s_add_u32 s6, s6, s7
    v_mul_u32_u24 v32, 3584, v253
    v_and_b32 v33, 1, v252
    v_lshl_add_u32 v32, v33, 5, v32
    v_lshrrev_b32 v33, 1, v252
    v_lshl_add_u32 v32, v33, 4, v32
    v_add_u32 v247, s6, v32
    s_cmp_eq_u32 s55, 0
    s_cselect_b32 s54, 0xff800000, 0
    s_cmp_eq_u32 s48, 0
    s_cselect_b32 s61, s54, 0
    s_mul_i32 s6, s55, 48
    s_add_u32 s6, s6, s48
    s_and_b32 s7, s2, 1
    s_lshl_b32 s7, s7, 10
    s_add_u32 s6, s6, s7
    s_add_u32 s6, s6, 8
    s_waitcnt lgkmcnt(0)
    s_and_b32 s11, s34, 15
    v_add_u32 v32, s6, v253
    v_lshrrev_b32 v33, 4, v32
    v_lshlrev_b32 v33, 14, v33
    v_and_b32 v32, 15, v32
    v_lshl_add_u32 v32, v32, 4, v33
    v_lshl_add_u32 v32, v252, 8, v32
    s_lshl_b32 s7, s11, 10
    v_add_u32 v18, s7, v32
    s_cmp_eq_u32 s55, 0
    s_cselect_b32 s8, 8, 0
    s_and_b32 s9, s55, s56
    s_cselect_b32 s9, 8, 16
    v_cmp_le_u32 s[4:5], s8, v253
    v_cmp_gt_u32 s[62:63], s9, v253
    v_subrev_u32 v32, 16384, v18
    v_add_u32 v33, 16384, v18
    v_cndmask_b32 v17, 2.0, v32, s[4:5]
    v_cndmask_b32 v19, 2.0, v33, s[62:63]
    s_mul_i32 s9, s57, 17920
    s_lshl_b32 s7, s40, 7
    s_add_u32 s6, s9, s7
    s_lshl2_add_u32 s6, s3, s6
    s_add_u32 s6, s6, 6429696
    v_mov_b32 v248, s6
    v_and_b32 v32, 4, v1
    v_add_u32 v32, 16, v32
    v_bfe_u32 v32, s34, v32, 4
    v_and_b32 v33, 3, v1
    v_lshlrev_b32 v34, 2, v33
    v_lshl_add_u32 v32, v32, 7, v34
    s_lshl_b32 s6, s44, 10
    s_add_u32 s6, s6, s9
    s_add_u32 s6, s6, 6429712
    v_add_u32 v40, s6, v32
    s_mul_i32 s6, s44, 46080
    s_add_u32 s9, s9, s6
    s_add_u32 s9, s9, 6291456
    s_lshl_b32 s38, s55, 10
    s_lshl_b32 s39, s55, 3
    v_lshl_add_u32 v42, v253, 4, s9
    v_lshl_add_u32 v43, v252, 2, v33
    v_lshl_add_u32 v43, v43, 4, s9
    v_lshrrev_b32 v35, 2, v253
    s_bfe_u32 s6, s34, 0x40008
    s_sub_u32 s6, 4, s6
    v_cmp_le_u32 s[62:63], s6, v252
    v_cmp_le_u32 s[64:65], s6, v35
    s_movk_i32 s8, 2304
    s_bfe_u32 s6, s34, 0x4000c
    s_bitcmp1_b32 s34, 4
    s_cselect_b32 s7, 2, 4
    s_cselect_b32 s9, -1, 1
    s_add_u32 s6, s6, s7
    v_mul_i32_i24 v32, s9, v252
    v_add_u32 v32, s6, v32
    v_cmp_ne_u32 vcc, 3, v252
    v_mad_u32_u24 v32, v32, s8, v42
    v_subrev_u32 v36, 9216, v32
    v_cndmask_b32 v38, 2.0, v32, vcc
    v_mul_i32_i24 v32, s9, v35
    v_add_u32 v32, s6, v32
    v_cmp_ne_u32 vcc, 3, v35
    v_mad_u32_u24 v32, v32, s8, v43
    v_subrev_u32 v37, 9216, v32
    v_cndmask_b32 v39, 2.0, v32, vcc
    s_mul_i32 s36, s36, 0x9e3779b1
    s_add_u32 s36, s36, 0x7f4a7c15
    v_mov_b32 v250, s36
    s_getreg_b32 s7, hwreg(HW_REG_XCC_ID, 0, 3)
    s_mul_i32 s8, s57, 17920
    s_lshl_b32 s7, s7, 7
    s_add_u32 s8, s8, s7
    s_add_u32 s8, s8, 6432768
    v_and_b32 v41, 31, v1
    v_lshl_add_u32 v41, v41, 2, s8
    s_lshl2_add_u32 s37, s40, s8
    s_barrier
    buffer_store_dword v250, off, s[20:23], s37
    v_add_u32 v5, 2, v5
    v_subrev_u32 v6, 7, v5
    v_min_u32 v5, v5, v6
    v_mad_u32_u24 v7, v4, 7, v5
    v_lshlrev_b32 v7, 7, v7
    buffer_load_dword v255, v7, s[12:15], 0 offen
    v_lshlrev_b32 v208, 2, v252
    v_sub_u32 v208, v253, v208
    v_mov_b32 v209, 0xff800000
    v_subrev_u32 v212, 0, v208
    v_subrev_u32 v213, 1, v208
    v_subrev_u32 v214, 2, v208
    v_subrev_u32 v215, 3, v208
    v_cmp_gt_u32 s[4:5], 8, v212
    v_cmp_gt_u32 s[46:47], 8, v213
    v_cmp_gt_u32 vcc, 8, v214
    v_cmp_gt_u32 s[98:99], 8, v215
    v_cndmask_b32 v24, v209, 0, s[4:5]
    v_cndmask_b32 v25, v209, 0, s[46:47]
    v_cndmask_b32 v26, v209, 0, vcc
    v_cndmask_b32 v27, v209, 0, s[98:99]
    v_cmp_ge_i32 s[4:5], -9, v212
    v_cmp_ge_i32 s[46:47], -9, v213
    v_cmp_ge_i32 vcc, -9, v214
    v_cmp_ge_i32 s[98:99], -9, v215
    v_cndmask_b32 v20, v209, 0, s[4:5]
    v_cndmask_b32 v21, v209, 0, s[46:47]
    v_cndmask_b32 v22, v209, 0, vcc
    v_cndmask_b32 v23, v209, 0, s[98:99]
    v_ashrrev_i32 v212, 31, v212
    v_ashrrev_i32 v213, 31, v213
    v_ashrrev_i32 v214, 31, v214
    v_ashrrev_i32 v215, 31, v215
    v_mov_b32 v208, 0xffff
    v_bfi_b32 v28, v208, v212, v213
    v_bfi_b32 v29, v208, v214, v215
    v_mov_b32 v30, 0x3e8b97f6
    v_or_b32 v56, s54, v20
    v_or_b32 v57, s54, v21
    v_or_b32 v58, s54, v22
    v_or_b32 v59, s54, v23
    v_subrev_u32 v208, 32, v1
    v_ashrrev_i32 v208, 31, v208
    v_and_b32 v208, s61, v208
    v_or_b32 v60, v208, v24
    v_or_b32 v61, v208, v25
    v_or_b32 v62, v208, v26
    v_or_b32 v63, v208, v27
    v_mov_b32 v32, 0x3f803f80
    v_mov_b32 v33, 0x3f803f80
    v_mov_b32 v34, 0x3f803f80
    v_mov_b32 v35, 0x3f803f80
    v_lshlrev_b32 v5, 10, v252
    v_sub_u32 v2, v241, v5
    v_sub_u32 v3, v242, v5
    v_sub_u32 v4, v243, v5
    v_sub_u32 v5, v244, v5
    s_movk_i32 s58, 4096
    s_movk_i32 s59, 8192
    s_movk_i32 s60, 12288
    s_add_u32 m0, s45, 0
    s_mov_b32 s6, 0
    buffer_load_dwordx4 v240, s[24:27], s6 offen lds
    s_add_u32 m0, s45, 4096
    s_mov_b32 s6, 28672
    buffer_load_dwordx4 v240, s[24:27], s6 offen lds
    s_add_u32 m0, s45, 8192
    s_mov_b32 s6, 57344
    buffer_load_dwordx4 v240, s[24:27], s6 offen lds
    s_add_u32 m0, s45, 12288
    s_mov_b32 s6, 86016
    buffer_load_dwordx4 v240, s[24:27], s6 offen lds
    s_add_u32 m0, s45, 16384
    s_mov_b32 s6, 114688
    buffer_load_dwordx4 v240, s[24:27], s6 offen lds
    s_add_u32 m0, s45, 20480
    s_mov_b32 s6, 143360
    buffer_load_dwordx4 v240, s[24:27], s6 offen lds
    s_add_u32 m0, s45, 24576
    s_mov_b32 s6, 172032
    buffer_load_dwordx4 v240, s[24:27], s6 offen lds
    s_add_u32 m0, s45, 28672
    s_mov_b32 s6, 200704
    buffer_load_dwordx4 v240, s[24:27], s6 offen lds
    s_add_u32 m0, s45, 32768
    s_mov_b32 s6, 229376
    buffer_load_dwordx4 v240, s[24:27], s6 offen lds
    s_add_u32 m0, s45, 36864
    s_mov_b32 s6, 258048
    buffer_load_dwordx4 v240, s[24:27], s6 offen lds
    s_add_u32 m0, s45, 40960
    s_mov_b32 s6, 286720
    buffer_load_dwordx4 v240, s[24:27], s6 offen lds
    s_add_u32 m0, s45, 45056
    s_mov_b32 s6, 315392
    buffer_load_dwordx4 v240, s[24:27], s6 offen lds
    s_add_u32 m0, s45, 49152
    s_mov_b32 s6, 344064
    buffer_load_dwordx4 v240, s[24:27], s6 offen lds
    s_add_u32 m0, s45, 53248
    s_mov_b32 s6, 372736
    buffer_load_dwordx4 v240, s[24:27], s6 offen lds
    s_waitcnt vmcnt(0) lgkmcnt(0)
    s_barrier
    s_and_b32 s6, s2, 1
    s_bfe_u32 s7, s2, 0x20001
    s_lshl2_add_u32 s6, s6, s7
    s_lshl_b32 s6, s6, 18
    s_lshl2_add_u32 s7, s44, s3
    s_mul_i32 s7, s7, 43
    v_min_u32 v6, 42, v1
    v_add_u32 v6, s7, v6
    v_add_u32 v7, 1024, v6
    v_min_u32 v7, 2047, v7
    v_lshlrev_b32 v7, 7, v7
    buffer_load_dword v255, v7, s[20:23], s6 offen
    v_add_u32 v7, 1540, v6
    v_min_u32 v7, 2047, v7
    v_lshlrev_b32 v7, 7, v7
    buffer_load_dword v255, v7, s[20:23], s6 offen
    ds_read_b64_tr_b16 a[0:1], v241 offset:0
    ds_read_b64_tr_b16 a[2:3], v241 offset:2048
    ds_read_b64_tr_b16 a[4:5], v242 offset:0
    ds_read_b64_tr_b16 a[6:7], v242 offset:2048
    ds_read_b64_tr_b16 a[8:9], v243 offset:0
    ds_read_b64_tr_b16 a[10:11], v243 offset:2048
    ds_read_b64_tr_b16 a[12:13], v244 offset:0
    ds_read_b64_tr_b16 a[14:15], v244 offset:2048
    ds_read_b64_tr_b16 a[16:17], v243 offset:3584
    ds_read_b64_tr_b16 a[18:19], v243 offset:5632
    ds_read_b64_tr_b16 a[20:21], v244 offset:3584
    ds_read_b64_tr_b16 a[22:23], v244 offset:5632
    ds_read_b64_tr_b16 a[24:25], v241 offset:3584
    ds_read_b64_tr_b16 a[26:27], v241 offset:5632
    ds_read_b64_tr_b16 a[28:29], v242 offset:3584
    ds_read_b64_tr_b16 a[30:31], v242 offset:5632
    ds_read_b64_tr_b16 a[112:113], v243 offset:25088
    ds_read_b64_tr_b16 a[114:115], v243 offset:27136
    ds_read_b64_tr_b16 a[116:117], v244 offset:25088
    ds_read_b64_tr_b16 a[118:119], v244 offset:27136
    ds_read_b64_tr_b16 a[120:121], v241 offset:25088
    ds_read_b64_tr_b16 a[122:123], v241 offset:27136
    ds_read_b64_tr_b16 a[124:125], v242 offset:25088
    ds_read_b64_tr_b16 a[126:127], v242 offset:27136
    ds_read_b64_tr_b16 a[128:129], v241 offset:28672
    ds_read_b64_tr_b16 a[130:131], v241 offset:30720
    ds_read_b64_tr_b16 a[132:133], v242 offset:28672
    ds_read_b64_tr_b16 a[134:135], v242 offset:30720
    ds_read_b64_tr_b16 a[136:137], v243 offset:28672
    ds_read_b64_tr_b16 a[138:139], v243 offset:30720
    ds_read_b64_tr_b16 a[140:141], v244 offset:28672
    ds_read_b64_tr_b16 a[142:143], v244 offset:30720
    ds_read_b64_tr_b16 a[224:225], v241 offset:50176
    ds_read_b64_tr_b16 a[226:227], v241 offset:52224
    ds_read_b64_tr_b16 a[228:229], v242 offset:50176
    ds_read_b64_tr_b16 a[230:231], v242 offset:52224
    ds_read_b64_tr_b16 a[232:233], v243 offset:50176
    ds_read_b64_tr_b16 a[234:235], v243 offset:52224
    ds_read_b64_tr_b16 a[236:237], v244 offset:50176
    ds_read_b64_tr_b16 a[238:239], v244 offset:52224
    s_mov_b32 s10, 40
L_plM:
    buffer_load_dword v42, v41, s[20:23], 0 offen sc1
    s_sub_u32 s10, s10, 1
    s_cbranch_scc1 L_pdM
    s_waitcnt vmcnt(0)
    v_cmp_ne_u32 vcc, v42, v250
    s_nop 0
    s_and_b64 exec, exec, vcc
    s_cbranch_scc1 L_plM
L_pdM:
    s_or_b32 s43, exec_lo, exec_hi
    s_mov_b64 exec, -1
    s_branch L_Sget
.p2align 12
L_B:
    s_mov_b64 exec, -1
    s_mov_b32 s22, 0x1000000
    s_mov_b32 s23, 0x20000
    s_add_u32 s6, s57, 5259264
    s_load_dword s36, s[20:21], s6
    s_lshl_b32 s6, s46, 7
    s_add_u32 s6, s6, 5242880
    v_mov_b32 v19, s6
    s_sub_u32 s6, s40, 24
    s_lshl2_add_u32 s47, s6, s3
    s_and_b32 s6, s2, 1
    s_bfe_u32 s7, s2, 0x20001
    s_lshl2_add_u32 s6, s6, s7
    s_lshl_b32 s6, s6, 5
    s_add_u32 s6, s6, s47
    s_lshl_b32 s6, s6, 13
    v_lshl_add_u32 v5, v1, 7, s6
    s_lshl2_add_u32 s6, s57, s47
    s_mul_i32 s6, s6, 35*128
    s_add_u32 s6, s6, 6291456
    v_min_u32 v6, 34, v1
    v_lshl_add_u32 v6, v6, 7, s6
    s_mov_b32 s18, 0x126000
    s_mov_b32 s19, 0x20000
    s_mul_i32 s6, s47, 42*128
    v_min_u32 v249, 41, v1
    v_lshl_add_u32 v249, v249, 7, s6
    s_add_u32 s100, s100, 1
    s_lshl_b32 s6, s3, 6
    v_lshl_add_u32 v11, v253, 1, s6
    v_cvt_f32_u32 v11, v11
    v_lshlrev_b32 v12, 5, v252
    v_cvt_f32_u32 v12, v12
    v_add_f32 v13, 0x00000000, v11
    v_mul_f32 v13, 0x3b124925, v13
    v_mul_f32 v224, v12, v13
    v_add_f32 v14, v13, v13
    v_fract_f32 v224, v224
    v_cos_f32 v16, v14
    v_add_f32 v225, v224, v13
    v_add_f32 v226, v224, v14
    v_add_f32 v227, v225, v14
    v_add_f32 v16, v16, v16
    v_cos_f32 v228, v224
    v_cos_f32 v229, v225
    v_cos_f32 v230, v226
    v_cos_f32 v231, v227
    v_sin_f32 v224, v224
    v_sin_f32 v225, v225
    v_sin_f32 v226, v226
    v_sin_f32 v227, v227
    v_cvt_pk_bf16_f32 v64, v228, v229
    v_cvt_pk_bf16_f32 v80, v224, v225
    v_pk_fma_f32 v[228:229], v[16:17], v[230:231], v[228:229] op_sel_hi:[0,1,1] neg_lo:[0,0,1] neg_hi:[0,0,1]
    v_pk_fma_f32 v[224:225], v[16:17], v[226:227], v[224:225] op_sel_hi:[0,1,1] neg_lo:[0,0,1] neg_hi:[0,0,1]
    v_cvt_pk_bf16_f32 v65, v230, v231
    v_cvt_pk_bf16_f32 v81, v226, v227
    v_pk_fma_f32 v[230:231], v[16:17], v[228:229], v[230:231] op_sel_hi:[0,1,1] neg_lo:[0,0,1] neg_hi:[0,0,1]
    v_pk_fma_f32 v[226:227], v[16:17], v[224:225], v[226:227] op_sel_hi:[0,1,1] neg_lo:[0,0,1] neg_hi:[0,0,1]
    v_cvt_pk_bf16_f32 v66, v228, v229
    v_cvt_pk_bf16_f32 v82, v224, v225
    v_pk_fma_f32 v[228:229], v[16:17], v[230:231], v[228:229] op_sel_hi:[0,1,1] neg_lo:[0,0,1] neg_hi:[0,0,1]
    v_pk_fma_f32 v[224:225], v[16:17], v[226:227], v[224:225] op_sel_hi:[0,1,1] neg_lo:[0,0,1] neg_hi:[0,0,1]
    v_cvt_pk_bf16_f32 v67, v230, v231
    v_cvt_pk_bf16_f32 v83, v226, v227
    v_pk_fma_f32 v[230:231], v[16:17], v[228:229], v[230:231] op_sel_hi:[0,1,1] neg_lo:[0,0,1] neg_hi:[0,0,1]
    v_pk_fma_f32 v[226:227], v[16:17], v[224:225], v[226:227] op_sel_hi:[0,1,1] neg_lo:[0,0,1] neg_hi:[0,0,1]
    v_cvt_pk_bf16_f32 v68, v228, v229
    v_cvt_pk_bf16_f32 v84, v224, v225
    v_pk_fma_f32 v[228:229], v[16:17], v[230:231], v[228:229] op_sel_hi:[0,1,1] neg_lo:[0,0,1] neg_hi:[0,0,1]
    v_pk_fma_f32 v[224:225], v[16:17], v[226:227], v[224:225] op_sel_hi:[0,1,1] neg_lo:[0,0,1] neg_hi:[0,0,1]
    v_cvt_pk_bf16_f32 v69, v230, v231
    v_cvt_pk_bf16_f32 v85, v226, v227
    v_pk_fma_f32 v[230:231], v[16:17], v[228:229], v[230:231] op_sel_hi:[0,1,1] neg_lo:[0,0,1] neg_hi:[0,0,1]
    v_pk_fma_f32 v[226:227], v[16:17], v[224:225], v[226:227] op_sel_hi:[0,1,1] neg_lo:[0,0,1] neg_hi:[0,0,1]
    v_cvt_pk_bf16_f32 v70, v228, v229
    v_cvt_pk_bf16_f32 v86, v224, v225
    v_pk_fma_f32 v[228:229], v[16:17], v[230:231], v[228:229] op_sel_hi:[0,1,1] neg_lo:[0,0,1] neg_hi:[0,0,1]
    v_pk_fma_f32 v[224:225], v[16:17], v[226:227], v[224:225] op_sel_hi:[0,1,1] neg_lo:[0,0,1] neg_hi:[0,0,1]
    v_cvt_pk_bf16_f32 v71, v230, v231
    v_cvt_pk_bf16_f32 v87, v226, v227
    v_pk_fma_f32 v[230:231], v[16:17], v[228:229], v[230:231] op_sel_hi:[0,1,1] neg_lo:[0,0,1] neg_hi:[0,0,1]
    v_pk_fma_f32 v[226:227], v[16:17], v[224:225], v[226:227] op_sel_hi:[0,1,1] neg_lo:[0,0,1] neg_hi:[0,0,1]
    v_cvt_pk_bf16_f32 v72, v228, v229
    v_cvt_pk_bf16_f32 v88, v224, v225
    v_pk_fma_f32 v[228:229], v[16:17], v[230:231], v[228:229] op_sel_hi:[0,1,1] neg_lo:[0,0,1] neg_hi:[0,0,1]
    v_pk_fma_f32 v[224:225], v[16:17], v[226:227], v[224:225] op_sel_hi:[0,1,1] neg_lo:[0,0,1] neg_hi:[0,0,1]
    v_cvt_pk_bf16_f32 v73, v230, v231
    v_cvt_pk_bf16_f32 v89, v226, v227
    v_pk_fma_f32 v[230:231], v[16:17], v[228:229], v[230:231] op_sel_hi:[0,1,1] neg_lo:[0,0,1] neg_hi:[0,0,1]
    v_pk_fma_f32 v[226:227], v[16:17], v[224:225], v[226:227] op_sel_hi:[0,1,1] neg_lo:[0,0,1] neg_hi:[0,0,1]
    v_cvt_pk_bf16_f32 v74, v228, v229
    v_cvt_pk_bf16_f32 v90, v224, v225
    v_pk_fma_f32 v[228:229], v[16:17], v[230:231], v[228:229] op_sel_hi:[0,1,1] neg_lo:[0,0,1] neg_hi:[0,0,1]
    v_pk_fma_f32 v[224:225], v[16:17], v[226:227], v[224:225] op_sel_hi:[0,1,1] neg_lo:[0,0,1] neg_hi:[0,0,1]
    v_cvt_pk_bf16_f32 v75, v230, v231
    v_cvt_pk_bf16_f32 v91, v226, v227
    v_pk_fma_f32 v[230:231], v[16:17], v[228:229], v[230:231] op_sel_hi:[0,1,1] neg_lo:[0,0,1] neg_hi:[0,0,1]
    v_pk_fma_f32 v[226:227], v[16:17], v[224:225], v[226:227] op_sel_hi:[0,1,1] neg_lo:[0,0,1] neg_hi:[0,0,1]
    v_cvt_pk_bf16_f32 v76, v228, v229
    v_cvt_pk_bf16_f32 v92, v224, v225
    v_pk_fma_f32 v[228:229], v[16:17], v[230:231], v[228:229] op_sel_hi:[0,1,1] neg_lo:[0,0,1] neg_hi:[0,0,1]
    v_pk_fma_f32 v[224:225], v[16:17], v[226:227], v[224:225] op_sel_hi:[0,1,1] neg_lo:[0,0,1] neg_hi:[0,0,1]
    v_cvt_pk_bf16_f32 v77, v230, v231
    v_cvt_pk_bf16_f32 v93, v226, v227
    v_pk_fma_f32 v[230:231], v[16:17], v[228:229], v[230:231] op_sel_hi:[0,1,1] neg_lo:[0,0,1] neg_hi:[0,0,1]
    v_pk_fma_f32 v[226:227], v[16:17], v[224:225], v[226:227] op_sel_hi:[0,1,1] neg_lo:[0,0,1] neg_hi:[0,0,1]
    v_cvt_pk_bf16_f32 v78, v228, v229
    v_cvt_pk_bf16_f32 v94, v224, v225
    v_cvt_pk_bf16_f32 v79, v230, v231
    v_cvt_pk_bf16_f32 v95, v226, v227
    v_add_f32 v13, 0x3f800000, v11
    v_mul_f32 v13, 0x3b124925, v13
    v_mul_f32 v224, v12, v13
    v_add_f32 v14, v13, v13
    v_fract_f32 v224, v224
    v_cos_f32 v16, v14
    v_add_f32 v225, v224, v13
    v_add_f32 v226, v224, v14
    v_add_f32 v227, v225, v14
    v_add_f32 v16, v16, v16
    v_cos_f32 v228, v224
    v_cos_f32 v229, v225
    v_cos_f32 v230, v226
    v_cos_f32 v231, v227
    v_sin_f32 v224, v224
    v_sin_f32 v225, v225
    v_sin_f32 v226, v226
    v_sin_f32 v227, v227
    v_cvt_pk_bf16_f32 v96, v228, v229
    v_cvt_pk_bf16_f32 v112, v224, v225
    v_pk_fma_f32 v[228:229], v[16:17], v[230:231], v[228:229] op_sel_hi:[0,1,1] neg_lo:[0,0,1] neg_hi:[0,0,1]
    v_pk_fma_f32 v[224:225], v[16:17], v[226:227], v[224:225] op_sel_hi:[0,1,1] neg_lo:[0,0,1] neg_hi:[0,0,1]
    v_cvt_pk_bf16_f32 v97, v230, v231
    v_cvt_pk_bf16_f32 v113, v226, v227
    v_pk_fma_f32 v[230:231], v[16:17], v[228:229], v[230:231] op_sel_hi:[0,1,1] neg_lo:[0,0,1] neg_hi:[0,0,1]
    v_pk_fma_f32 v[226:227], v[16:17], v[224:225], v[226:227] op_sel_hi:[0,1,1] neg_lo:[0,0,1] neg_hi:[0,0,1]
    v_cvt_pk_bf16_f32 v98, v228, v229
    v_cvt_pk_bf16_f32 v114, v224, v225
    v_pk_fma_f32 v[228:229], v[16:17], v[230:231], v[228:229] op_sel_hi:[0,1,1] neg_lo:[0,0,1] neg_hi:[0,0,1]
    v_pk_fma_f32 v[224:225], v[16:17], v[226:227], v[224:225] op_sel_hi:[0,1,1] neg_lo:[0,0,1] neg_hi:[0,0,1]
    v_cvt_pk_bf16_f32 v99, v230, v231
    v_cvt_pk_bf16_f32 v115, v226, v227
    v_pk_fma_f32 v[230:231], v[16:17], v[228:229], v[230:231] op_sel_hi:[0,1,1] neg_lo:[0,0,1] neg_hi:[0,0,1]
    v_pk_fma_f32 v[226:227], v[16:17], v[224:225], v[226:227] op_sel_hi:[0,1,1] neg_lo:[0,0,1] neg_hi:[0,0,1]
    v_cvt_pk_bf16_f32 v100, v228, v229
    v_cvt_pk_bf16_f32 v116, v224, v225
    v_pk_fma_f32 v[228:229], v[16:17], v[230:231], v[228:229] op_sel_hi:[0,1,1] neg_lo:[0,0,1] neg_hi:[0,0,1]
    v_pk_fma_f32 v[224:225], v[16:17], v[226:227], v[224:225] op_sel_hi:[0,1,1] neg_lo:[0,0,1] neg_hi:[0,0,1]
    v_cvt_pk_bf16_f32 v101, v230, v231
    v_cvt_pk_bf16_f32 v117, v226, v227
    v_pk_fma_f32 v[230:231], v[16:17], v[228:229], v[230:231] op_sel_hi:[0,1,1] neg_lo:[0,0,1] neg_hi:[0,0,1]
    v_pk_fma_f32 v[226:227], v[16:17], v[224:225], v[226:227] op_sel_hi:[0,1,1] neg_lo:[0,0,1] neg_hi:[0,0,1]
    v_cvt_pk_bf16_f32 v102, v228, v229
    v_cvt_pk_bf16_f32 v118, v224, v225
    v_pk_fma_f32 v[228:229], v[16:17], v[230:231], v[228:229] op_sel_hi:[0,1,1] neg_lo:[0,0,1] neg_hi:[0,0,1]
    v_pk_fma_f32 v[224:225], v[16:17], v[226:227], v[224:225] op_sel_hi:[0,1,1] neg_lo:[0,0,1] neg_hi:[0,0,1]
    v_cvt_pk_bf16_f32 v103, v230, v231
    v_cvt_pk_bf16_f32 v119, v226, v227
    v_pk_fma_f32 v[230:231], v[16:17], v[228:229], v[230:231] op_sel_hi:[0,1,1] neg_lo:[0,0,1] neg_hi:[0,0,1]
    v_pk_fma_f32 v[226:227], v[16:17], v[224:225], v[226:227] op_sel_hi:[0,1,1] neg_lo:[0,0,1] neg_hi:[0,0,1]
    v_cvt_pk_bf16_f32 v104, v228, v229
    v_cvt_pk_bf16_f32 v120, v224, v225
    v_pk_fma_f32 v[228:229], v[16:17], v[230:231], v[228:229] op_sel_hi:[0,1,1] neg_lo:[0,0,1] neg_hi:[0,0,1]
    v_pk_fma_f32 v[224:225], v[16:17], v[226:227], v[224:225] op_sel_hi:[0,1,1] neg_lo:[0,0,1] neg_hi:[0,0,1]
    v_cvt_pk_bf16_f32 v105, v230, v231
    v_cvt_pk_bf16_f32 v121, v226, v227
    v_pk_fma_f32 v[230:231], v[16:17], v[228:229], v[230:231] op_sel_hi:[0,1,1] neg_lo:[0,0,1] neg_hi:[0,0,1]
    v_pk_fma_f32 v[226:227], v[16:17], v[224:225], v[226:227] op_sel_hi:[0,1,1] neg_lo:[0,0,1] neg_hi:[0,0,1]
    v_cvt_pk_bf16_f32 v106, v228, v229
    v_cvt_pk_bf16_f32 v122, v224, v225
    v_pk_fma_f32 v[228:229], v[16:17], v[230:231], v[228:229] op_sel_hi:[0,1,1] neg_lo:[0,0,1] neg_hi:[0,0,1]
    v_pk_fma_f32 v[224:225], v[16:17], v[226:227], v[224:225] op_sel_hi:[0,1,1] neg_lo:[0,0,1] neg_hi:[0,0,1]
    v_cvt_pk_bf16_f32 v107, v230, v231
    v_cvt_pk_bf16_f32 v123, v226, v227
    v_pk_fma_f32 v[230:231], v[16:17], v[228:229], v[230:231] op_sel_hi:[0,1,1] neg_lo:[0,0,1] neg_hi:[0,0,1]
    v_pk_fma_f32 v[226:227], v[16:17], v[224:225], v[226:227] op_sel_hi:[0,1,1] neg_lo:[0,0,1] neg_hi:[0,0,1]
    v_cvt_pk_bf16_f32 v108, v228, v229
    v_cvt_pk_bf16_f32 v124, v224, v225
    v_pk_fma_f32 v[228:229], v[16:17], v[230:231], v[228:229] op_sel_hi:[0,1,1] neg_lo:[0,0,1] neg_hi:[0,0,1]
    v_pk_fma_f32 v[224:225], v[16:17], v[226:227], v[224:225] op_sel_hi:[0,1,1] neg_lo:[0,0,1] neg_hi:[0,0,1]
    v_cvt_pk_bf16_f32 v109, v230, v231
    v_cvt_pk_bf16_f32 v125, v226, v227
    v_pk_fma_f32 v[230:231], v[16:17], v[228:229], v[230:231] op_sel_hi:[0,1,1] neg_lo:[0,0,1] neg_hi:[0,0,1]
    v_pk_fma_f32 v[226:227], v[16:17], v[224:225], v[226:227] op_sel_hi:[0,1,1] neg_lo:[0,0,1] neg_hi:[0,0,1]
    v_cvt_pk_bf16_f32 v110, v228, v229
    v_cvt_pk_bf16_f32 v126, v224, v225
    v_cvt_pk_bf16_f32 v111, v230, v231
    v_cvt_pk_bf16_f32 v127, v226, v227
    s_waitcnt lgkmcnt(0)
    s_mul_i32 s36, s36, 0x9e3779b1
    s_add_u32 s36, s36, 0x7f4a7c15
    v_mov_b32 v250, s36
    s_getreg_b32 s7, hwreg(HW_REG_XCC_ID, 0, 3)
    s_mul_i32 s8, s57, 17920
    s_lshl_b32 s7, s7, 7
    s_add_u32 s8, s8, s7
    s_add_u32 s8, s8, 6432768
    v_and_b32 v7, 31, v1
    v_lshl_add_u32 v7, v7, 2, s8
    s_lshl2_add_u32 s37, s40, s8
    s_add_u32 s100, s100, 1
    s_sub_u32 s10, s100, 7
    s_min_u32 s100, s100, s10
    s_mul_i32 s51, s100, 64*2688
    v_add_f32 v13, 0x42000000, v11
    buffer_load_dword v255, v249, s[16:19], s51 offen
    v_mul_f32 v13, 0x3b124925, v13
    v_mul_f32 v224, v12, v13
    v_add_f32 v14, v13, v13
    v_fract_f32 v224, v224
    v_cos_f32 v16, v14
    v_add_f32 v225, v224, v13
    v_add_f32 v226, v224, v14
    v_add_f32 v227, v225, v14
    v_add_f32 v16, v16, v16
    v_cos_f32 v228, v224
    v_cos_f32 v229, v225
    v_cos_f32 v230, v226
    v_cos_f32 v231, v227
    v_sin_f32 v224, v224
    v_sin_f32 v225, v225
    v_sin_f32 v226, v226
    v_sin_f32 v227, v227
    v_cvt_pk_bf16_f32 v128, v228, v229
    v_cvt_pk_bf16_f32 v144, v224, v225
    v_pk_fma_f32 v[228:229], v[16:17], v[230:231], v[228:229] op_sel_hi:[0,1,1] neg_lo:[0,0,1] neg_hi:[0,0,1]
    v_pk_fma_f32 v[224:225], v[16:17], v[226:227], v[224:225] op_sel_hi:[0,1,1] neg_lo:[0,0,1] neg_hi:[0,0,1]
    v_cvt_pk_bf16_f32 v129, v230, v231
    v_cvt_pk_bf16_f32 v145, v226, v227
    v_pk_fma_f32 v[230:231], v[16:17], v[228:229], v[230:231] op_sel_hi:[0,1,1] neg_lo:[0,0,1] neg_hi:[0,0,1]
    v_pk_fma_f32 v[226:227], v[16:17], v[224:225], v[226:227] op_sel_hi:[0,1,1] neg_lo:[0,0,1] neg_hi:[0,0,1]
    s_add_u32 s100, s100, 1
    s_sub_u32 s10, s100, 7
    s_min_u32 s100, s100, s10
    s_mul_i32 s51, s100, 64*2688
    v_cvt_pk_bf16_f32 v130, v228, v229
    buffer_load_dword v255, v249, s[16:19], s51 offen
    v_cvt_pk_bf16_f32 v146, v224, v225
    v_pk_fma_f32 v[228:229], v[16:17], v[230:231], v[228:229] op_sel_hi:[0,1,1] neg_lo:[0,0,1] neg_hi:[0,0,1]
    v_pk_fma_f32 v[224:225], v[16:17], v[226:227], v[224:225] op_sel_hi:[0,1,1] neg_lo:[0,0,1] neg_hi:[0,0,1]
    v_cvt_pk_bf16_f32 v131, v230, v231
    v_cvt_pk_bf16_f32 v147, v226, v227
    v_pk_fma_f32 v[230:231], v[16:17], v[228:229], v[230:231] op_sel_hi:[0,1,1] neg_lo:[0,0,1] neg_hi:[0,0,1]
    v_pk_fma_f32 v[226:227], v[16:17], v[224:225], v[226:227] op_sel_hi:[0,1,1] neg_lo:[0,0,1] neg_hi:[0,0,1]
    v_cvt_pk_bf16_f32 v132, v228, v229
    v_cvt_pk_bf16_f32 v148, v224, v225
    v_pk_fma_f32 v[228:229], v[16:17], v[230:231], v[228:229] op_sel_hi:[0,1,1] neg_lo:[0,0,1] neg_hi:[0,0,1]
    v_pk_fma_f32 v[224:225], v[16:17], v[226:227], v[224:225] op_sel_hi:[0,1,1] neg_lo:[0,0,1] neg_hi:[0,0,1]
    v_cvt_pk_bf16_f32 v133, v230, v231
    v_cvt_pk_bf16_f32 v149, v226, v227
    v_pk_fma_f32 v[230:231], v[16:17], v[228:229], v[230:231] op_sel_hi:[0,1,1] neg_lo:[0,0,1] neg_hi:[0,0,1]
    v_pk_fma_f32 v[226:227], v[16:17], v[224:225], v[226:227] op_sel_hi:[0,1,1] neg_lo:[0,0,1] neg_hi:[0,0,1]
    v_cvt_pk_bf16_f32 v134, v228, v229
    v_cvt_pk_bf16_f32 v150, v224, v225
    v_pk_fma_f32 v[228:229], v[16:17], v[230:231], v[228:229] op_sel_hi:[0,1,1] neg_lo:[0,0,1] neg_hi:[0,0,1]
    v_pk_fma_f32 v[224:225], v[16:17], v[226:227], v[224:225] op_sel_hi:[0,1,1] neg_lo:[0,0,1] neg_hi:[0,0,1]
    v_cvt_pk_bf16_f32 v135, v230, v231
    v_cvt_pk_bf16_f32 v151, v226, v227
    v_pk_fma_f32 v[230:231], v[16:17], v[228:229], v[230:231] op_sel_hi:[0,1,1] neg_lo:[0,0,1] neg_hi:[0,0,1]
    v_pk_fma_f32 v[226:227], v[16:17], v[224:225], v[226:227] op_sel_hi:[0,1,1] neg_lo:[0,0,1] neg_hi:[0,0,1]
    v_cvt_pk_bf16_f32 v136, v228, v229
    v_cvt_pk_bf16_f32 v152, v224, v225
    s_add_u32 s100, s100, 1
    s_sub_u32 s10, s100, 7
    s_min_u32 s100, s100, s10
    s_mul_i32 s51, s100, 64*2688
    v_pk_fma_f32 v[228:229], v[16:17], v[230:231], v[228:229] op_sel_hi:[0,1,1] neg_lo:[0,0,1] neg_hi:[0,0,1]
    buffer_load_dword v255, v249, s[16:19], s51 offen
    v_pk_fma_f32 v[224:225], v[16:17], v[226:227], v[224:225] op_sel_hi:[0,1,1] neg_lo:[0,0,1] neg_hi:[0,0,1]
    v_cvt_pk_bf16_f32 v137, v230, v231
    v_cvt_pk_bf16_f32 v153, v226, v227
    v_pk_fma_f32 v[230:231], v[16:17], v[228:229], v[230:231] op_sel_hi:[0,1,1] neg_lo:[0,0,1] neg_hi:[0,0,1]
    v_pk_fma_f32 v[226:227], v[16:17], v[224:225], v[226:227] op_sel_hi:[0,1,1] neg_lo:[0,0,1] neg_hi:[0,0,1]
    v_cvt_pk_bf16_f32 v138, v228, v229
    v_cvt_pk_bf16_f32 v154, v224, v225
    v_pk_fma_f32 v[228:229], v[16:17], v[230:231], v[228:229] op_sel_hi:[0,1,1] neg_lo:[0,0,1] neg_hi:[0,0,1]
    v_pk_fma_f32 v[224:225], v[16:17], v[226:227], v[224:225] op_sel_hi:[0,1,1] neg_lo:[0,0,1] neg_hi:[0,0,1]
    v_cvt_pk_bf16_f32 v139, v230, v231
    v_cvt_pk_bf16_f32 v155, v226, v227
    v_pk_fma_f32 v[230:231], v[16:17], v[228:229], v[230:231] op_sel_hi:[0,1,1] neg_lo:[0,0,1] neg_hi:[0,0,1]
    v_pk_fma_f32 v[226:227], v[16:17], v[224:225], v[226:227] op_sel_hi:[0,1,1] neg_lo:[0,0,1] neg_hi:[0,0,1]
    v_cvt_pk_bf16_f32 v140, v228, v229
    v_cvt_pk_bf16_f32 v156, v224, v225
    v_pk_fma_f32 v[228:229], v[16:17], v[230:231], v[228:229] op_sel_hi:[0,1,1] neg_lo:[0,0,1] neg_hi:[0,0,1]
    v_pk_fma_f32 v[224:225], v[16:17], v[226:227], v[224:225] op_sel_hi:[0,1,1] neg_lo:[0,0,1] neg_hi:[0,0,1]
    v_cvt_pk_bf16_f32 v141, v230, v231
    v_cvt_pk_bf16_f32 v157, v226, v227
    v_pk_fma_f32 v[230:231], v[16:17], v[228:229], v[230:231] op_sel_hi:[0,1,1] neg_lo:[0,0,1] neg_hi:[0,0,1]
    v_pk_fma_f32 v[226:227], v[16:17], v[224:225], v[226:227] op_sel_hi:[0,1,1] neg_lo:[0,0,1] neg_hi:[0,0,1]
    v_cvt_pk_bf16_f32 v142, v228, v229
    v_cvt_pk_bf16_f32 v158, v224, v225
    v_cvt_pk_bf16_f32 v143, v230, v231
    v_cvt_pk_bf16_f32 v159, v226, v227
    v_and_b32 v32, 3, v1
    v_bfe_u32 v33, v1, 2, 1
    v_lshl_or_b32 v32, v32, 1, v33
    s_and_b32 s6, s3, 1
    s_lshl_b32 s6, s6, 3
    v_add_u32 v33, s6, v252
    v_xor_b32 v32, v32, v33
    v_lshlrev_b32 v32, 4, v32
    v_lshl_add_u32 v32, v253, 8, v32
    s_lshr_b32 s6, s3, 1
    s_lshl_b32 s6, s6, 12
    v_add_u32 v8, s6, v32
    v_xor_b32 v9, 64, v8
    v_and_b32 v32, 1, v252
    v_xor_b32 v32, v32, v253
    v_lshlrev_b32 v32, 4, v32
    v_lshl_add_u32 v60, v252, 10, v32
    v_xor_b32 v61, 32, v60
    v_xor_b32 v62, 64, v60
    v_xor_b32 v63, 96, v60
    s_mov_b32 s8, 0xffff0000
    v_add_f32 v13, 0x42040000, v11
    v_mul_f32 v13, 0x3b124925, v13
    v_mul_f32 v224, v12, v13
    v_add_f32 v14, v13, v13
    v_fract_f32 v224, v224
    v_cos_f32 v16, v14
    v_add_f32 v225, v224, v13
    v_add_f32 v226, v224, v14
    v_add_f32 v227, v225, v14
    v_add_f32 v16, v16, v16
    v_cos_f32 v228, v224
    v_cos_f32 v229, v225
    v_cos_f32 v230, v226
    v_cos_f32 v231, v227
    v_sin_f32 v224, v224
    v_sin_f32 v225, v225
    v_sin_f32 v226, v226
    v_sin_f32 v227, v227
    v_cvt_pk_bf16_f32 v160, v228, v229
    v_cvt_pk_bf16_f32 v176, v224, v225
    v_pk_fma_f32 v[228:229], v[16:17], v[230:231], v[228:229] op_sel_hi:[0,1,1] neg_lo:[0,0,1] neg_hi:[0,0,1]
    v_pk_fma_f32 v[224:225], v[16:17], v[226:227], v[224:225] op_sel_hi:[0,1,1] neg_lo:[0,0,1] neg_hi:[0,0,1]
    v_cvt_pk_bf16_f32 v161, v230, v231
    v_cvt_pk_bf16_f32 v177, v226, v227
    v_pk_fma_f32 v[230:231], v[16:17], v[228:229], v[230:231] op_sel_hi:[0,1,1] neg_lo:[0,0,1] neg_hi:[0,0,1]
    v_pk_fma_f32 v[226:227], v[16:17], v[224:225], v[226:227] op_sel_hi:[0,1,1] neg_lo:[0,0,1] neg_hi:[0,0,1]
    v_cvt_pk_bf16_f32 v162, v228, v229
    v_cvt_pk_bf16_f32 v178, v224, v225
    v_pk_fma_f32 v[228:229], v[16:17], v[230:231], v[228:229] op_sel_hi:[0,1,1] neg_lo:[0,0,1] neg_hi:[0,0,1]
    v_pk_fma_f32 v[224:225], v[16:17], v[226:227], v[224:225] op_sel_hi:[0,1,1] neg_lo:[0,0,1] neg_hi:[0,0,1]
    s_waitcnt vmcnt(7)
    v_mov_b32_dpp v40, v200 row_shr:1 row_mask:0xf bank_mask:0xf bound_ctrl:0
    v_mov_b32_dpp v41, v204 row_shr:1 row_mask:0xf bank_mask:0xf bound_ctrl:0
    v_lshlrev_b32 v28, 16, v192
    v_lshlrev_b32 v30, 16, v41
    v_lshlrev_b32 v32, 16, v196
    v_lshlrev_b32 v34, 16, v40
    v_and_b32 v29, s8, v192
    v_and_b32 v31, s8, v207
    v_and_b32 v33, s8, v196
    v_and_b32 v35, s8, v203
    v_pk_add_f32 v[36:37], v[28:29], v[30:31]
    v_pk_add_f32 v[38:39], v[32:33], v[34:35]
    v_pk_add_f32 v[28:29], v[28:29], v[30:31] neg_lo:[0,1] neg_hi:[0,1]
    v_pk_add_f32 v[32:33], v[32:33], v[34:35] neg_lo:[0,1] neg_hi:[0,1]
    v_pk_add_f32 v[30:31], v[36:37], v[38:39]
    v_pk_add_f32 v[34:35], v[28:29], v[32:33]
    v_pk_add_f32 v[36:37], v[36:37], v[38:39] neg_lo:[0,1] neg_hi:[0,1]
    v_pk_add_f32 v[28:29], v[28:29], v[32:33] neg_lo:[0,1] neg_hi:[0,1]
    v_cvt_pk_bf16_f32 v232, v30, v31
    v_cvt_pk_bf16_f32 v236, v34, v35
    v_cvt_pk_bf16_f32 v240, v36, v37
    v_cvt_pk_bf16_f32 v244, v28, v29
    v_lshlrev_b32 v28, 16, v193
    v_lshlrev_b32 v30, 16, v207
    v_lshlrev_b32 v32, 16, v197
    v_lshlrev_b32 v34, 16, v203
    v_and_b32 v29, s8, v193
    v_and_b32 v31, s8, v206
    v_and_b32 v33, s8, v197
    v_and_b32 v35, s8, v202
    v_pk_add_f32 v[36:37], v[28:29], v[30:31]
    v_pk_add_f32 v[38:39], v[32:33], v[34:35]
    v_pk_add_f32 v[28:29], v[28:29], v[30:31] neg_lo:[0,1] neg_hi:[0,1]
    v_pk_add_f32 v[32:33], v[32:33], v[34:35] neg_lo:[0,1] neg_hi:[0,1]
    v_pk_add_f32 v[30:31], v[36:37], v[38:39]
    v_pk_add_f32 v[34:35], v[28:29], v[32:33]
    v_pk_add_f32 v[36:37], v[36:37], v[38:39] neg_lo:[0,1] neg_hi:[0,1]
    v_pk_add_f32 v[28:29], v[28:29], v[32:33] neg_lo:[0,1] neg_hi:[0,1]
    v_cvt_pk_bf16_f32 v233, v30, v31
    v_cvt_pk_bf16_f32 v237, v34, v35
    v_cvt_pk_bf16_f32 v241, v36, v37
    v_cvt_pk_bf16_f32 v245, v28, v29
    v_lshlrev_b32 v28, 16, v194
    v_lshlrev_b32 v30, 16, v206
    v_lshlrev_b32 v32, 16, v198
    v_lshlrev_b32 v34, 16, v202
    v_and_b32 v29, s8, v194
    v_and_b32 v31, s8, v205
    v_and_b32 v33, s8, v198
    v_and_b32 v35, s8, v201
    v_pk_add_f32 v[36:37], v[28:29], v[30:31]
    v_pk_add_f32 v[38:39], v[32:33], v[34:35]
    v_pk_add_f32 v[28:29], v[28:29], v[30:31] neg_lo:[0,1] neg_hi:[0,1]
    v_pk_add_f32 v[32:33], v[32:33], v[34:35] neg_lo:[0,1] neg_hi:[0,1]
    v_pk_add_f32 v[30:31], v[36:37], v[38:39]
    v_pk_add_f32 v[34:35], v[28:29], v[32:33]
    v_pk_add_f32 v[36:37], v[36:37], v[38:39] neg_lo:[0,1] neg_hi:[0,1]
    v_pk_add_f32 v[28:29], v[28:29], v[32:33] neg_lo:[0,1] neg_hi:[0,1]
    v_cvt_pk_bf16_f32 v234, v30, v31
    v_cvt_pk_bf16_f32 v238, v34, v35
    v_cvt_pk_bf16_f32 v242, v36, v37
    v_cvt_pk_bf16_f32 v246, v28, v29
    v_lshlrev_b32 v28, 16, v195
    v_lshlrev_b32 v30, 16, v205
    v_lshlrev_b32 v32, 16, v199
    v_lshlrev_b32 v34, 16, v201
    v_and_b32 v29, s8, v195
    v_and_b32 v31, s8, v204
    v_and_b32 v33, s8, v199
    v_and_b32 v35, s8, v200
    v_pk_add_f32 v[36:37], v[28:29], v[30:31]
    v_pk_add_f32 v[38:39], v[32:33], v[34:35]
    v_pk_add_f32 v[28:29], v[28:29], v[30:31] neg_lo:[0,1] neg_hi:[0,1]
    v_pk_add_f32 v[32:33], v[32:33], v[34:35] neg_lo:[0,1] neg_hi:[0,1]
    v_pk_add_f32 v[30:31], v[36:37], v[38:39]
    v_pk_add_f32 v[34:35], v[28:29], v[32:33]
    v_pk_add_f32 v[36:37], v[36:37], v[38:39] neg_lo:[0,1] neg_hi:[0,1]
    v_pk_add_f32 v[28:29], v[28:29], v[32:33] neg_lo:[0,1] neg_hi:[0,1]
    v_cvt_pk_bf16_f32 v235, v30, v31
    v_cvt_pk_bf16_f32 v239, v34, v35
    v_cvt_pk_bf16_f32 v243, v36, v37
    v_cvt_pk_bf16_f32 v247, v28, v29
    s_waitcnt vmcnt(3)
    ds_write_b128 v8, v[232:235] offset:0
    v_mov_b32_dpp v40, v216 row_shr:1 row_mask:0xf bank_mask:0xf bound_ctrl:0
    v_mov_b32_dpp v41, v220 row_shr:1 row_mask:0xf bank_mask:0xf bound_ctrl:0
    v_lshlrev_b32 v28, 16, v208
    v_lshlrev_b32 v30, 16, v41
    v_lshlrev_b32 v32, 16, v212
    v_lshlrev_b32 v34, 16, v40
    v_and_b32 v29, s8, v208
    v_and_b32 v31, s8, v223
    v_and_b32 v33, s8, v212
    v_and_b32 v35, s8, v219
    ds_write_b128 v8, v[236:239] offset:8192
    v_pk_add_f32 v[36:37], v[28:29], v[30:31]
    v_pk_add_f32 v[38:39], v[32:33], v[34:35]
    v_pk_add_f32 v[28:29], v[28:29], v[30:31] neg_lo:[0,1] neg_hi:[0,1]
    v_pk_add_f32 v[32:33], v[32:33], v[34:35] neg_lo:[0,1] neg_hi:[0,1]
    v_pk_add_f32 v[30:31], v[36:37], v[38:39]
    v_pk_add_f32 v[34:35], v[28:29], v[32:33]
    v_pk_add_f32 v[36:37], v[36:37], v[38:39] neg_lo:[0,1] neg_hi:[0,1]
    v_pk_add_f32 v[28:29], v[28:29], v[32:33] neg_lo:[0,1] neg_hi:[0,1]
    v_cvt_pk_bf16_f32 v192, v30, v31
    v_cvt_pk_bf16_f32 v196, v34, v35
    ds_write_b128 v8, v[240:243] offset:16384
    v_cvt_pk_bf16_f32 v200, v36, v37
    v_cvt_pk_bf16_f32 v204, v28, v29
    v_lshlrev_b32 v28, 16, v209
    v_lshlrev_b32 v30, 16, v223
    v_lshlrev_b32 v32, 16, v213
    v_lshlrev_b32 v34, 16, v219
    v_and_b32 v29, s8, v209
    v_and_b32 v31, s8, v222
    v_and_b32 v33, s8, v213
    v_and_b32 v35, s8, v218
    ds_write_b128 v8, v[244:247] offset:24576
    v_pk_add_f32 v[36:37], v[28:29], v[30:31]
    v_pk_add_f32 v[38:39], v[32:33], v[34:35]
    v_pk_add_f32 v[28:29], v[28:29], v[30:31] neg_lo:[0,1] neg_hi:[0,1]
    v_pk_add_f32 v[32:33], v[32:33], v[34:35] neg_lo:[0,1] neg_hi:[0,1]
    v_pk_add_f32 v[30:31], v[36:37], v[38:39]
    v_pk_add_f32 v[34:35], v[28:29], v[32:33]
    v_pk_add_f32 v[36:37], v[36:37], v[38:39] neg_lo:[0,1] neg_hi:[0,1]
    v_pk_add_f32 v[28:29], v[28:29], v[32:33] neg_lo:[0,1] neg_hi:[0,1]
    v_cvt_pk_bf16_f32 v193, v30, v31
    v_cvt_pk_bf16_f32 v197, v34, v35
    s_add_u32 s100, s100, 1
    s_sub_u32 s10, s100, 7
    s_min_u32 s100, s100, s10
    s_mul_i32 s51, s100, 64*2688
    v_cvt_pk_bf16_f32 v201, v36, v37
    buffer_load_dword v255, v249, s[16:19], s51 offen
    v_cvt_pk_bf16_f32 v205, v28, v29
    v_lshlrev_b32 v28, 16, v210
    v_lshlrev_b32 v30, 16, v222
    v_lshlrev_b32 v32, 16, v214
    v_lshlrev_b32 v34, 16, v218
    v_and_b32 v29, s8, v210
    v_and_b32 v31, s8, v221
    v_and_b32 v33, s8, v214
    v_and_b32 v35, s8, v217
    s_add_u32 s100, s100, 1
    s_sub_u32 s10, s100, 7
    s_min_u32 s100, s100, s10
    s_mul_i32 s51, s100, 64*2688
    v_pk_add_f32 v[36:37], v[28:29], v[30:31]
    buffer_load_dword v255, v249, s[16:19], s51 offen
    v_pk_add_f32 v[38:39], v[32:33], v[34:35]
    v_pk_add_f32 v[28:29], v[28:29], v[30:31] neg_lo:[0,1] neg_hi:[0,1]
    v_pk_add_f32 v[32:33], v[32:33], v[34:35] neg_lo:[0,1] neg_hi:[0,1]
    v_pk_add_f32 v[30:31], v[36:37], v[38:39]
    v_pk_add_f32 v[34:35], v[28:29], v[32:33]
    v_pk_add_f32 v[36:37], v[36:37], v[38:39] neg_lo:[0,1] neg_hi:[0,1]
    v_pk_add_f32 v[28:29], v[28:29], v[32:33] neg_lo:[0,1] neg_hi:[0,1]
    v_cvt_pk_bf16_f32 v194, v30, v31
    v_cvt_pk_bf16_f32 v198, v34, v35
    buffer_load_dword v255, v6, s[20:23], 0 offen
    v_cvt_pk_bf16_f32 v202, v36, v37
    v_cvt_pk_bf16_f32 v206, v28, v29
    v_lshlrev_b32 v28, 16, v211
    v_lshlrev_b32 v30, 16, v221
    v_lshlrev_b32 v32, 16, v215
    v_lshlrev_b32 v34, 16, v217
    v_and_b32 v29, s8, v211
    v_and_b32 v31, s8, v220
    v_and_b32 v33, s8, v215
    v_and_b32 v35, s8, v216
    v_and_b32 v251, 56, v1
    s_mov_b32 s51, 5259264
    v_pk_add_f32 v[36:37], v[28:29], v[30:31]
    buffer_load_dword v251, v251, s[20:23], s51 offen
    v_pk_add_f32 v[38:39], v[32:33], v[34:35]
    v_pk_add_f32 v[28:29], v[28:29], v[30:31] neg_lo:[0,1] neg_hi:[0,1]
    v_pk_add_f32 v[32:33], v[32:33], v[34:35] neg_lo:[0,1] neg_hi:[0,1]
    v_pk_add_f32 v[30:31], v[36:37], v[38:39]
    v_pk_add_f32 v[34:35], v[28:29], v[32:33]
    v_pk_add_f32 v[36:37], v[36:37], v[38:39] neg_lo:[0,1] neg_hi:[0,1]
    v_pk_add_f32 v[28:29], v[28:29], v[32:33] neg_lo:[0,1] neg_hi:[0,1]
    v_cvt_pk_bf16_f32 v195, v30, v31
    v_cvt_pk_bf16_f32 v199, v34, v35
    v_cvt_pk_bf16_f32 v203, v36, v37
    v_cvt_pk_bf16_f32 v207, v28, v29
    ds_write_b128 v9, v[192:195] offset:0
    v_cvt_pk_bf16_f32 v163, v230, v231
    v_cvt_pk_bf16_f32 v179, v226, v227
    v_pk_fma_f32 v[230:231], v[16:17], v[228:229], v[230:231] op_sel_hi:[0,1,1] neg_lo:[0,0,1] neg_hi:[0,0,1]
    v_pk_fma_f32 v[226:227], v[16:17], v[224:225], v[226:227] op_sel_hi:[0,1,1] neg_lo:[0,0,1] neg_hi:[0,0,1]
    ds_write_b128 v9, v[196:199] offset:8192
    v_cvt_pk_bf16_f32 v164, v228, v229
    v_cvt_pk_bf16_f32 v180, v224, v225
    v_pk_fma_f32 v[228:229], v[16:17], v[230:231], v[228:229] op_sel_hi:[0,1,1] neg_lo:[0,0,1] neg_hi:[0,0,1]
    v_pk_fma_f32 v[224:225], v[16:17], v[226:227], v[224:225] op_sel_hi:[0,1,1] neg_lo:[0,0,1] neg_hi:[0,0,1]
    ds_write_b128 v9, v[200:203] offset:16384
    v_cvt_pk_bf16_f32 v165, v230, v231
    v_cvt_pk_bf16_f32 v181, v226, v227
    v_pk_fma_f32 v[230:231], v[16:17], v[228:229], v[230:231] op_sel_hi:[0,1,1] neg_lo:[0,0,1] neg_hi:[0,0,1]
    v_pk_fma_f32 v[226:227], v[16:17], v[224:225], v[226:227] op_sel_hi:[0,1,1] neg_lo:[0,0,1] neg_hi:[0,0,1]
    ds_write_b128 v9, v[204:207] offset:24576
    v_cvt_pk_bf16_f32 v166, v228, v229
    v_cvt_pk_bf16_f32 v182, v224, v225
    v_pk_fma_f32 v[228:229], v[16:17], v[230:231], v[228:229] op_sel_hi:[0,1,1] neg_lo:[0,0,1] neg_hi:[0,0,1]
    v_pk_fma_f32 v[224:225], v[16:17], v[226:227], v[224:225] op_sel_hi:[0,1,1] neg_lo:[0,0,1] neg_hi:[0,0,1]
    v_cvt_pk_bf16_f32 v167, v230, v231
    v_cvt_pk_bf16_f32 v183, v226, v227
    v_pk_fma_f32 v[230:231], v[16:17], v[228:229], v[230:231] op_sel_hi:[0,1,1] neg_lo:[0,0,1] neg_hi:[0,0,1]
    v_pk_fma_f32 v[226:227], v[16:17], v[224:225], v[226:227] op_sel_hi:[0,1,1] neg_lo:[0,0,1] neg_hi:[0,0,1]
    v_cvt_pk_bf16_f32 v168, v228, v229
    v_cvt_pk_bf16_f32 v184, v224, v225
    v_pk_fma_f32 v[228:229], v[16:17], v[230:231], v[228:229] op_sel_hi:[0,1,1] neg_lo:[0,0,1] neg_hi:[0,0,1]
    v_pk_fma_f32 v[224:225], v[16:17], v[226:227], v[224:225] op_sel_hi:[0,1,1] neg_lo:[0,0,1] neg_hi:[0,0,1]
    s_waitcnt lgkmcnt(0)
    s_barrier
    buffer_store_dword v250, off, s[20:23], s37
    ds_read_b128 a[0:3], v60 offset:0
    v_cvt_pk_bf16_f32 v169, v230, v231
    v_cvt_pk_bf16_f32 v185, v226, v227
    ds_read_b128 a[16:19], v60 offset:4096
    v_pk_fma_f32 v[230:231], v[16:17], v[228:229], v[230:231] op_sel_hi:[0,1,1] neg_lo:[0,0,1] neg_hi:[0,0,1]
    v_pk_fma_f32 v[226:227], v[16:17], v[224:225], v[226:227] op_sel_hi:[0,1,1] neg_lo:[0,0,1] neg_hi:[0,0,1]
    ds_read_b128 a[32:35], v60 offset:8192
    v_cvt_pk_bf16_f32 v170, v228, v229
    v_cvt_pk_bf16_f32 v186, v224, v225
    ds_read_b128 a[48:51], v60 offset:12288
    v_pk_fma_f32 v[228:229], v[16:17], v[230:231], v[228:229] op_sel_hi:[0,1,1] neg_lo:[0,0,1] neg_hi:[0,0,1]
    v_pk_fma_f32 v[224:225], v[16:17], v[226:227], v[224:225] op_sel_hi:[0,1,1] neg_lo:[0,0,1] neg_hi:[0,0,1]
    ds_read_b128 a[4:7], v61 offset:256
    v_cvt_pk_bf16_f32 v171, v230, v231
    v_cvt_pk_bf16_f32 v187, v226, v227
    ds_read_b128 a[20:23], v61 offset:4352
    v_pk_fma_f32 v[230:231], v[16:17], v[228:229], v[230:231] op_sel_hi:[0,1,1] neg_lo:[0,0,1] neg_hi:[0,0,1]
    v_pk_fma_f32 v[226:227], v[16:17], v[224:225], v[226:227] op_sel_hi:[0,1,1] neg_lo:[0,0,1] neg_hi:[0,0,1]
    ds_read_b128 a[36:39], v61 offset:8448
    v_cvt_pk_bf16_f32 v172, v228, v229
    v_cvt_pk_bf16_f32 v188, v224, v225
    ds_read_b128 a[52:55], v61 offset:12544
    v_pk_fma_f32 v[228:229], v[16:17], v[230:231], v[228:229] op_sel_hi:[0,1,1] neg_lo:[0,0,1] neg_hi:[0,0,1]
    v_pk_fma_f32 v[224:225], v[16:17], v[226:227], v[224:225] op_sel_hi:[0,1,1] neg_lo:[0,0,1] neg_hi:[0,0,1]
    v_cvt_pk_bf16_f32 v173, v230, v231
    v_cvt_pk_bf16_f32 v189, v226, v227
    v_pk_fma_f32 v[230:231], v[16:17], v[228:229], v[230:231] op_sel_hi:[0,1,1] neg_lo:[0,0,1] neg_hi:[0,0,1]
    v_pk_fma_f32 v[226:227], v[16:17], v[224:225], v[226:227] op_sel_hi:[0,1,1] neg_lo:[0,0,1] neg_hi:[0,0,1]
    v_cvt_pk_bf16_f32 v174, v228, v229
    v_cvt_pk_bf16_f32 v190, v224, v225
    v_cvt_pk_bf16_f32 v175, v230, v231
    v_cvt_pk_bf16_f32 v191, v226, v227
    ds_read_b128 a[8:11], v62 offset:512
    v_lshlrev_b32 v232, 8, v252
    s_waitcnt lgkmcnt(8)
    v_mfma_f32_16x16x32_bf16 v[192:195], a[0:3], v[64:67], 0
    ds_read_b128 a[24:27], v62 offset:4608
    v_add_u32 v232, s46, v232
    s_waitcnt lgkmcnt(8)
    v_mfma_f32_16x16x32_bf16 v[196:199], a[16:19], v[64:67], 0
    ds_read_b128 a[40:43], v62 offset:8704
    v_cvt_f32_u32 v232, v232
    s_waitcnt lgkmcnt(8)
    v_mfma_f32_16x16x32_bf16 v[200:203], a[32:35], v[80:83], 0
    ds_read_b128 a[56:59], v62 offset:12800
    v_cvt_f32_u32 v233, v253
    s_waitcnt lgkmcnt(8)
    v_mfma_f32_16x16x32_bf16 v[204:207], a[48:51], v[80:83], 0
    ds_read_b128 a[12:15], v63 offset:768
    v_mul_f32 v233, 0x3a000000, v233
    s_waitcnt lgkmcnt(8)
    v_mfma_f32_16x16x32_bf16 v[192:195], a[4:7], v[68:71], v[192:195]
L_padB1:
    s_cbranch_execz L_B
    ds_read_b128 a[28:31], v63 offset:4864
    v_and_b32 v234, 1, v253
    s_waitcnt lgkmcnt(8)
    v_mfma_f32_16x16x32_bf16 v[196:199], a[20:23], v[68:71], v[196:199]
    ds_read_b128 a[44:47], v63 offset:8960
    v_mul_u32_u24 v234, 0x8000, v234
    s_waitcnt lgkmcnt(8)
    v_mfma_f32_16x16x32_bf16 v[200:203], a[36:39], v[84:87], v[200:203]
    ds_read_b128 a[60:63], v63 offset:13056
    v_lshl_or_b32 v234, v234, 16, v234
    s_waitcnt lgkmcnt(8)
    v_mfma_f32_16x16x32_bf16 v[204:207], a[52:55], v[84:87], v[204:207]
    ds_read_b128 a[64:67], v60 offset:16384
    s_mov_b32 s9, 0x80008000
    s_waitcnt lgkmcnt(8)
    v_mfma_f32_16x16x32_bf16 v[192:195], a[8:11], v[72:75], v[192:195]
    ds_read_b128 a[80:83], v60 offset:20480
    v_xor_b32 v235, s9, v234
    s_waitcnt lgkmcnt(8)
    v_mfma_f32_16x16x32_bf16 v[196:199], a[24:27], v[72:75], v[196:199]
    ds_read_b128 a[96:99], v60 offset:24576
    v_mul_f32 v236, v232, v233
    s_waitcnt lgkmcnt(8)
    v_mfma_f32_16x16x32_bf16 v[200:203], a[40:43], v[88:91], v[200:203]
    ds_read_b128 a[112:115], v60 offset:28672
    v_fmamk_f32 v237, v233, 0x42800000, v236
    s_waitcnt lgkmcnt(8)
    v_mfma_f32_16x16x32_bf16 v[204:207], a[56:59], v[88:91], v[204:207]
    ds_read_b128 a[68:71], v61 offset:16640
    v_fmamk_f32 v238, v233, 0x43000000, v236
    s_waitcnt lgkmcnt(8)
    v_mfma_f32_16x16x32_bf16 v[192:195], a[12:15], v[76:79], v[192:195]
    ds_read_b128 a[84:87], v61 offset:20736
    v_fmamk_f32 v239, v233, 0x43400000, v236
    s_waitcnt lgkmcnt(8)
    v_mfma_f32_16x16x32_bf16 v[196:199], a[28:31], v[76:79], v[196:199]
    ds_read_b128 a[100:103], v61 offset:24832
    v_cos_f32 v240, v236
    s_waitcnt lgkmcnt(8)
    v_mfma_f32_16x16x32_bf16 v[200:203], a[44:47], v[92:95], v[200:203]
    ds_read_b128 a[116:119], v61 offset:28928
    v_cos_f32 v241, v237
    s_waitcnt lgkmcnt(8)
    v_mfma_f32_16x16x32_bf16 v[204:207], a[60:63], v[92:95], v[204:207]
    ds_read_b128 a[72:75], v62 offset:16896
    v_cos_f32 v242, v238
    s_waitcnt lgkmcnt(8)
    v_mfma_f32_16x16x32_bf16 v[208:211], a[64:67], v[96:99], 0
    ds_read_b128 a[88:91], v62 offset:20992
    v_cos_f32 v243, v239
    s_waitcnt lgkmcnt(8)
    v_mfma_f32_16x16x32_bf16 v[212:215], a[80:83], v[96:99], 0
    ds_read_b128 a[104:107], v62 offset:25088
    v_sin_f32 v244, v236
    s_waitcnt lgkmcnt(8)
    v_mfma_f32_16x16x32_bf16 v[216:219], a[96:99], v[112:115], 0
    ds_read_b128 a[120:123], v62 offset:29184
    v_sin_f32 v245, v237
    s_waitcnt lgkmcnt(8)
    v_mfma_f32_16x16x32_bf16 v[220:223], a[112:115], v[112:115], 0
    ds_read_b128 a[76:79], v63 offset:17152
    v_sin_f32 v246, v238
    s_waitcnt lgkmcnt(8)
    v_mfma_f32_16x16x32_bf16 v[208:211], a[68:71], v[100:103], v[208:211]
    ds_read_b128 a[92:95], v63 offset:21248
    v_sin_f32 v247, v239
    s_waitcnt lgkmcnt(8)
    v_mfma_f32_16x16x32_bf16 v[212:215], a[84:87], v[100:103], v[212:215]
    ds_read_b128 a[108:111], v63 offset:25344
    v_cvt_pk_bf16_f32 v44, v240, v241
    s_waitcnt lgkmcnt(8)
    v_mfma_f32_16x16x32_bf16 v[216:219], a[100:103], v[116:119], v[216:219]
    ds_read_b128 a[124:127], v63 offset:29440
    v_cvt_pk_bf16_f32 v52, v244, v245
    s_waitcnt lgkmcnt(8)
    v_mfma_f32_16x16x32_bf16 v[220:223], a[116:119], v[116:119], v[220:223]
    v_cvt_pk_bf16_f32 v28, v192, v193
    v_cvt_pk_bf16_f32 v45, v242, v243
    s_waitcnt lgkmcnt(7)
    v_mfma_f32_16x16x32_bf16 v[208:211], a[72:75], v[104:107], v[208:211]
    v_cvt_pk_bf16_f32 v29, v194, v195
    v_cvt_pk_bf16_f32 v53, v246, v247
    s_waitcnt lgkmcnt(6)
    v_mfma_f32_16x16x32_bf16 v[212:215], a[88:91], v[104:107], v[212:215]
    v_cvt_pk_bf16_f32 v30, v196, v197
    v_xor_b32 v46, v234, v44
    s_waitcnt lgkmcnt(5)
    v_mfma_f32_16x16x32_bf16 v[216:219], a[104:107], v[120:123], v[216:219]
    v_cvt_pk_bf16_f32 v31, v198, v199
    v_xor_b32 v54, v234, v52
    s_waitcnt lgkmcnt(4)
    v_mfma_f32_16x16x32_bf16 v[220:223], a[120:123], v[120:123], v[220:223]
    v_cvt_pk_bf16_f32 v32, v200, v201
    v_xor_b32 v20, s9, v52
    s_waitcnt lgkmcnt(3)
    v_mfma_f32_16x16x32_bf16 v[208:211], a[76:79], v[108:111], v[208:211]
    v_cvt_pk_bf16_f32 v33, v202, v203
    v_xor_b32 v22, v235, v52
    s_waitcnt lgkmcnt(2)
    v_mfma_f32_16x16x32_bf16 v[212:215], a[92:95], v[108:111], v[212:215]
    v_cvt_pk_bf16_f32 v34, v204, v205
    v_xor_b32 v47, v234, v45
    s_waitcnt lgkmcnt(1)
    v_mfma_f32_16x16x32_bf16 v[216:219], a[108:111], v[124:127], v[216:219]
    v_cvt_pk_bf16_f32 v35, v206, v207
    v_xor_b32 v55, v234, v53
    s_waitcnt lgkmcnt(0)
    v_mfma_f32_16x16x32_bf16 v[220:223], a[124:127], v[124:127], v[220:223]
    v_xor_b32 v21, s9, v53
    v_xor_b32 v23, v235, v53
    v_mfma_f32_16x16x32_bf16 v[192:195], a[0:3], v[128:131], 0
    v_add_f32 v233, 0x3c000000, v233
    v_mul_f32 v236, v232, v233
    v_mfma_f32_16x16x32_bf16 v[196:199], a[16:19], v[128:131], 0
    v_fmamk_f32 v237, v233, 0x42800000, v236
    v_fmamk_f32 v238, v233, 0x43000000, v236
    v_mfma_f32_16x16x32_bf16 v[200:203], a[32:35], v[144:147], 0
    v_fmamk_f32 v239, v233, 0x43400000, v236
    v_cos_f32 v240, v236
    v_mfma_f32_16x16x32_bf16 v[204:207], a[48:51], v[144:147], 0
    v_cos_f32 v241, v237
    v_cos_f32 v242, v238
    v_mfma_f32_16x16x32_bf16 v[192:195], a[4:7], v[132:135], v[192:195]
    v_cos_f32 v243, v239
    v_sin_f32 v244, v236
    v_mfma_f32_16x16x32_bf16 v[196:199], a[20:23], v[132:135], v[196:199]
    v_sin_f32 v245, v237
    v_sin_f32 v246, v238
    v_mfma_f32_16x16x32_bf16 v[200:203], a[36:39], v[148:151], v[200:203]
    v_sin_f32 v247, v239
    v_cvt_pk_bf16_f32 v48, v240, v241
    v_mfma_f32_16x16x32_bf16 v[204:207], a[52:55], v[148:151], v[204:207]
    v_cvt_pk_bf16_f32 v56, v244, v245
    v_cvt_pk_bf16_f32 v49, v242, v243
    v_mfma_f32_16x16x32_bf16 v[192:195], a[8:11], v[136:139], v[192:195]
    v_cvt_pk_bf16_f32 v57, v246, v247
    v_xor_b32 v50, v234, v48
    v_mfma_f32_16x16x32_bf16 v[196:199], a[24:27], v[136:139], v[196:199]
    v_xor_b32 v58, v234, v56
    v_xor_b32 v24, s9, v56
    v_mfma_f32_16x16x32_bf16 v[200:203], a[40:43], v[152:155], v[200:203]
    v_xor_b32 v26, v235, v56
    v_xor_b32 v51, v234, v49
    v_mfma_f32_16x16x32_bf16 v[204:207], a[56:59], v[152:155], v[204:207]
    v_xor_b32 v59, v234, v57
    v_xor_b32 v25, s9, v57
    v_mfma_f32_16x16x32_bf16 v[192:195], a[12:15], v[140:143], v[192:195]
    v_xor_b32 v27, v235, v57
    v_cvt_pk_bf16_f32 v36, v208, v209
    v_mfma_f32_16x16x32_bf16 v[196:199], a[28:31], v[140:143], v[196:199]
    v_cvt_pk_bf16_f32 v37, v210, v211
    v_cvt_pk_bf16_f32 v38, v212, v213
    v_mfma_f32_16x16x32_bf16 v[200:203], a[44:47], v[156:159], v[200:203]
    v_cvt_pk_bf16_f32 v39, v214, v215
    v_cvt_pk_bf16_f32 v40, v216, v217
    v_mfma_f32_16x16x32_bf16 v[204:207], a[60:63], v[156:159], v[204:207]
    v_cvt_pk_bf16_f32 v41, v218, v219
    v_cvt_pk_bf16_f32 v42, v220, v221
    v_cvt_pk_bf16_f32 v43, v222, v223
    buffer_load_dword v255, v19, s[20:23], 0 offen sc1
    s_mul_i32 s6, s3, 4608
    v_mfma_f32_16x16x32_bf16 v[64:67], v[28:31], v[44:47], 0
    s_add_u32 s6, s6, 32768
    v_mul_u32_u24 v2, 144, v253
    v_mfma_f32_16x16x32_bf16 v[68:71], v[28:31], v[52:55], 0
    v_lshl_add_u32 v2, v252, 5, v2
    v_add_u32 v10, s6, v2
    v_mfma_f32_16x16x32_bf16 v[64:67], v[32:35], v[20:23], v[64:67]
    v_lshrrev_b32 v2, 3, v1
    v_and_b32 v3, 7, v1
    v_mfma_f32_16x16x32_bf16 v[68:71], v[32:35], v[44:47], v[68:71]
    v_mul_u32_u24 v4, 144, v2
    v_lshl_add_u32 v4, v3, 4, v4
    v_mfma_f32_16x16x32_bf16 v[72:75], v[28:31], v[48:51], 0
    v_add_u32 v15, s6, v4
    v_mul_u32_u24 v2, 65664, v2
    v_mfma_f32_16x16x32_bf16 v[76:79], v[28:31], v[56:59], 0
    v_lshl_add_u32 v2, v3, 4, v2
    s_lshl_b32 s7, s3, 7
    v_mfma_f32_16x16x32_bf16 v[72:75], v[32:35], v[24:27], v[72:75]
    s_add_u32 s7, s7, s46
    s_lshl_b32 s6, s7, 7
    v_mfma_f32_16x16x32_bf16 v[76:79], v[32:35], v[48:51], v[76:79]
    s_add_u32 s6, s6, 2097152
    v_add_u32 v18, s6, v2
    v_mfma_f32_16x16x32_bf16 v[80:83], v[36:39], v[44:47], 0
    v_mfma_f32_16x16x32_bf16 v[84:87], v[36:39], v[52:55], 0
    v_mfma_f32_16x16x32_bf16 v[80:83], v[40:43], v[20:23], v[80:83]
    v_mfma_f32_16x16x32_bf16 v[84:87], v[40:43], v[44:47], v[84:87]
    v_mfma_f32_16x16x32_bf16 v[88:91], v[36:39], v[48:51], 0
    v_mfma_f32_16x16x32_bf16 v[92:95], v[36:39], v[56:59], 0
    v_mfma_f32_16x16x32_bf16 v[88:91], v[40:43], v[24:27], v[88:91]
    v_mfma_f32_16x16x32_bf16 v[92:95], v[40:43], v[48:51], v[92:95]
    v_cvt_pk_bf16_f32 v28, v192, v193
    v_cvt_pk_bf16_f32 v29, v194, v195
    v_mfma_f32_16x16x32_bf16 v[208:211], a[64:67], v[160:163], 0
    v_cvt_pk_bf16_f32 v30, v196, v197
    v_cvt_pk_bf16_f32 v31, v198, v199
    v_mfma_f32_16x16x32_bf16 v[212:215], a[80:83], v[160:163], 0
    v_cvt_pk_bf16_f32 v32, v200, v201
    v_cvt_pk_bf16_f32 v33, v202, v203
    v_mfma_f32_16x16x32_bf16 v[216:219], a[96:99], v[176:179], 0
    v_cvt_pk_bf16_f32 v34, v204, v205
    v_cvt_pk_bf16_f32 v35, v206, v207
    v_mfma_f32_16x16x32_bf16 v[220:223], a[112:115], v[176:179], 0
    v_cvt_pk_bf16_f32 v96, v64, v80
    v_cvt_pk_bf16_f32 v97, v65, v81
    v_mfma_f32_16x16x32_bf16 v[208:211], a[68:71], v[164:167], v[208:211]
    v_cvt_pk_bf16_f32 v98, v68, v84
    v_cvt_pk_bf16_f32 v99, v69, v85
    v_mfma_f32_16x16x32_bf16 v[212:215], a[84:87], v[164:167], v[212:215]
    ds_write_b128 v10, v[96:99] offset:0
    v_cvt_pk_bf16_f32 v100, v66, v82
    v_mfma_f32_16x16x32_bf16 v[216:219], a[100:103], v[180:183], v[216:219]
    v_cvt_pk_bf16_f32 v101, v67, v83
    v_cvt_pk_bf16_f32 v102, v70, v86
    v_mfma_f32_16x16x32_bf16 v[220:223], a[116:119], v[180:183], v[220:223]
    v_cvt_pk_bf16_f32 v103, v71, v87
    ds_write_b128 v10, v[100:103] offset:16
    v_mfma_f32_16x16x32_bf16 v[208:211], a[72:75], v[168:171], v[208:211]
    v_cvt_pk_bf16_f32 v104, v72, v88
    v_cvt_pk_bf16_f32 v105, v73, v89
    v_mfma_f32_16x16x32_bf16 v[212:215], a[88:91], v[168:171], v[212:215]
    v_cvt_pk_bf16_f32 v106, v76, v92
    v_cvt_pk_bf16_f32 v107, v77, v93
    v_mfma_f32_16x16x32_bf16 v[216:219], a[104:107], v[184:187], v[216:219]
    ds_write_b128 v10, v[104:107] offset:2304
    v_cvt_pk_bf16_f32 v108, v74, v90
    v_mfma_f32_16x16x32_bf16 v[220:223], a[120:123], v[184:187], v[220:223]
    v_cvt_pk_bf16_f32 v109, v75, v91
    v_cvt_pk_bf16_f32 v110, v78, v94
    v_mfma_f32_16x16x32_bf16 v[208:211], a[76:79], v[172:175], v[208:211]
    v_cvt_pk_bf16_f32 v111, v79, v95
    ds_write_b128 v10, v[108:111] offset:2320
    v_mfma_f32_16x16x32_bf16 v[212:215], a[92:95], v[172:175], v[212:215]
    ds_read_b128 v[112:115], v15 offset:0
    ds_read_b128 v[116:119], v15 offset:1152
    v_mfma_f32_16x16x32_bf16 v[216:219], a[108:111], v[188:191], v[216:219]
    ds_read_b128 v[120:123], v15 offset:2304
    ds_read_b128 v[124:127], v15 offset:3456
    v_mfma_f32_16x16x32_bf16 v[220:223], a[124:127], v[188:191], v[220:223]
    s_mov_b32 s6, 0
    s_waitcnt lgkmcnt(3)
    buffer_store_dwordx4 v[112:115], v18, s[20:23], s6 offen sc1
    v_mfma_f32_16x16x32_bf16 v[64:67], v[28:31], v[44:47], 0
    s_mov_b32 s6, 525312
    s_waitcnt lgkmcnt(2)
    buffer_store_dwordx4 v[116:119], v18, s[20:23], s6 offen sc1
    v_mfma_f32_16x16x32_bf16 v[68:71], v[28:31], v[52:55], 0
    v_mfma_f32_16x16x32_bf16 v[64:67], v[32:35], v[20:23], v[64:67]
    v_mfma_f32_16x16x32_bf16 v[68:71], v[32:35], v[44:47], v[68:71]
    v_cvt_pk_bf16_f32 v36, v208, v209
    v_cvt_pk_bf16_f32 v37, v210, v211
    v_mfma_f32_16x16x32_bf16 v[72:75], v[28:31], v[48:51], 0
    v_cvt_pk_bf16_f32 v38, v212, v213
    v_cvt_pk_bf16_f32 v39, v214, v215
    v_mfma_f32_16x16x32_bf16 v[76:79], v[28:31], v[56:59], 0
    v_cvt_pk_bf16_f32 v40, v216, v217
    v_cvt_pk_bf16_f32 v41, v218, v219
    v_mfma_f32_16x16x32_bf16 v[72:75], v[32:35], v[24:27], v[72:75]
    v_cvt_pk_bf16_f32 v42, v220, v221
    v_cvt_pk_bf16_f32 v43, v222, v223
    v_mfma_f32_16x16x32_bf16 v[76:79], v[32:35], v[48:51], v[76:79]
    v_mfma_f32_16x16x32_bf16 v[80:83], v[36:39], v[44:47], 0
    s_mov_b32 s6, 1050624
    s_waitcnt lgkmcnt(1)
    buffer_store_dwordx4 v[120:123], v18, s[20:23], s6 offen sc1
    v_mfma_f32_16x16x32_bf16 v[84:87], v[36:39], v[52:55], 0
    s_mov_b32 s6, 1575936
    s_waitcnt lgkmcnt(0)
    buffer_store_dwordx4 v[124:127], v18, s[20:23], s6 offen sc1
    v_mfma_f32_16x16x32_bf16 v[80:83], v[40:43], v[20:23], v[80:83]
    v_mfma_f32_16x16x32_bf16 v[84:87], v[40:43], v[44:47], v[84:87]
    v_mfma_f32_16x16x32_bf16 v[88:91], v[36:39], v[48:51], 0
    v_mfma_f32_16x16x32_bf16 v[92:95], v[36:39], v[56:59], 0
    v_mfma_f32_16x16x32_bf16 v[88:91], v[40:43], v[24:27], v[88:91]
    v_mfma_f32_16x16x32_bf16 v[92:95], v[40:43], v[48:51], v[92:95]
    s_nop 2
    v_cvt_pk_bf16_f32 v96, v64, v80
    v_cvt_pk_bf16_f32 v97, v65, v81
    v_cvt_pk_bf16_f32 v98, v68, v84
    v_cvt_pk_bf16_f32 v99, v69, v85
    ds_write_b128 v10, v[96:99] offset:0
    v_cvt_pk_bf16_f32 v100, v66, v82
    v_cvt_pk_bf16_f32 v101, v67, v83
    v_cvt_pk_bf16_f32 v102, v70, v86
    v_cvt_pk_bf16_f32 v103, v71, v87
    ds_write_b128 v10, v[100:103] offset:16
    ds_read_b128 v[112:115], v15 offset:0
    ds_read_b128 v[116:119], v15 offset:1152
    v_cvt_pk_bf16_f32 v104, v72, v88
    v_cvt_pk_bf16_f32 v105, v73, v89
    v_cvt_pk_bf16_f32 v106, v76, v92
    v_cvt_pk_bf16_f32 v107, v77, v93
    ds_write_b128 v10, v[104:107] offset:2304
    v_cvt_pk_bf16_f32 v108, v74, v90
    v_cvt_pk_bf16_f32 v109, v75, v91
    v_cvt_pk_bf16_f32 v110, v78, v94
    v_cvt_pk_bf16_f32 v111, v79, v95
    ds_write_b128 v10, v[108:111] offset:2320
    ds_read_b128 v[120:123], v15 offset:2304
    ds_read_b128 v[124:127], v15 offset:3456
    s_mov_b32 s6, 8192
    s_waitcnt lgkmcnt(5)
    buffer_store_dwordx4 v[112:115], v18, s[20:23], s6 offen sc1
    s_mov_b32 s6, 533504
    s_waitcnt lgkmcnt(4)
    buffer_store_dwordx4 v[116:119], v18, s[20:23], s6 offen sc1
    s_mov_b32 s6, 1058816
    s_waitcnt lgkmcnt(1)
    buffer_store_dwordx4 v[120:123], v18, s[20:23], s6 offen sc1
    s_mov_b32 s6, 1584128
    s_waitcnt lgkmcnt(0)
    buffer_store_dwordx4 v[124:127], v18, s[20:23], s6 offen sc1
    s_cmp_ge_u32 s40, 28
    s_cbranch_scc1 L_B2
    s_mov_b32 s22, 0x1000000
    s_mov_b32 s23, 0x20000
    s_mov_b32 s26, 0x62000
    s_mov_b32 s27, 0x20000
    s_mov_b32 s30, 0x380000
    s_mov_b32 s31, 0x20000
    s_mul_i32 s6, s40, 37
    s_lshr_b32 s6, s6, 8
    s_mul_i32 s7, s6, 7
    s_sub_u32 s41, s40, s7
    s_lshr_b32 s7, s57, 3
    s_add_u32 s41, s41, s7
    s_sub_u32 s7, s41, 7
    s_min_u32 s41, s41, s7
    s_lshl_b32 s6, s6, 2
    s_add_u32 s6, s6, s3
    v_bfe_u32 v32, v1, 1, 1
    v_lshl_add_u32 v32, s6, 1, v32
    v_mul_u32_u24 v33, 47, v32
    v_lshrrev_b32 v33, 9, v33
    v_mul_u32_u24 v34, 11, v33
    v_sub_u32 v32, v32, v34
    v_add_u32 v32, 3, v32
    v_and_b32 v32, 8, v32
    v_lshl_add_u32 v32, v33, 10, v32
    v_and_b32 v33, 1, v1
    v_lshl_add_u32 v32, v33, 2, v32
    v_bfe_u32 v33, v1, 2, 3
    v_lshl_add_u32 v32, v33, 7, v32
    s_mul_i32 s7, s57, 17920
    s_add_u32 s7, s7, 6429696
    v_add_u32 v246, s7, v32
    s_and_b32 s7, s2, 6
    s_lshl3_add_u32 s6, s7, s6
    s_and_b32 s8, s2, 1
    s_lshl_b32 s7, s8, 6
    s_add_u32 s42, s6, s7
    v_lshrrev_b32 v32, 3, v1
    v_and_b32 v33, 6, v32
    v_and_b32 v34, 7, v1
    v_xor_b32 v33, v33, v34
    v_lshrrev_b32 v32, 3, v0
    v_mul_u32_u24 v32, 896, v32
    v_lshl_add_u32 v32, v33, 4, v32
    s_lshl_b32 s7, s41, 7
    v_add_u32 v240, s7, v32
    v_mov_b32 v34, 0
    v_mov_b32 v35, 0
    v_lshlrev_b32 v32, 3, v1
    v_add_u32 v32, 162816, v32
    ds_write_b64 v32, v[34:35]
    s_lshl_b32 s45, s3, 10
    s_add_u32 s45, s45, 105472
    v_lshrrev_b32 v32, 2, v1
    v_bfe_u32 v33, v1, 3, 2
    v_lshlrev_b32 v33, 5, v33
    v_lshl_add_u32 v33, v32, 7, v33
    v_and_b32 v34, 3, v1
    v_lshl_add_u32 v33, v34, 3, v33
    v_add_u32 v241, 105472, v33
    v_xor_b32 v242, 32, v241
    v_xor_b32 v243, 64, v241
    v_xor_b32 v244, 96, v241
    s_lshl_b32 s9, s42, 14
    v_lshl_add_u32 v245, v1, 4, s9
    s_lshl_b32 s6, s6, 5
    s_add_u32 s6, s6, s8
    s_mul_i32 s6, s6, 1792
    s_add_u32 s6, s6, s7
    v_mul_u32_u24 v32, 3584, v253
    v_and_b32 v33, 1, v252
    v_lshl_add_u32 v32, v33, 5, v32
    v_lshrrev_b32 v33, 1, v252
    v_lshl_add_u32 v32, v33, 4, v32
    v_add_u32 v247, s6, v32
    v_mov_b32 v248, 0x40000000
    s_waitcnt vmcnt(0)
    s_cmp_eq_u32 s3, 0
    s_cselect_b32 s6, 0, 0x40000000
    s_mov_b64 exec, 1
    s_barrier
    buffer_store_dword v250, v19, s[20:23], s6 offen sc1
    s_mov_b64 exec, -1
    buffer_load_dword v255, v5, s[20:23], 0 offen
    s_add_u32 m0, s45, 0
    s_mov_b32 s6, 0
    buffer_load_dwordx4 v240, s[24:27], s6 offen lds
    s_add_u32 m0, s45, 4096
    s_mov_b32 s6, 28672
    buffer_load_dwordx4 v240, s[24:27], s6 offen lds
    s_add_u32 m0, s45, 8192
    s_mov_b32 s6, 57344
    buffer_load_dwordx4 v240, s[24:27], s6 offen lds
    s_add_u32 m0, s45, 12288
    s_mov_b32 s6, 86016
    buffer_load_dwordx4 v240, s[24:27], s6 offen lds
    s_add_u32 m0, s45, 16384
    s_mov_b32 s6, 114688
    buffer_load_dwordx4 v240, s[24:27], s6 offen lds
    s_add_u32 m0, s45, 20480
    s_mov_b32 s6, 143360
    buffer_load_dwordx4 v240, s[24:27], s6 offen lds
    s_add_u32 m0, s45, 24576
    s_mov_b32 s6, 172032
    buffer_load_dwordx4 v240, s[24:27], s6 offen lds
    s_add_u32 m0, s45, 28672
    s_mov_b32 s6, 200704
    buffer_load_dwordx4 v240, s[24:27], s6 offen lds
    s_add_u32 m0, s45, 32768
    s_mov_b32 s6, 229376
    buffer_load_dwordx4 v240, s[24:27], s6 offen lds
    s_add_u32 m0, s45, 36864
    s_mov_b32 s6, 258048
    buffer_load_dwordx4 v240, s[24:27], s6 offen lds
    s_add_u32 m0, s45, 40960
    s_mov_b32 s6, 286720
    buffer_load_dwordx4 v240, s[24:27], s6 offen lds
    s_add_u32 m0, s45, 45056
    s_mov_b32 s6, 315392
    buffer_load_dwordx4 v240, s[24:27], s6 offen lds
    s_add_u32 m0, s45, 49152
    s_mov_b32 s6, 344064
    buffer_load_dwordx4 v240, s[24:27], s6 offen lds
    s_add_u32 m0, s45, 53248
    s_mov_b32 s6, 372736
    buffer_load_dwordx4 v240, s[24:27], s6 offen lds
    s_mov_b32 s10, 40
L_plN:
    buffer_load_dword v32, v7, s[20:23], 0 offen sc1
    s_sub_u32 s10, s10, 1
    s_cbranch_scc1 L_pdN
    s_waitcnt vmcnt(0)
    v_cmp_ne_u32 vcc, v32, v250
    s_nop 0
    s_and_b64 exec, exec, vcc
    s_cbranch_scc1 L_plN
L_pdN:
    s_or_b32 s43, exec_lo, exec_hi
    s_mov_b64 exec, -1
    v_lshlrev_b32 v5, 10, v252
    v_sub_u32 v2, v241, v5
    v_sub_u32 v3, v242, v5
    v_sub_u32 v4, v243, v5
    v_sub_u32 v5, v244, v5
    s_movk_i32 s58, 4096
    s_movk_i32 s59, 8192
    s_movk_i32 s60, 12288
    s_mov_b32 s11, 0
    s_waitcnt vmcnt(0) lgkmcnt(0)
    s_barrier
    s_branch L_P2
.p2align 12
L_B2:
    buffer_load_dword v21, v7, s[20:23], 0 offen sc1
    s_mov_b32 s30, 0x380000
    s_mov_b32 s31, 0x20000
    s_lshr_b32 s6, s57, 1
    s_add_u32 s48, s6, s40
    s_sub_u32 s48, s48, 28
    v_cvt_f32_u32 v12, v253
    v_mul_f32 v12, 0x3c800000, v12
    v_lshlrev_b32 v13, 2, v252
    v_cvt_f32_u32 v13, v13
    v_mul_f32 v13, v13, v12
    v_fmamk_f32 v32, v12, 0x00000000, v13
    v_fmamk_f32 v33, v12, 0x3f800000, v13
    v_fmamk_f32 v34, v12, 0x40000000, v13
    v_fmamk_f32 v35, v12, 0x40400000, v13
    v_fmamk_f32 v36, v12, 0x41800000, v13
    v_fmamk_f32 v37, v12, 0x41880000, v13
    v_fmamk_f32 v38, v12, 0x41900000, v13
    v_fmamk_f32 v39, v12, 0x41980000, v13
    v_cos_f32 v40, v32
    v_cos_f32 v41, v33
    v_cos_f32 v42, v34
    v_cos_f32 v43, v35
    v_cos_f32 v44, v36
    v_cos_f32 v45, v37
    v_cos_f32 v46, v38
    v_cos_f32 v47, v39
    v_sin_f32 v48, v32
    v_sin_f32 v49, v33
    v_sin_f32 v50, v34
    v_sin_f32 v51, v35
    v_sin_f32 v52, v36
    v_sin_f32 v53, v37
    v_sin_f32 v54, v38
    v_sin_f32 v55, v39
    v_cvt_pk_bf16_f32 v128, v40, -v48
    v_cvt_pk_bf16_f32 v129, v41, -v49
    v_cvt_pk_bf16_f32 v130, v42, -v50
    v_cvt_pk_bf16_f32 v131, v43, -v51
    v_cvt_pk_bf16_f32 v132, v44, -v52
    v_cvt_pk_bf16_f32 v133, v45, -v53
    v_cvt_pk_bf16_f32 v134, v46, -v54
    v_cvt_pk_bf16_f32 v135, v47, -v55
    v_cvt_pk_bf16_f32 v144, v40, -v48
    v_cvt_pk_bf16_f32 v145, -v49, -v41
    v_cvt_pk_bf16_f32 v146, -v42, v50
    v_cvt_pk_bf16_f32 v147, v51, v43
    v_cvt_pk_bf16_f32 v148, v44, -v52
    v_cvt_pk_bf16_f32 v149, -v53, -v45
    v_cvt_pk_bf16_f32 v150, -v46, v54
    v_cvt_pk_bf16_f32 v151, v55, v47
    v_cvt_pk_bf16_f32 v160, v40, -v48
    v_cvt_pk_bf16_f32 v161, -v41, v49
    v_cvt_pk_bf16_f32 v162, v42, -v50
    v_cvt_pk_bf16_f32 v163, -v43, v51
    v_cvt_pk_bf16_f32 v164, v44, -v52
    v_cvt_pk_bf16_f32 v165, -v45, v53
    v_cvt_pk_bf16_f32 v166, v46, -v54
    v_cvt_pk_bf16_f32 v167, -v47, v55
    v_cvt_pk_bf16_f32 v176, v40, -v48
    v_cvt_pk_bf16_f32 v177, v49, v41
    v_cvt_pk_bf16_f32 v178, -v42, v50
    v_cvt_pk_bf16_f32 v179, -v51, -v43
    v_cvt_pk_bf16_f32 v180, v44, -v52
    v_cvt_pk_bf16_f32 v181, v53, v45
    v_cvt_pk_bf16_f32 v182, -v46, v54
    v_cvt_pk_bf16_f32 v183, -v55, -v47
    v_fmamk_f32 v32, v12, 0x42000000, v13
    v_fmamk_f32 v33, v12, 0x42040000, v13
    v_fmamk_f32 v34, v12, 0x42080000, v13
    v_fmamk_f32 v35, v12, 0x420c0000, v13
    v_fmamk_f32 v36, v12, 0x42400000, v13
    v_fmamk_f32 v37, v12, 0x42440000, v13
    v_fmamk_f32 v38, v12, 0x42480000, v13
    v_fmamk_f32 v39, v12, 0x424c0000, v13
    v_cos_f32 v40, v32
    v_cos_f32 v41, v33
    v_cos_f32 v42, v34
    v_cos_f32 v43, v35
    v_cos_f32 v44, v36
    v_cos_f32 v45, v37
    v_cos_f32 v46, v38
    v_cos_f32 v47, v39
    v_sin_f32 v48, v32
    v_sin_f32 v49, v33
    v_sin_f32 v50, v34
    v_sin_f32 v51, v35
    v_sin_f32 v52, v36
    v_sin_f32 v53, v37
    v_sin_f32 v54, v38
    v_sin_f32 v55, v39
    v_cvt_pk_bf16_f32 v136, v40, -v48
    v_cvt_pk_bf16_f32 v137, v41, -v49
    v_cvt_pk_bf16_f32 v138, v42, -v50
    v_cvt_pk_bf16_f32 v139, v43, -v51
    v_cvt_pk_bf16_f32 v140, v44, -v52
    v_cvt_pk_bf16_f32 v141, v45, -v53
    v_cvt_pk_bf16_f32 v142, v46, -v54
    v_cvt_pk_bf16_f32 v143, v47, -v55
    v_cvt_pk_bf16_f32 v152, v40, -v48
    v_cvt_pk_bf16_f32 v153, -v49, -v41
    v_cvt_pk_bf16_f32 v154, -v42, v50
    v_cvt_pk_bf16_f32 v155, v51, v43
    v_cvt_pk_bf16_f32 v156, v44, -v52
    v_cvt_pk_bf16_f32 v157, -v53, -v45
    v_cvt_pk_bf16_f32 v158, -v46, v54
    v_cvt_pk_bf16_f32 v159, v55, v47
    v_cvt_pk_bf16_f32 v168, v40, -v48
    v_cvt_pk_bf16_f32 v169, -v41, v49
    v_cvt_pk_bf16_f32 v170, v42, -v50
    v_cvt_pk_bf16_f32 v171, -v43, v51
    v_cvt_pk_bf16_f32 v172, v44, -v52
    v_cvt_pk_bf16_f32 v173, -v45, v53
    v_cvt_pk_bf16_f32 v174, v46, -v54
    v_cvt_pk_bf16_f32 v175, -v47, v55
    v_cvt_pk_bf16_f32 v184, v40, -v48
    v_cvt_pk_bf16_f32 v185, v49, v41
    v_cvt_pk_bf16_f32 v186, -v42, v50
    v_cvt_pk_bf16_f32 v187, -v51, -v43
    v_cvt_pk_bf16_f32 v188, v44, -v52
    v_cvt_pk_bf16_f32 v189, v53, v45
    v_cvt_pk_bf16_f32 v190, -v46, v54
    v_cvt_pk_bf16_f32 v191, -v55, -v47
    v_bfe_u32 v33, v1, 5, 1
    v_xor_b32 v33, v33, v1
    s_mul_i32 s6, s48, 65664
    s_lshl_b32 s11, s3, 13
    s_add_u32 s6, s6, s11
    s_add_u32 s6, s6, 2097152
    v_lshl_add_u32 v2, v33, 4, s6
    s_add_u32 s11, s11, 65536
    v_bfe_u32 v4, v1, 3, 1
    v_lshl_add_u32 v4, v252, 2, v4
    v_lshlrev_b32 v4, 7, v4
    v_and_b32 v32, 1, v252
    v_lshl_add_u32 v4, v32, 4, v4
    v_and_b32 v32, 3, v1
    v_lshl_add_u32 v4, v32, 5, v4
    v_bfe_u32 v33, v1, 2, 1
    v_lshl_add_u32 v4, v33, 3, v4
    v_add_u32 v4, s11, v4
    v_xor_b32 v5, 16, v4
    s_movk_i32 s61, 528
    v_mul_u32_u24 v6, 528, v253
    v_lshl_add_u32 v6, v252, 4, v6
    v_lshl_add_u32 v6, s3, 6, v6
    v_lshl_add_u32 v33, s3, 2, v252
    v_lshlrev_b32 v32, 4, v253
    v_mad_u32_u24 v8, v33, s61, v32
    v_lshl_add_u32 v9, v33, 5, s48
    v_sub_u32 v10, 2048, v9
    v_and_b32 v11, 2047, v10
    v_subrev_u32 v10, 1536, v10
    v_mul_u32_u24 v9, 1792, v9
    v_mul_u32_u24 v10, 1792, v10
    v_mul_u32_u24 v11, 1792, v11
    v_add_u32 v9, v9, v32
    v_sub_u32 v32, 240, v32
    v_add_u32 v10, v10, v32
    v_add_u32 v11, v11, v32
    v_cmp_gt_u32 vcc, 12, v253
    v_mov_b32 v16, 0xffff
    s_mov_b32 s58, 917504
    s_mov_b32 s59, 1835008
    s_mov_b32 s60, 2752512
    v_cndmask_b32 v12, 2.0, v9, vcc
    v_cndmask_b32 v13, 2.0, v10, vcc
    v_cndmask_b32 v14, 2.0, v11, vcc
    s_waitcnt vmcnt(0)
    s_cmp_eq_u32 s3, 0
    s_cselect_b32 s6, 0, 0x40000000
    s_mov_b64 exec, 1
    s_barrier
    buffer_store_dword v250, v19, s[20:23], s6 offen sc1
    s_mov_b64 exec, -1
    s_mov_b32 s6, 0x9e3779b1
    v_mul_lo_u32 v251, v251, s6
    v_add_u32 v251, 0x7f4a7c15, v251
    v_lshlrev_b32 v3, 7, v1
    v_add_u32 v3, 5242880, v3
    v_cmp_ne_u32 vcc, v21, v250
    s_lshl_b32 s6, s3, 4
    s_or_b32 s43, vcc_lo, vcc_hi
    s_bfm_b64 exec, 16, s6
    s_mov_b32 s10, 65536
L_plB:
    buffer_load_dword v32, v3, s[20:23], 0 offen sc1
    s_sub_u32 s10, s10, 1
    s_cbranch_scc1 L_pdB
    s_waitcnt vmcnt(0)
    v_cmp_ne_u32 vcc, v32, v251
    s_nop 0
    s_and_b64 exec, exec, vcc
    s_cbranch_scc1 L_plB
L_pdB:
    s_mov_b64 exec, -1
    s_barrier
    s_add_u32 m0, s11, 32768
    s_mov_b32 s9, 32768
    buffer_load_dwordx4 v2, s[20:23], s9 offen offset:0 sc1 lds
    buffer_load_dwordx4 v2, s[20:23], s9 offen offset:1024 sc1 lds
    buffer_load_dwordx4 v2, s[20:23], s9 offen offset:2048 sc1 lds
    buffer_load_dwordx4 v2, s[20:23], s9 offen offset:3072 sc1 lds
    s_add_u32 m0, s11, 36864
    s_mov_b32 s9, 36864
    buffer_load_dwordx4 v2, s[20:23], s9 offen offset:0 sc1 lds
    buffer_load_dwordx4 v2, s[20:23], s9 offen offset:1024 sc1 lds
    buffer_load_dwordx4 v2, s[20:23], s9 offen offset:2048 sc1 lds
    buffer_load_dwordx4 v2, s[20:23], s9 offen offset:3072 sc1 lds
    s_add_u32 m0, s11, 0
    s_mov_b32 s9, 0
    buffer_load_dwordx4 v2, s[20:23], s9 offen offset:0 sc1 lds
    buffer_load_dwordx4 v2, s[20:23], s9 offen offset:1024 sc1 lds
    buffer_load_dwordx4 v2, s[20:23], s9 offen offset:2048 sc1 lds
    buffer_load_dwordx4 v2, s[20:23], s9 offen offset:3072 sc1 lds
    s_add_u32 m0, s11, 4096
    s_mov_b32 s9, 4096
    s_waitcnt vmcnt(4)
    buffer_load_dwordx4 v2, s[20:23], s9 offen offset:0 sc1 lds
    ds_read_b64_tr_b16 v[96:97], v4 offset:32768
    ds_read_b64_tr_b16 v[98:99], v4 offset:33024
    ds_read_b64_tr_b16 v[112:113], v5 offset:32768
    ds_read_b64_tr_b16 v[114:115], v5 offset:33024
    buffer_load_dwordx4 v2, s[20:23], s9 offen offset:1024 sc1 lds
    ds_read_b64_tr_b16 v[100:101], v4 offset:34816
    ds_read_b64_tr_b16 v[102:103], v4 offset:35072
    ds_read_b64_tr_b16 v[116:117], v5 offset:34816
    ds_read_b64_tr_b16 v[118:119], v5 offset:35072
    buffer_load_dwordx4 v2, s[20:23], s9 offen offset:2048 sc1 lds
    ds_read_b64_tr_b16 v[104:105], v4 offset:36864
    ds_read_b64_tr_b16 v[106:107], v4 offset:37120
    ds_read_b64_tr_b16 v[120:121], v5 offset:36864
    ds_read_b64_tr_b16 v[122:123], v5 offset:37120
    buffer_load_dwordx4 v2, s[20:23], s9 offen offset:3072 sc1 lds
    ds_read_b64_tr_b16 v[108:109], v4 offset:38912
    ds_read_b64_tr_b16 v[110:111], v4 offset:39168
    ds_read_b64_tr_b16 v[124:125], v5 offset:38912
    ds_read_b64_tr_b16 v[126:127], v5 offset:39168
    s_waitcnt lgkmcnt(14)
    v_mfma_f32_16x16x32_bf16 v[32:35], v[96:99], v[128:131], 0
    s_waitcnt lgkmcnt(12)
    v_mfma_f32_16x16x32_bf16 v[36:39], v[112:115], v[128:131], 0
    s_waitcnt lgkmcnt(10)
    v_mfma_f32_16x16x32_bf16 v[32:35], v[100:103], v[132:135], v[32:35]
    s_waitcnt lgkmcnt(8)
    v_mfma_f32_16x16x32_bf16 v[36:39], v[116:119], v[132:135], v[36:39]
    s_waitcnt lgkmcnt(6)
    v_mfma_f32_16x16x32_bf16 v[32:35], v[104:107], v[136:139], v[32:35]
    s_waitcnt lgkmcnt(4)
    v_mfma_f32_16x16x32_bf16 v[36:39], v[120:123], v[136:139], v[36:39]
    s_waitcnt lgkmcnt(2)
    v_mfma_f32_16x16x32_bf16 v[32:35], v[108:111], v[140:143], v[32:35]
    s_waitcnt lgkmcnt(0)
    v_mfma_f32_16x16x32_bf16 v[36:39], v[124:127], v[140:143], v[36:39]
    v_mfma_f32_16x16x32_bf16 v[40:43], v[96:99], v[144:147], 0
    v_mfma_f32_16x16x32_bf16 v[44:47], v[112:115], v[144:147], 0
    v_mfma_f32_16x16x32_bf16 v[40:43], v[100:103], v[148:151], v[40:43]
    v_mfma_f32_16x16x32_bf16 v[44:47], v[116:119], v[148:151], v[44:47]
    v_mfma_f32_16x16x32_bf16 v[40:43], v[104:107], v[152:155], v[40:43]
    s_nop 0
    v_cvt_pk_bf16_f32 v48, v32, v33
    v_cvt_pk_bf16_f32 v49, v34, v35
    v_mfma_f32_16x16x32_bf16 v[44:47], v[120:123], v[152:155], v[44:47]
    v_cvt_pk_bf16_f32 v50, v36, v37
    v_cvt_pk_bf16_f32 v51, v38, v39
    v_mfma_f32_16x16x32_bf16 v[40:43], v[108:111], v[156:159], v[40:43]
    ds_write_b128 v6, v[48:51] offset:256
    v_mfma_f32_16x16x32_bf16 v[44:47], v[124:127], v[156:159], v[44:47]
    v_mfma_f32_16x16x32_bf16 v[32:35], v[96:99], v[160:163], 0
    v_mfma_f32_16x16x32_bf16 v[36:39], v[112:115], v[160:163], 0
    v_mfma_f32_16x16x32_bf16 v[32:35], v[100:103], v[164:167], v[32:35]
    v_mfma_f32_16x16x32_bf16 v[36:39], v[116:119], v[164:167], v[36:39]
    v_mfma_f32_16x16x32_bf16 v[32:35], v[104:107], v[168:171], v[32:35]
    s_nop 0
    v_cvt_pk_bf16_f32 v52, v40, v41
    v_cvt_pk_bf16_f32 v53, v42, v43
    v_mfma_f32_16x16x32_bf16 v[36:39], v[120:123], v[168:171], v[36:39]
    v_cvt_pk_bf16_f32 v54, v44, v45
    v_cvt_pk_bf16_f32 v55, v46, v47
    v_mfma_f32_16x16x32_bf16 v[32:35], v[108:111], v[172:175], v[32:35]
    ds_write_b128 v6, v[52:55] offset:8704
    v_mfma_f32_16x16x32_bf16 v[36:39], v[124:127], v[172:175], v[36:39]
    v_mfma_f32_16x16x32_bf16 v[40:43], v[96:99], v[176:179], 0
    v_mfma_f32_16x16x32_bf16 v[44:47], v[112:115], v[176:179], 0
    s_waitcnt lgkmcnt(0)
    s_barrier
    v_mfma_f32_16x16x32_bf16 v[40:43], v[100:103], v[180:183], v[40:43]
    ds_read_b128 v[192:195], v8 offset:256
    ds_read_b32 v196, v8 offset:272
    v_mfma_f32_16x16x32_bf16 v[44:47], v[116:119], v[180:183], v[44:47]
    ds_read_b128 v[198:201], v8 offset:8704
    ds_read_b32 v202, v8 offset:8720
    v_mfma_f32_16x16x32_bf16 v[40:43], v[104:107], v[184:187], v[40:43]
    v_cvt_pk_bf16_f32 v48, v32, v33
    v_cvt_pk_bf16_f32 v49, v34, v35
    v_mfma_f32_16x16x32_bf16 v[44:47], v[120:123], v[184:187], v[44:47]
    v_cvt_pk_bf16_f32 v50, v36, v37
    v_cvt_pk_bf16_f32 v51, v38, v39
    v_mfma_f32_16x16x32_bf16 v[40:43], v[108:111], v[188:191], v[40:43]
    ds_write_b128 v6, v[48:51] offset:17152
    v_mfma_f32_16x16x32_bf16 v[44:47], v[124:127], v[188:191], v[44:47]
    s_waitcnt vmcnt(0)
    ds_read_b64_tr_b16 v[64:65], v4 offset:0
    ds_read_b64_tr_b16 v[66:67], v4 offset:256
    ds_read_b64_tr_b16 v[80:81], v5 offset:0
    ds_read_b64_tr_b16 v[82:83], v5 offset:256
    ds_read_b64_tr_b16 v[68:69], v4 offset:2048
    ds_read_b64_tr_b16 v[70:71], v4 offset:2304
    ds_read_b64_tr_b16 v[84:85], v5 offset:2048
    ds_read_b64_tr_b16 v[86:87], v5 offset:2304
    v_cvt_pk_bf16_f32 v52, v40, v41
    v_cvt_pk_bf16_f32 v53, v42, v43
    v_cvt_pk_bf16_f32 v54, v44, v45
    v_cvt_pk_bf16_f32 v55, v46, v47
    ds_write_b128 v6, v[52:55] offset:25600
    ds_read_b64_tr_b16 v[72:73], v4 offset:4096
    ds_read_b64_tr_b16 v[74:75], v4 offset:4352
    s_waitcnt lgkmcnt(9)
    v_mfma_f32_16x16x32_bf16 v[32:35], v[64:67], v[128:131], 0
    ds_read_b64_tr_b16 v[88:89], v5 offset:4096
    ds_read_b64_tr_b16 v[90:91], v5 offset:4352
    s_waitcnt lgkmcnt(9)
    v_mfma_f32_16x16x32_bf16 v[36:39], v[80:83], v[128:131], 0
    ds_read_b64_tr_b16 v[76:77], v4 offset:6144
    ds_read_b64_tr_b16 v[78:79], v4 offset:6400
    s_waitcnt lgkmcnt(9)
    v_mfma_f32_16x16x32_bf16 v[32:35], v[68:71], v[132:135], v[32:35]
    ds_read_b64_tr_b16 v[92:93], v5 offset:6144
    ds_read_b64_tr_b16 v[94:95], v5 offset:6400
    s_waitcnt lgkmcnt(9)
    v_mfma_f32_16x16x32_bf16 v[36:39], v[84:87], v[132:135], v[36:39]
    buffer_store_dwordx4 v[192:195], v12, s[28:31], 0 offen offset:1152 sc1
    v_bfi_b32 v240, v16, v196, v195
    s_waitcnt lgkmcnt(6)
    v_mfma_f32_16x16x32_bf16 v[32:35], v[72:75], v[136:139], v[32:35]
    v_bfi_b32 v241, v16, v195, v194
    v_bfi_b32 v242, v16, v194, v193
    s_waitcnt lgkmcnt(4)
    v_mfma_f32_16x16x32_bf16 v[36:39], v[88:91], v[136:139], v[36:39]
    v_bfi_b32 v243, v16, v193, v192
    buffer_store_dwordx4 v[240:243], v14, s[28:31], 0 offen offset:1280 sc1
    s_waitcnt lgkmcnt(2)
    v_mfma_f32_16x16x32_bf16 v[32:35], v[76:79], v[140:143], v[32:35]
    s_waitcnt lgkmcnt(0)
    s_barrier
    v_mfma_f32_16x16x32_bf16 v[36:39], v[92:95], v[140:143], v[36:39]
    ds_read_b128 v[204:207], v8 offset:17152
    ds_read_b32 v208, v8 offset:17168
    v_mfma_f32_16x16x32_bf16 v[40:43], v[64:67], v[144:147], 0
    ds_read_b128 v[210:213], v8 offset:25600
    ds_read_b32 v214, v8 offset:25616
    v_mfma_f32_16x16x32_bf16 v[44:47], v[80:83], v[144:147], 0
    buffer_store_dwordx4 v[198:201], v12, s[28:31], s58 offen offset:1152 sc1
    v_bfi_b32 v244, v16, v202, v201
    v_mfma_f32_16x16x32_bf16 v[40:43], v[68:71], v[148:151], v[40:43]
    v_bfi_b32 v245, v16, v201, v200
    v_bfi_b32 v246, v16, v200, v199
    v_mfma_f32_16x16x32_bf16 v[44:47], v[84:87], v[148:151], v[44:47]
    v_bfi_b32 v247, v16, v199, v198
    buffer_store_dwordx4 v[244:247], v13, s[28:31], s59 offen offset:1280 sc1
    v_mfma_f32_16x16x32_bf16 v[40:43], v[72:75], v[152:155], v[40:43]
    v_cvt_pk_bf16_f32 v48, v32, v33
    v_cvt_pk_bf16_f32 v49, v34, v35
    v_mfma_f32_16x16x32_bf16 v[44:47], v[88:91], v[152:155], v[44:47]
    v_cvt_pk_bf16_f32 v50, v36, v37
    v_cvt_pk_bf16_f32 v51, v38, v39
    v_mfma_f32_16x16x32_bf16 v[40:43], v[76:79], v[156:159], v[40:43]
    ds_write_b128 v6, v[48:51] offset:0
    v_mfma_f32_16x16x32_bf16 v[44:47], v[92:95], v[156:159], v[44:47]
    s_waitcnt lgkmcnt(4)
    buffer_store_dwordx4 v[204:207], v12, s[28:31], s59 offen offset:1152 sc1
    s_waitcnt lgkmcnt(3)
    v_bfi_b32 v240, v16, v208, v207
    v_mfma_f32_16x16x32_bf16 v[32:35], v[64:67], v[160:163], 0
    v_bfi_b32 v241, v16, v207, v206
    v_bfi_b32 v242, v16, v206, v205
    v_mfma_f32_16x16x32_bf16 v[36:39], v[80:83], v[160:163], 0
    v_bfi_b32 v243, v16, v205, v204
    buffer_store_dwordx4 v[240:243], v13, s[28:31], s58 offen offset:1280 sc1
    v_mfma_f32_16x16x32_bf16 v[32:35], v[68:71], v[164:167], v[32:35]
    v_cvt_pk_bf16_f32 v52, v40, v41
    v_cvt_pk_bf16_f32 v53, v42, v43
    v_mfma_f32_16x16x32_bf16 v[36:39], v[84:87], v[164:167], v[36:39]
    v_cvt_pk_bf16_f32 v54, v44, v45
    v_cvt_pk_bf16_f32 v55, v46, v47
    v_mfma_f32_16x16x32_bf16 v[32:35], v[72:75], v[168:171], v[32:35]
    ds_write_b128 v6, v[52:55] offset:8448
    s_waitcnt lgkmcnt(3)
    buffer_store_dwordx4 v[210:213], v12, s[28:31], s60 offen offset:1152 sc1
    v_mfma_f32_16x16x32_bf16 v[36:39], v[88:91], v[168:171], v[36:39]
    s_waitcnt lgkmcnt(2)
    v_bfi_b32 v244, v16, v214, v213
    v_bfi_b32 v245, v16, v213, v212
    v_mfma_f32_16x16x32_bf16 v[32:35], v[76:79], v[172:175], v[32:35]
    v_bfi_b32 v246, v16, v212, v211
    v_bfi_b32 v247, v16, v211, v210
    v_mfma_f32_16x16x32_bf16 v[36:39], v[92:95], v[172:175], v[36:39]
    buffer_store_dwordx4 v[244:247], v13, s[28:31], 0 offen offset:1280 sc1
    v_mfma_f32_16x16x32_bf16 v[40:43], v[64:67], v[176:179], 0
    s_waitcnt lgkmcnt(0)
    s_barrier
    v_mfma_f32_16x16x32_bf16 v[44:47], v[80:83], v[176:179], 0
    ds_read_b128 v[192:195], v8 offset:0
    ds_read_b32 v196, v8 offset:16
    v_mfma_f32_16x16x32_bf16 v[40:43], v[68:71], v[180:183], v[40:43]
    ds_read_b128 v[198:201], v8 offset:8448
    ds_read_b32 v202, v8 offset:8464
    v_mfma_f32_16x16x32_bf16 v[44:47], v[84:87], v[180:183], v[44:47]
    v_cvt_pk_bf16_f32 v48, v32, v33
    v_cvt_pk_bf16_f32 v49, v34, v35
    v_mfma_f32_16x16x32_bf16 v[40:43], v[72:75], v[184:187], v[40:43]
    v_cvt_pk_bf16_f32 v50, v36, v37
    v_cvt_pk_bf16_f32 v51, v38, v39
    v_mfma_f32_16x16x32_bf16 v[44:47], v[88:91], v[184:187], v[44:47]
    ds_write_b128 v6, v[48:51] offset:16896
    v_mfma_f32_16x16x32_bf16 v[40:43], v[76:79], v[188:191], v[40:43]
    v_mfma_f32_16x16x32_bf16 v[44:47], v[92:95], v[188:191], v[44:47]
    s_waitcnt lgkmcnt(4)
    buffer_store_dwordx4 v[192:195], v9, s[28:31], 0 offen offset:896 sc1
    s_waitcnt lgkmcnt(3)
    v_bfi_b32 v240, v16, v196, v195
    v_bfi_b32 v241, v16, v195, v194
    v_bfi_b32 v242, v16, v194, v193
    v_bfi_b32 v243, v16, v193, v192
    buffer_store_dwordx4 v[240:243], v11, s[28:31], 0 offen offset:1536 sc1
    v_cvt_pk_bf16_f32 v52, v40, v41
    v_cvt_pk_bf16_f32 v53, v42, v43
    v_cvt_pk_bf16_f32 v54, v44, v45
    v_cvt_pk_bf16_f32 v55, v46, v47
    ds_write_b128 v6, v[52:55] offset:25344
    s_waitcnt lgkmcnt(3)
    buffer_store_dwordx4 v[198:201], v9, s[28:31], s58 offen offset:896 sc1
    s_waitcnt lgkmcnt(2)
    v_bfi_b32 v244, v16, v202, v201
    v_bfi_b32 v245, v16, v201, v200
    v_bfi_b32 v246, v16, v200, v199
    v_bfi_b32 v247, v16, v199, v198
    buffer_store_dwordx4 v[244:247], v10, s[28:31], s59 offen offset:1536 sc1
    s_waitcnt lgkmcnt(0)
    s_barrier
    ds_read_b128 v[204:207], v8 offset:16896
    ds_read_b32 v208, v8 offset:16912
    ds_read_b128 v[210:213], v8 offset:25344
    ds_read_b32 v214, v8 offset:25360
    s_waitcnt lgkmcnt(3)
    buffer_store_dwordx4 v[204:207], v9, s[28:31], s59 offen offset:896 sc1
    s_waitcnt lgkmcnt(2)
    v_bfi_b32 v240, v16, v208, v207
    v_bfi_b32 v241, v16, v207, v206
    v_bfi_b32 v242, v16, v206, v205
    v_bfi_b32 v243, v16, v205, v204
    buffer_store_dwordx4 v[240:243], v10, s[28:31], s58 offen offset:1536 sc1
    s_waitcnt lgkmcnt(1)
    buffer_store_dwordx4 v[210:213], v9, s[28:31], s60 offen offset:896 sc1
    s_waitcnt lgkmcnt(0)
    v_bfi_b32 v244, v16, v214, v213
    v_bfi_b32 v245, v16, v213, v212
    v_bfi_b32 v246, v16, v212, v211
    v_bfi_b32 v247, v16, v211, v210
    buffer_store_dwordx4 v[244:247], v10, s[28:31], 0 offen offset:1536 sc1
    s_cmp_lg_u32 s47, 16
    s_cbranch_scc1 L_fin
    s_cmp_eq_u32 s43, 0
    s_cbranch_scc1 L_adv
    s_mul_i32 s6, s57, 17920
    s_add_u32 s6, s6, 6429696
    v_lshrrev_b32 v33, 2, v1
    v_and_b32 v34, 3, v1
    v_lshlrev_b32 v34, 2, v34
    v_lshl_add_u32 v33, v33, 7, v34
    v_add_u32 v33, s6, v33
    v_add_u32 v34, 1024, v33
    s_mov_b32 s10, 65536
L_plK:
    buffer_load_dword v32, v33, s[20:23], 0 offen sc1
    s_sub_u32 s10, s10, 1
    s_cbranch_scc1 L_pdK
    s_waitcnt vmcnt(0)
    v_cmp_ne_u32 vcc, v32, v250
    s_nop 0
    s_and_b64 exec, exec, vcc
    s_cbranch_scc1 L_plK
L_pdK:
    s_mov_b64 exec, -1
    s_mov_b32 s10, 65536
L_plL:
    buffer_load_dword v32, v34, s[20:23], 0 offen sc1
    s_sub_u32 s10, s10, 1
    s_cbranch_scc1 L_pdL
    s_waitcnt vmcnt(0)
    v_cmp_ne_u32 vcc, v32, v250
    s_nop 0
    s_and_b64 exec, exec, vcc
    s_cbranch_scc1 L_plL
L_pdL:
    s_mov_b64 exec, -1
L_adv:
    s_add_u32 s6, s57, 5259264
    buffer_store_dword v250, off, s[20:23], s6 sc1
L_fin:
L_end:
    s_endpgm
.section .rodata,"a"
.p2align 6
.amdhsa_kernel concat_heads__sliding_local_dilated__spectral_fnet__prompt_kernel
  .amdhsa_next_free_vgpr 512
  .amdhsa_next_free_sgpr 102
  .amdhsa_accum_offset 256
  .amdhsa_group_segment_fixed_size 0
  .amdhsa_kernarg_size 88
  .amdhsa_user_sgpr_count 2
  .amdhsa_user_sgpr_kernarg_segment_ptr 1
  .amdhsa_system_sgpr_workgroup_id_x 1
  .amdhsa_float_denorm_mode_32 3
.end_amdhsa_kernel
```

```asm
; @launch grid=(256,1,1) block=(256,1,1) lds=163840
.amdgcn_target "amdgcn-amd-amdhsa--gfx950"
.text
.p2align 12
.fill 0x340, 4, 0xbf800000
.text
.globl concat_heads__sliding_local_dilated__spectral_fnet__prompt_kernel
.p2align 8
.type concat_heads__sliding_local_dilated__spectral_fnet__prompt_kernel,@function
concat_heads__sliding_local_dilated__spectral_fnet__prompt_kernel:
    s_load_dwordx2 s[16:17], s[0:1], 8
    s_load_dwordx2 s[20:21], s[0:1], 80
    s_cmpk_ge_u32 s2, 256
    s_cbranch_scc1 L_end
    s_lshr_b32 s40, s2, 3
    s_getpc_b64 s[4:5]
L_pc:
    v_lshrrev_b32 v2, 5, v0
    v_lshrrev_b32 v3, 6, v0
    v_lshl_add_u32 v2, s40, 3, v2
    v_min_u32 v2, (L_end - L_pc) / 128, v2
    v_lshlrev_b32 v2, 7, v2
    v_readfirstlane_b32 s3, v3
    global_load_dword v255, v2, s[4:5]
    s_load_dwordx2 s[12:13], s[0:1], 0
    s_load_dwordx2 s[32:33], s[0:1], 24
    s_load_dwordx2 s[24:25], s[0:1], 16
    s_load_dwordx2 s[28:29], s[0:1], 64
    v_and_b32 v1, 63, v0
    s_and_b32 s9, s2, 7
    s_lshl_b32 s57, s9, 3
    s_min_u32 s100, s9, 6
    v_lshrrev_b32 v252, 4, v1
    v_and_b32 v253, 15, v1
    s_lshr_b32 s44, s2, 6
    s_cmp_lg_u32 s44, 3
    s_cbranch_scc1 L_A
    s_mov_b32 s34, 0x1c0000
    s_mov_b32 s35, 0x20000
    s_add_u32 s46, s57, s40
    s_sub_u32 s46, s46, 24
    s_lshl_b32 s6, s3, 9
    s_add_u32 s6, s6, s46
    s_mul_i32 s48, s6, 896
    v_cmp_gt_u32 vcc, 56, v1
    v_lshlrev_b32 v2, 4, v1
    s_mul_i32 s7, s3, 10240
    v_cndmask_b32 v2, 2.0, v2, vcc
    s_add_u32 m0, s7, 61440
    s_waitcnt lgkmcnt(0)
    buffer_load_dwordx4 v2, s[32:35], s48 offen lds
    s_add_u32 m0, m0, 1296
    s_add_u32 s48, s48, 57344
    buffer_load_dwordx4 v2, s[32:35], s48 offen lds
    s_add_u32 m0, m0, 1264
    s_add_u32 s48, s48, 57344
    buffer_load_dwordx4 v2, s[32:35], s48 offen lds
    s_add_u32 m0, m0, 1296
    s_add_u32 s48, s48, 57344
    buffer_load_dwordx4 v2, s[32:35], s48 offen lds
    s_add_u32 m0, m0, 1264
    s_add_u32 s48, s48, 57344
    buffer_load_dwordx4 v2, s[32:35], s48 offen lds
    s_add_u32 m0, m0, 1296
    s_add_u32 s48, s48, 57344
    buffer_load_dwordx4 v2, s[32:35], s48 offen lds
    s_add_u32 m0, m0, 1264
    s_add_u32 s48, s48, 57344
    buffer_load_dwordx4 v2, s[32:35], s48 offen lds
    s_add_u32 m0, m0, 1296
    s_add_u32 s48, s48, 57344
    buffer_load_dwordx4 v2, s[32:35], s48 offen lds
    s_mov_b64 exec, 0
    s_cmp_eq_u32 s3, 1
    s_cbranch_scc1 L_padB1
    s_branch L_B
L_A:
    s_mov_b32 s14, 0x1c0000
    s_mov_b32 s15, 0x20000
    s_and_b32 s47, s40, 7
    s_mul_i32 s48, s44, 88
    s_and_b32 s6, s2, 6
    s_lshl_b32 s6, s6, 7
    s_add_u32 s48, s48, s6
    s_lshr_b32 s56, s44, 1
    s_and_b32 s7, s2, 1
    s_cmp_lg_u32 s47, 7
    s_cbranch_scc1 L_G
    s_lshl1_add_u32 s6, s48, s7
    s_cmp_eq_u32 s3, 3
    s_cselect_b32 s6, 0x100000, s6
    v_and_b32 v4, -2, v0
    v_add_u32 v4, s6, v4
    v_subrev_u32 v4, 16, v4 clamp
    v_and_b32 v5, 1, v0
    v_add_u32 v5, s100, v5
    v_add_u32 v5, 1, v5
    v_subrev_u32 v6, 7, v5
    v_min_u32 v5, v5, v6
    v_mad_u32_u24 v7, v4, 7, v5
    v_lshlrev_b32 v7, 7, v7
    s_waitcnt lgkmcnt(0)
    buffer_load_dword v255, v7, s[12:15], 0 offen
    s_branch L_S
L_G:
    s_mov_b32 s18, 0x126000
    s_mov_b32 s19, 0x20000
    v_and_b32 v34, 8, v1
    v_lshrrev_b32 v35, 1, v1
    v_and_or_b32 v34, v35, 16, v34
    v_lshrrev_b32 v35, 2, v1
    v_and_or_b32 v34, v35, 4, v34
    v_add_u32 v34, s3, v34
    v_mul_u32_u24 v34, 2688, v34
    v_and_b32 v33, 7, v1
    v_lshl_add_u32 v34, v33, 4, v34
    v_lshl_add_u32 v34, s47, 7, v34
    s_mul_i32 s8, s3, 1056
    s_mov_b32 s6, s44
    s_mul_i32 s9, s6, 896
    v_add_u32 v5, s9, v34
    s_mul_i32 s9, s6, 4224
    s_add_u32 s50, s9, s8
    s_add_u32 s6, s6, 1
    s_cmp_eq_u32 s6, 3
    s_cselect_b32 s6, 0, s6
    s_mul_i32 s9, s6, 896
    v_add_u32 v8, s9, v34
    s_mul_i32 s9, s6, 4224
    s_add_u32 s46, s9, s8
    s_add_u32 s6, s6, 1
    s_cmp_eq_u32 s6, 3
    s_cselect_b32 s6, 0, s6
    s_mul_i32 s9, s6, 896
    v_add_u32 v249, s9, v34
    s_mul_i32 s9, s6, 4224
    s_add_u32 s98, s9, s8
    s_mul_i32 s52, s100, 64*2688
    s_lshl_b32 s51, s100, 7
    s_add_u32 s53, s52, 32*2688
    s_add_u32 s100, s100, 1
    s_sub_u32 s10, s100, 7
    s_min_u32 s100, s100, s10
    s_lshl1_add_u32 s7, s48, s7
    s_sub_u32 s7, s7, 16
    v_lshrrev_b32 v32, 3, v1
    v_xor_b32 v34, v33, v252
    v_mul_u32_u24 v35, 1792, v32
    v_lshl_add_u32 v34, v34, 4, v35
    s_cmp_eq_u32 s48, 0
    s_cselect_b32 s10, 0, -1
    s_cmp_eq_u32 s56, 0
    s_cselect_b32 s10, s10, 11
    s_mul_i32 s11, s3, 3
    s_lshl_b32 s6, s47, 1
    s_lshr_b32 s6, 0x924, s6
    s_and_b32 s6, s6, 3
    s_add_u32 s8, s11, s6
    s_lshl_b32 s49, s8, 10
    s_lshl4_add_u32 s9, s8, s7
    s_mul_i32 s9, s9, 896
    s_cmp_eq_u32 s8, s10
    s_cselect_b32 s9, 0x40000000, s9
    s_lshl_b32 s8, s8, 6
    s_and_b32 s8, s8, 64
    v_xor_b32 v35, s8, v34
    v_add_u32 v2, s9, v35
    s_add_u32 s6, s6, 1
    s_cmp_eq_u32 s6, 3
    s_cselect_b32 s6, 0, s6
    s_add_u32 s8, s11, s6
    s_lshl_b32 s99, s8, 10
    s_lshl4_add_u32 s9, s8, s7
    s_mul_i32 s9, s9, 896
    s_cmp_eq_u32 s8, s10
    s_cselect_b32 s9, 0x40000000, s9
    s_lshl_b32 s8, s8, 6
    s_and_b32 s8, s8, 64
    v_xor_b32 v35, s8, v34
    v_add_u32 v3, s9, v35
    s_add_u32 s6, s6, 1
    s_cmp_eq_u32 s6, 3
    s_cselect_b32 s6, 0, s6
    s_add_u32 s8, s11, s6
    s_lshl_b32 s101, s8, 10
    s_lshl4_add_u32 s9, s8, s7
    s_mul_i32 s9, s9, 896
    s_cmp_eq_u32 s8, s10
    s_cselect_b32 s9, 0x40000000, s9
    s_lshl_b32 s8, s8, 6
    s_and_b32 s8, s8, 64
    v_xor_b32 v35, s8, v34
    v_add_u32 v4, s9, v35
    s_waitcnt lgkmcnt(0)
    s_add_u32 m0, s50, 37632
    s_and_b32 s11, s3, 1
    buffer_load_dwordx4 v5, s[16:19], s52 offen lds
    s_lshl1_add_u32 s6, s47, s11
    s_add_u32 m0, s50, 50304
    s_lshl_b32 s6, s6, 4
    buffer_load_dwordx4 v5, s[16:19], s53 offen lds
    s_add_u32 s6, s6, L_tab - L_pc
    s_add_u32 m0, s49, 62976
    s_load_dwordx4 s[32:35], s[4:5], s6
    buffer_load_dwordx4 v2, s[12:15], s51 offen lds
    s_add_u32 s6, s57, 5259264
    s_add_u32 m0, s46, 37632
    s_load_dword s36, s[20:21], s6
    buffer_load_dwordx4 v8, s[16:19], s52 offen lds
    s_lshr_b32 s55, s3, 1
    s_add_u32 m0, s46, 50304
    s_mov_b32 s22, 0x1000000
    buffer_load_dwordx4 v8, s[16:19], s53 offen lds
    s_mov_b32 s23, 0x20000
    s_mov_b32 s26, 0x62000
    s_mov_b32 s27, 0x20000
    s_mov_b32 s30, 0x380000
    s_mov_b32 s31, 0x20000
    s_mul_i32 s6, s40, 37
    s_lshr_b32 s6, s6, 8
    s_mul_i32 s7, s6, 7
    s_sub_u32 s41, s40, s7
    s_add_u32 m0, s99, 62976
    s_lshr_b32 s7, s57, 3
    buffer_load_dwordx4 v3, s[12:15], s51 offen lds
    s_add_u32 s41, s41, s7
    s_sub_u32 s7, s41, 7
    s_min_u32 s41, s41, s7
    s_lshl_b32 s6, s6, 2
    s_add_u32 s6, s6, s3
    v_bfe_u32 v32, v1, 1, 1
    v_lshl_add_u32 v32, s6, 1, v32
    v_mul_u32_u24 v33, 47, v32
    v_lshrrev_b32 v33, 9, v33
    s_add_u32 m0, s98, 37632
    v_mul_u32_u24 v34, 11, v33
    buffer_load_dwordx4 v249, s[16:19], s52 offen lds
    v_sub_u32 v32, v32, v34
    v_add_u32 v32, 3, v32
    v_and_b32 v32, 8, v32
    v_lshl_add_u32 v32, v33, 10, v32
    v_and_b32 v33, 1, v1
    v_lshl_add_u32 v32, v33, 2, v32
    v_bfe_u32 v33, v1, 2, 3
    v_lshl_add_u32 v32, v33, 7, v32
    s_mul_i32 s7, s57, 17920
    s_add_u32 m0, s98, 50304
    s_add_u32 s7, s7, 6429696
    buffer_load_dwordx4 v249, s[16:19], s53 offen lds
    v_add_u32 v246, s7, v32
    s_and_b32 s7, s2, 6
    s_lshl3_add_u32 s6, s7, s6
    s_and_b32 s8, s2, 1
    s_lshl_b32 s7, s8, 6
    s_add_u32 s42, s6, s7
    v_lshrrev_b32 v32, 3, v1
    v_and_b32 v33, 6, v32
    v_and_b32 v34, 7, v1
    s_add_u32 m0, s101, 62976
    v_xor_b32 v33, v33, v34
    buffer_load_dwordx4 v4, s[12:15], s51 offen lds
    v_lshrrev_b32 v32, 3, v0
    v_mul_u32_u24 v32, 896, v32
    v_lshl_add_u32 v32, v33, 4, v32
    s_lshl_b32 s7, s41, 7
    v_add_u32 v240, s7, v32
    v_mov_b32 v34, 0
    v_mov_b32 v35, 0
    v_lshlrev_b32 v32, 3, v1
    v_add_u32 v32, 162816, v32
    ds_write_b64 v32, v[34:35]
    s_lshl_b32 s45, s3, 10
    s_add_u32 s45, s45, 105472
    v_lshrrev_b32 v32, 2, v1
    v_bfe_u32 v33, v1, 3, 2
    v_lshlrev_b32 v33, 5, v33
    v_lshl_add_u32 v33, v32, 7, v33
    v_and_b32 v34, 3, v1
    v_lshl_add_u32 v33, v34, 3, v33
    v_add_u32 v241, 105472, v33
    v_xor_b32 v242, 32, v241
    v_xor_b32 v243, 64, v241
    v_xor_b32 v244, 96, v241
    s_lshl_b32 s9, s42, 14
    v_lshl_add_u32 v245, v1, 4, s9
    s_lshl_b32 s6, s6, 5
    s_add_u32 s6, s6, s8
    s_mul_i32 s6, s6, 1792
    s_add_u32 s6, s6, s7
    v_mul_u32_u24 v32, 3584, v253
    v_and_b32 v33, 1, v252
    v_lshl_add_u32 v32, v33, 5, v32
    v_lshrrev_b32 v33, 1, v252
    v_lshl_add_u32 v32, v33, 4, v32
    v_add_u32 v247, s6, v32
    s_cmp_eq_u32 s55, 0
    s_cselect_b32 s54, 0xff800000, 0
    s_cmp_eq_u32 s48, 0
    s_cselect_b32 s61, s54, 0
    s_mul_i32 s6, s55, 48
    s_add_u32 s6, s6, s48
    s_and_b32 s7, s2, 1
    s_lshl_b32 s7, s7, 10
    s_add_u32 s6, s6, s7
    s_add_u32 s6, s6, 8
    s_waitcnt lgkmcnt(0)
    s_and_b32 s11, s34, 15
    v_add_u32 v32, s6, v253
    v_lshrrev_b32 v33, 4, v32
    v_lshlrev_b32 v33, 14, v33
    v_and_b32 v32, 15, v32
    v_lshl_add_u32 v32, v32, 4, v33
    v_lshl_add_u32 v32, v252, 8, v32
    s_lshl_b32 s7, s11, 10
    v_add_u32 v18, s7, v32
    s_cmp_eq_u32 s55, 0
    s_cselect_b32 s8, 8, 0
    s_and_b32 s9, s55, s56
    s_cselect_b32 s9, 8, 16
    v_cmp_le_u32 s[4:5], s8, v253
    v_cmp_gt_u32 s[62:63], s9, v253
    v_subrev_u32 v32, 16384, v18
    v_add_u32 v33, 16384, v18
    v_cndmask_b32 v17, 2.0, v32, s[4:5]
    v_cndmask_b32 v19, 2.0, v33, s[62:63]
    s_mul_i32 s9, s57, 17920
    s_lshl_b32 s7, s40, 7
    s_add_u32 s6, s9, s7
    s_lshl2_add_u32 s6, s3, s6
    s_add_u32 s6, s6, 6429696
    v_mov_b32 v248, s6
    v_and_b32 v32, 4, v1
    v_add_u32 v32, 16, v32
    v_bfe_u32 v32, s34, v32, 4
    v_and_b32 v33, 3, v1
    v_lshlrev_b32 v34, 2, v33
    v_lshl_add_u32 v32, v32, 7, v34
    s_lshl_b32 s6, s44, 10
    s_add_u32 s6, s6, s9
    s_add_u32 s6, s6, 6429712
    v_add_u32 v40, s6, v32
    s_mul_i32 s6, s44, 46080
    s_add_u32 s9, s9, s6
    s_add_u32 s9, s9, 6291456
    s_lshl_b32 s38, s55, 10
    s_lshl_b32 s39, s55, 3
    v_lshl_add_u32 v42, v253, 4, s9
    v_lshl_add_u32 v43, v252, 2, v33
    v_lshl_add_u32 v43, v43, 4, s9
    v_lshrrev_b32 v35, 2, v253
    s_bfe_u32 s6, s34, 0x40008
    s_sub_u32 s6, 4, s6
    v_cmp_le_u32 s[62:63], s6, v252
    v_cmp_le_u32 s[64:65], s6, v35
    s_movk_i32 s8, 2304
    v_lshlrev_b32 v32, 3, v252
    v_bfe_u32 v32, s33, v32, 8
    v_mad_u32_u24 v32, v32, s8, v42
    v_cndmask_b32 v36, 2.0, v32, s[62:63]
    v_lshlrev_b32 v32, 3, v35
    v_bfe_u32 v32, s33, v32, 8
    v_mad_u32_u24 v32, v32, s8, v43
    v_cndmask_b32 v37, 2.0, v32, s[64:65]
    s_bfe_u32 s6, s34, 0x4000c
    s_bitcmp1_b32 s34, 4
    s_cselect_b32 s7, 2, 4
    s_cselect_b32 s9, -1, 1
    s_add_u32 s6, s6, s7
    v_mul_i32_i24 v32, s9, v252
    v_add_u32 v32, s6, v32
    v_cmp_ne_u32 vcc, 3, v252
    v_mad_u32_u24 v32, v32, s8, v42
    s_nop 0
    v_cndmask_b32 v38, 2.0, v32, vcc
    v_mul_i32_i24 v32, s9, v35
    v_add_u32 v32, s6, v32
    v_cmp_ne_u32 vcc, 3, v35
    v_mad_u32_u24 v32, v32, s8, v43
    s_nop 0
    v_cndmask_b32 v39, 2.0, v32, vcc
    s_mul_i32 s36, s36, 0x9e3779b1
    s_add_u32 s36, s36, 0x7f4a7c15
    v_mov_b32 v250, s36
    s_getreg_b32 s7, hwreg(HW_REG_XCC_ID, 0, 3)
    s_mul_i32 s8, s57, 17920
    s_lshl_b32 s7, s7, 7
    s_add_u32 s8, s8, s7
    s_add_u32 s8, s8, 6432768
    v_and_b32 v41, 31, v1
    v_lshl_add_u32 v41, v41, 2, s8
    s_lshl2_add_u32 s37, s40, s8
    v_lshrrev_b32 v32, 5, v1
    v_lshlrev_b32 v32, 9, v32
    v_bfe_u32 v33, v1, 4, 1
    v_lshl_add_u32 v32, v33, 7, v32
    s_movk_i32 s6, 1056
    v_mad_u32_u24 v32, v35, s6, v32
    v_bfe_u32 v33, s32, v34, 4
    v_lshl_add_u32 v9, v33, 3, v32
    v_add_u32 v34, 16, v34
    v_bfe_u32 v33, s32, v34, 4
    v_lshl_add_u32 v10, v33, 3, v32
    v_lshrrev_b32 v32, 1, v253
    v_xor_b32 v32, v32, v252
    v_lshlrev_b32 v32, 4, v32
    v_lshl_add_u32 v32, v253, 7, v32
    s_mul_i32 s6, s55, 6144
    s_add_u32 s6, s6, 25344
    v_add_u32 v11, s6, v32
    v_xor_b32 v32, 64, v32
    v_add_u32 v12, s6, v32
    v_add_u32 v13, 75264, v9
    v_add_u32 v15, 75264, v11
    v_add_u32 v14, 75264, v10
    s_mov_b64 exec, 0
    s_cmp_eq_u32 s3, 1
    s_cbranch_scc1 L_padA1
    s_cmp_eq_u32 s3, 2
    s_cbranch_scc1 L_padA2
L_back:
    s_mov_b64 exec, -1
    s_mul_i32 s59, s100, 64*2688
    s_lshl_b32 s58, s100, 7
    s_add_u32 s60, s59, 32*2688
    s_add_u32 s100, s100, 1
    s_sub_u32 s10, s100, 7
    s_min_u32 s100, s100, s10
    s_add_u32 m0, s50, 75264
    v_add_u32 v16, 75264, v12
    buffer_load_dwordx4 v5, s[16:19], s59 offen lds
    s_lshl_b32 s6, s3, 11
    s_add_u32 s6, s6, 75264
    s_add_u32 m0, s50, 87936
    v_lshl_add_u32 v6, v1, 4, s6
    buffer_load_dwordx4 v5, s[16:19], s60 offen lds
    s_lshl_b32 s6, s55, 12
    v_subrev_u32 v7, s6, v6
    s_add_u32 m0, s49, 100608
    v_lshlrev_b32 v208, 2, v252
    buffer_load_dwordx4 v2, s[12:15], s58 offen lds
    v_sub_u32 v208, v253, v208
    v_mov_b32 v209, 0xff800000
    s_add_u32 m0, s46, 75264
    v_subrev_u32 v212, 0, v208
    buffer_load_dwordx4 v8, s[16:19], s59 offen lds
    v_subrev_u32 v213, 1, v208
    v_subrev_u32 v214, 2, v208
    s_add_u32 m0, s46, 87936
    v_subrev_u32 v215, 3, v208
    buffer_load_dwordx4 v8, s[16:19], s60 offen lds
    v_cmp_gt_u32 s[4:5], 8, v212
    v_cmp_gt_u32 s[8:9], 8, v213
    s_mul_i32 s52, s100, 64*2688
    s_lshl_b32 s51, s100, 7
    s_add_u32 s53, s52, 32*2688
    s_add_u32 s100, s100, 1
    s_sub_u32 s10, s100, 7
    s_min_u32 s100, s100, s10
    s_add_u32 m0, s99, 100608
    v_cmp_gt_u32 vcc, 8, v214
    buffer_load_dwordx4 v3, s[12:15], s58 offen lds
    v_cmp_gt_u32 s[6:7], 8, v215
    v_cndmask_b32 v24, v209, 0, s[4:5]
    s_add_u32 m0, s98, 75264
    v_cndmask_b32 v25, v209, 0, s[8:9]
    buffer_load_dwordx4 v249, s[16:19], s59 offen lds
    v_cndmask_b32 v26, v209, 0, vcc
    v_cndmask_b32 v27, v209, 0, s[6:7]
    s_add_u32 m0, s98, 87936
    v_cmp_ge_i32 s[4:5], -9, v212
    buffer_load_dwordx4 v249, s[16:19], s60 offen lds
    v_cmp_ge_i32 s[8:9], -9, v213
    v_cmp_ge_i32 vcc, -9, v214
    s_add_u32 m0, s101, 100608
    v_cmp_ge_i32 s[6:7], -9, v215
    buffer_load_dwordx4 v4, s[12:15], s58 offen lds
    v_cndmask_b32 v20, v209, 0, s[4:5]
    v_cndmask_b32 v21, v209, 0, s[8:9]
    v_cndmask_b32 v22, v209, 0, vcc
    v_cndmask_b32 v23, v209, 0, s[6:7]
    v_ashrrev_i32 v212, 31, v212
    v_ashrrev_i32 v213, 31, v213
    v_ashrrev_i32 v214, 31, v214
    v_ashrrev_i32 v215, 31, v215
    v_mov_b32 v208, 0xffff
    v_bfi_b32 v28, v208, v212, v213
    v_bfi_b32 v29, v208, v214, v215
    v_mov_b32 v30, 0x3e8b97f6
    v_or_b32 v56, s54, v20
    v_or_b32 v57, s54, v21
    v_or_b32 v58, s54, v22
    v_or_b32 v59, s54, v23
    v_subrev_u32 v208, 32, v1
    v_ashrrev_i32 v208, 31, v208
    v_and_b32 v208, s61, v208
    v_or_b32 v60, v208, v24
    v_or_b32 v61, v208, v25
    v_or_b32 v62, v208, v26
    v_or_b32 v63, v208, v27
    v_mov_b32 v32, 0x3f803f80
    v_mov_b32 v33, 0x3f803f80
    v_mov_b32 v34, 0x3f803f80
    v_mov_b32 v35, 0x3f803f80
    s_waitcnt vmcnt(9) lgkmcnt(0)
    s_barrier
    buffer_store_dword v250, off, s[20:23], s37
    ds_read_b128 v[136:139], v11 offset:37632
    ds_read_b64_tr_b16 v[160:161], v9 offset:37632
    ds_read_b64_tr_b16 v[162:163], v9 offset:37888
    ds_read_b128 v[140:143], v11 offset:39680
    s_add_u32 m0, s50, 0
    ds_read_b128 v[144:147], v11 offset:41728
    buffer_load_dwordx4 v5, s[16:19], s52 offen lds
    ds_read_b64_tr_b16 v[164:165], v10 offset:37632
    ds_read_b64_tr_b16 v[166:167], v10 offset:37888
    ds_read_b64_tr_b16 v[168:169], v9 offset:41856
    s_add_u32 m0, s50, 12672
    ds_read_b64_tr_b16 v[170:171], v9 offset:42112
    buffer_load_dwordx4 v5, s[16:19], s53 offen lds
    ds_read_b64_tr_b16 v[172:173], v10 offset:41856
    ds_read_b64_tr_b16 v[174:175], v10 offset:42112
    ds_read_b64_tr_b16 v[176:177], v9 offset:46080
    s_add_u32 m0, s49, 25344
    ds_read_b64_tr_b16 v[178:179], v9 offset:46336
    buffer_load_dwordx4 v2, s[12:15], s51 offen lds
    ds_read_b64_tr_b16 v[180:181], v10 offset:46080
    ds_read_b64_tr_b16 v[182:183], v10 offset:46336
    s_waitcnt lgkmcnt(12)
    v_mfma_f32_16x16x32_bf16 v[64:67], v[160:163], v[136:139], 0
    ds_read_b128 v[148:151], v12 offset:37632
    s_add_u32 m0, s46, 0
    s_waitcnt lgkmcnt(12)
    v_mfma_f32_16x16x32_bf16 v[88:91], v[160:163], v[140:143], 0
    ds_read_b64_tr_b16 v[184:185], v9 offset:50304
    buffer_load_dwordx4 v8, s[16:19], s52 offen lds
    s_waitcnt lgkmcnt(12)
    v_mfma_f32_16x16x32_bf16 v[112:115], v[160:163], v[144:147], 0
    ds_read_b64_tr_b16 v[186:187], v9 offset:50560
    s_mul_i32 s59, s100, 64*2688
    s_waitcnt lgkmcnt(11)
    v_mfma_f32_16x16x32_bf16 v[68:71], v[164:167], v[136:139], 0
    ds_read_b128 v[152:155], v12 offset:39680
    s_add_u32 m0, s46, 12672
    v_mfma_f32_16x16x32_bf16 v[92:95], v[164:167], v[140:143], 0
    ds_read_b128 v[156:159], v12 offset:41728
    buffer_load_dwordx4 v8, s[16:19], s53 offen lds
    v_mfma_f32_16x16x32_bf16 v[116:119], v[164:167], v[144:147], 0
    ds_read_b64_tr_b16 v[188:189], v10 offset:50304
    s_lshl_b32 s58, s100, 7
    s_waitcnt lgkmcnt(12)
    v_mfma_f32_16x16x32_bf16 v[72:75], v[168:171], v[136:139], 0
    ds_read_b64_tr_b16 v[190:191], v10 offset:50560
    s_add_u32 m0, s99, 25344
    v_mfma_f32_16x16x32_bf16 v[96:99], v[168:171], v[140:143], 0
    ds_read_b64_tr_b16 v[192:193], v9 offset:54528
    buffer_load_dwordx4 v3, s[12:15], s51 offen lds
    v_mfma_f32_16x16x32_bf16 v[120:123], v[168:171], v[144:147], 0
    ds_read_b64_tr_b16 v[194:195], v9 offset:54784
    s_add_u32 s60, s59, 32*2688
    s_waitcnt lgkmcnt(13)
    v_mfma_f32_16x16x32_bf16 v[76:79], v[172:175], v[136:139], 0
    ds_read_b64_tr_b16 v[196:197], v10 offset:54528
    s_add_u32 s100, s100, 1
    v_mfma_f32_16x16x32_bf16 v[100:103], v[172:175], v[140:143], 0
    ds_read_b64_tr_b16 v[198:199], v10 offset:54784
    s_add_u32 m0, s98, 0
    v_mfma_f32_16x16x32_bf16 v[124:127], v[172:175], v[144:147], 0
    ds_read_b64_tr_b16 v[200:201], v9 offset:58752
    buffer_load_dwordx4 v249, s[16:19], s52 offen lds
    s_waitcnt lgkmcnt(14)
    v_mfma_f32_16x16x32_bf16 v[80:83], v[136:139], v[176:179], 0
    ds_read_b64_tr_b16 v[202:203], v9 offset:59008
    s_sub_u32 s10, s100, 7
    v_mfma_f32_16x16x32_bf16 v[104:107], v[140:143], v[176:179], 0
    ds_read_b64_tr_b16 v[204:205], v10 offset:58752
    s_add_u32 m0, s98, 12672
    v_mfma_f32_16x16x32_bf16 v[128:131], v[144:147], v[176:179], 0
    ds_read_b64_tr_b16 v[206:207], v10 offset:59008
    buffer_load_dwordx4 v249, s[16:19], s53 offen lds
    s_waitcnt lgkmcnt(15)
    v_mfma_f32_16x16x32_bf16 v[84:87], v[136:139], v[180:183], 0
    s_min_u32 s100, s100, s10
    v_mfma_f32_16x16x32_bf16 v[108:111], v[140:143], v[180:183], 0
    s_add_u32 m0, s101, 25344
    v_mfma_f32_16x16x32_bf16 v[132:135], v[144:147], v[180:183], 0
    s_waitcnt lgkmcnt(0)
    buffer_load_dwordx4 v4, s[12:15], s51 offen lds
    v_mfma_f32_16x16x32_bf16 v[64:67], v[184:187], v[148:151], v[64:67]
    v_mfma_f32_16x16x32_bf16 v[88:91], v[184:187], v[152:155], v[88:91]
    v_mfma_f32_16x16x32_bf16 v[112:115], v[184:187], v[156:159], v[112:115]
    s_waitcnt vmcnt(10) lgkmcnt(0)
    s_barrier
    v_mfma_f32_16x16x32_bf16 v[68:71], v[188:191], v[148:151], v[68:71]
    ds_read_b128 v[136:139], v15 offset:0
    ds_read_b64_tr_b16 v[160:161], v13 offset:0
    v_mfma_f32_16x16x32_bf16 v[92:95], v[188:191], v[152:155], v[92:95]
    ds_read_b64_tr_b16 v[162:163], v13 offset:256
    s_add_u32 m0, s50, 37632
    v_mfma_f32_16x16x32_bf16 v[116:119], v[188:191], v[156:159], v[116:119]
    ds_read_b128 v[140:143], v15 offset:2048
    buffer_load_dwordx4 v5, s[16:19], s59 offen lds
    v_mfma_f32_16x16x32_bf16 v[72:75], v[192:195], v[148:151], v[72:75]
    ds_read_b128 v[144:147], v15 offset:4096
    s_mul_i32 s52, s100, 64*2688
    v_mfma_f32_16x16x32_bf16 v[96:99], v[192:195], v[152:155], v[96:99]
    ds_read_b64_tr_b16 v[164:165], v14 offset:0
    ds_read_b64_tr_b16 v[166:167], v14 offset:256
    v_mfma_f32_16x16x32_bf16 v[120:123], v[192:195], v[156:159], v[120:123]
    ds_read_b64_tr_b16 v[168:169], v13 offset:4224
    s_add_u32 m0, s50, 50304
    v_mfma_f32_16x16x32_bf16 v[76:79], v[196:199], v[148:151], v[76:79]
    ds_read_b64_tr_b16 v[170:171], v13 offset:4480
    buffer_load_dwordx4 v5, s[16:19], s60 offen lds
    v_mfma_f32_16x16x32_bf16 v[100:103], v[196:199], v[152:155], v[100:103]
    ds_read_b64_tr_b16 v[172:173], v14 offset:4224
    s_lshl_b32 s51, s100, 7
    v_mfma_f32_16x16x32_bf16 v[124:127], v[196:199], v[156:159], v[124:127]
    ds_read_b64_tr_b16 v[174:175], v14 offset:4480
    ds_read_b64_tr_b16 v[176:177], v13 offset:8448
    v_mfma_f32_16x16x32_bf16 v[80:83], v[148:151], v[200:203], v[80:83]
    ds_read_b64_tr_b16 v[178:179], v13 offset:8704
    s_add_u32 s53, s52, 32*2688
    v_mfma_f32_16x16x32_bf16 v[104:107], v[152:155], v[200:203], v[104:107]
    ds_read_b64_tr_b16 v[180:181], v14 offset:8448
    s_add_u32 m0, s49, 62976
    v_mfma_f32_16x16x32_bf16 v[128:131], v[156:159], v[200:203], v[128:131]
    ds_read_b64_tr_b16 v[182:183], v14 offset:8704
    buffer_load_dwordx4 v2, s[12:15], s58 offen lds
    v_mfma_f32_16x16x32_bf16 v[84:87], v[148:151], v[204:207], v[84:87]
    s_add_u32 s100, s100, 1
    s_sub_u32 s10, s100, 7
    v_mfma_f32_16x16x32_bf16 v[108:111], v[152:155], v[204:207], v[108:111]
    s_add_u32 m0, s46, 37632
    s_min_u32 s100, s100, s10
    v_mfma_f32_16x16x32_bf16 v[132:135], v[156:159], v[204:207], v[132:135]
    s_waitcnt lgkmcnt(0)
    buffer_load_dwordx4 v8, s[16:19], s59 offen lds
    v_mfma_f32_16x16x32_bf16 v[64:67], v[160:163], v[136:139], v[64:67]
    ds_read_b128 v[148:151], v16 offset:0
    v_mfma_f32_16x16x32_bf16 v[88:91], v[160:163], v[140:143], v[88:91]
    ds_read_b64_tr_b16 v[184:185], v13 offset:12672
    v_mfma_f32_16x16x32_bf16 v[112:115], v[160:163], v[144:147], v[112:115]
    ds_read_b64_tr_b16 v[186:187], v13 offset:12928
    s_add_u32 m0, s46, 50304
    v_mfma_f32_16x16x32_bf16 v[68:71], v[164:167], v[136:139], v[68:71]
    ds_read_b128 v[152:155], v16 offset:2048
    buffer_load_dwordx4 v8, s[16:19], s60 offen lds
    v_mfma_f32_16x16x32_bf16 v[92:95], v[164:167], v[140:143], v[92:95]
    ds_read_b128 v[156:159], v16 offset:4096
    v_mfma_f32_16x16x32_bf16 v[116:119], v[164:167], v[144:147], v[116:119]
    ds_read_b64_tr_b16 v[188:189], v14 offset:12672
    s_add_u32 m0, s99, 62976
    v_mfma_f32_16x16x32_bf16 v[72:75], v[168:171], v[136:139], v[72:75]
    ds_read_b64_tr_b16 v[190:191], v14 offset:12928
    buffer_load_dwordx4 v3, s[12:15], s58 offen lds
    v_mfma_f32_16x16x32_bf16 v[96:99], v[168:171], v[140:143], v[96:99]
    ds_read_b64_tr_b16 v[192:193], v13 offset:16896
    v_mfma_f32_16x16x32_bf16 v[120:123], v[168:171], v[144:147], v[120:123]
    ds_read_b64_tr_b16 v[194:195], v13 offset:17152
    v_mfma_f32_16x16x32_bf16 v[76:79], v[172:175], v[136:139], v[76:79]
    ds_read_b64_tr_b16 v[196:197], v14 offset:16896
    s_add_u32 m0, s98, 37632
    v_mfma_f32_16x16x32_bf16 v[100:103], v[172:175], v[140:143], v[100:103]
    ds_read_b64_tr_b16 v[198:199], v14 offset:17152
    buffer_load_dwordx4 v249, s[16:19], s59 offen lds
    v_mfma_f32_16x16x32_bf16 v[124:127], v[172:175], v[144:147], v[124:127]
    ds_read_b64_tr_b16 v[200:201], v13 offset:21120
    v_mfma_f32_16x16x32_bf16 v[80:83], v[136:139], v[176:179], v[80:83]
    ds_read_b64_tr_b16 v[202:203], v13 offset:21376
    s_add_u32 m0, s98, 50304
    v_mfma_f32_16x16x32_bf16 v[104:107], v[140:143], v[176:179], v[104:107]
    ds_read_b64_tr_b16 v[204:205], v14 offset:21120
    buffer_load_dwordx4 v249, s[16:19], s60 offen lds
    v_mfma_f32_16x16x32_bf16 v[128:131], v[144:147], v[176:179], v[128:131]
    ds_read_b64_tr_b16 v[206:207], v14 offset:21376
    v_mfma_f32_16x16x32_bf16 v[84:87], v[136:139], v[180:183], v[84:87]
    v_mfma_f32_16x16x32_bf16 v[108:111], v[140:143], v[180:183], v[108:111]
L_padA1:
    s_cbranch_execz L_back
    s_add_u32 m0, s101, 62976
    v_mfma_f32_16x16x32_bf16 v[132:135], v[144:147], v[180:183], v[132:135]
    s_waitcnt lgkmcnt(0)
    buffer_load_dwordx4 v4, s[12:15], s58 offen lds
    v_mfma_f32_16x16x32_bf16 v[64:67], v[184:187], v[148:151], v[64:67]
    v_mfma_f32_16x16x32_bf16 v[88:91], v[184:187], v[152:155], v[88:91]
    v_mfma_f32_16x16x32_bf16 v[112:115], v[184:187], v[156:159], v[112:115]
    s_waitcnt vmcnt(9) lgkmcnt(0)
    s_barrier
    v_mfma_f32_16x16x32_bf16 v[68:71], v[188:191], v[148:151], v[68:71]
    ds_read_b128 v[136:139], v11 offset:0
    ds_read_b64_tr_b16 v[160:161], v9 offset:0
    v_mfma_f32_16x16x32_bf16 v[92:95], v[188:191], v[152:155], v[92:95]
    ds_read_b64_tr_b16 v[162:163], v9 offset:256
    s_add_u32 m0, s50, 75264
    v_mfma_f32_16x16x32_bf16 v[116:119], v[188:191], v[156:159], v[116:119]
    ds_read_b128 v[140:143], v11 offset:2048
    buffer_load_dwordx4 v5, s[16:19], s52 offen lds
    v_mfma_f32_16x16x32_bf16 v[72:75], v[192:195], v[148:151], v[72:75]
    ds_read_b128 v[144:147], v11 offset:4096
    s_mul_i32 s59, s100, 64*2688
    v_mfma_f32_16x16x32_bf16 v[96:99], v[192:195], v[152:155], v[96:99]
    ds_read_b64_tr_b16 v[164:165], v10 offset:0
    ds_read_b64_tr_b16 v[166:167], v10 offset:256
    v_mfma_f32_16x16x32_bf16 v[120:123], v[192:195], v[156:159], v[120:123]
    ds_read_b64_tr_b16 v[168:169], v9 offset:4224
    s_add_u32 m0, s50, 87936
    v_mfma_f32_16x16x32_bf16 v[76:79], v[196:199], v[148:151], v[76:79]
    ds_read_b64_tr_b16 v[170:171], v9 offset:4480
    buffer_load_dwordx4 v5, s[16:19], s53 offen lds
    v_mfma_f32_16x16x32_bf16 v[100:103], v[196:199], v[152:155], v[100:103]
    ds_read_b64_tr_b16 v[172:173], v10 offset:4224
    s_lshl_b32 s58, s100, 7
    v_mfma_f32_16x16x32_bf16 v[124:127], v[196:199], v[156:159], v[124:127]
    ds_read_b64_tr_b16 v[174:175], v10 offset:4480
    ds_read_b64_tr_b16 v[176:177], v9 offset:8448
    v_mfma_f32_16x16x32_bf16 v[80:83], v[148:151], v[200:203], v[80:83]
    ds_read_b64_tr_b16 v[178:179], v9 offset:8704
    s_add_u32 s60, s59, 32*2688
    v_mfma_f32_16x16x32_bf16 v[104:107], v[152:155], v[200:203], v[104:107]
    ds_read_b64_tr_b16 v[180:181], v10 offset:8448
    s_add_u32 m0, s49, 100608
    v_mfma_f32_16x16x32_bf16 v[128:131], v[156:159], v[200:203], v[128:131]
    ds_read_b64_tr_b16 v[182:183], v10 offset:8704
    buffer_load_dwordx4 v2, s[12:15], s51 offen lds
    v_mfma_f32_16x16x32_bf16 v[84:87], v[148:151], v[204:207], v[84:87]
    s_add_u32 s100, s100, 1
    s_sub_u32 s10, s100, 7
    v_mfma_f32_16x16x32_bf16 v[108:111], v[152:155], v[204:207], v[108:111]
    s_add_u32 m0, s46, 75264
    s_min_u32 s100, s100, s10
    v_mfma_f32_16x16x32_bf16 v[132:135], v[156:159], v[204:207], v[132:135]
    s_waitcnt lgkmcnt(0)
    buffer_load_dwordx4 v8, s[16:19], s52 offen lds
    v_mfma_f32_16x16x32_bf16 v[64:67], v[160:163], v[136:139], v[64:67]
    ds_read_b128 v[148:151], v12 offset:0
    v_mfma_f32_16x16x32_bf16 v[88:91], v[160:163], v[140:143], v[88:91]
    ds_read_b64_tr_b16 v[184:185], v9 offset:12672
    v_mfma_f32_16x16x32_bf16 v[112:115], v[160:163], v[144:147], v[112:115]
    ds_read_b64_tr_b16 v[186:187], v9 offset:12928
    s_add_u32 m0, s46, 87936
    v_mfma_f32_16x16x32_bf16 v[68:71], v[164:167], v[136:139], v[68:71]
    ds_read_b128 v[152:155], v12 offset:2048
    buffer_load_dwordx4 v8, s[16:19], s53 offen lds
    v_mfma_f32_16x16x32_bf16 v[92:95], v[164:167], v[140:143], v[92:95]
    ds_read_b128 v[156:159], v12 offset:4096
    v_mfma_f32_16x16x32_bf16 v[116:119], v[164:167], v[144:147], v[116:119]
    ds_read_b64_tr_b16 v[188:189], v10 offset:12672
    s_add_u32 m0, s99, 100608
    v_mfma_f32_16x16x32_bf16 v[72:75], v[168:171], v[136:139], v[72:75]
    ds_read_b64_tr_b16 v[190:191], v10 offset:12928
    buffer_load_dwordx4 v3, s[12:15], s51 offen lds
    v_mfma_f32_16x16x32_bf16 v[96:99], v[168:171], v[140:143], v[96:99]
    ds_read_b64_tr_b16 v[192:193], v9 offset:16896
    v_mfma_f32_16x16x32_bf16 v[120:123], v[168:171], v[144:147], v[120:123]
    ds_read_b64_tr_b16 v[194:195], v9 offset:17152
    v_mfma_f32_16x16x32_bf16 v[76:79], v[172:175], v[136:139], v[76:79]
    ds_read_b64_tr_b16 v[196:197], v10 offset:16896
    s_add_u32 m0, s98, 75264
    v_mfma_f32_16x16x32_bf16 v[100:103], v[172:175], v[140:143], v[100:103]
    ds_read_b64_tr_b16 v[198:199], v10 offset:17152
    buffer_load_dwordx4 v249, s[16:19], s52 offen lds
    v_mfma_f32_16x16x32_bf16 v[124:127], v[172:175], v[144:147], v[124:127]
    ds_read_b64_tr_b16 v[200:201], v9 offset:21120
    v_mfma_f32_16x16x32_bf16 v[80:83], v[136:139], v[176:179], v[80:83]
    ds_read_b64_tr_b16 v[202:203], v9 offset:21376
    s_add_u32 m0, s98, 87936
    v_mfma_f32_16x16x32_bf16 v[104:107], v[140:143], v[176:179], v[104:107]
    ds_read_b64_tr_b16 v[204:205], v10 offset:21120
    buffer_load_dwordx4 v249, s[16:19], s53 offen lds
    v_mfma_f32_16x16x32_bf16 v[128:131], v[144:147], v[176:179], v[128:131]
    ds_read_b64_tr_b16 v[206:207], v10 offset:21376
    v_mfma_f32_16x16x32_bf16 v[84:87], v[136:139], v[180:183], v[84:87]
    v_mfma_f32_16x16x32_bf16 v[108:111], v[140:143], v[180:183], v[108:111]
    s_add_u32 m0, s101, 100608
    v_mfma_f32_16x16x32_bf16 v[132:135], v[144:147], v[180:183], v[132:135]
    s_waitcnt lgkmcnt(0)
    buffer_load_dwordx4 v4, s[12:15], s51 offen lds
    v_mfma_f32_16x16x32_bf16 v[64:67], v[184:187], v[148:151], v[64:67]
    v_mfma_f32_16x16x32_bf16 v[88:91], v[184:187], v[152:155], v[88:91]
    v_mfma_f32_16x16x32_bf16 v[112:115], v[184:187], v[156:159], v[112:115]
    s_waitcnt vmcnt(9) lgkmcnt(0)
    s_barrier
    v_mfma_f32_16x16x32_bf16 v[68:71], v[188:191], v[148:151], v[68:71]
    ds_read_b128 v[136:139], v11 offset:37632
    ds_read_b64_tr_b16 v[160:161], v9 offset:37632
    v_mfma_f32_16x16x32_bf16 v[92:95], v[188:191], v[152:155], v[92:95]
    ds_read_b64_tr_b16 v[162:163], v9 offset:37888
    s_add_u32 m0, s50, 0
    v_mfma_f32_16x16x32_bf16 v[116:119], v[188:191], v[156:159], v[116:119]
    ds_read_b128 v[140:143], v11 offset:39680
    buffer_load_dwordx4 v5, s[16:19], s59 offen lds
    v_mfma_f32_16x16x32_bf16 v[72:75], v[192:195], v[148:151], v[72:75]
    ds_read_b128 v[144:147], v11 offset:41728
    s_mul_i32 s52, s100, 64*2688
    v_mfma_f32_16x16x32_bf16 v[96:99], v[192:195], v[152:155], v[96:99]
    ds_read_b64_tr_b16 v[164:165], v10 offset:37632
    ds_read_b64_tr_b16 v[166:167], v10 offset:37888
    v_mfma_f32_16x16x32_bf16 v[120:123], v[192:195], v[156:159], v[120:123]
    ds_read_b64_tr_b16 v[168:169], v9 offset:41856
    s_add_u32 m0, s50, 12672
    v_mfma_f32_16x16x32_bf16 v[76:79], v[196:199], v[148:151], v[76:79]
    ds_read_b64_tr_b16 v[170:171], v9 offset:42112
    buffer_load_dwordx4 v5, s[16:19], s60 offen lds
    v_mfma_f32_16x16x32_bf16 v[100:103], v[196:199], v[152:155], v[100:103]
    ds_read_b64_tr_b16 v[172:173], v10 offset:41856
    s_lshl_b32 s51, s100, 7
    v_mfma_f32_16x16x32_bf16 v[124:127], v[196:199], v[156:159], v[124:127]
    ds_read_b64_tr_b16 v[174:175], v10 offset:42112
    ds_read_b64_tr_b16 v[176:177], v9 offset:46080
    v_mfma_f32_16x16x32_bf16 v[80:83], v[148:151], v[200:203], v[80:83]
    ds_read_b64_tr_b16 v[178:179], v9 offset:46336
    s_add_u32 s53, s52, 32*2688
    v_mfma_f32_16x16x32_bf16 v[104:107], v[152:155], v[200:203], v[104:107]
    ds_read_b64_tr_b16 v[180:181], v10 offset:46080
    s_add_u32 m0, s49, 25344
    v_mfma_f32_16x16x32_bf16 v[128:131], v[156:159], v[200:203], v[128:131]
    ds_read_b64_tr_b16 v[182:183], v10 offset:46336
    buffer_load_dwordx4 v2, s[12:15], s58 offen lds
    v_mfma_f32_16x16x32_bf16 v[84:87], v[148:151], v[204:207], v[84:87]
    v_mfma_f32_16x16x32_bf16 v[108:111], v[152:155], v[204:207], v[108:111]
    s_add_u32 m0, s46, 0
    v_mfma_f32_16x16x32_bf16 v[132:135], v[156:159], v[204:207], v[132:135]
    s_waitcnt lgkmcnt(0)
    buffer_load_dwordx4 v8, s[16:19], s59 offen lds
    v_mfma_f32_16x16x32_bf16 v[64:67], v[160:163], v[136:139], v[64:67]
    ds_read_b128 v[148:151], v12 offset:37632
    v_mfma_f32_16x16x32_bf16 v[88:91], v[160:163], v[140:143], v[88:91]
    ds_read_b64_tr_b16 v[184:185], v9 offset:50304
    v_mfma_f32_16x16x32_bf16 v[112:115], v[160:163], v[144:147], v[112:115]
    ds_read_b64_tr_b16 v[186:187], v9 offset:50560
    s_add_u32 m0, s46, 12672
    v_mfma_f32_16x16x32_bf16 v[68:71], v[164:167], v[136:139], v[68:71]
    ds_read_b128 v[152:155], v12 offset:39680
    buffer_load_dwordx4 v8, s[16:19], s60 offen lds
    v_mfma_f32_16x16x32_bf16 v[92:95], v[164:167], v[140:143], v[92:95]
    ds_read_b128 v[156:159], v12 offset:41728
    v_mfma_f32_16x16x32_bf16 v[116:119], v[164:167], v[144:147], v[116:119]
    ds_read_b64_tr_b16 v[188:189], v10 offset:50304
    s_add_u32 m0, s99, 25344
    v_mfma_f32_16x16x32_bf16 v[72:75], v[168:171], v[136:139], v[72:75]
    ds_read_b64_tr_b16 v[190:191], v10 offset:50560
    buffer_load_dwordx4 v3, s[12:15], s58 offen lds
    v_mfma_f32_16x16x32_bf16 v[96:99], v[168:171], v[140:143], v[96:99]
    ds_read_b64_tr_b16 v[192:193], v9 offset:54528
    v_mfma_f32_16x16x32_bf16 v[120:123], v[168:171], v[144:147], v[120:123]
    ds_read_b64_tr_b16 v[194:195], v9 offset:54784
    v_mfma_f32_16x16x32_bf16 v[76:79], v[172:175], v[136:139], v[76:79]
    ds_read_b64_tr_b16 v[196:197], v10 offset:54528
    s_add_u32 m0, s98, 0
    v_mfma_f32_16x16x32_bf16 v[100:103], v[172:175], v[140:143], v[100:103]
    ds_read_b64_tr_b16 v[198:199], v10 offset:54784
    buffer_load_dwordx4 v249, s[16:19], s59 offen lds
    v_mfma_f32_16x16x32_bf16 v[124:127], v[172:175], v[144:147], v[124:127]
    ds_read_b64_tr_b16 v[200:201], v9 offset:58752
    v_mfma_f32_16x16x32_bf16 v[80:83], v[136:139], v[176:179], v[80:83]
    ds_read_b64_tr_b16 v[202:203], v9 offset:59008
    s_add_u32 m0, s98, 12672
    v_mfma_f32_16x16x32_bf16 v[104:107], v[140:143], v[176:179], v[104:107]
    ds_read_b64_tr_b16 v[204:205], v10 offset:58752
    buffer_load_dwordx4 v249, s[16:19], s60 offen lds
    v_mfma_f32_16x16x32_bf16 v[128:131], v[144:147], v[176:179], v[128:131]
    ds_read_b64_tr_b16 v[206:207], v10 offset:59008
    v_mfma_f32_16x16x32_bf16 v[84:87], v[136:139], v[180:183], v[84:87]
    v_mfma_f32_16x16x32_bf16 v[108:111], v[140:143], v[180:183], v[108:111]
    s_add_u32 m0, s101, 25344
    v_mfma_f32_16x16x32_bf16 v[132:135], v[144:147], v[180:183], v[132:135]
    s_waitcnt lgkmcnt(0)
    buffer_load_dwordx4 v4, s[12:15], s58 offen lds
    v_mfma_f32_16x16x32_bf16 v[64:67], v[184:187], v[148:151], v[64:67]
    v_mfma_f32_16x16x32_bf16 v[88:91], v[184:187], v[152:155], v[88:91]
    v_mfma_f32_16x16x32_bf16 v[112:115], v[184:187], v[156:159], v[112:115]
    s_waitcnt vmcnt(9) lgkmcnt(0)
    s_barrier
    v_mfma_f32_16x16x32_bf16 v[68:71], v[188:191], v[148:151], v[68:71]
    ds_read_b128 v[136:139], v15 offset:0
    ds_read_b64_tr_b16 v[160:161], v13 offset:0
    v_mfma_f32_16x16x32_bf16 v[92:95], v[188:191], v[152:155], v[92:95]
    ds_read_b64_tr_b16 v[162:163], v13 offset:256
    s_add_u32 m0, s50, 37632
    v_mfma_f32_16x16x32_bf16 v[116:119], v[188:191], v[156:159], v[116:119]
    ds_read_b128 v[140:143], v15 offset:2048
    buffer_load_dwordx4 v5, s[16:19], s52 offen lds
    v_mfma_f32_16x16x32_bf16 v[72:75], v[192:195], v[148:151], v[72:75]
    ds_read_b128 v[144:147], v15 offset:4096
    v_mfma_f32_16x16x32_bf16 v[96:99], v[192:195], v[152:155], v[96:99]
    ds_read_b64_tr_b16 v[164:165], v14 offset:0
    ds_read_b64_tr_b16 v[166:167], v14 offset:256
    v_mfma_f32_16x16x32_bf16 v[120:123], v[192:195], v[156:159], v[120:123]
    ds_read_b64_tr_b16 v[168:169], v13 offset:4224
    s_add_u32 m0, s50, 50304
    v_mfma_f32_16x16x32_bf16 v[76:79], v[196:199], v[148:151], v[76:79]
    ds_read_b64_tr_b16 v[170:171], v13 offset:4480
    buffer_load_dwordx4 v5, s[16:19], s53 offen lds
    v_mfma_f32_16x16x32_bf16 v[100:103], v[196:199], v[152:155], v[100:103]
    ds_read_b64_tr_b16 v[172:173], v14 offset:4224
    v_mfma_f32_16x16x32_bf16 v[124:127], v[196:199], v[156:159], v[124:127]
    ds_read_b64_tr_b16 v[174:175], v14 offset:4480
    ds_read_b64_tr_b16 v[176:177], v13 offset:8448
    v_mfma_f32_16x16x32_bf16 v[80:83], v[148:151], v[200:203], v[80:83]
    ds_read_b64_tr_b16 v[178:179], v13 offset:8704
    v_mfma_f32_16x16x32_bf16 v[104:107], v[152:155], v[200:203], v[104:107]
    ds_read_b64_tr_b16 v[180:181], v14 offset:8448
    s_add_u32 m0, s49, 62976
    v_mfma_f32_16x16x32_bf16 v[128:131], v[156:159], v[200:203], v[128:131]
    ds_read_b64_tr_b16 v[182:183], v14 offset:8704
    buffer_load_dwordx4 v2, s[12:15], s51 offen lds
    v_mfma_f32_16x16x32_bf16 v[84:87], v[148:151], v[204:207], v[84:87]
    v_mfma_f32_16x16x32_bf16 v[108:111], v[152:155], v[204:207], v[108:111]
    s_add_u32 m0, s46, 37632
    v_mfma_f32_16x16x32_bf16 v[132:135], v[156:159], v[204:207], v[132:135]
    s_waitcnt lgkmcnt(0)
    buffer_load_dwordx4 v8, s[16:19], s52 offen lds
    v_mfma_f32_16x16x32_bf16 v[64:67], v[160:163], v[136:139], v[64:67]
    ds_read_b128 v[148:151], v16 offset:0
    v_mfma_f32_16x16x32_bf16 v[88:91], v[160:163], v[140:143], v[88:91]
    ds_read_b64_tr_b16 v[184:185], v13 offset:12672
    v_mfma_f32_16x16x32_bf16 v[112:115], v[160:163], v[144:147], v[112:115]
    ds_read_b64_tr_b16 v[186:187], v13 offset:12928
    s_add_u32 m0, s46, 50304
    v_mfma_f32_16x16x32_bf16 v[68:71], v[164:167], v[136:139], v[68:71]
    ds_read_b128 v[152:155], v16 offset:2048
    buffer_load_dwordx4 v8, s[16:19], s53 offen lds
    v_mfma_f32_16x16x32_bf16 v[92:95], v[164:167], v[140:143], v[92:95]
    ds_read_b128 v[156:159], v16 offset:4096
    v_mfma_f32_16x16x32_bf16 v[116:119], v[164:167], v[144:147], v[116:119]
    ds_read_b64_tr_b16 v[188:189], v14 offset:12672
    s_add_u32 m0, s99, 62976
    v_mfma_f32_16x16x32_bf16 v[72:75], v[168:171], v[136:139], v[72:75]
    ds_read_b64_tr_b16 v[190:191], v14 offset:12928
    buffer_load_dwordx4 v3, s[12:15], s51 offen lds
    v_mfma_f32_16x16x32_bf16 v[96:99], v[168:171], v[140:143], v[96:99]
    ds_read_b64_tr_b16 v[192:193], v13 offset:16896
    v_mfma_f32_16x16x32_bf16 v[120:123], v[168:171], v[144:147], v[120:123]
    ds_read_b64_tr_b16 v[194:195], v13 offset:17152
    v_mfma_f32_16x16x32_bf16 v[76:79], v[172:175], v[136:139], v[76:79]
    ds_read_b64_tr_b16 v[196:197], v14 offset:16896
    s_add_u32 m0, s98, 37632
    v_mfma_f32_16x16x32_bf16 v[100:103], v[172:175], v[140:143], v[100:103]
    ds_read_b64_tr_b16 v[198:199], v14 offset:17152
    buffer_load_dwordx4 v249, s[16:19], s52 offen lds
    v_mfma_f32_16x16x32_bf16 v[124:127], v[172:175], v[144:147], v[124:127]
    ds_read_b64_tr_b16 v[200:201], v13 offset:21120
    v_mfma_f32_16x16x32_bf16 v[80:83], v[136:139], v[176:179], v[80:83]
    ds_read_b64_tr_b16 v[202:203], v13 offset:21376
    s_add_u32 m0, s98, 50304
    v_mfma_f32_16x16x32_bf16 v[104:107], v[140:143], v[176:179], v[104:107]
    ds_read_b64_tr_b16 v[204:205], v14 offset:21120
    buffer_load_dwordx4 v249, s[16:19], s53 offen lds
    v_mfma_f32_16x16x32_bf16 v[128:131], v[144:147], v[176:179], v[128:131]
    ds_read_b64_tr_b16 v[206:207], v14 offset:21376
    v_mfma_f32_16x16x32_bf16 v[84:87], v[136:139], v[180:183], v[84:87]
    v_mfma_f32_16x16x32_bf16 v[108:111], v[140:143], v[180:183], v[108:111]
    s_add_u32 m0, s101, 62976
    v_mfma_f32_16x16x32_bf16 v[132:135], v[144:147], v[180:183], v[132:135]
    s_waitcnt lgkmcnt(0)
    buffer_load_dwordx4 v4, s[12:15], s51 offen lds
    v_mfma_f32_16x16x32_bf16 v[64:67], v[184:187], v[148:151], v[64:67]
    v_mfma_f32_16x16x32_bf16 v[88:91], v[184:187], v[152:155], v[88:91]
    v_mfma_f32_16x16x32_bf16 v[112:115], v[184:187], v[156:159], v[112:115]
    buffer_load_dword v43, v41, s[20:23], 0 offen sc1
    s_waitcnt vmcnt(10) lgkmcnt(0)
    s_barrier
    v_mfma_f32_16x16x32_bf16 v[68:71], v[188:191], v[148:151], v[68:71]
    ds_read_b128 v[136:139], v11 offset:0
    ds_read_b64_tr_b16 v[160:161], v9 offset:0
    v_mfma_f32_16x16x32_bf16 v[92:95], v[188:191], v[152:155], v[92:95]
    ds_read_b64_tr_b16 v[162:163], v9 offset:256
    s_add_u32 m0, s45, 0
    v_mfma_f32_16x16x32_bf16 v[116:119], v[188:191], v[156:159], v[116:119]
    ds_read_b128 v[140:143], v11 offset:2048
    s_mov_b32 s6, 0
    v_mfma_f32_16x16x32_bf16 v[72:75], v[192:195], v[148:151], v[72:75]
    ds_read_b128 v[144:147], v11 offset:4096
    buffer_load_dwordx4 v240, s[24:27], s6 offen lds
    v_mfma_f32_16x16x32_bf16 v[96:99], v[192:195], v[152:155], v[96:99]
    ds_read_b64_tr_b16 v[164:165], v10 offset:0
    ds_read_b64_tr_b16 v[166:167], v10 offset:256
    v_mfma_f32_16x16x32_bf16 v[120:123], v[192:195], v[156:159], v[120:123]
    ds_read_b64_tr_b16 v[168:169], v9 offset:4224
    s_add_u32 m0, s45, 4096
    v_mfma_f32_16x16x32_bf16 v[76:79], v[196:199], v[148:151], v[76:79]
    ds_read_b64_tr_b16 v[170:171], v9 offset:4480
    s_mov_b32 s6, 28672
    v_mfma_f32_16x16x32_bf16 v[100:103], v[196:199], v[152:155], v[100:103]
    ds_read_b64_tr_b16 v[172:173], v10 offset:4224
    buffer_load_dwordx4 v240, s[24:27], s6 offen lds
    v_mfma_f32_16x16x32_bf16 v[124:127], v[196:199], v[156:159], v[124:127]
    ds_read_b64_tr_b16 v[174:175], v10 offset:4480
    ds_read_b64_tr_b16 v[176:177], v9 offset:8448
    v_mfma_f32_16x16x32_bf16 v[80:83], v[148:151], v[200:203], v[80:83]
    ds_read_b64_tr_b16 v[178:179], v9 offset:8704
    v_lshlrev_b32 v5, 10, v252
    v_mfma_f32_16x16x32_bf16 v[104:107], v[152:155], v[200:203], v[104:107]
    ds_read_b64_tr_b16 v[180:181], v10 offset:8448
    s_add_u32 m0, s45, 8192
    v_mfma_f32_16x16x32_bf16 v[128:131], v[156:159], v[200:203], v[128:131]
    ds_read_b64_tr_b16 v[182:183], v10 offset:8704
    s_mov_b32 s6, 57344
    v_mfma_f32_16x16x32_bf16 v[84:87], v[148:151], v[204:207], v[84:87]
    buffer_load_dwordx4 v240, s[24:27], s6 offen lds
    v_sub_u32 v2, v241, v5
    v_mfma_f32_16x16x32_bf16 v[108:111], v[152:155], v[204:207], v[108:111]
    s_add_u32 m0, s45, 12288
    v_sub_u32 v3, v242, v5
    v_mfma_f32_16x16x32_bf16 v[132:135], v[156:159], v[204:207], v[132:135]
    s_waitcnt lgkmcnt(0)
    s_mov_b32 s6, 86016
    v_mfma_f32_16x16x32_bf16 v[64:67], v[160:163], v[136:139], v[64:67]
    ds_read_b128 v[148:151], v12 offset:0
    buffer_load_dwordx4 v240, s[24:27], s6 offen lds
    v_mfma_f32_16x16x32_bf16 v[88:91], v[160:163], v[140:143], v[88:91]
    ds_read_b64_tr_b16 v[184:185], v9 offset:12672
    v_sub_u32 v4, v243, v5
    v_mfma_f32_16x16x32_bf16 v[112:115], v[160:163], v[144:147], v[112:115]
    ds_read_b64_tr_b16 v[186:187], v9 offset:12928
    s_add_u32 m0, s45, 16384
    v_mfma_f32_16x16x32_bf16 v[68:71], v[164:167], v[136:139], v[68:71]
    ds_read_b128 v[152:155], v12 offset:2048
    s_mov_b32 s6, 114688
    v_mfma_f32_16x16x32_bf16 v[92:95], v[164:167], v[140:143], v[92:95]
    ds_read_b128 v[156:159], v12 offset:4096
    buffer_load_dwordx4 v240, s[24:27], s6 offen lds
    v_mfma_f32_16x16x32_bf16 v[116:119], v[164:167], v[144:147], v[116:119]
    ds_read_b64_tr_b16 v[188:189], v10 offset:12672
    s_add_u32 m0, s45, 20480
    v_mfma_f32_16x16x32_bf16 v[72:75], v[168:171], v[136:139], v[72:75]
    ds_read_b64_tr_b16 v[190:191], v10 offset:12928
    s_mov_b32 s6, 143360
    v_mfma_f32_16x16x32_bf16 v[96:99], v[168:171], v[140:143], v[96:99]
    ds_read_b64_tr_b16 v[192:193], v9 offset:16896
    buffer_load_dwordx4 v240, s[24:27], s6 offen lds
    v_mfma_f32_16x16x32_bf16 v[120:123], v[168:171], v[144:147], v[120:123]
    ds_read_b64_tr_b16 v[194:195], v9 offset:17152
    v_sub_u32 v5, v244, v5
    v_mfma_f32_16x16x32_bf16 v[76:79], v[172:175], v[136:139], v[76:79]
    ds_read_b64_tr_b16 v[196:197], v10 offset:16896
    s_add_u32 m0, s45, 24576
    v_mfma_f32_16x16x32_bf16 v[100:103], v[172:175], v[140:143], v[100:103]
    ds_read_b64_tr_b16 v[198:199], v10 offset:17152
    s_mov_b32 s6, 172032
    v_mfma_f32_16x16x32_bf16 v[124:127], v[172:175], v[144:147], v[124:127]
    ds_read_b64_tr_b16 v[200:201], v9 offset:21120
    buffer_load_dwordx4 v240, s[24:27], s6 offen lds
    v_mfma_f32_16x16x32_bf16 v[80:83], v[136:139], v[176:179], v[80:83]
    ds_read_b64_tr_b16 v[202:203], v9 offset:21376
    s_add_u32 m0, s45, 28672
    v_mfma_f32_16x16x32_bf16 v[104:107], v[140:143], v[176:179], v[104:107]
    ds_read_b64_tr_b16 v[204:205], v10 offset:21120
    s_mov_b32 s6, 200704
    v_mfma_f32_16x16x32_bf16 v[128:131], v[144:147], v[176:179], v[128:131]
    ds_read_b64_tr_b16 v[206:207], v10 offset:21376
    buffer_load_dwordx4 v240, s[24:27], s6 offen lds
    v_mfma_f32_16x16x32_bf16 v[84:87], v[136:139], v[180:183], v[84:87]
    s_movk_i32 s58, 4096
    s_movk_i32 s59, 8192
    v_mfma_f32_16x16x32_bf16 v[108:111], v[140:143], v[180:183], v[108:111]
    s_add_u32 m0, s45, 32768
    s_movk_i32 s60, 12288
    v_mfma_f32_16x16x32_bf16 v[132:135], v[144:147], v[180:183], v[132:135]
    s_waitcnt lgkmcnt(0)
    s_mov_b32 s6, 229376
    v_mfma_f32_16x16x32_bf16 v[64:67], v[184:187], v[148:151], v[64:67]
    buffer_load_dwordx4 v240, s[24:27], s6 offen lds
    v_mfma_f32_16x16x32_bf16 v[88:91], v[184:187], v[152:155], v[88:91]
    s_add_u32 m0, s45, 36864
    v_mfma_f32_16x16x32_bf16 v[112:115], v[184:187], v[156:159], v[112:115]
    s_mov_b32 s6, 258048
    v_mfma_f32_16x16x32_bf16 v[68:71], v[188:191], v[148:151], v[68:71]
    buffer_load_dwordx4 v240, s[24:27], s6 offen lds
    v_mfma_f32_16x16x32_bf16 v[92:95], v[188:191], v[152:155], v[92:95]
    v_mfma_f32_16x16x32_bf16 v[116:119], v[188:191], v[156:159], v[116:119]
    s_waitcnt vmcnt(10) lgkmcnt(0)
    s_barrier
    ds_read_b128 v[144:147], v11 offset:41728
    ds_read_b64_tr_b16 v[164:165], v10 offset:37632
    v_mfma_f32_16x16x32_bf16 v[72:75], v[192:195], v[148:151], v[72:75]
    ds_read_b64_tr_b16 v[166:167], v10 offset:37888
    ds_read_b128 v[140:143], v11 offset:39680
    v_mfma_f32_16x16x32_bf16 v[96:99], v[192:195], v[152:155], v[96:99]
    ds_read_b128 v[136:139], v11 offset:37632
    ds_read_b64_tr_b16 v[172:173], v10 offset:41856
    v_mfma_f32_16x16x32_bf16 v[120:123], v[192:195], v[156:159], v[120:123]
    ds_read_b64_tr_b16 v[174:175], v10 offset:42112
    ds_read_b64_tr_b16 v[180:181], v10 offset:46080
    v_mfma_f32_16x16x32_bf16 v[76:79], v[196:199], v[148:151], v[76:79]
    ds_read_b64_tr_b16 v[182:183], v10 offset:46336
    ds_read_b64_tr_b16 v[168:169], v9 offset:41856
    v_mfma_f32_16x16x32_bf16 v[100:103], v[196:199], v[152:155], v[100:103]
    ds_read_b64_tr_b16 v[170:171], v9 offset:42112
    ds_read_b64_tr_b16 v[176:177], v9 offset:46080
    v_mfma_f32_16x16x32_bf16 v[124:127], v[196:199], v[156:159], v[124:127]
    ds_read_b64_tr_b16 v[178:179], v9 offset:46336
    ds_read_b64_tr_b16 v[160:161], v9 offset:37632
    v_mfma_f32_16x16x32_bf16 v[80:83], v[148:151], v[200:203], v[80:83]
    ds_read_b64_tr_b16 v[162:163], v9 offset:37888
    v_mfma_f32_16x16x32_bf16 v[104:107], v[152:155], v[200:203], v[104:107]
    v_mfma_f32_16x16x32_bf16 v[128:131], v[156:159], v[200:203], v[128:131]
    v_mfma_f32_16x16x32_bf16 v[84:87], v[148:151], v[204:207], v[84:87]
    v_mfma_f32_16x16x32_bf16 v[108:111], v[152:155], v[204:207], v[108:111]
    v_mfma_f32_16x16x32_bf16 v[132:135], v[156:159], v[204:207], v[132:135]
    ds_read_b128 v[156:159], v12 offset:41728
    s_add_u32 m0, s45, 40960
    s_waitcnt lgkmcnt(13)
    v_mfma_f32_16x16x32_bf16 v[116:119], v[164:167], v[144:147], v[116:119]
    ds_read_b64_tr_b16 v[188:189], v10 offset:50304
    s_mov_b32 s6, 286720
    s_waitcnt lgkmcnt(13)
    v_mfma_f32_16x16x32_bf16 v[92:95], v[164:167], v[140:143], v[92:95]
    ds_read_b64_tr_b16 v[190:191], v10 offset:50560
    buffer_load_dwordx4 v240, s[24:27], s6 offen lds
    s_waitcnt lgkmcnt(13)
    v_mfma_f32_16x16x32_bf16 v[68:71], v[164:167], v[136:139], v[68:71]
    ds_read_b64_tr_b16 v[196:197], v10 offset:54528
    s_waitcnt lgkmcnt(12)
    v_mfma_f32_16x16x32_bf16 v[124:127], v[172:175], v[144:147], v[124:127]
    ds_read_b64_tr_b16 v[198:199], v10 offset:54784
    s_add_u32 m0, s45, 45056
    v_mfma_f32_16x16x32_bf16 v[100:103], v[172:175], v[140:143], v[100:103]
    ds_read_b128 v[152:155], v12 offset:39680
    s_mov_b32 s6, 315392
    v_mfma_f32_16x16x32_bf16 v[76:79], v[172:175], v[136:139], v[76:79]
    ds_read_b128 v[148:151], v12 offset:37632
    buffer_load_dwordx4 v240, s[24:27], s6 offen lds
    s_waitcnt lgkmcnt(13)
    v_mfma_f32_16x16x32_bf16 v[132:135], v[144:147], v[180:183], v[132:135]
    ds_read_b64_tr_b16 v[204:205], v10 offset:58752
    v_mfma_f32_16x16x32_bf16 v[108:111], v[140:143], v[180:183], v[108:111]
    ds_read_b64_tr_b16 v[206:207], v10 offset:59008
    s_add_u32 m0, s45, 49152
    v_mfma_f32_16x16x32_bf16 v[84:87], v[136:139], v[180:183], v[84:87]
    ds_read_b64_tr_b16 v[192:193], v9 offset:54528
    s_mov_b32 s6, 344064
    s_waitcnt lgkmcnt(7)
    v_mfma_f32_16x16x32_bf16 v[116:119], v[188:191], v[156:159], v[116:119]
    ds_read_b64_tr_b16 v[194:195], v9 offset:54784
    buffer_load_dwordx4 v240, s[24:27], s6 offen lds
    s_waitcnt lgkmcnt(6)
    v_mfma_f32_16x16x32_bf16 v[124:127], v[196:199], v[156:159], v[124:127]
    ds_read_b64_tr_b16 v[200:201], v9 offset:58752
    s_waitcnt lgkmcnt(6)
    v_mfma_f32_16x16x32_bf16 v[92:95], v[188:191], v[152:155], v[92:95]
    ds_read_b64_tr_b16 v[202:203], v9 offset:59008
    s_add_u32 m0, s45, 53248
    v_mfma_f32_16x16x32_bf16 v[100:103], v[196:199], v[152:155], v[100:103]
    ds_read_b64_tr_b16 v[184:185], v9 offset:50304
    s_mov_b32 s6, 372736
    s_waitcnt lgkmcnt(7)
    v_mfma_f32_16x16x32_bf16 v[68:71], v[188:191], v[148:151], v[68:71]
    ds_read_b64_tr_b16 v[186:187], v9 offset:50560
    buffer_load_dwordx4 v240, s[24:27], s6 offen lds
    v_mfma_f32_16x16x32_bf16 v[76:79], v[196:199], v[148:151], v[76:79]
    v_cmp_ne_u32 vcc, v43, v250
    s_waitcnt lgkmcnt(6)
    v_mfma_f32_16x16x32_bf16 v[132:135], v[156:159], v[204:207], v[132:135]
    v_mfma_f32_16x16x32_bf16 v[108:111], v[152:155], v[204:207], v[108:111]
    s_or_b32 s43, vcc_lo, vcc_hi
    v_mfma_f32_16x16x32_bf16 v[84:87], v[148:151], v[204:207], v[84:87]
    v_cvt_pk_bf16_f32 v218, v116, v117
    v_cvt_pk_bf16_f32 v219, v118, v119
    v_cvt_pk_bf16_f32 v216, v124, v125
    v_mfma_f32_16x16x32_bf16 v[120:123], v[168:171], v[144:147], v[120:123]
    v_cvt_pk_bf16_f32 v217, v126, v127
    buffer_store_dwordx4 v[216:219], v36, s[20:23], s38 offen offset:512
    v_cvt_pk_bf16_f32 v214, v92, v93
    v_mfma_f32_16x16x32_bf16 v[96:99], v[168:171], v[140:143], v[96:99]
    v_cvt_pk_bf16_f32 v215, v94, v95
    v_cvt_pk_bf16_f32 v212, v100, v101
    v_cvt_pk_bf16_f32 v213, v102, v103
    v_mfma_f32_16x16x32_bf16 v[72:75], v[168:171], v[136:139], v[72:75]
    buffer_store_dwordx4 v[212:215], v36, s[20:23], s38 offen offset:256
    v_cvt_pk_bf16_f32 v210, v68, v69
    v_cvt_pk_bf16_f32 v211, v70, v71
    v_mfma_f32_16x16x32_bf16 v[128:131], v[144:147], v[176:179], v[128:131]
    v_cvt_pk_bf16_f32 v208, v76, v77
    v_cvt_pk_bf16_f32 v209, v78, v79
    buffer_store_dwordx4 v[208:211], v36, s[20:23], s38 offen offset:0
    v_mfma_f32_16x16x32_bf16 v[104:107], v[140:143], v[176:179], v[104:107]
    v_cvt_pk_bf16_f32 v238, v132, v133
    v_cvt_pk_bf16_f32 v239, v134, v135
    v_cvt_pk_bf16_f32 v236, v108, v109
    v_mfma_f32_16x16x32_bf16 v[80:83], v[136:139], v[176:179], v[80:83]
    v_cvt_pk_bf16_f32 v237, v110, v111
    buffer_store_dwordx4 v[236:239], v37, s[20:23], s38 offen offset:768
    v_cvt_pk_bf16_f32 v234, v84, v85
    v_mfma_f32_16x16x32_bf16 v[112:115], v[160:163], v[144:147], v[112:115]
    v_cvt_pk_bf16_f32 v235, v86, v87
    buffer_store_dwordx2 v[234:235], v37, s[20:23], s39 offen offset:2048
    v_mfma_f32_16x16x32_bf16 v[88:91], v[160:163], v[140:143], v[88:91]
    ds_write_b64 v6, v[216:217] offset:0
    ds_write_b64 v6, v[238:239] offset:1032
    v_mfma_f32_16x16x32_bf16 v[64:67], v[160:163], v[136:139], v[64:67]
    s_waitcnt lgkmcnt(6)
    v_mfma_f32_16x16x32_bf16 v[120:123], v[192:195], v[156:159], v[120:123]
    s_waitcnt lgkmcnt(4)
    v_mfma_f32_16x16x32_bf16 v[128:131], v[156:159], v[200:203], v[128:131]
    s_waitcnt lgkmcnt(2)
    v_mfma_f32_16x16x32_bf16 v[112:115], v[184:187], v[156:159], v[112:115]
    v_mfma_f32_16x16x32_bf16 v[96:99], v[192:195], v[152:155], v[96:99]
    v_mfma_f32_16x16x32_bf16 v[104:107], v[152:155], v[200:203], v[104:107]
    s_nop 1
    v_cvt_pk_bf16_f32 v52, v120, v121
    v_cvt_pk_bf16_f32 v53, v122, v123
    v_mfma_f32_16x16x32_bf16 v[88:91], v[184:187], v[152:155], v[88:91]
    v_cvt_pk_bf16_f32 v230, v128, v129
    v_cvt_pk_bf16_f32 v231, v130, v131
    v_mfma_f32_16x16x32_bf16 v[72:75], v[192:195], v[148:151], v[72:75]
    ds_write_b64 v6, v[52:53] offset:8
    ds_write_b64 v6, v[230:231] offset:1024
    v_mfma_f32_16x16x32_bf16 v[80:83], v[148:151], v[200:203], v[80:83]
    v_cvt_pk_bf16_f32 v54, v112, v113
    v_cvt_pk_bf16_f32 v55, v114, v115
    v_mfma_f32_16x16x32_bf16 v[64:67], v[184:187], v[148:151], v[64:67]
    v_cvt_pk_bf16_f32 v48, v96, v97
    v_cvt_pk_bf16_f32 v49, v98, v99
    v_cvt_pk_bf16_f32 v228, v104, v105
    v_cvt_pk_bf16_f32 v229, v106, v107
    v_cvt_pk_bf16_f32 v50, v88, v89
L_padA2:
    s_cbranch_execz L_back
    v_cvt_pk_bf16_f32 v51, v90, v91
    s_cmp_lg_u32 s43, 0
    s_waitcnt vmcnt(0)
    s_cbranch_scc1 L_rsX
L_rfX:
    buffer_store_dword v250, v248, s[20:23], 0 offen offset:16
L_rdX:
    s_waitcnt vmcnt(5) lgkmcnt(0)
    s_barrier
    ds_read_b128 v[220:223], v7
    ds_read_b64 v[224:225], v7 offset:1024
    ds_read_b64 v[232:233], v7 offset:1032
    v_cvt_pk_bf16_f32 v44, v72, v73
    v_cvt_pk_bf16_f32 v45, v74, v75
    v_cvt_pk_bf16_f32 v46, v64, v65
    v_cvt_pk_bf16_f32 v47, v66, v67
    v_cvt_pk_bf16_f32 v226, v80, v81
    v_cvt_pk_bf16_f32 v227, v82, v83
    v_mfma_f32_16x16x16_bf16 v[164:167], v[52:53], v[54:55], v[24:27]
    v_mfma_f32_16x16x16_bf16 v[160:163], v[48:49], v[54:55], v[20:23]
    v_mfma_f32_16x16x16_bf16 v[172:175], v[48:49], v[50:51], v[24:27]
    v_mfma_f32_16x16x16_bf16 v[168:171], v[44:45], v[50:51], v[20:23]
    v_mfma_f32_16x16x16_bf16 v[188:191], v[44:45], v[46:47], v[60:63]
    s_waitcnt lgkmcnt(2)
    v_mfma_f32_16x16x16_bf16 v[184:187], v[222:223], v[46:47], v[56:59]
    s_bitcmp1_b32 s34, 9
    s_waitcnt lgkmcnt(0)
    s_cbranch_scc1 L_get
    s_mov_b64 exec, s[62:63]
    v_mov_b32 v218, 0
    v_mov_b32 v219, 0
    v_mov_b32 v214, 0
    v_mov_b32 v215, 0
    v_mov_b32 v210, 0
    v_mov_b32 v211, 0
    s_mov_b64 exec, s[64:65]
    v_mov_b32 v232, 0
    v_mov_b32 v233, 0
    v_mov_b32 v234, 0
    v_mov_b32 v235, 0
    v_mov_b32 v236, 0
    v_mov_b32 v237, 0
    v_mov_b32 v238, 0
    v_mov_b32 v239, 0
    s_mov_b64 exec, -1
    s_branch L_imp
L_get:
    ds_read_b64_tr_b16 a[0:1], v241 offset:0
    ds_read_b64_tr_b16 a[2:3], v241 offset:2048
    ds_read_b64_tr_b16 a[4:5], v242 offset:0
    ds_read_b64_tr_b16 a[6:7], v242 offset:2048
    ds_read_b64_tr_b16 a[8:9], v243 offset:0
    ds_read_b64_tr_b16 a[10:11], v243 offset:2048
    ds_read_b64_tr_b16 a[12:13], v244 offset:0
    ds_read_b64_tr_b16 a[14:15], v244 offset:2048
    s_mov_b32 s10, 65536
L_plX:
    buffer_load_dword v42, v40, s[20:23], 0 offen sc1
    s_sub_u32 s10, s10, 1
    s_cbranch_scc1 L_pdX
    s_waitcnt vmcnt(0)
    v_cmp_ne_u32 vcc, v42, v250
    s_nop 0
    s_and_b64 exec, exec, vcc
    s_cbranch_scc1 L_plX
L_pdX:
    s_mov_b64 exec, -1
    s_cmp_lg_u32 s43, 0
    s_cbranch_scc1 L_asX
L_adX:
    s_mov_b64 exec, s[62:63]
    buffer_load_dwordx4 v[216:219], v38, s[20:23], s38 offen offset:512 sc1
    buffer_load_dwordx4 v[212:215], v38, s[20:23], s38 offen offset:256 sc1
    buffer_load_dwordx4 v[208:211], v38, s[20:23], s38 offen offset:0 sc1
    buffer_load_dwordx2 v[220:221], v38, s[20:23], 0 offen offset:512 sc1
    s_mov_b64 exec, s[64:65]
    buffer_load_dwordx4 v[236:239], v39, s[20:23], s38 offen offset:768 sc1
    buffer_load_dwordx2 v[234:235], v39, s[20:23], s39 offen offset:2048 sc1
    buffer_load_dwordx2 v[232:233], v39, s[20:23], 0 offen offset:776 sc1
    s_mov_b64 exec, -1
    ds_read_b64_tr_b16 a[16:17], v243 offset:3584
    ds_read_b64_tr_b16 a[18:19], v243 offset:5632
    ds_read_b64_tr_b16 a[20:21], v244 offset:3584
    ds_read_b64_tr_b16 a[22:23], v244 offset:5632
    ds_read_b64_tr_b16 a[24:25], v241 offset:3584
    ds_read_b64_tr_b16 a[26:27], v241 offset:5632
    ds_read_b64_tr_b16 a[28:29], v242 offset:3584
    ds_read_b64_tr_b16 a[30:31], v242 offset:5632
    ds_read_b64_tr_b16 a[48:49], v243 offset:10752
    ds_read_b64_tr_b16 a[50:51], v243 offset:12800
    ds_read_b64_tr_b16 a[52:53], v244 offset:10752
    ds_read_b64_tr_b16 a[54:55], v244 offset:12800
    ds_read_b64_tr_b16 a[56:57], v241 offset:10752
    ds_read_b64_tr_b16 a[58:59], v241 offset:12800
    ds_read_b64_tr_b16 a[60:61], v242 offset:10752
    ds_read_b64_tr_b16 a[62:63], v242 offset:12800
    ds_read_b64_tr_b16 a[80:81], v243 offset:17920
    ds_read_b64_tr_b16 a[82:83], v243 offset:19968
    ds_read_b64_tr_b16 a[84:85], v244 offset:17920
    ds_read_b64_tr_b16 a[86:87], v244 offset:19968
    ds_read_b64_tr_b16 a[88:89], v241 offset:17920
    ds_read_b64_tr_b16 a[90:91], v241 offset:19968
    ds_read_b64_tr_b16 a[92:93], v242 offset:17920
    ds_read_b64_tr_b16 a[94:95], v242 offset:19968
    ds_read_b64_tr_b16 a[112:113], v243 offset:25088
    ds_read_b64_tr_b16 a[114:115], v243 offset:27136
    ds_read_b64_tr_b16 a[116:117], v244 offset:25088
    ds_read_b64_tr_b16 a[118:119], v244 offset:27136
    ds_read_b64_tr_b16 a[120:121], v241 offset:25088
    ds_read_b64_tr_b16 a[122:123], v241 offset:27136
    ds_read_b64_tr_b16 a[124:125], v242 offset:25088
    ds_read_b64_tr_b16 a[126:127], v242 offset:27136
    s_branch L_imp
L_Sget:
    s_mov_b32 s10, 65536
L_plS:
    buffer_load_dword v42, v40, s[20:23], 0 offen sc1
    s_sub_u32 s10, s10, 1
    s_cbranch_scc1 L_pdS
    s_waitcnt vmcnt(0)
    v_cmp_ne_u32 vcc, v42, v250
    s_nop 0
    s_and_b64 exec, exec, vcc
    s_cbranch_scc1 L_plS
L_pdS:
    s_mov_b64 exec, -1
    s_cmp_lg_u32 s43, 0
    s_cbranch_scc1 L_asS
L_adS:
    buffer_load_dwordx4 v[52:55], v36, s[20:23], s38 offen offset:512 sc1
    buffer_load_dwordx4 v[216:219], v38, s[20:23], s38 offen offset:512 sc1
    buffer_load_dwordx4 v[48:51], v36, s[20:23], s38 offen offset:256 sc1
    buffer_load_dwordx4 v[212:215], v38, s[20:23], s38 offen offset:256 sc1
    buffer_load_dwordx4 v[44:47], v36, s[20:23], s38 offen offset:0 sc1
    buffer_load_dwordx4 v[208:211], v38, s[20:23], s38 offen offset:0 sc1
    buffer_load_dwordx2 v[222:223], v36, s[20:23], 0 offen offset:512 sc1
    buffer_load_dwordx2 v[220:221], v38, s[20:23], 0 offen offset:512 sc1
    s_waitcnt vmcnt(7)
    v_mfma_f32_16x16x16_bf16 v[164:167], v[52:53], v[54:55], v[24:27]
    buffer_load_dwordx4 v[228:231], v37, s[20:23], s38 offen offset:768 sc1
    s_waitcnt vmcnt(7)
    v_mfma_f32_16x16x16_bf16 v[164:167], v[216:217], v[218:219], v[164:167]
    s_waitcnt vmcnt(6)
    v_mfma_f32_16x16x16_bf16 v[160:163], v[48:49], v[54:55], v[20:23]
    buffer_load_dwordx2 v[226:227], v37, s[20:23], s39 offen offset:2048 sc1
    s_waitcnt vmcnt(6)
    v_mfma_f32_16x16x16_bf16 v[160:163], v[212:213], v[218:219], v[160:163]
    v_mfma_f32_16x16x16_bf16 v[172:175], v[48:49], v[50:51], v[24:27]
    buffer_load_dwordx2 v[224:225], v37, s[20:23], 0 offen offset:776 sc1
    v_mfma_f32_16x16x16_bf16 v[172:175], v[212:213], v[214:215], v[172:175]
    s_waitcnt vmcnt(6)
    v_mfma_f32_16x16x16_bf16 v[168:171], v[44:45], v[50:51], v[20:23]
    buffer_load_dwordx4 v[236:239], v39, s[20:23], s38 offen offset:768 sc1
    s_waitcnt vmcnt(6)
    v_mfma_f32_16x16x16_bf16 v[168:171], v[208:209], v[214:215], v[168:171]
    v_mfma_f32_16x16x16_bf16 v[188:191], v[44:45], v[46:47], v[60:63]
    buffer_load_dwordx2 v[234:235], v39, s[20:23], s39 offen offset:2048 sc1
    v_mfma_f32_16x16x16_bf16 v[188:191], v[208:209], v[210:211], v[188:191]
    s_waitcnt vmcnt(6)
    v_mfma_f32_16x16x16_bf16 v[184:187], v[222:223], v[46:47], v[56:59]
    buffer_load_dwordx2 v[232:233], v39, s[20:23], 0 offen offset:776 sc1
    s_waitcnt vmcnt(6)
    v_mfma_f32_16x16x16_bf16 v[184:187], v[220:221], v[210:211], v[184:187]
    s_branch L_sm
L_imp:
    s_waitcnt vmcnt(6)
    v_mfma_f32_16x16x16_bf16 v[164:167], v[216:217], v[218:219], v[164:167]
    s_waitcnt vmcnt(5)
    v_mfma_f32_16x16x16_bf16 v[160:163], v[212:213], v[218:219], v[160:163]
    v_mfma_f32_16x16x16_bf16 v[172:175], v[212:213], v[214:215], v[172:175]
    s_waitcnt vmcnt(4)
    v_mfma_f32_16x16x16_bf16 v[168:171], v[208:209], v[214:215], v[168:171]
    v_mfma_f32_16x16x16_bf16 v[188:191], v[208:209], v[210:211], v[188:191]
    s_waitcnt vmcnt(3)
    v_mfma_f32_16x16x16_bf16 v[184:187], v[220:221], v[210:211], v[184:187]
    s_waitcnt vmcnt(0)
L_sm:
    s_nop 0
    v_max_f32 v160, v160, v164
    v_max_f32 v161, v161, v165
    v_max_f32 v162, v162, v166
    v_max_f32 v163, v163, v167
    v_max_f32 v168, v168, v172
    v_max_f32 v169, v169, v173
    v_max_f32 v170, v170, v174
    v_max_f32 v171, v171, v175
    v_max_f32 v184, v184, v188
    v_max_f32 v185, v185, v189
    v_max_f32 v186, v186, v190
    v_max_f32 v187, v187, v191
    v_max3_f32 v75, v160, v161, v162
    v_max3_f32 v74, v168, v169, v170
    v_max3_f32 v73, v184, v185, v186
    v_max_f32 v68, v75, v163
    v_max_f32 v72, v75, v163
    v_max_f32 v66, v74, v171
    v_max_f32 v71, v74, v171
    v_max_f32 v64, v73, v187
    v_max_f32 v70, v73, v187
    v_permlane32_swap_b32 v68, v72
    v_permlane32_swap_b32 v66, v71
    v_permlane32_swap_b32 v64, v70
    v_max_f32 v75, v68, v72
    v_max_f32 v68, v68, v72
    v_max_f32 v74, v66, v71
    v_max_f32 v66, v66, v71
    v_max_f32 v73, v64, v70
    v_max_f32 v64, v64, v70
    v_permlane16_swap_b32 v68, v75
    v_permlane16_swap_b32 v66, v74
    v_permlane16_swap_b32 v64, v73
    v_max_f32 v68, v68, v75
    v_max_f32 v66, v66, v74
    v_max_f32 v64, v64, v73
    v_mul_f32 v68, v30, v68
    v_mul_f32 v66, v30, v66
    v_mul_f32 v64, v30, v64
    v_pk_fma_f32 v[160:161], v[160:161], v[30:31], v[68:69] op_sel_hi:[1,0,0] neg_lo:[0,0,1] neg_hi:[0,0,1]
    v_pk_fma_f32 v[162:163], v[162:163], v[30:31], v[68:69] op_sel_hi:[1,0,0] neg_lo:[0,0,1] neg_hi:[0,0,1]
    v_pk_fma_f32 v[168:169], v[168:169], v[30:31], v[66:67] op_sel_hi:[1,0,0] neg_lo:[0,0,1] neg_hi:[0,0,1]
    v_pk_fma_f32 v[170:171], v[170:171], v[30:31], v[66:67] op_sel_hi:[1,0,0] neg_lo:[0,0,1] neg_hi:[0,0,1]
    v_pk_fma_f32 v[184:185], v[184:185], v[30:31], v[64:65] op_sel_hi:[1,0,0] neg_lo:[0,0,1] neg_hi:[0,0,1]
    v_pk_fma_f32 v[186:187], v[186:187], v[30:31], v[64:65] op_sel_hi:[1,0,0] neg_lo:[0,0,1] neg_hi:[0,0,1]
    v_exp_f32 v160, v160
    v_exp_f32 v161, v161
    v_exp_f32 v162, v162
    v_exp_f32 v163, v163
    v_exp_f32 v168, v168
    v_exp_f32 v169, v169
    v_exp_f32 v170, v170
    v_exp_f32 v171, v171
    v_cvt_pk_bf16_f32 v164, v160, v161
    v_cvt_pk_bf16_f32 v165, v162, v163
    v_and_b32 v96, v28, v164
    v_and_b32 v97, v29, v165
    v_bfi_b32 v98, v28, 0, v164
    v_bfi_b32 v99, v29, 0, v165
    v_exp_f32 v184, v184
    v_exp_f32 v185, v185
    s_bitcmp0_b32 s34, 10
    s_cbranch_scc1 L_nov
    s_waitcnt vmcnt(0)
L_nov:
    v_mfma_f32_16x16x32_bf16 v[120:123], v[32:35], v[96:99], 0
    v_exp_f32 v186, v186
    v_exp_f32 v187, v187
    v_mfma_f32_16x16x32_bf16 v[156:159], v[236:239], v[96:99], 0
    v_cvt_pk_bf16_f32 v172, v168, v169
    v_cvt_pk_bf16_f32 v173, v170, v171
    v_mfma_f32_16x16x32_bf16 v[152:155], v[228:231], v[96:99], 0
    v_and_b32 v92, v28, v172
    v_and_b32 v93, v29, v173
    v_bfi_b32 v94, v28, 0, v172
    v_bfi_b32 v95, v29, 0, v173
    v_cvt_pk_bf16_f32 v188, v184, v185
    v_cvt_pk_bf16_f32 v189, v186, v187
    v_mfma_f32_16x16x32_bf16 v[116:119], v[32:35], v[92:95], 0
    v_and_b32 v88, v28, v188
    v_and_b32 v89, v29, v189
    v_mfma_f32_16x16x32_bf16 v[148:151], v[234:237], v[92:95], 0
    v_bfi_b32 v90, v28, 0, v188
    v_bfi_b32 v91, v29, 0, v189
    v_mfma_f32_16x16x32_bf16 v[144:147], v[226:229], v[92:95], 0
    v_rcp_f32 v68, v120
    v_mfma_f32_16x16x32_bf16 v[112:115], v[32:35], v[88:91], 0
    v_mfma_f32_16x16x32_bf16 v[140:143], v[232:235], v[88:91], 0
    v_mfma_f32_16x16x32_bf16 v[136:139], v[224:227], v[88:91], 0
    v_pk_mul_f32 v[152:153], v[152:153], v[68:69] op_sel_hi:[1,0]
    v_pk_mul_f32 v[154:155], v[154:155], v[68:69] op_sel_hi:[1,0]
    v_pk_mul_f32 v[156:157], v[156:157], v[68:69] op_sel_hi:[1,0]
    v_pk_mul_f32 v[158:159], v[158:159], v[68:69] op_sel_hi:[1,0]
    v_rcp_f32 v66, v116
    v_cvt_pk_bf16_f32 v200, v152, v153
    v_cvt_pk_bf16_f32 v201, v154, v155
    v_cvt_pk_bf16_f32 v202, v156, v157
    v_cvt_pk_bf16_f32 v203, v158, v159
    buffer_store_dwordx4 v[200:203], v19, s[20:23], 0 offen
    v_pk_mul_f32 v[144:145], v[144:145], v[66:67] op_sel_hi:[1,0]
    v_pk_mul_f32 v[146:147], v[146:147], v[66:67] op_sel_hi:[1,0]
    v_pk_mul_f32 v[148:149], v[148:149], v[66:67] op_sel_hi:[1,0]
    v_pk_mul_f32 v[150:151], v[150:151], v[66:67] op_sel_hi:[1,0]
    v_rcp_f32 v64, v112
    v_cvt_pk_bf16_f32 v196, v144, v145
    v_cvt_pk_bf16_f32 v197, v146, v147
    v_cvt_pk_bf16_f32 v198, v148, v149
    v_cvt_pk_bf16_f32 v199, v150, v151
    buffer_store_dwordx4 v[196:199], v18, s[20:23], 0 offen
    v_pk_mul_f32 v[136:137], v[136:137], v[64:65] op_sel_hi:[1,0]
    v_pk_mul_f32 v[138:139], v[138:139], v[64:65] op_sel_hi:[1,0]
    v_pk_mul_f32 v[140:141], v[140:141], v[64:65] op_sel_hi:[1,0]
    v_pk_mul_f32 v[142:143], v[142:143], v[64:65] op_sel_hi:[1,0]
    v_cvt_pk_bf16_f32 v192, v136, v137
    v_cvt_pk_bf16_f32 v193, v138, v139
    v_cvt_pk_bf16_f32 v194, v140, v141
    v_cvt_pk_bf16_f32 v195, v142, v143
    buffer_store_dwordx4 v[192:195], v17, s[20:23], 0 offen
    s_and_b32 s11, s34, 0x600
L_P2:
    buffer_load_dword v42, v246, s[20:23], 0 offen sc1
    s_cmp_lg_u32 s11, 0
    s_cbranch_scc1 L_nord0
    ds_read_b64_tr_b16 a[0:1], v241 offset:0
    ds_read_b64_tr_b16 a[2:3], v241 offset:2048
    ds_read_b64_tr_b16 a[4:5], v242 offset:0
    ds_read_b64_tr_b16 a[6:7], v242 offset:2048
    ds_read_b64_tr_b16 a[8:9], v243 offset:0
    ds_read_b64_tr_b16 a[10:11], v243 offset:2048
    ds_read_b64_tr_b16 a[12:13], v244 offset:0
    ds_read_b64_tr_b16 a[14:15], v244 offset:2048
L_nord0:
    s_cmp_lg_u32 s43, 0
    s_waitcnt vmcnt(0)
    s_cbranch_scc1 L_rsO
L_rfO:
    buffer_store_dword v250, v248, s[20:23], 0 offen offset:0
L_rdO:
    s_cmp_lg_u32 s11, 0
    s_cbranch_scc1 L_nord
    ds_read_b64_tr_b16 a[16:17], v243 offset:3584
    ds_read_b64_tr_b16 a[18:19], v243 offset:5632
    ds_read_b64_tr_b16 a[20:21], v244 offset:3584
    ds_read_b64_tr_b16 a[22:23], v244 offset:5632
    ds_read_b64_tr_b16 a[24:25], v241 offset:3584
    ds_read_b64_tr_b16 a[26:27], v241 offset:5632
    ds_read_b64_tr_b16 a[28:29], v242 offset:3584
    ds_read_b64_tr_b16 a[30:31], v242 offset:5632
    ds_read_b64_tr_b16 a[48:49], v243 offset:10752
    ds_read_b64_tr_b16 a[50:51], v243 offset:12800
    ds_read_b64_tr_b16 a[52:53], v244 offset:10752
    ds_read_b64_tr_b16 a[54:55], v244 offset:12800
    ds_read_b64_tr_b16 a[56:57], v241 offset:10752
    ds_read_b64_tr_b16 a[58:59], v241 offset:12800
    ds_read_b64_tr_b16 a[60:61], v242 offset:10752
    ds_read_b64_tr_b16 a[62:63], v242 offset:12800
    ds_read_b64_tr_b16 a[80:81], v243 offset:17920
    ds_read_b64_tr_b16 a[82:83], v243 offset:19968
    ds_read_b64_tr_b16 a[84:85], v244 offset:17920
    ds_read_b64_tr_b16 a[86:87], v244 offset:19968
    ds_read_b64_tr_b16 a[88:89], v241 offset:17920
    ds_read_b64_tr_b16 a[90:91], v241 offset:19968
    ds_read_b64_tr_b16 a[92:93], v242 offset:17920
    ds_read_b64_tr_b16 a[94:95], v242 offset:19968
    ds_read_b64_tr_b16 a[112:113], v243 offset:25088
    ds_read_b64_tr_b16 a[114:115], v243 offset:27136
    ds_read_b64_tr_b16 a[116:117], v244 offset:25088
    ds_read_b64_tr_b16 a[118:119], v244 offset:27136
    ds_read_b64_tr_b16 a[120:121], v241 offset:25088
    ds_read_b64_tr_b16 a[122:123], v241 offset:27136
    ds_read_b64_tr_b16 a[124:125], v242 offset:25088
    ds_read_b64_tr_b16 a[126:127], v242 offset:27136
L_nord:
    v_cmp_ne_u32 vcc, v42, v250
    s_cmp_lg_u32 s43, 0
    s_cselect_b32 s6, -1, 0xf5af5af
    s_mov_b32 exec_hi, 0
    s_and_b32 exec_lo, vcc_lo, s6
    s_cbranch_scc0 L_pdP
    s_mov_b32 s10, 65536
L_plP:
    buffer_load_dword v42, v246, s[20:23], 0 offen sc1
    s_sub_u32 s10, s10, 1
    s_cbranch_scc1 L_pdP
    s_waitcnt vmcnt(0)
    v_cmp_ne_u32 vcc, v42, v250
    s_nop 0
    s_and_b64 exec, exec, vcc
    s_cbranch_scc1 L_plP
L_pdP:
    s_mov_b64 exec, -1
    s_cmp_lg_u32 s43, 0
    s_cbranch_scc1 L_asP
L_adP:
    buffer_load_dwordx4 v[64:67], v245, s[20:23], 0 offen offset:0 sc1
    buffer_load_dwordx4 v[68:71], v245, s[20:23], 0 offen offset:1024 sc1
    buffer_load_dwordx4 v[72:75], v245, s[20:23], 0 offen offset:3072 sc1
    buffer_load_dwordx4 v[76:79], v245, s[20:23], s58 offen offset:1024 sc1
    buffer_load_dword v28, v246, s[20:23], 0 offen sc1
    ds_read_b64_tr_b16 a[128:129], v241 offset:28672
    ds_read_b64_tr_b16 a[130:131], v241 offset:30720
    ds_read_b64_tr_b16 a[132:133], v242 offset:28672
    ds_read_b64_tr_b16 a[134:135], v242 offset:30720
    ds_read_b64_tr_b16 a[136:137], v243 offset:28672
    ds_read_b64_tr_b16 a[138:139], v243 offset:30720
    ds_read_b64_tr_b16 a[140:141], v244 offset:28672
    ds_read_b64_tr_b16 a[142:143], v244 offset:30720
    buffer_load_dwordx4 v[80:83], v245, s[20:23], s58 offen offset:3072 sc1
    ds_read_b64_tr_b16 a[160:161], v241 offset:35840
    ds_read_b64_tr_b16 a[162:163], v241 offset:37888
    ds_read_b64_tr_b16 a[164:165], v242 offset:35840
    ds_read_b64_tr_b16 a[166:167], v242 offset:37888
    ds_read_b64_tr_b16 a[168:169], v243 offset:35840
    ds_read_b64_tr_b16 a[170:171], v243 offset:37888
    ds_read_b64_tr_b16 a[172:173], v244 offset:35840
    ds_read_b64_tr_b16 a[174:175], v244 offset:37888
    buffer_load_dwordx4 v[84:87], v245, s[20:23], s59 offen offset:0 sc1
    ds_read_b64_tr_b16 a[192:193], v241 offset:43008
    ds_read_b64_tr_b16 a[194:195], v241 offset:45056
    ds_read_b64_tr_b16 a[196:197], v242 offset:43008
    ds_read_b64_tr_b16 a[198:199], v242 offset:45056
    ds_read_b64_tr_b16 a[200:201], v243 offset:43008
    ds_read_b64_tr_b16 a[202:203], v243 offset:45056
    ds_read_b64_tr_b16 a[204:205], v244 offset:43008
    ds_read_b64_tr_b16 a[206:207], v244 offset:45056
    ds_read_b64_tr_b16 a[224:225], v241 offset:50176
    ds_read_b64_tr_b16 a[226:227], v241 offset:52224
    ds_read_b64_tr_b16 a[228:229], v242 offset:50176
    ds_read_b64_tr_b16 a[230:231], v242 offset:52224
    ds_read_b64_tr_b16 a[232:233], v243 offset:50176
    ds_read_b64_tr_b16 a[234:235], v243 offset:52224
    ds_read_b64_tr_b16 a[236:237], v244 offset:50176
    ds_read_b64_tr_b16 a[238:239], v244 offset:52224
    s_waitcnt lgkmcnt(15)
    s_waitcnt vmcnt(6)
    v_mfma_f32_16x16x32_bf16 v[32:35], a[0:3], v[64:67], 0
    ds_read_b64_tr_b16 a[240:241], v243 offset:53760
    buffer_load_dwordx4 v[88:91], v245, s[20:23], s59 offen offset:2048 sc1
    v_mfma_f32_16x16x32_bf16 v[36:39], a[4:7], v[64:67], 0
    ds_read_b64_tr_b16 a[242:243], v243 offset:55808
    v_mfma_f32_16x16x32_bf16 v[40:43], a[8:11], v[64:67], 0
    ds_read_b64_tr_b16 a[244:245], v244 offset:53760
    v_mfma_f32_16x16x32_bf16 v[44:47], a[12:15], v[64:67], 0
    ds_read_b64_tr_b16 a[246:247], v244 offset:55808
    s_waitcnt vmcnt(6)
    v_mfma_f32_16x16x32_bf16 v[32:35], a[16:19], v[68:71], v[32:35]
    ds_read_b64_tr_b16 a[248:249], v241 offset:53760
    buffer_load_dwordx4 v[92:95], v245, s[20:23], s60 offen offset:0 sc1
    v_mfma_f32_16x16x32_bf16 v[36:39], a[20:23], v[68:71], v[36:39]
    ds_read_b64_tr_b16 a[250:251], v241 offset:55808
    v_mfma_f32_16x16x32_bf16 v[40:43], a[24:27], v[68:71], v[40:43]
    ds_read_b64_tr_b16 a[252:253], v242 offset:53760
    v_mfma_f32_16x16x32_bf16 v[44:47], a[28:31], v[68:71], v[44:47]
    ds_read_b64_tr_b16 a[254:255], v242 offset:55808
    s_waitcnt vmcnt(6)
    v_mfma_f32_16x16x32_bf16 v[32:35], a[48:51], v[72:75], v[32:35]
    ds_read_b64_tr_b16 a[32:33], v2 offset:10240
    buffer_load_dwordx4 v[96:99], v245, s[20:23], s60 offen offset:2048 sc1
    v_mfma_f32_16x16x32_bf16 v[36:39], a[52:55], v[72:75], v[36:39]
    ds_read_b64_tr_b16 a[34:35], v2 offset:8192
    v_mfma_f32_16x16x32_bf16 v[40:43], a[56:59], v[72:75], v[40:43]
    ds_read_b64_tr_b16 a[36:37], v3 offset:10240
    v_mfma_f32_16x16x32_bf16 v[44:47], a[60:63], v[72:75], v[44:47]
    ds_read_b64_tr_b16 a[38:39], v3 offset:8192
    s_waitcnt vmcnt(6)
    v_mfma_f32_16x16x32_bf16 v[32:35], a[80:83], v[76:79], v[32:35]
    ds_read_b64_tr_b16 a[40:41], v4 offset:10240
    buffer_load_dwordx4 v[100:103], v245, s[20:23], s60 offen offset:3072 sc1
    v_mfma_f32_16x16x32_bf16 v[36:39], a[84:87], v[76:79], v[36:39]
    ds_read_b64_tr_b16 a[42:43], v4 offset:8192
    v_mfma_f32_16x16x32_bf16 v[40:43], a[88:91], v[76:79], v[40:43]
    ds_read_b64_tr_b16 a[44:45], v5 offset:10240
    v_mfma_f32_16x16x32_bf16 v[44:47], a[92:95], v[76:79], v[44:47]
    ds_read_b64_tr_b16 a[46:47], v5 offset:8192
    s_waitcnt vmcnt(6)
    v_cmp_ne_u32 vcc, v28, v250
    s_nop 0
    s_and_b32 exec_lo, vcc_lo, 0xa50a50
    s_mov_b32 exec_hi, 0
    s_cbranch_scc0 L_pdQ
    s_mov_b32 s10, 65536
L_plQ:
    buffer_load_dword v28, v246, s[20:23], 0 offen sc1
    s_sub_u32 s10, s10, 1
    s_cbranch_scc1 L_pdQ
    s_waitcnt vmcnt(0)
    v_cmp_ne_u32 vcc, v28, v250
    s_nop 0
    s_and_b64 exec, exec, vcc
    s_cbranch_scc1 L_plQ
L_pdQ:
    s_mov_b64 exec, -1
    buffer_load_dwordx4 v[104:107], v245, s[20:23], 0 offen offset:2048 sc1
    s_waitcnt vmcnt(6)
    v_mfma_f32_16x16x32_bf16 v[32:35], a[112:115], v[80:83], v[32:35]
    ds_read_b64_tr_b16 a[96:97], v241 offset:21504
    buffer_load_dwordx4 v[108:111], v245, s[20:23], s58 offen offset:2048 sc1
    v_mfma_f32_16x16x32_bf16 v[36:39], a[116:119], v[80:83], v[36:39]
    ds_read_b64_tr_b16 a[98:99], v241 offset:23552
    v_mfma_f32_16x16x32_bf16 v[40:43], a[120:123], v[80:83], v[40:43]
    ds_read_b64_tr_b16 a[100:101], v242 offset:21504
    v_mfma_f32_16x16x32_bf16 v[44:47], a[124:127], v[80:83], v[44:47]
    ds_read_b64_tr_b16 a[102:103], v242 offset:23552
    s_waitcnt vmcnt(6)
    v_mfma_f32_16x16x32_bf16 v[32:35], a[128:131], v[84:87], v[32:35]
    ds_read_b64_tr_b16 a[104:105], v243 offset:21504
    buffer_load_dword v29, v246, s[20:23], 0 offen sc1
    v_mfma_f32_16x16x32_bf16 v[36:39], a[132:135], v[84:87], v[36:39]
    ds_read_b64_tr_b16 a[106:107], v243 offset:23552
    v_mfma_f32_16x16x32_bf16 v[40:43], a[136:139], v[84:87], v[40:43]
    ds_read_b64_tr_b16 a[108:109], v244 offset:21504
    v_mfma_f32_16x16x32_bf16 v[44:47], a[140:143], v[84:87], v[44:47]
    ds_read_b64_tr_b16 a[110:111], v244 offset:23552
    s_waitcnt vmcnt(6)
    v_mfma_f32_16x16x32_bf16 v[32:35], a[160:163], v[88:91], v[32:35]
    ds_read_b64_tr_b16 a[144:145], v4 offset:35328
    buffer_load_dwordx4 v[112:115], v245, s[20:23], s59 offen offset:1024 sc1
    v_mfma_f32_16x16x32_bf16 v[36:39], a[164:167], v[88:91], v[36:39]
    ds_read_b64_tr_b16 a[146:147], v4 offset:33280
    v_mfma_f32_16x16x32_bf16 v[40:43], a[168:171], v[88:91], v[40:43]
    ds_read_b64_tr_b16 a[148:149], v5 offset:35328
    v_mfma_f32_16x16x32_bf16 v[44:47], a[172:175], v[88:91], v[44:47]
    ds_read_b64_tr_b16 a[150:151], v5 offset:33280
    s_waitcnt lgkmcnt(15) vmcnt(6)
    v_mfma_f32_16x16x32_bf16 v[32:35], a[192:195], v[92:95], v[32:35]
    ds_read_b64_tr_b16 a[152:153], v2 offset:35328
    buffer_load_dwordx4 v[116:119], v245, s[20:23], s60 offen offset:1024 sc1
    v_mfma_f32_16x16x32_bf16 v[36:39], a[196:199], v[92:95], v[36:39]
    ds_read_b64_tr_b16 a[154:155], v2 offset:33280
    v_mfma_f32_16x16x32_bf16 v[40:43], a[200:203], v[92:95], v[40:43]
    ds_read_b64_tr_b16 a[156:157], v3 offset:35328
    v_mfma_f32_16x16x32_bf16 v[44:47], a[204:207], v[92:95], v[44:47]
    ds_read_b64_tr_b16 a[158:159], v3 offset:33280
    s_waitcnt vmcnt(6)
    v_mfma_f32_16x16x32_bf16 v[32:35], a[224:227], v[96:99], v[32:35]
    ds_read_b64_tr_b16 a[208:209], v243 offset:46592
    v_mfma_f32_16x16x32_bf16 v[36:39], a[228:231], v[96:99], v[36:39]
    ds_read_b64_tr_b16 a[210:211], v243 offset:48640
    v_mfma_f32_16x16x32_bf16 v[40:43], a[232:235], v[96:99], v[40:43]
    ds_read_b64_tr_b16 a[212:213], v244 offset:46592
    v_mfma_f32_16x16x32_bf16 v[44:47], a[236:239], v[96:99], v[44:47]
    ds_read_b64_tr_b16 a[214:215], v244 offset:48640
    s_waitcnt vmcnt(5)
    v_mfma_f32_16x16x32_bf16 v[32:35], a[240:243], v[100:103], v[32:35]
    ds_read_b64_tr_b16 a[216:217], v241 offset:46592
    v_mfma_f32_16x16x32_bf16 v[36:39], a[244:247], v[100:103], v[36:39]
    ds_read_b64_tr_b16 a[218:219], v241 offset:48640
    v_mfma_f32_16x16x32_bf16 v[40:43], a[248:251], v[100:103], v[40:43]
    ds_read_b64_tr_b16 a[220:221], v242 offset:46592
    v_mfma_f32_16x16x32_bf16 v[44:47], a[252:255], v[100:103], v[44:47]
    ds_read_b64_tr_b16 a[222:223], v242 offset:48640
    s_waitcnt vmcnt(4)
    v_mfma_f32_16x16x32_bf16 v[32:35], a[32:35], v[104:107], v[32:35]
    ds_read_b64_tr_b16 a[64:65], v241 offset:14336
    v_mfma_f32_16x16x32_bf16 v[36:39], a[36:39], v[104:107], v[36:39]
    ds_read_b64_tr_b16 a[66:67], v241 offset:16384
    s_waitcnt lgkmcnt(15)
    v_mfma_f32_16x16x32_bf16 v[40:43], a[40:43], v[104:107], v[40:43]
    ds_read_b64_tr_b16 a[68:69], v242 offset:14336
    v_mfma_f32_16x16x32_bf16 v[44:47], a[44:47], v[104:107], v[44:47]
    ds_read_b64_tr_b16 a[70:71], v242 offset:16384
    s_waitcnt vmcnt(2)
    v_cmp_ne_u32 vcc, v29, v250
    s_nop 0
    s_and_b32 exec_lo, vcc_lo, 0xf0000000
    s_mov_b32 exec_hi, 0
    s_cbranch_scc0 L_pdW
    s_mov_b32 s10, 65536
L_plW:
    buffer_load_dword v29, v246, s[20:23], 0 offen sc1
    s_sub_u32 s10, s10, 1
    s_cbranch_scc1 L_pdW
    s_waitcnt vmcnt(0)
    v_cmp_ne_u32 vcc, v29, v250
    s_nop 0
    s_and_b64 exec, exec, vcc
    s_cbranch_scc1 L_plW
L_pdW:
    s_mov_b64 exec, -1
    buffer_load_dwordx4 v[120:123], v245, s[20:23], s58 offen offset:0 sc1
    buffer_load_dwordx4 v[124:127], v245, s[20:23], s59 offen offset:3072 sc1
    v_mfma_f32_16x16x32_bf16 v[32:35], a[96:99], v[108:111], v[32:35]
    ds_read_b64_tr_b16 a[72:73], v243 offset:14336
    v_mfma_f32_16x16x32_bf16 v[36:39], a[100:103], v[108:111], v[36:39]
    ds_read_b64_tr_b16 a[74:75], v243 offset:16384
    v_mfma_f32_16x16x32_bf16 v[40:43], a[104:107], v[108:111], v[40:43]
    ds_read_b64_tr_b16 a[76:77], v244 offset:14336
    v_mfma_f32_16x16x32_bf16 v[44:47], a[108:111], v[108:111], v[44:47]
    ds_read_b64_tr_b16 a[78:79], v244 offset:16384
    s_waitcnt vmcnt(3)
    v_mfma_f32_16x16x32_bf16 v[32:35], a[144:147], v[112:115], v[32:35]
    ds_read_b64_tr_b16 a[176:177], v243 offset:39424
    s_waitcnt lgkmcnt(15)
    v_mfma_f32_16x16x32_bf16 v[36:39], a[148:151], v[112:115], v[36:39]
    ds_read_b64_tr_b16 a[178:179], v243 offset:41472
    v_mfma_f32_16x16x32_bf16 v[40:43], a[152:155], v[112:115], v[40:43]
    ds_read_b64_tr_b16 a[180:181], v244 offset:39424
    v_mfma_f32_16x16x32_bf16 v[44:47], a[156:159], v[112:115], v[44:47]
    ds_read_b64_tr_b16 a[182:183], v244 offset:41472
    s_waitcnt vmcnt(2)
    v_mfma_f32_16x16x32_bf16 v[32:35], a[208:211], v[116:119], v[32:35]
    ds_read_b64_tr_b16 a[184:185], v241 offset:39424
    s_waitcnt lgkmcnt(15)
    v_mfma_f32_16x16x32_bf16 v[36:39], a[212:215], v[116:119], v[36:39]
    ds_read_b64_tr_b16 a[186:187], v241 offset:41472
    v_mfma_f32_16x16x32_bf16 v[40:43], a[216:219], v[116:119], v[40:43]
    ds_read_b64_tr_b16 a[188:189], v242 offset:39424
    s_waitcnt lgkmcnt(15)
    v_mfma_f32_16x16x32_bf16 v[44:47], a[220:223], v[116:119], v[44:47]
    ds_read_b64_tr_b16 a[190:191], v242 offset:41472
    s_waitcnt lgkmcnt(14) vmcnt(1)
    v_mfma_f32_16x16x32_bf16 v[32:35], a[64:67], v[120:123], v[32:35]
    s_waitcnt lgkmcnt(12)
    v_mfma_f32_16x16x32_bf16 v[36:39], a[68:71], v[120:123], v[36:39]
    s_waitcnt lgkmcnt(10)
    v_mfma_f32_16x16x32_bf16 v[40:43], a[72:75], v[120:123], v[40:43]
    s_waitcnt lgkmcnt(8)
    v_mfma_f32_16x16x32_bf16 v[44:47], a[76:79], v[120:123], v[44:47]
    s_waitcnt lgkmcnt(6) vmcnt(0)
    v_mfma_f32_16x16x32_bf16 v[32:35], a[176:179], v[124:127], v[32:35]
    s_waitcnt lgkmcnt(4)
    v_mfma_f32_16x16x32_bf16 v[36:39], a[180:183], v[124:127], v[36:39]
    s_waitcnt lgkmcnt(2)
    v_mfma_f32_16x16x32_bf16 v[40:43], a[184:187], v[124:127], v[40:43]
    s_waitcnt lgkmcnt(0)
    v_mfma_f32_16x16x32_bf16 v[44:47], a[188:191], v[124:127], v[44:47]
    s_nop 1
    v_cvt_pk_bf16_f32 v48, v32, v33
    v_cvt_pk_bf16_f32 v49, v34, v35
    v_cvt_pk_bf16_f32 v50, v36, v37
    v_cvt_pk_bf16_f32 v51, v38, v39
    v_cvt_pk_bf16_f32 v52, v40, v41
    v_cvt_pk_bf16_f32 v53, v42, v43
    v_cvt_pk_bf16_f32 v54, v44, v45
    v_cvt_pk_bf16_f32 v55, v46, v47
    v_permlane16_swap_b32 v48, v50
    v_permlane16_swap_b32 v49, v51
    buffer_store_dwordx4 v[48:51], v247, s[28:31], 0 offen offset:0
    v_permlane16_swap_b32 v52, v54
    v_permlane16_swap_b32 v53, v55
    buffer_store_dwordx4 v[52:55], v247, s[28:31], 0 offen offset:64
    s_endpgm
L_rsX:
    s_mov_b32 s10, 40
L_plRX:
    buffer_load_dword v42, v41, s[20:23], 0 offen sc1
    s_sub_u32 s10, s10, 1
    s_cbranch_scc1 L_pdRX
    s_waitcnt vmcnt(0)
    v_cmp_ne_u32 vcc, v42, v250
    s_nop 0
    s_and_b64 exec, exec, vcc
    s_cbranch_scc1 L_plRX
L_pdRX:
    s_or_b32 s43, exec_lo, exec_hi
    s_mov_b64 exec, -1
    s_cmp_eq_u32 s43, 0
    s_cbranch_scc1 L_rfX
    buffer_wbl2 sc1
    s_waitcnt vmcnt(0)
    buffer_store_dword v250, v248, s[20:23], 0 offen offset:16 sc1
    s_branch L_rdX
L_rsO:
    buffer_wbl2 sc1
    s_waitcnt vmcnt(0)
    buffer_store_dword v250, v248, s[20:23], 0 offen offset:0 sc1
    s_branch L_rdO
L_asX:
    buffer_inv sc1
    s_waitcnt vmcnt(0)
    s_branch L_adX
L_asP:
    buffer_inv sc1
    s_waitcnt vmcnt(0)
    s_branch L_adP
L_asS:
    buffer_inv sc1
    s_waitcnt vmcnt(0)
    s_branch L_adS
.type L_tab,@object
L_tab:
    .long 0xf6543210, 0x01000000, 0x00000100, 0
    .long 0xedcba987, 0x00000000, 0x00000101, 0
    .long 0xfed01234, 0x05040300, 0x00000312, 0
    .long 0xcba98765, 0x02000000, 0x00000103, 0
    .long 0x29876543, 0x08000000, 0x00000105, 0
    .long 0x10fedcba, 0x07060000, 0x00333206, 0
    .long 0x07654321, 0x09000000, 0x00000107, 0
    .long 0xfedcba98, 0x0a000000, 0x00000108, 0
    .long 0xfe012345, 0x0d0c0000, 0x0033a219, 0
    .long 0xdcba9876, 0x0b000000, 0x0000010a, 0
    .long 0x3a987654, 0x11000000, 0x0000010c, 0
    .long 0x210fedcb, 0x100f0e00, 0x0066d30d, 0
    .long 0x18765432, 0x13000000, 0x0000010e, 0
    .long 0x0fedcba9, 0x12000000, 0x0000010f, 0
    .long 0x00000000, 0x00000000, 0x00212404, 0
    .long 0x00000000, 0x00000000, 0x0054b40b, 0
.size L_tab, 256
L_S:
    v_add_u32 v5, 2, v5
    v_subrev_u32 v6, 7, v5
    v_min_u32 v5, v5, v6
    v_mad_u32_u24 v7, v4, 7, v5
    v_lshlrev_b32 v7, 7, v7
    buffer_load_dword v255, v7, s[12:15], 0 offen
    s_and_b32 s11, s3, 1
    s_lshl1_add_u32 s6, s47, s11
    s_lshl_b32 s6, s6, 4
    s_add_u32 s6, s6, L_tab - L_pc
    s_load_dwordx4 s[32:35], s[4:5], s6
    s_add_u32 s6, s57, 5259264
    s_load_dword s36, s[20:21], s6
    s_lshr_b32 s55, s3, 1
    s_mov_b32 s22, 0x1000000
    s_mov_b32 s23, 0x20000
    s_mov_b32 s26, 0x62000
    s_mov_b32 s27, 0x20000
    s_mov_b32 s30, 0x380000
    s_mov_b32 s31, 0x20000
    s_mul_i32 s6, s40, 37
    s_lshr_b32 s6, s6, 8
    s_mul_i32 s7, s6, 7
    s_sub_u32 s41, s40, s7
    s_lshr_b32 s7, s57, 3
    s_add_u32 s41, s41, s7
    s_sub_u32 s7, s41, 7
    s_min_u32 s41, s41, s7
    s_lshl_b32 s6, s6, 2
    s_add_u32 s6, s6, s3
    v_bfe_u32 v32, v1, 1, 1
    v_lshl_add_u32 v32, s6, 1, v32
    v_mul_u32_u24 v33, 47, v32
    v_lshrrev_b32 v33, 9, v33
    v_mul_u32_u24 v34, 11, v33
    v_sub_u32 v32, v32, v34
    v_add_u32 v32, 3, v32
    v_and_b32 v32, 8, v32
    v_lshl_add_u32 v32, v33, 10, v32
    v_and_b32 v33, 1, v1
    v_lshl_add_u32 v32, v33, 2, v32
    v_bfe_u32 v33, v1, 2, 3
    v_lshl_add_u32 v32, v33, 7, v32
    s_mul_i32 s7, s57, 17920
    s_add_u32 s7, s7, 6429696
    v_add_u32 v246, s7, v32
    s_and_b32 s7, s2, 6
    s_lshl3_add_u32 s6, s7, s6
    s_and_b32 s8, s2, 1
    s_lshl_b32 s7, s8, 6
    s_add_u32 s42, s6, s7
    v_lshrrev_b32 v32, 3, v1
    v_and_b32 v33, 6, v32
    v_and_b32 v34, 7, v1
    v_xor_b32 v33, v33, v34
    v_lshrrev_b32 v32, 3, v0
    v_mul_u32_u24 v32, 896, v32
    v_lshl_add_u32 v32, v33, 4, v32
    s_lshl_b32 s7, s41, 7
    v_add_u32 v240, s7, v32
    v_mov_b32 v34, 0
    v_mov_b32 v35, 0
    v_lshlrev_b32 v32, 3, v1
    v_add_u32 v32, 162816, v32
    ds_write_b64 v32, v[34:35]
    s_lshl_b32 s45, s3, 10
    s_add_u32 s45, s45, 105472
    v_lshrrev_b32 v32, 2, v1
    v_bfe_u32 v33, v1, 3, 2
    v_lshlrev_b32 v33, 5, v33
    v_lshl_add_u32 v33, v32, 7, v33
    v_and_b32 v34, 3, v1
    v_lshl_add_u32 v33, v34, 3, v33
    v_add_u32 v241, 105472, v33
    v_xor_b32 v242, 32, v241
    v_xor_b32 v243, 64, v241
    v_xor_b32 v244, 96, v241
    s_lshl_b32 s9, s42, 14
    v_lshl_add_u32 v245, v1, 4, s9
    s_lshl_b32 s6, s6, 5
    s_add_u32 s6, s6, s8
    s_mul_i32 s6, s6, 1792
    s_add_u32 s6, s6, s7
    v_mul_u32_u24 v32, 3584, v253
    v_and_b32 v33, 1, v252
    v_lshl_add_u32 v32, v33, 5, v32
    v_lshrrev_b32 v33, 1, v252
    v_lshl_add_u32 v32, v33, 4, v32
    v_add_u32 v247, s6, v32
    s_cmp_eq_u32 s55, 0
    s_cselect_b32 s54, 0xff800000, 0
    s_cmp_eq_u32 s48, 0
    s_cselect_b32 s61, s54, 0
    s_mul_i32 s6, s55, 48
    s_add_u32 s6, s6, s48
    s_and_b32 s7, s2, 1
    s_lshl_b32 s7, s7, 10
    s_add_u32 s6, s6, s7
    s_add_u32 s6, s6, 8
    s_waitcnt lgkmcnt(0)
    s_and_b32 s11, s34, 15
    v_add_u32 v32, s6, v253
    v_lshrrev_b32 v33, 4, v32
    v_lshlrev_b32 v33, 14, v33
    v_and_b32 v32, 15, v32
    v_lshl_add_u32 v32, v32, 4, v33
    v_lshl_add_u32 v32, v252, 8, v32
    s_lshl_b32 s7, s11, 10
    v_add_u32 v18, s7, v32
    s_cmp_eq_u32 s55, 0
    s_cselect_b32 s8, 8, 0
    s_and_b32 s9, s55, s56
    s_cselect_b32 s9, 8, 16
    v_cmp_le_u32 s[4:5], s8, v253
    v_cmp_gt_u32 s[62:63], s9, v253
    v_subrev_u32 v32, 16384, v18
    v_add_u32 v33, 16384, v18
    v_cndmask_b32 v17, 2.0, v32, s[4:5]
    v_cndmask_b32 v19, 2.0, v33, s[62:63]
    s_mul_i32 s9, s57, 17920
    s_lshl_b32 s7, s40, 7
    s_add_u32 s6, s9, s7
    s_lshl2_add_u32 s6, s3, s6
    s_add_u32 s6, s6, 6429696
    v_mov_b32 v248, s6
    v_and_b32 v32, 4, v1
    v_add_u32 v32, 16, v32
    v_bfe_u32 v32, s34, v32, 4
    v_and_b32 v33, 3, v1
    v_lshlrev_b32 v34, 2, v33
    v_lshl_add_u32 v32, v32, 7, v34
    s_lshl_b32 s6, s44, 10
    s_add_u32 s6, s6, s9
    s_add_u32 s6, s6, 6429712
    v_add_u32 v40, s6, v32
    s_mul_i32 s6, s44, 46080
    s_add_u32 s9, s9, s6
    s_add_u32 s9, s9, 6291456
    s_lshl_b32 s38, s55, 10
    s_lshl_b32 s39, s55, 3
    v_lshl_add_u32 v42, v253, 4, s9
    v_lshl_add_u32 v43, v252, 2, v33
    v_lshl_add_u32 v43, v43, 4, s9
    v_lshrrev_b32 v35, 2, v253
    s_bfe_u32 s6, s34, 0x40008
    s_sub_u32 s6, 4, s6
    v_cmp_le_u32 s[62:63], s6, v252
    v_cmp_le_u32 s[64:65], s6, v35
    s_movk_i32 s8, 2304
    s_bfe_u32 s6, s34, 0x4000c
    s_bitcmp1_b32 s34, 4
    s_cselect_b32 s7, 2, 4
    s_cselect_b32 s9, -1, 1
    s_add_u32 s6, s6, s7
    v_mul_i32_i24 v32, s9, v252
    v_add_u32 v32, s6, v32
    v_cmp_ne_u32 vcc, 3, v252
    v_mad_u32_u24 v32, v32, s8, v42
    v_subrev_u32 v36, 9216, v32
    v_cndmask_b32 v38, 2.0, v32, vcc
    v_mul_i32_i24 v32, s9, v35
    v_add_u32 v32, s6, v32
    v_cmp_ne_u32 vcc, 3, v35
    v_mad_u32_u24 v32, v32, s8, v43
    v_subrev_u32 v37, 9216, v32
    v_cndmask_b32 v39, 2.0, v32, vcc
    s_mul_i32 s36, s36, 0x9e3779b1
    s_add_u32 s36, s36, 0x7f4a7c15
    v_mov_b32 v250, s36
    s_getreg_b32 s7, hwreg(HW_REG_XCC_ID, 0, 3)
    s_mul_i32 s8, s57, 17920
    s_lshl_b32 s7, s7, 7
    s_add_u32 s8, s8, s7
    s_add_u32 s8, s8, 6432768
    v_and_b32 v41, 31, v1
    v_lshl_add_u32 v41, v41, 2, s8
    s_lshl2_add_u32 s37, s40, s8
    s_barrier
    buffer_store_dword v250, off, s[20:23], s37
    v_add_u32 v5, 2, v5
    v_subrev_u32 v6, 7, v5
    v_min_u32 v5, v5, v6
    v_mad_u32_u24 v7, v4, 7, v5
    v_lshlrev_b32 v7, 7, v7
    buffer_load_dword v255, v7, s[12:15], 0 offen
    s_lshl2_add_u32 s7, s44, s3
    s_mul_i32 s6, s57, 49*128
    s_mul_i32 s8, s7, 33*128
    s_add_u32 s6, s6, s8
    v_min_u32 v6, 32, v1
    v_lshlrev_b32 v6, 7, v6
    buffer_load_dword v255, v6, s[24:27], s6 offen
    s_mul_i32 s6, s57, 17920
    s_mul_i32 s8, s7, 47*128
    s_add_u32 s6, s6, s8
    s_add_u32 s6, s6, 6291456
    s_add_u32 s8, s6, 70144
    v_min_u32 v6, 46, v1
    v_lshlrev_b32 v6, 7, v6
    buffer_load_dword v255, v6, s[20:23], s8 offen
    buffer_load_dword v255, v6, s[20:23], s6 offen
    v_lshlrev_b32 v208, 2, v252
    v_sub_u32 v208, v253, v208
    v_mov_b32 v209, 0xff800000
    v_subrev_u32 v212, 0, v208
    v_subrev_u32 v213, 1, v208
    v_subrev_u32 v214, 2, v208
    v_subrev_u32 v215, 3, v208
    v_cmp_gt_u32 s[4:5], 8, v212
    v_cmp_gt_u32 s[8:9], 8, v213
    v_cmp_gt_u32 vcc, 8, v214
    v_cmp_gt_u32 s[6:7], 8, v215
    v_cndmask_b32 v24, v209, 0, s[4:5]
    v_cndmask_b32 v25, v209, 0, s[8:9]
    v_cndmask_b32 v26, v209, 0, vcc
    v_cndmask_b32 v27, v209, 0, s[6:7]
    v_cmp_ge_i32 s[4:5], -9, v212
    v_cmp_ge_i32 s[8:9], -9, v213
    v_cmp_ge_i32 vcc, -9, v214
    v_cmp_ge_i32 s[6:7], -9, v215
    v_cndmask_b32 v20, v209, 0, s[4:5]
    v_cndmask_b32 v21, v209, 0, s[8:9]
    v_cndmask_b32 v22, v209, 0, vcc
    v_cndmask_b32 v23, v209, 0, s[6:7]
    v_ashrrev_i32 v212, 31, v212
    v_ashrrev_i32 v213, 31, v213
    v_ashrrev_i32 v214, 31, v214
    v_ashrrev_i32 v215, 31, v215
    v_mov_b32 v208, 0xffff
    v_bfi_b32 v28, v208, v212, v213
    v_bfi_b32 v29, v208, v214, v215
    v_mov_b32 v30, 0x3e8b97f6
    v_or_b32 v56, s54, v20
    v_or_b32 v57, s54, v21
    v_or_b32 v58, s54, v22
    v_or_b32 v59, s54, v23
    v_subrev_u32 v208, 32, v1
    v_ashrrev_i32 v208, 31, v208
    v_and_b32 v208, s61, v208
    v_or_b32 v60, v208, v24
    v_or_b32 v61, v208, v25
    v_or_b32 v62, v208, v26
    v_or_b32 v63, v208, v27
    v_mov_b32 v32, 0x3f803f80
    v_mov_b32 v33, 0x3f803f80
    v_mov_b32 v34, 0x3f803f80
    v_mov_b32 v35, 0x3f803f80
    v_lshlrev_b32 v5, 10, v252
    v_sub_u32 v2, v241, v5
    v_sub_u32 v3, v242, v5
    v_sub_u32 v4, v243, v5
    v_sub_u32 v5, v244, v5
    s_movk_i32 s58, 4096
    s_movk_i32 s59, 8192
    s_movk_i32 s60, 12288
    s_add_u32 m0, s45, 0
    s_mov_b32 s6, 0
    buffer_load_dwordx4 v240, s[24:27], s6 offen lds
    s_add_u32 m0, s45, 4096
    s_mov_b32 s6, 28672
    buffer_load_dwordx4 v240, s[24:27], s6 offen lds
    s_add_u32 m0, s45, 8192
    s_mov_b32 s6, 57344
    buffer_load_dwordx4 v240, s[24:27], s6 offen lds
    s_add_u32 m0, s45, 12288
    s_mov_b32 s6, 86016
    buffer_load_dwordx4 v240, s[24:27], s6 offen lds
    s_add_u32 m0, s45, 16384
    s_mov_b32 s6, 114688
    buffer_load_dwordx4 v240, s[24:27], s6 offen lds
    s_add_u32 m0, s45, 20480
    s_mov_b32 s6, 143360
    buffer_load_dwordx4 v240, s[24:27], s6 offen lds
    s_add_u32 m0, s45, 24576
    s_mov_b32 s6, 172032
    buffer_load_dwordx4 v240, s[24:27], s6 offen lds
    s_add_u32 m0, s45, 28672
    s_mov_b32 s6, 200704
    buffer_load_dwordx4 v240, s[24:27], s6 offen lds
    s_add_u32 m0, s45, 32768
    s_mov_b32 s6, 229376
    buffer_load_dwordx4 v240, s[24:27], s6 offen lds
    s_add_u32 m0, s45, 36864
    s_mov_b32 s6, 258048
    buffer_load_dwordx4 v240, s[24:27], s6 offen lds
    s_add_u32 m0, s45, 40960
    s_mov_b32 s6, 286720
    buffer_load_dwordx4 v240, s[24:27], s6 offen lds
    s_add_u32 m0, s45, 45056
    s_mov_b32 s6, 315392
    buffer_load_dwordx4 v240, s[24:27], s6 offen lds
    s_add_u32 m0, s45, 49152
    s_mov_b32 s6, 344064
    buffer_load_dwordx4 v240, s[24:27], s6 offen lds
    s_add_u32 m0, s45, 53248
    s_mov_b32 s6, 372736
    buffer_load_dwordx4 v240, s[24:27], s6 offen lds
    s_waitcnt vmcnt(0) lgkmcnt(0)
    s_barrier
    ds_read_b64_tr_b16 a[0:1], v241 offset:0
    ds_read_b64_tr_b16 a[2:3], v241 offset:2048
    ds_read_b64_tr_b16 a[4:5], v242 offset:0
    ds_read_b64_tr_b16 a[6:7], v242 offset:2048
    ds_read_b64_tr_b16 a[8:9], v243 offset:0
    ds_read_b64_tr_b16 a[10:11], v243 offset:2048
    ds_read_b64_tr_b16 a[12:13], v244 offset:0
    ds_read_b64_tr_b16 a[14:15], v244 offset:2048
    ds_read_b64_tr_b16 a[16:17], v243 offset:3584
    ds_read_b64_tr_b16 a[18:19], v243 offset:5632
    ds_read_b64_tr_b16 a[20:21], v244 offset:3584
    ds_read_b64_tr_b16 a[22:23], v244 offset:5632
    ds_read_b64_tr_b16 a[24:25], v241 offset:3584
    ds_read_b64_tr_b16 a[26:27], v241 offset:5632
    ds_read_b64_tr_b16 a[28:29], v242 offset:3584
    ds_read_b64_tr_b16 a[30:31], v242 offset:5632
    ds_read_b64_tr_b16 a[48:49], v243 offset:10752
    ds_read_b64_tr_b16 a[50:51], v243 offset:12800
    ds_read_b64_tr_b16 a[52:53], v244 offset:10752
    ds_read_b64_tr_b16 a[54:55], v244 offset:12800
    ds_read_b64_tr_b16 a[56:57], v241 offset:10752
    ds_read_b64_tr_b16 a[58:59], v241 offset:12800
    ds_read_b64_tr_b16 a[60:61], v242 offset:10752
    ds_read_b64_tr_b16 a[62:63], v242 offset:12800
    ds_read_b64_tr_b16 a[80:81], v243 offset:17920
    ds_read_b64_tr_b16 a[82:83], v243 offset:19968
    ds_read_b64_tr_b16 a[84:85], v244 offset:17920
    ds_read_b64_tr_b16 a[86:87], v244 offset:19968
    ds_read_b64_tr_b16 a[88:89], v241 offset:17920
    ds_read_b64_tr_b16 a[90:91], v241 offset:19968
    ds_read_b64_tr_b16 a[92:93], v242 offset:17920
    ds_read_b64_tr_b16 a[94:95], v242 offset:19968
    ds_read_b64_tr_b16 a[112:113], v243 offset:25088
    ds_read_b64_tr_b16 a[114:115], v243 offset:27136
    ds_read_b64_tr_b16 a[116:117], v244 offset:25088
    ds_read_b64_tr_b16 a[118:119], v244 offset:27136
    ds_read_b64_tr_b16 a[120:121], v241 offset:25088
    ds_read_b64_tr_b16 a[122:123], v241 offset:27136
    ds_read_b64_tr_b16 a[124:125], v242 offset:25088
    ds_read_b64_tr_b16 a[126:127], v242 offset:27136
    s_mov_b32 s10, 40
L_plM:
    buffer_load_dword v42, v41, s[20:23], 0 offen sc1
    s_sub_u32 s10, s10, 1
    s_cbranch_scc1 L_pdM
    s_waitcnt vmcnt(0)
    v_cmp_ne_u32 vcc, v42, v250
    s_nop 0
    s_and_b64 exec, exec, vcc
    s_cbranch_scc1 L_plM
L_pdM:
    s_or_b32 s43, exec_lo, exec_hi
    s_mov_b64 exec, -1
    s_branch L_Sget
.p2align 12
L_B:
    s_mov_b64 exec, -1
    s_mov_b32 s22, 0x1000000
    s_mov_b32 s23, 0x20000
    s_add_u32 s6, s57, 5259264
    s_load_dword s36, s[20:21], s6
    s_lshl_b32 s6, s46, 7
    s_add_u32 s6, s6, 5242880
    v_mov_b32 v19, s6
    s_sub_u32 s6, s40, 24
    s_lshl2_add_u32 s47, s6, s3
    s_and_b32 s6, s2, 1
    s_bfe_u32 s7, s2, 0x20001
    s_lshl2_add_u32 s6, s6, s7
    s_lshl_b32 s6, s6, 5
    s_add_u32 s6, s6, s47
    s_lshl_b32 s6, s6, 13
    v_lshl_add_u32 v5, v1, 7, s6
    s_lshl_b32 s7, s47, 12
    s_sub_u32 s6, s6, s7
    s_add_u32 s6, s6, 0x20000
    v_lshrrev_b32 v6, 1, v1
    v_lshl_add_u32 v6, v6, 7, s6
    s_mov_b32 s18, 0x126000
    s_mov_b32 s19, 0x20000
    s_mul_i32 s6, s47, 42*128
    v_min_u32 v249, 41, v1
    v_lshl_add_u32 v249, v249, 7, s6
    s_add_u32 s100, s100, 1
    s_lshl_b32 s6, s3, 5
    v_lshl_add_u32 v11, v253, 1, s6
    v_cvt_f32_u32 v11, v11
    v_lshlrev_b32 v12, 5, v252
    v_cvt_f32_u32 v12, v12
    v_add_f32 v13, 0x00000000, v11
    v_mul_f32 v13, 0x3b124925, v13
    v_mul_f32 v224, v12, v13
    v_add_f32 v14, v13, v13
    v_fract_f32 v224, v224
    v_cos_f32 v16, v14
    v_add_f32 v225, v224, v13
    v_add_f32 v226, v224, v14
    v_add_f32 v227, v225, v14
    v_add_f32 v16, v16, v16
    v_cos_f32 v228, v224
    v_cos_f32 v229, v225
    v_cos_f32 v230, v226
    v_cos_f32 v231, v227
    v_sin_f32 v224, v224
    v_sin_f32 v225, v225
    v_sin_f32 v226, v226
    v_sin_f32 v227, v227
    v_cvt_pk_bf16_f32 v64, v228, v230
    v_cvt_pk_bf16_f32 v72, v229, v231
    v_cvt_pk_bf16_f32 v80, v224, v226
    v_cvt_pk_bf16_f32 v88, v225, v227
    v_pk_fma_f32 v[228:229], v[16:17], v[230:231], v[228:229] op_sel_hi:[0,1,1] neg_lo:[0,0,1] neg_hi:[0,0,1]
    v_pk_fma_f32 v[224:225], v[16:17], v[226:227], v[224:225] op_sel_hi:[0,1,1] neg_lo:[0,0,1] neg_hi:[0,0,1]
    v_pk_fma_f32 v[230:231], v[16:17], v[228:229], v[230:231] op_sel_hi:[0,1,1] neg_lo:[0,0,1] neg_hi:[0,0,1]
    v_pk_fma_f32 v[226:227], v[16:17], v[224:225], v[226:227] op_sel_hi:[0,1,1] neg_lo:[0,0,1] neg_hi:[0,0,1]
    v_cvt_pk_bf16_f32 v65, v228, v230
    v_cvt_pk_bf16_f32 v73, v229, v231
    v_cvt_pk_bf16_f32 v81, v224, v226
    v_cvt_pk_bf16_f32 v89, v225, v227
    v_pk_fma_f32 v[228:229], v[16:17], v[230:231], v[228:229] op_sel_hi:[0,1,1] neg_lo:[0,0,1] neg_hi:[0,0,1]
    v_pk_fma_f32 v[224:225], v[16:17], v[226:227], v[224:225] op_sel_hi:[0,1,1] neg_lo:[0,0,1] neg_hi:[0,0,1]
    v_pk_fma_f32 v[230:231], v[16:17], v[228:229], v[230:231] op_sel_hi:[0,1,1] neg_lo:[0,0,1] neg_hi:[0,0,1]
    v_pk_fma_f32 v[226:227], v[16:17], v[224:225], v[226:227] op_sel_hi:[0,1,1] neg_lo:[0,0,1] neg_hi:[0,0,1]
    v_cvt_pk_bf16_f32 v66, v228, v230
    v_cvt_pk_bf16_f32 v74, v229, v231
    v_cvt_pk_bf16_f32 v82, v224, v226
    v_cvt_pk_bf16_f32 v90, v225, v227
    v_pk_fma_f32 v[228:229], v[16:17], v[230:231], v[228:229] op_sel_hi:[0,1,1] neg_lo:[0,0,1] neg_hi:[0,0,1]
    v_pk_fma_f32 v[224:225], v[16:17], v[226:227], v[224:225] op_sel_hi:[0,1,1] neg_lo:[0,0,1] neg_hi:[0,0,1]
    v_pk_fma_f32 v[230:231], v[16:17], v[228:229], v[230:231] op_sel_hi:[0,1,1] neg_lo:[0,0,1] neg_hi:[0,0,1]
    v_pk_fma_f32 v[226:227], v[16:17], v[224:225], v[226:227] op_sel_hi:[0,1,1] neg_lo:[0,0,1] neg_hi:[0,0,1]
    v_cvt_pk_bf16_f32 v67, v228, v230
    v_cvt_pk_bf16_f32 v75, v229, v231
    v_cvt_pk_bf16_f32 v83, v224, v226
    v_cvt_pk_bf16_f32 v91, v225, v227
    v_pk_fma_f32 v[228:229], v[16:17], v[230:231], v[228:229] op_sel_hi:[0,1,1] neg_lo:[0,0,1] neg_hi:[0,0,1]
    v_pk_fma_f32 v[224:225], v[16:17], v[226:227], v[224:225] op_sel_hi:[0,1,1] neg_lo:[0,0,1] neg_hi:[0,0,1]
    v_pk_fma_f32 v[230:231], v[16:17], v[228:229], v[230:231] op_sel_hi:[0,1,1] neg_lo:[0,0,1] neg_hi:[0,0,1]
    v_pk_fma_f32 v[226:227], v[16:17], v[224:225], v[226:227] op_sel_hi:[0,1,1] neg_lo:[0,0,1] neg_hi:[0,0,1]
    v_cvt_pk_bf16_f32 v68, v228, v230
    v_cvt_pk_bf16_f32 v76, v229, v231
    v_cvt_pk_bf16_f32 v84, v224, v226
    v_cvt_pk_bf16_f32 v92, v225, v227
    v_pk_fma_f32 v[228:229], v[16:17], v[230:231], v[228:229] op_sel_hi:[0,1,1] neg_lo:[0,0,1] neg_hi:[0,0,1]
    v_pk_fma_f32 v[224:225], v[16:17], v[226:227], v[224:225] op_sel_hi:[0,1,1] neg_lo:[0,0,1] neg_hi:[0,0,1]
    v_pk_fma_f32 v[230:231], v[16:17], v[228:229], v[230:231] op_sel_hi:[0,1,1] neg_lo:[0,0,1] neg_hi:[0,0,1]
    v_pk_fma_f32 v[226:227], v[16:17], v[224:225], v[226:227] op_sel_hi:[0,1,1] neg_lo:[0,0,1] neg_hi:[0,0,1]
    v_cvt_pk_bf16_f32 v69, v228, v230
    v_cvt_pk_bf16_f32 v77, v229, v231
    v_cvt_pk_bf16_f32 v85, v224, v226
    v_cvt_pk_bf16_f32 v93, v225, v227
    v_pk_fma_f32 v[228:229], v[16:17], v[230:231], v[228:229] op_sel_hi:[0,1,1] neg_lo:[0,0,1] neg_hi:[0,0,1]
    v_pk_fma_f32 v[224:225], v[16:17], v[226:227], v[224:225] op_sel_hi:[0,1,1] neg_lo:[0,0,1] neg_hi:[0,0,1]
    v_pk_fma_f32 v[230:231], v[16:17], v[228:229], v[230:231] op_sel_hi:[0,1,1] neg_lo:[0,0,1] neg_hi:[0,0,1]
    v_pk_fma_f32 v[226:227], v[16:17], v[224:225], v[226:227] op_sel_hi:[0,1,1] neg_lo:[0,0,1] neg_hi:[0,0,1]
    v_cvt_pk_bf16_f32 v70, v228, v230
    v_cvt_pk_bf16_f32 v78, v229, v231
    v_cvt_pk_bf16_f32 v86, v224, v226
    v_cvt_pk_bf16_f32 v94, v225, v227
    v_pk_fma_f32 v[228:229], v[16:17], v[230:231], v[228:229] op_sel_hi:[0,1,1] neg_lo:[0,0,1] neg_hi:[0,0,1]
    v_pk_fma_f32 v[224:225], v[16:17], v[226:227], v[224:225] op_sel_hi:[0,1,1] neg_lo:[0,0,1] neg_hi:[0,0,1]
    v_pk_fma_f32 v[230:231], v[16:17], v[228:229], v[230:231] op_sel_hi:[0,1,1] neg_lo:[0,0,1] neg_hi:[0,0,1]
    v_pk_fma_f32 v[226:227], v[16:17], v[224:225], v[226:227] op_sel_hi:[0,1,1] neg_lo:[0,0,1] neg_hi:[0,0,1]
    v_cvt_pk_bf16_f32 v71, v228, v230
    v_cvt_pk_bf16_f32 v79, v229, v231
    v_cvt_pk_bf16_f32 v87, v224, v226
    v_cvt_pk_bf16_f32 v95, v225, v227
    v_add_f32 v13, 0x3f800000, v11
    v_mul_f32 v13, 0x3b124925, v13
    v_mul_f32 v224, v12, v13
    v_add_f32 v14, v13, v13
    v_fract_f32 v224, v224
    v_cos_f32 v16, v14
    v_add_f32 v225, v224, v13
    v_add_f32 v226, v224, v14
    v_add_f32 v227, v225, v14
    v_add_f32 v16, v16, v16
    v_cos_f32 v228, v224
    v_cos_f32 v229, v225
    v_cos_f32 v230, v226
    v_cos_f32 v231, v227
    v_sin_f32 v224, v224
    v_sin_f32 v225, v225
    v_sin_f32 v226, v226
    v_sin_f32_e64 v227, v227
    v_cvt_pk_bf16_f32 v96, v228, v230
    v_cvt_pk_bf16_f32 v104, v229, v231
    v_cvt_pk_bf16_f32 v112, v224, v226
    v_cvt_pk_bf16_f32 v120, v225, v227
    v_pk_fma_f32 v[228:229], v[16:17], v[230:231], v[228:229] op_sel_hi:[0,1,1] neg_lo:[0,0,1] neg_hi:[0,0,1]
    v_pk_fma_f32 v[224:225], v[16:17], v[226:227], v[224:225] op_sel_hi:[0,1,1] neg_lo:[0,0,1] neg_hi:[0,0,1]
    v_pk_fma_f32 v[230:231], v[16:17], v[228:229], v[230:231] op_sel_hi:[0,1,1] neg_lo:[0,0,1] neg_hi:[0,0,1]
    v_pk_fma_f32 v[226:227], v[16:17], v[224:225], v[226:227] op_sel_hi:[0,1,1] neg_lo:[0,0,1] neg_hi:[0,0,1]
    v_cvt_pk_bf16_f32 v97, v228, v230
    v_cvt_pk_bf16_f32 v105, v229, v231
    v_cvt_pk_bf16_f32 v113, v224, v226
    v_cvt_pk_bf16_f32 v121, v225, v227
    v_pk_fma_f32 v[228:229], v[16:17], v[230:231], v[228:229] op_sel_hi:[0,1,1] neg_lo:[0,0,1] neg_hi:[0,0,1]
    v_pk_fma_f32 v[224:225], v[16:17], v[226:227], v[224:225] op_sel_hi:[0,1,1] neg_lo:[0,0,1] neg_hi:[0,0,1]
    v_pk_fma_f32 v[230:231], v[16:17], v[228:229], v[230:231] op_sel_hi:[0,1,1] neg_lo:[0,0,1] neg_hi:[0,0,1]
    v_pk_fma_f32 v[226:227], v[16:17], v[224:225], v[226:227] op_sel_hi:[0,1,1] neg_lo:[0,0,1] neg_hi:[0,0,1]
    v_cvt_pk_bf16_f32 v98, v228, v230
    v_cvt_pk_bf16_f32 v106, v229, v231
    v_cvt_pk_bf16_f32 v114, v224, v226
    v_cvt_pk_bf16_f32 v122, v225, v227
    v_pk_fma_f32 v[228:229], v[16:17], v[230:231], v[228:229] op_sel_hi:[0,1,1] neg_lo:[0,0,1] neg_hi:[0,0,1]
    v_pk_fma_f32 v[224:225], v[16:17], v[226:227], v[224:225] op_sel_hi:[0,1,1] neg_lo:[0,0,1] neg_hi:[0,0,1]
    v_pk_fma_f32 v[230:231], v[16:17], v[228:229], v[230:231] op_sel_hi:[0,1,1] neg_lo:[0,0,1] neg_hi:[0,0,1]
    v_pk_fma_f32 v[226:227], v[16:17], v[224:225], v[226:227] op_sel_hi:[0,1,1] neg_lo:[0,0,1] neg_hi:[0,0,1]
    v_cvt_pk_bf16_f32 v99, v228, v230
    v_cvt_pk_bf16_f32 v107, v229, v231
    v_cvt_pk_bf16_f32 v115, v224, v226
    v_cvt_pk_bf16_f32 v123, v225, v227
    v_pk_fma_f32 v[228:229], v[16:17], v[230:231], v[228:229] op_sel_hi:[0,1,1] neg_lo:[0,0,1] neg_hi:[0,0,1]
    v_pk_fma_f32 v[224:225], v[16:17], v[226:227], v[224:225] op_sel_hi:[0,1,1] neg_lo:[0,0,1] neg_hi:[0,0,1]
    v_pk_fma_f32 v[230:231], v[16:17], v[228:229], v[230:231] op_sel_hi:[0,1,1] neg_lo:[0,0,1] neg_hi:[0,0,1]
    v_pk_fma_f32 v[226:227], v[16:17], v[224:225], v[226:227] op_sel_hi:[0,1,1] neg_lo:[0,0,1] neg_hi:[0,0,1]
    v_cvt_pk_bf16_f32 v100, v228, v230
    v_cvt_pk_bf16_f32 v108, v229, v231
    v_cvt_pk_bf16_f32 v116, v224, v226
    v_cvt_pk_bf16_f32 v124, v225, v227
    v_pk_fma_f32 v[228:229], v[16:17], v[230:231], v[228:229] op_sel_hi:[0,1,1] neg_lo:[0,0,1] neg_hi:[0,0,1]
    v_pk_fma_f32 v[224:225], v[16:17], v[226:227], v[224:225] op_sel_hi:[0,1,1] neg_lo:[0,0,1] neg_hi:[0,0,1]
    v_pk_fma_f32 v[230:231], v[16:17], v[228:229], v[230:231] op_sel_hi:[0,1,1] neg_lo:[0,0,1] neg_hi:[0,0,1]
    v_pk_fma_f32 v[226:227], v[16:17], v[224:225], v[226:227] op_sel_hi:[0,1,1] neg_lo:[0,0,1] neg_hi:[0,0,1]
    v_cvt_pk_bf16_f32 v101, v228, v230
    v_cvt_pk_bf16_f32 v109, v229, v231
    v_cvt_pk_bf16_f32 v117, v224, v226
    v_cvt_pk_bf16_f32 v125, v225, v227
    v_pk_fma_f32 v[228:229], v[16:17], v[230:231], v[228:229] op_sel_hi:[0,1,1] neg_lo:[0,0,1] neg_hi:[0,0,1]
    v_pk_fma_f32 v[224:225], v[16:17], v[226:227], v[224:225] op_sel_hi:[0,1,1] neg_lo:[0,0,1] neg_hi:[0,0,1]
    v_pk_fma_f32 v[230:231], v[16:17], v[228:229], v[230:231] op_sel_hi:[0,1,1] neg_lo:[0,0,1] neg_hi:[0,0,1]
    v_pk_fma_f32 v[226:227], v[16:17], v[224:225], v[226:227] op_sel_hi:[0,1,1] neg_lo:[0,0,1] neg_hi:[0,0,1]
    v_cvt_pk_bf16_f32 v102, v228, v230
    v_cvt_pk_bf16_f32 v110, v229, v231
    v_cvt_pk_bf16_f32 v118, v224, v226
    v_cvt_pk_bf16_f32 v126, v225, v227
    v_pk_fma_f32 v[228:229], v[16:17], v[230:231], v[228:229] op_sel_hi:[0,1,1] neg_lo:[0,0,1] neg_hi:[0,0,1]
    v_pk_fma_f32 v[224:225], v[16:17], v[226:227], v[224:225] op_sel_hi:[0,1,1] neg_lo:[0,0,1] neg_hi:[0,0,1]
    v_pk_fma_f32 v[230:231], v[16:17], v[228:229], v[230:231] op_sel_hi:[0,1,1] neg_lo:[0,0,1] neg_hi:[0,0,1]
    v_pk_fma_f32 v[226:227], v[16:17], v[224:225], v[226:227] op_sel_hi:[0,1,1] neg_lo:[0,0,1] neg_hi:[0,0,1]
    v_cvt_pk_bf16_f32 v103, v228, v230
    v_cvt_pk_bf16_f32 v111, v229, v231
    v_cvt_pk_bf16_f32 v119, v224, v226
    v_cvt_pk_bf16_f32 v127, v225, v227
    s_waitcnt lgkmcnt(0)
    s_mul_i32 s36, s36, 0x9e3779b1
    s_add_u32 s36, s36, 0x7f4a7c15
    v_mov_b32 v250, s36
    s_getreg_b32 s7, hwreg(HW_REG_XCC_ID, 0, 3)
    s_mul_i32 s8, s57, 17920
    s_lshl_b32 s7, s7, 7
    s_add_u32 s8, s8, s7
    s_add_u32 s8, s8, 6432768
    v_and_b32 v7, 31, v1
    v_lshl_add_u32 v7, v7, 2, s8
    s_lshl2_add_u32 s37, s40, s8
    s_add_u32 s100, s100, 1
    s_sub_u32 s10, s100, 7
    s_min_u32 s100, s100, s10
    s_mul_i32 s51, s100, 64*2688
    v_bfe_u32 v32, v0, 3, 4
    buffer_load_dword v255, v249, s[16:19], s51 offen
    v_and_b32 v33, 7, v0
    v_xor_b32 v32, v32, v33
    v_lshlrev_b32 v32, 4, v32
    v_lshl_add_u32 v32, v33, 8, v32
    s_lshr_b32 s6, s3, 1
    v_lshl_add_u32 v8, s6, 11, v32
    v_lshlrev_b32 v33, 1, v252
    v_xor_b32 v32, v33, v253
    v_lshlrev_b32 v32, 4, v32
    v_lshl_add_u32 v60, v33, 8, v32
    v_xor_b32 v61, 16, v60
    s_mov_b32 s8, 0xffff0000
    v_lshrrev_b32 v32, 3, v0
    v_mul_u32_u24 v32, 1280, v32
    v_and_b32 v33, 8, v0
    v_lshl_add_u32 v32, v33, 1, v32
    v_add_u32 v32, 61440, v32
    v_and_b32 v33, 7, v0
    v_cmp_gt_u32 vcc, 7, v33
    v_lshlrev_b32 v33, 5, v33
    v_add_u32 v34, v32, v33
    v_sub_u32 v35, v32, v33
    v_add_u32 v32, 896, v32
    v_cndmask_b32 v224, v32, v34, vcc
    v_add_u32 v33, 448, v34
    v_cndmask_b32 v225, v32, v33, vcc
    v_add_u32 v33, 416, v35
    v_cndmask_b32 v226, v32, v33, vcc
    v_add_u32 v33, 864, v35
    v_cndmask_b32 v227, v32, v33, vcc
    v_lshlrev_b32 v232, 8, v252
    v_add_u32 v232, s46, v232
    v_cvt_f32_u32 v232, v232
    v_cvt_f32_u32 v233, v253
    v_mul_f32 v233, 0x3a000000, v233
    v_and_b32 v234, 1, v253
    v_mul_u32_u24 v234, 0x8000, v234
    s_add_u32 s100, s100, 1
    s_sub_u32 s10, s100, 7
    s_min_u32 s100, s100, s10
    s_mul_i32 s51, s100, 64*2688
    v_lshl_or_b32 v234, v234, 16, v234
    buffer_load_dword v255, v249, s[16:19], s51 offen
    s_mov_b32 s9, 0x80008000
    v_xor_b32 v235, s9, v234
    v_mul_f32 v236, v232, v233
    v_fmamk_f32 v237, v233, 0x42800000, v236
    v_fmamk_f32 v238, v233, 0x43000000, v236
    v_fmamk_f32 v239, v233, 0x43400000, v236
    v_cos_f32 v240, v236
    v_cos_f32 v241, v237
    v_cos_f32 v242, v238
    v_cos_f32 v243, v239
    v_sin_f32 v244, v236
    v_sin_f32 v245, v237
    v_sin_f32 v246, v238
    v_sin_f32 v247, v239
    v_cvt_pk_bf16_f32 v44, v240, v241
    v_cvt_pk_bf16_f32 v52, v244, v245
    v_cvt_pk_bf16_f32 v45, v242, v243
    v_cvt_pk_bf16_f32 v53, v246, v247
    v_xor_b32 v46, v234, v44
    v_xor_b32 v54, v234, v52
    v_xor_b32 v20, s9, v52
    v_xor_b32 v22, v235, v52
    v_xor_b32 v128, s9, v44
    v_xor_b32 v130, v235, v44
    v_xor_b32 v47, v234, v45
    v_xor_b32 v55, v234, v53
    v_xor_b32 v21, s9, v53
    v_xor_b32 v23, v235, v53
    v_xor_b32 v129, s9, v45
    v_xor_b32 v131, v235, v45
    v_add_f32 v233, 0x3c000000, v233
    v_mul_f32 v236, v232, v233
    v_fmamk_f32 v237, v233, 0x42800000, v236
    v_fmamk_f32 v238, v233, 0x43000000, v236
    v_fmamk_f32 v239, v233, 0x43400000, v236
    v_cos_f32 v240, v236
    v_cos_f32 v241, v237
    v_and_b32 v251, 56, v1
    s_mov_b32 s51, 5259264
    v_cos_f32 v242, v238
    buffer_load_dword v251, v251, s[20:23], s51 offen
    v_cos_f32 v243, v239
    v_sin_f32 v244, v236
    v_sin_f32 v245, v237
    v_sin_f32 v246, v238
    v_sin_f32 v247, v239
    v_cvt_pk_bf16_f32 v48, v240, v241
    v_cvt_pk_bf16_f32 v56, v244, v245
    v_cvt_pk_bf16_f32 v49, v242, v243
    v_cvt_pk_bf16_f32 v57, v246, v247
    v_xor_b32 v50, v234, v48
    v_xor_b32 v58, v234, v56
    v_xor_b32 v24, s9, v56
    v_xor_b32 v26, v235, v56
    v_xor_b32 v132, s9, v48
    v_xor_b32 v134, v235, v48
    v_xor_b32 v51, v234, v49
    v_xor_b32 v59, v234, v57
    v_xor_b32 v25, s9, v57
    v_xor_b32 v27, v235, v57
    v_xor_b32 v133, s9, v49
    v_xor_b32 v135, v235, v49
    s_mul_i32 s6, s3, 4608
    s_add_u32 s6, s6, 32768
    v_mul_u32_u24 v2, 144, v253
    v_lshl_add_u32 v2, v252, 5, v2
    v_add_u32 v10, s6, v2
    v_lshrrev_b32 v2, 3, v1
    v_and_b32 v3, 7, v1
    v_mul_u32_u24 v4, 144, v2
    v_lshl_add_u32 v4, v3, 4, v4
    v_add_u32 v15, s6, v4
    v_mul_u32_u24 v2, 65664, v2
    v_lshl_add_u32 v2, v3, 4, v2
    s_lshl_b32 s7, s3, 6
    s_add_u32 s7, s7, s46
    s_lshl_b32 s6, s7, 7
    s_add_u32 s6, s6, 2097152
    v_add_u32 v18, s6, v2
    s_waitcnt vmcnt(3)
    ds_read_b128 v[216:219], v226 offset:0
    ds_read_b128 v[220:223], v227 offset:0
    ds_read_b128 v[192:195], v224 offset:0
    ds_read_b128 v[204:207], v227 offset:16
    ds_read_b128 v[196:199], v225 offset:0
    ds_read_b128 v[200:203], v226 offset:16
    ds_read_b128 v[208:211], v224 offset:16
    ds_read_b128 v[212:215], v225 offset:16
    s_waitcnt lgkmcnt(7)
    v_mov_b32_dpp v40, v216 row_shr:1 row_mask:0xf bank_mask:0xf bound_ctrl:0
    s_waitcnt lgkmcnt(6)
    v_mov_b32_dpp v41, v220 row_shr:1 row_mask:0xf bank_mask:0xf bound_ctrl:0
    s_waitcnt lgkmcnt(5)
    v_lshlrev_b32 v28, 16, v192
    v_lshlrev_b32 v30, 16, v41
    s_waitcnt lgkmcnt(3)
    v_lshlrev_b32 v32, 16, v196
    v_lshlrev_b32 v34, 16, v40
    v_lshlrev_b32 v29, 16, v193
    v_lshlrev_b32 v31, 16, v207
    v_lshlrev_b32 v33, 16, v197
    s_waitcnt lgkmcnt(2)
    v_lshlrev_b32_e64 v35, 16, v203
    v_pk_add_f32 v[36:37], v[28:29], v[30:31]
    v_pk_add_f32 v[38:39], v[32:33], v[34:35]
    v_pk_add_f32 v[28:29], v[28:29], v[30:31] neg_lo:[0,1] neg_hi:[0,1]
    v_pk_add_f32 v[32:33], v[32:33], v[34:35] neg_lo:[0,1] neg_hi:[0,1]
    v_pk_add_f32 v[30:31], v[36:37], v[38:39]
    v_pk_add_f32 v[34:35], v[28:29], v[32:33]
    v_pk_add_f32 v[36:37], v[36:37], v[38:39] neg_lo:[0,1] neg_hi:[0,1]
    v_pk_add_f32 v[28:29], v[28:29], v[32:33] neg_lo:[0,1] neg_hi:[0,1]
    v_cvt_pk_bf16_f32 v136, v30, v31
    v_cvt_pk_bf16_f32 v144, v34, v35
    v_cvt_pk_bf16_f32 v152, v36, v37
    v_cvt_pk_bf16_f32 v160, v28, v29
    v_lshlrev_b32 v28, 16, v194
    v_lshlrev_b32 v30, 16, v206
    v_lshlrev_b32 v32, 16, v198
    v_lshlrev_b32 v34, 16, v202
    v_lshlrev_b32 v29, 16, v195
    v_lshlrev_b32 v31, 16, v205
    v_lshlrev_b32 v33, 16, v199
    v_lshlrev_b32 v35, 16, v201
    v_pk_add_f32 v[36:37], v[28:29], v[30:31]
    v_pk_add_f32 v[38:39], v[32:33], v[34:35]
    v_pk_add_f32 v[28:29], v[28:29], v[30:31] neg_lo:[0,1] neg_hi:[0,1]
    v_pk_add_f32 v[32:33], v[32:33], v[34:35] neg_lo:[0,1] neg_hi:[0,1]
    v_pk_add_f32 v[30:31], v[36:37], v[38:39]
    v_pk_add_f32 v[34:35], v[28:29], v[32:33]
    v_pk_add_f32 v[36:37], v[36:37], v[38:39] neg_lo:[0,1] neg_hi:[0,1]
    v_pk_add_f32 v[28:29], v[28:29], v[32:33] neg_lo:[0,1] neg_hi:[0,1]
    v_cvt_pk_bf16_f32 v137, v30, v31
    v_cvt_pk_bf16_f32 v145, v34, v35
    v_cvt_pk_bf16_f32 v153, v36, v37
    v_cvt_pk_bf16_f32 v161, v28, v29
    s_waitcnt lgkmcnt(1)
    v_lshlrev_b32 v28, 16, v208
    v_lshlrev_b32 v30, 16, v204
    s_waitcnt lgkmcnt(0)
    v_lshlrev_b32 v32, 16, v212
    v_lshlrev_b32 v34, 16, v200
    v_lshlrev_b32 v29, 16, v209
    v_lshlrev_b32 v31, 16, v223
    v_lshlrev_b32 v33, 16, v213
    v_lshlrev_b32 v35, 16, v219
    v_pk_add_f32 v[36:37], v[28:29], v[30:31]
    v_pk_add_f32 v[38:39], v[32:33], v[34:35]
    v_pk_add_f32 v[28:29], v[28:29], v[30:31] neg_lo:[0,1] neg_hi:[0,1]
    v_pk_add_f32 v[32:33], v[32:33], v[34:35] neg_lo:[0,1] neg_hi:[0,1]
    v_pk_add_f32 v[30:31], v[36:37], v[38:39]
    v_pk_add_f32 v[34:35], v[28:29], v[32:33]
    v_pk_add_f32 v[36:37], v[36:37], v[38:39] neg_lo:[0,1] neg_hi:[0,1]
    v_pk_add_f32 v[28:29], v[28:29], v[32:33] neg_lo:[0,1] neg_hi:[0,1]
    v_cvt_pk_bf16_f32 v138, v30, v31
    v_cvt_pk_bf16_f32 v146, v34, v35
    v_cvt_pk_bf16_f32 v154, v36, v37
    v_cvt_pk_bf16_f32 v162, v28, v29
    v_lshlrev_b32 v28, 16, v210
    v_lshlrev_b32 v30, 16, v222
    v_lshlrev_b32 v32, 16, v214
    v_lshlrev_b32 v34, 16, v218
    v_lshlrev_b32 v29, 16, v211
    v_lshlrev_b32 v31, 16, v221
    v_lshlrev_b32 v33, 16, v215
    v_lshlrev_b32 v35, 16, v217
    v_pk_add_f32 v[36:37], v[28:29], v[30:31]
    v_pk_add_f32 v[38:39], v[32:33], v[34:35]
    v_pk_add_f32 v[28:29], v[28:29], v[30:31] neg_lo:[0,1] neg_hi:[0,1]
    v_pk_add_f32 v[32:33], v[32:33], v[34:35] neg_lo:[0,1] neg_hi:[0,1]
    v_pk_add_f32 v[30:31], v[36:37], v[38:39]
    v_pk_add_f32 v[34:35], v[28:29], v[32:33]
    v_pk_add_f32 v[36:37], v[36:37], v[38:39] neg_lo:[0,1] neg_hi:[0,1]
    v_pk_add_f32 v[28:29], v[28:29], v[32:33] neg_lo:[0,1] neg_hi:[0,1]
    v_cvt_pk_bf16_f32 v139, v30, v31
    v_cvt_pk_bf16_f32 v147, v34, v35
    v_cvt_pk_bf16_f32 v155, v36, v37
    v_cvt_pk_bf16_f32 v163, v28, v29
    ds_write_b128 v8, v[136:139] offset:0
    buffer_load_dword v255, v6, s[20:23], 0 offen
    v_and_b32 v28, s8, v192
    v_and_b32 v30, s8, v207
    v_and_b32 v32, s8, v196
    v_and_b32 v34, s8, v203
    v_and_b32 v29, s8, v193
    v_and_b32 v31, s8, v206
    v_and_b32 v33, s8, v197
    v_and_b32 v35, s8, v202
    v_pk_add_f32 v[36:37], v[28:29], v[30:31]
    ds_write_b128 v8, v[144:147] offset:8192
    v_pk_add_f32 v[38:39], v[32:33], v[34:35]
    v_pk_add_f32 v[28:29], v[28:29], v[30:31] neg_lo:[0,1] neg_hi:[0,1]
    v_pk_add_f32 v[32:33], v[32:33], v[34:35] neg_lo:[0,1] neg_hi:[0,1]
    v_pk_add_f32 v[30:31], v[36:37], v[38:39]
    v_pk_add_f32 v[34:35], v[28:29], v[32:33]
    v_pk_add_f32 v[36:37], v[36:37], v[38:39] neg_lo:[0,1] neg_hi:[0,1]
    v_pk_add_f32 v[28:29], v[28:29], v[32:33] neg_lo:[0,1] neg_hi:[0,1]
    v_cvt_pk_bf16_f32 v140, v30, v31
    v_cvt_pk_bf16_f32 v148, v34, v35
    v_cvt_pk_bf16_f32 v156, v36, v37
    ds_write_b128 v8, v[152:155] offset:16384
    v_cvt_pk_bf16_f32 v164, v28, v29
    v_and_b32 v28, s8, v194
    v_and_b32 v30, s8, v205
    v_and_b32 v32, s8, v198
    v_and_b32 v34, s8, v201
    v_and_b32 v29, s8, v195
    v_and_b32 v31, s8, v204
    v_and_b32 v33, s8, v199
    v_and_b32 v35, s8, v200
    v_pk_add_f32 v[36:37], v[28:29], v[30:31]
    ds_write_b128 v8, v[160:163] offset:24576
    v_pk_add_f32 v[38:39], v[32:33], v[34:35]
    v_pk_add_f32 v[28:29], v[28:29], v[30:31] neg_lo:[0,1] neg_hi:[0,1]
    v_pk_add_f32 v[32:33], v[32:33], v[34:35] neg_lo:[0,1] neg_hi:[0,1]
    v_pk_add_f32 v[30:31], v[36:37], v[38:39]
    v_pk_add_f32 v[34:35], v[28:29], v[32:33]
    v_pk_add_f32 v[36:37], v[36:37], v[38:39] neg_lo:[0,1] neg_hi:[0,1]
    v_pk_add_f32 v[28:29], v[28:29], v[32:33] neg_lo:[0,1] neg_hi:[0,1]
    v_cvt_pk_bf16_f32 v141, v30, v31
    v_cvt_pk_bf16_f32 v149, v34, v35
    v_cvt_pk_bf16_f32 v157, v36, v37
    v_cvt_pk_bf16_f32 v165, v28, v29
    v_and_b32 v28, s8, v208
    v_and_b32 v30, s8, v223
    v_and_b32 v32, s8, v212
    v_and_b32 v34, s8, v219
    v_and_b32 v29, s8, v209
    v_and_b32 v31, s8, v222
    v_and_b32 v33, s8, v213
    v_and_b32 v35, s8, v218
    v_pk_add_f32 v[36:37], v[28:29], v[30:31]
    v_pk_add_f32 v[38:39], v[32:33], v[34:35]
    v_pk_add_f32 v[28:29], v[28:29], v[30:31] neg_lo:[0,1] neg_hi:[0,1]
    v_pk_add_f32 v[32:33], v[32:33], v[34:35] neg_lo:[0,1] neg_hi:[0,1]
    v_pk_add_f32 v[30:31], v[36:37], v[38:39]
    v_pk_add_f32 v[34:35], v[28:29], v[32:33]
    v_pk_add_f32 v[36:37], v[36:37], v[38:39] neg_lo:[0,1] neg_hi:[0,1]
    v_pk_add_f32 v[28:29], v[28:29], v[32:33] neg_lo:[0,1] neg_hi:[0,1]
    v_cvt_pk_bf16_f32 v142, v30, v31
    v_cvt_pk_bf16_f32 v150, v34, v35
    s_waitcnt lgkmcnt(0)
    s_barrier
    ds_read_b128 a[0:3], v60 offset:0
    ds_read_b128 a[8:11], v60 offset:2048
    ds_read_b128 a[32:35], v60 offset:8192
    ds_read_b128 a[40:43], v60 offset:10240
    ds_read_b128 a[4:7], v61 offset:256
    ds_read_b128 a[12:15], v61 offset:2304
    ds_read_b128 a[36:39], v61 offset:8448
    ds_read_b128 a[44:47], v61 offset:10496
    v_cvt_pk_bf16_f32 v158, v36, v37
    v_cvt_pk_bf16_f32 v166, v28, v29
    v_and_b32 v28, s8, v210
    v_and_b32 v30, s8, v221
    v_and_b32 v32, s8, v214
    v_and_b32 v34, s8, v217
    v_and_b32 v29, s8, v211
    v_and_b32 v31, s8, v220
    v_and_b32 v33, s8, v215
    v_and_b32 v35, s8, v216
    v_pk_add_f32 v[36:37], v[28:29], v[30:31]
    v_pk_add_f32 v[38:39], v[32:33], v[34:35]
    v_pk_add_f32 v[28:29], v[28:29], v[30:31] neg_lo:[0,1] neg_hi:[0,1]
    v_pk_add_f32 v[32:33], v[32:33], v[34:35] neg_lo:[0,1] neg_hi:[0,1]
    v_pk_add_f32 v[30:31], v[36:37], v[38:39]
    v_pk_add_f32 v[34:35], v[28:29], v[32:33]
    v_pk_add_f32 v[36:37], v[36:37], v[38:39] neg_lo:[0,1] neg_hi:[0,1]
    v_pk_add_f32 v[28:29], v[28:29], v[32:33] neg_lo:[0,1] neg_hi:[0,1]
    v_cvt_pk_bf16_f32 v143, v30, v31
    v_cvt_pk_bf16_f32 v151, v34, v35
    v_cvt_pk_bf16_f32 v159, v36, v37
    v_cvt_pk_bf16_f32 v167, v28, v29
    s_waitcnt lgkmcnt(7)
    v_mfma_f32_16x16x32_bf16 v[192:195], a[0:3], v[64:67], 0
    ds_write_b128 v8, v[140:143] offset:4096
    s_waitcnt lgkmcnt(7)
    v_mfma_f32_16x16x32_bf16 v[196:199], a[8:11], v[64:67], 0
    ds_read_b128 a[64:67], v60 offset:16384
    s_waitcnt lgkmcnt(7)
    v_mfma_f32_16x16x32_bf16 v[200:203], a[32:35], v[80:83], 0
    ds_read_b128 a[72:75], v60 offset:18432
    s_waitcnt lgkmcnt(7)
    v_mfma_f32_16x16x32_bf16 v[204:207], a[40:43], v[80:83], 0
    ds_write_b128 v8, v[148:151] offset:12288
    s_waitcnt lgkmcnt(7)
    v_mfma_f32_16x16x32_bf16 v[192:195], a[4:7], v[68:71], v[192:195]
    ds_read_b128 a[96:99], v60 offset:24576
    s_waitcnt lgkmcnt(7)
    v_mfma_f32_16x16x32_bf16 v[196:199], a[12:15], v[68:71], v[196:199]
    ds_read_b128 a[104:107], v60 offset:26624
    s_waitcnt lgkmcnt(7)
    v_mfma_f32_16x16x32_bf16 v[200:203], a[36:39], v[84:87], v[200:203]
    ds_write_b128 v8, v[156:159] offset:20480
    s_waitcnt lgkmcnt(7)
    v_mfma_f32_16x16x32_bf16 v[204:207], a[44:47], v[84:87], v[204:207]
    ds_read_b128 a[68:71], v61 offset:16640
    s_waitcnt lgkmcnt(6)
    v_mfma_f32_16x16x32_bf16 v[208:211], a[64:67], v[96:99], 0
    ds_read_b128 a[76:79], v61 offset:18688
    s_waitcnt lgkmcnt(6)
    v_mfma_f32_16x16x32_bf16 v[212:215], a[72:75], v[96:99], 0
    ds_write_b128 v8, v[164:167] offset:28672
    s_waitcnt lgkmcnt(5)
    v_mfma_f32_16x16x32_bf16 v[216:219], a[96:99], v[112:115], 0
    ds_read_b128 a[100:103], v61 offset:24832
    s_waitcnt lgkmcnt(5)
    v_mfma_f32_16x16x32_bf16 v[220:223], a[104:107], v[112:115], 0
    ds_read_b128 a[108:111], v61 offset:26880
    v_cvt_pk_bf16_f32 v160, v192, v193
    s_waitcnt lgkmcnt(4)
    v_mfma_f32_16x16x32_bf16 v[208:211], a[68:71], v[100:103], v[208:211]
    v_cvt_pk_bf16_f32 v161, v194, v195
    v_cvt_pk_bf16_f32 v162, v196, v197
    s_waitcnt lgkmcnt(3)
    v_mfma_f32_16x16x32_bf16 v[212:215], a[76:79], v[100:103], v[212:215]
    v_cvt_pk_bf16_f32 v163, v198, v199
    v_cvt_pk_bf16_f32 v164, v200, v201
    s_waitcnt lgkmcnt(1)
    v_mfma_f32_16x16x32_bf16 v[216:219], a[100:103], v[116:119], v[216:219]
    v_cvt_pk_bf16_f32 v165, v202, v203
    v_cvt_pk_bf16_f32 v166, v204, v205
    s_waitcnt lgkmcnt(0)
    v_mfma_f32_16x16x32_bf16 v[220:223], a[108:111], v[116:119], v[220:223]
    v_cvt_pk_bf16_f32 v167, v206, v207
    s_waitcnt lgkmcnt(0)
    s_barrier
    ds_read_b128 a[16:19], v60 offset:4096
    v_cvt_pk_bf16_f32 v168, v208, v209
    v_mfma_f32_16x16x32_bf16 v[64:67], v[160:163], v[44:47], 0
    ds_read_b128 a[24:27], v60 offset:6144
    v_cvt_pk_bf16_f32 v169, v210, v211
    v_mfma_f32_16x16x32_bf16 v[80:83], v[160:163], v[52:55], 0
    ds_read_b128 a[48:51], v60 offset:12288
    v_cvt_pk_bf16_f32 v170, v212, v213
    v_mfma_f32_16x16x32_bf16 v[68:71], v[160:163], v[48:51], 0
    ds_read_b128 a[56:59], v60 offset:14336
    v_cvt_pk_bf16_f32 v171, v214, v215
    v_mfma_f32_16x16x32_bf16 v[84:87], v[160:163], v[56:59], 0
    ds_read_b128 a[20:23], v61 offset:4352
    v_cvt_pk_bf16_f32 v172, v216, v217
    v_mfma_f32_16x16x32_bf16 v[64:67], v[164:167], v[20:23], v[64:67]
    ds_read_b128 a[28:31], v61 offset:6400
    v_cvt_pk_bf16_f32 v173, v218, v219
    v_mfma_f32_16x16x32_bf16 v[80:83], v[164:167], v[44:47], v[80:83]
    ds_read_b128 a[52:55], v61 offset:12544
    v_cvt_pk_bf16_f32 v174, v220, v221
    v_mfma_f32_16x16x32_bf16 v[68:71], v[164:167], v[24:27], v[68:71]
    ds_read_b128 a[60:63], v61 offset:14592
    v_cvt_pk_bf16_f32 v175, v222, v223
    v_mfma_f32_16x16x32_bf16 v[84:87], v[164:167], v[48:51], v[84:87]
    ds_read_b128 a[80:83], v60 offset:20480
    buffer_store_dword v250, off, s[20:23], s37
    v_mfma_f32_16x16x32_bf16 v[96:99], v[168:171], v[44:47], 0
    ds_read_b128 a[88:91], v60 offset:22528
    v_mfma_f32_16x16x32_bf16 v[112:115], v[168:171], v[52:55], 0
    ds_read_b128 a[112:115], v60 offset:28672
    v_mfma_f32_16x16x32_bf16 v[100:103], v[168:171], v[48:51], 0
    ds_read_b128 a[120:123], v60 offset:30720
    v_mfma_f32_16x16x32_bf16 v[116:119], v[168:171], v[56:59], 0
    ds_read_b128 a[84:87], v61 offset:20736
    v_mfma_f32_16x16x32_bf16 v[96:99], v[172:175], v[20:23], v[96:99]
    ds_read_b128 a[92:95], v61 offset:22784
    v_mfma_f32_16x16x32_bf16 v[112:115], v[172:175], v[44:47], v[112:115]
    ds_read_b128 a[116:119], v61 offset:28928
    v_mfma_f32_16x16x32_bf16 v[100:103], v[172:175], v[24:27], v[100:103]
    ds_read_b128 a[124:127], v61 offset:30976
    v_mfma_f32_16x16x32_bf16 v[116:119], v[172:175], v[48:51], v[116:119]
    buffer_load_dword v255, v19, s[20:23], 0 offen sc1
    s_waitcnt lgkmcnt(15)
    v_mfma_f32_16x16x32_bf16 v[192:195], a[16:19], v[72:75], 0
    s_waitcnt lgkmcnt(14)
    v_mfma_f32_16x16x32_bf16 v[196:199], a[24:27], v[72:75], 0
    s_waitcnt lgkmcnt(13)
    v_mfma_f32_16x16x32_bf16 v[200:203], a[48:51], v[88:91], 0
    s_waitcnt lgkmcnt(12)
    v_mfma_f32_16x16x32_bf16 v[204:207], a[56:59], v[88:91], 0
    s_waitcnt lgkmcnt(11)
    v_mfma_f32_16x16x32_bf16 v[192:195], a[20:23], v[76:79], v[192:195]
    s_waitcnt lgkmcnt(10)
    v_mfma_f32_16x16x32_bf16 v[196:199], a[28:31], v[76:79], v[196:199]
    s_waitcnt lgkmcnt(9)
    v_mfma_f32_16x16x32_bf16 v[200:203], a[52:55], v[92:95], v[200:203]
    s_waitcnt lgkmcnt(8)
L_padB1:
    s_cbranch_execz L_B
    v_mfma_f32_16x16x32_bf16 v[204:207], a[60:63], v[92:95], v[204:207]
    s_waitcnt lgkmcnt(7)
    v_mfma_f32_16x16x32_bf16 v[208:211], a[80:83], v[104:107], 0
    s_waitcnt lgkmcnt(6)
    v_mfma_f32_16x16x32_bf16 v[212:215], a[88:91], v[104:107], 0
    s_waitcnt lgkmcnt(5)
    v_mfma_f32_16x16x32_bf16 v[216:219], a[112:115], v[120:123], 0
    s_waitcnt lgkmcnt(4)
    v_mfma_f32_16x16x32_bf16 v[220:223], a[120:123], v[120:123], 0
    v_cvt_pk_bf16_f32 v176, v192, v193
    v_cvt_pk_bf16_f32 v177, v194, v195
    s_waitcnt lgkmcnt(3)
    v_mfma_f32_16x16x32_bf16 v[208:211], a[84:87], v[108:111], v[208:211]
    v_cvt_pk_bf16_f32 v178, v196, v197
    v_cvt_pk_bf16_f32 v179, v198, v199
    s_waitcnt lgkmcnt(2)
    v_mfma_f32_16x16x32_bf16 v[212:215], a[92:95], v[108:111], v[212:215]
    v_cvt_pk_bf16_f32 v180, v200, v201
    v_cvt_pk_bf16_f32 v181, v202, v203
    s_waitcnt lgkmcnt(1)
    v_mfma_f32_16x16x32_bf16 v[216:219], a[116:119], v[124:127], v[216:219]
    v_cvt_pk_bf16_f32 v182, v204, v205
    v_cvt_pk_bf16_f32 v183, v206, v207
    s_waitcnt lgkmcnt(0)
    v_mfma_f32_16x16x32_bf16 v[220:223], a[124:127], v[124:127], v[220:223]
    v_mfma_f32_16x16x32_bf16 v[72:75], v[176:179], v[128:131], v[64:67]
    v_mfma_f32_16x16x32_bf16 v[88:91], v[176:179], v[20:23], v[80:83]
    v_mfma_f32_16x16x32_bf16 v[64:67], v[176:179], v[44:47], v[64:67]
    v_mfma_f32_16x16x32_bf16 v[80:83], v[176:179], v[52:55], v[80:83]
    v_cvt_pk_bf16_f32 v184, v208, v209
    v_cvt_pk_bf16_f32 v185, v210, v211
    v_mfma_f32_16x16x32_bf16 v[72:75], v[180:183], v[52:55], v[72:75]
    v_cvt_pk_bf16_f32 v186, v212, v213
    v_cvt_pk_bf16_f32 v187, v214, v215
    v_mfma_f32_16x16x32_bf16 v[88:91], v[180:183], v[128:131], v[88:91]
    v_cvt_pk_bf16_f32 v188, v216, v217
    v_cvt_pk_bf16_f32 v189, v218, v219
    v_mfma_f32_16x16x32_bf16 v[64:67], v[180:183], v[20:23], v[64:67]
    v_cvt_pk_bf16_f32 v190, v220, v221
    v_cvt_pk_bf16_f32 v191, v222, v223
    v_mfma_f32_16x16x32_bf16 v[80:83], v[180:183], v[44:47], v[80:83]
    v_mfma_f32_16x16x32_bf16 v[104:107], v[184:187], v[128:131], v[96:99]
    v_mfma_f32_16x16x32_bf16 v[120:123], v[184:187], v[20:23], v[112:115]
    v_mfma_f32_16x16x32_bf16 v[104:107], v[188:191], v[52:55], v[104:107]
    v_mfma_f32_16x16x32_bf16 v[120:123], v[188:191], v[128:131], v[120:123]
    v_mfma_f32_16x16x32_bf16 v[96:99], v[184:187], v[44:47], v[96:99]
    v_mfma_f32_16x16x32_bf16 v[112:115], v[184:187], v[52:55], v[112:115]
    v_mfma_f32_16x16x32_bf16 v[96:99], v[188:191], v[20:23], v[96:99]
    v_mfma_f32_16x16x32_bf16 v[112:115], v[188:191], v[44:47], v[112:115]
    s_nop 2
    v_cvt_pk_bf16_f32 v144, v72, v104
    v_cvt_pk_bf16_f32 v145, v73, v105
    v_mfma_f32_16x16x32_bf16 v[76:79], v[176:179], v[132:135], v[68:71]
    v_cvt_pk_bf16_f32 v146, v88, v120
    v_cvt_pk_bf16_f32 v147, v89, v121
    v_mfma_f32_16x16x32_bf16 v[92:95], v[176:179], v[24:27], v[84:87]
    ds_write_b128 v10, v[144:147] offset:2304
    v_mfma_f32_16x16x32_bf16 v[108:111], v[184:187], v[132:135], v[100:103]
    v_cvt_pk_bf16_f32 v148, v74, v106
    v_cvt_pk_bf16_f32 v149, v75, v107
    v_mfma_f32_16x16x32_bf16 v[124:127], v[184:187], v[24:27], v[116:119]
    v_cvt_pk_bf16_f32 v150, v90, v122
    v_cvt_pk_bf16_f32 v151, v91, v123
    v_mfma_f32_16x16x32_bf16 v[76:79], v[180:183], v[56:59], v[76:79]
    ds_write_b128 v10, v[148:151] offset:2320
    v_mfma_f32_16x16x32_bf16 v[92:95], v[180:183], v[132:135], v[92:95]
    ds_read_b128 v[232:235], v15 offset:2304
    ds_read_b128 v[236:239], v15 offset:3456
    v_mfma_f32_16x16x32_bf16 v[108:111], v[188:191], v[56:59], v[108:111]
    v_cvt_pk_bf16_f32 v136, v64, v96
    v_cvt_pk_bf16_f32 v137, v65, v97
    v_mfma_f32_16x16x32_bf16 v[124:127], v[188:191], v[132:135], v[124:127]
    v_cvt_pk_bf16_f32 v138, v80, v112
    v_cvt_pk_bf16_f32 v139, v81, v113
    v_mfma_f32_16x16x32_bf16 v[68:71], v[176:179], v[48:51], v[68:71]
    ds_write_b128 v10, v[136:139] offset:0
    v_mfma_f32_16x16x32_bf16 v[84:87], v[176:179], v[56:59], v[84:87]
    v_cvt_pk_bf16_f32 v140, v66, v98
    v_cvt_pk_bf16_f32 v141, v67, v99
    v_mfma_f32_16x16x32_bf16 v[100:103], v[184:187], v[48:51], v[100:103]
    v_cvt_pk_bf16_f32 v142, v82, v114
    v_cvt_pk_bf16_f32 v143, v83, v115
    v_mfma_f32_16x16x32_bf16 v[116:119], v[184:187], v[56:59], v[116:119]
    ds_write_b128 v10, v[140:143] offset:16
    v_mfma_f32_16x16x32_bf16 v[68:71], v[180:183], v[24:27], v[68:71]
    ds_read_b128 v[224:227], v15 offset:0
    ds_read_b128 v[228:231], v15 offset:1152
    v_mfma_f32_16x16x32_bf16 v[84:87], v[180:183], v[48:51], v[84:87]
    s_mov_b32 s6, 32768
    s_waitcnt lgkmcnt(5)
    buffer_store_dwordx4 v[232:235], v18, s[20:23], s6 offen sc1
    v_mfma_f32_16x16x32_bf16 v[100:103], v[188:191], v[24:27], v[100:103]
    s_mov_b32 s6, 558080
    s_waitcnt lgkmcnt(4)
    buffer_store_dwordx4 v[236:239], v18, s[20:23], s6 offen sc1
    v_mfma_f32_16x16x32_bf16 v[116:119], v[188:191], v[48:51], v[116:119]
    v_cvt_pk_bf16_f32 v144, v76, v108
    v_cvt_pk_bf16_f32 v145, v77, v109
    v_cvt_pk_bf16_f32 v146, v92, v124
    v_cvt_pk_bf16_f32 v147, v93, v125
    ds_write_b128 v10, v[144:147] offset:2304
    v_cvt_pk_bf16_f32 v148, v78, v110
    v_cvt_pk_bf16_f32 v149, v79, v111
    v_cvt_pk_bf16_f32 v150, v94, v126
    v_cvt_pk_bf16_f32 v151, v95, v127
    ds_write_b128 v10, v[148:151] offset:2320
    ds_read_b128 v[200:203], v15 offset:2304
    ds_read_b128 v[204:207], v15 offset:3456
    s_mov_b32 s6, 0
    s_waitcnt lgkmcnt(5)
    buffer_store_dwordx4 v[224:227], v18, s[20:23], s6 offen sc1
    s_mov_b32 s6, 525312
    s_waitcnt lgkmcnt(4)
    buffer_store_dwordx4 v[228:231], v18, s[20:23], s6 offen sc1
    v_cvt_pk_bf16_f32 v136, v68, v100
    v_cvt_pk_bf16_f32 v137, v69, v101
    v_cvt_pk_bf16_f32 v138, v84, v116
    v_cvt_pk_bf16_f32 v139, v85, v117
    ds_write_b128 v10, v[136:139] offset:0
    v_cvt_pk_bf16_f32 v140, v70, v102
    v_cvt_pk_bf16_f32 v141, v71, v103
    v_cvt_pk_bf16_f32 v142, v86, v118
    v_cvt_pk_bf16_f32 v143, v87, v119
    ds_write_b128 v10, v[140:143] offset:16
    ds_read_b128 v[192:195], v15 offset:0
    ds_read_b128 v[196:199], v15 offset:1152
    s_mov_b32 s6, 1083392
    s_waitcnt lgkmcnt(5)
    buffer_store_dwordx4 v[200:203], v18, s[20:23], s6 offen sc1
    s_mov_b32 s6, 1608704
    s_waitcnt lgkmcnt(4)
    buffer_store_dwordx4 v[204:207], v18, s[20:23], s6 offen sc1
    s_mov_b32 s6, 1050624
    s_waitcnt lgkmcnt(1)
    buffer_store_dwordx4 v[192:195], v18, s[20:23], s6 offen sc1
    s_mov_b32 s6, 1575936
    s_waitcnt lgkmcnt(0)
    buffer_store_dwordx4 v[196:199], v18, s[20:23], s6 offen sc1
    s_cmp_ge_u32 s40, 28
    s_cbranch_scc1 L_B2
    s_mov_b32 s22, 0x1000000
    s_mov_b32 s23, 0x20000
    s_mov_b32 s26, 0x62000
    s_mov_b32 s27, 0x20000
    s_mov_b32 s30, 0x380000
    s_mov_b32 s31, 0x20000
    s_mul_i32 s6, s40, 37
    s_lshr_b32 s6, s6, 8
    s_mul_i32 s7, s6, 7
    s_sub_u32 s41, s40, s7
    s_lshr_b32 s7, s57, 3
    s_add_u32 s41, s41, s7
    s_sub_u32 s7, s41, 7
    s_min_u32 s41, s41, s7
    s_lshl_b32 s6, s6, 2
    s_add_u32 s6, s6, s3
    v_bfe_u32 v32, v1, 1, 1
    v_lshl_add_u32 v32, s6, 1, v32
    v_mul_u32_u24 v33, 47, v32
    v_lshrrev_b32 v33, 9, v33
    v_mul_u32_u24 v34, 11, v33
    v_sub_u32 v32, v32, v34
    v_add_u32 v32, 3, v32
    v_and_b32 v32, 8, v32
    v_lshl_add_u32 v32, v33, 10, v32
    v_and_b32 v33, 1, v1
    v_lshl_add_u32 v32, v33, 2, v32
    v_bfe_u32 v33, v1, 2, 3
    v_lshl_add_u32 v32, v33, 7, v32
    s_mul_i32 s7, s57, 17920
    s_add_u32 s7, s7, 6429696
    v_add_u32 v246, s7, v32
    s_and_b32 s7, s2, 6
    s_lshl3_add_u32 s6, s7, s6
    s_and_b32 s8, s2, 1
    s_lshl_b32 s7, s8, 6
    s_add_u32 s42, s6, s7
    v_lshrrev_b32 v32, 3, v1
    v_and_b32 v33, 6, v32
    v_and_b32 v34, 7, v1
    v_xor_b32 v33, v33, v34
    v_lshrrev_b32 v32, 3, v0
    v_mul_u32_u24 v32, 896, v32
    v_lshl_add_u32 v32, v33, 4, v32
    s_lshl_b32 s7, s41, 7
    v_add_u32 v240, s7, v32
    v_mov_b32 v34, 0
    v_mov_b32 v35, 0
    v_lshlrev_b32 v32, 3, v1
    v_add_u32 v32, 162816, v32
    ds_write_b64 v32, v[34:35]
    s_lshl_b32 s45, s3, 10
    s_add_u32 s45, s45, 105472
    v_lshrrev_b32 v32, 2, v1
    v_bfe_u32 v33, v1, 3, 2
    v_lshlrev_b32 v33, 5, v33
    v_lshl_add_u32 v33, v32, 7, v33
    v_and_b32 v34, 3, v1
    v_lshl_add_u32 v33, v34, 3, v33
    v_add_u32 v241, 105472, v33
    v_xor_b32 v242, 32, v241
    v_xor_b32 v243, 64, v241
    v_xor_b32 v244, 96, v241
    s_lshl_b32 s9, s42, 14
    v_lshl_add_u32 v245, v1, 4, s9
    s_lshl_b32 s6, s6, 5
    s_add_u32 s6, s6, s8
    s_mul_i32 s6, s6, 1792
    s_add_u32 s6, s6, s7
    v_mul_u32_u24 v32, 3584, v253
    v_and_b32 v33, 1, v252
    v_lshl_add_u32 v32, v33, 5, v32
    v_lshrrev_b32 v33, 1, v252
    v_lshl_add_u32 v32, v33, 4, v32
    v_add_u32 v247, s6, v32
    v_mov_b32 v248, 0x40000000
    s_waitcnt vmcnt(0)
    s_cmp_eq_u32 s3, 0
    s_cselect_b32 s6, 0, 0x40000000
    s_mov_b64 exec, 1
    s_barrier
    buffer_store_dword v250, v19, s[20:23], s6 offen sc1
    s_mov_b64 exec, -1
    s_mov_b32 s6, 0x20000
    buffer_load_dword v255, v5, s[20:23], 0 offen
    s_add_u32 m0, s45, 0
    s_mov_b32 s6, 0
    buffer_load_dwordx4 v240, s[24:27], s6 offen lds
    s_add_u32 m0, s45, 4096
    s_mov_b32 s6, 28672
    buffer_load_dwordx4 v240, s[24:27], s6 offen lds
    s_add_u32 m0, s45, 8192
    s_mov_b32 s6, 57344
    buffer_load_dwordx4 v240, s[24:27], s6 offen lds
    s_add_u32 m0, s45, 12288
    s_mov_b32 s6, 86016
    buffer_load_dwordx4 v240, s[24:27], s6 offen lds
    s_add_u32 m0, s45, 16384
    s_mov_b32 s6, 114688
    buffer_load_dwordx4 v240, s[24:27], s6 offen lds
    s_add_u32 m0, s45, 20480
    s_mov_b32 s6, 143360
    buffer_load_dwordx4 v240, s[24:27], s6 offen lds
    s_add_u32 m0, s45, 24576
    s_mov_b32 s6, 172032
    buffer_load_dwordx4 v240, s[24:27], s6 offen lds
    s_add_u32 m0, s45, 28672
    s_mov_b32 s6, 200704
    buffer_load_dwordx4 v240, s[24:27], s6 offen lds
    s_add_u32 m0, s45, 32768
    s_mov_b32 s6, 229376
    buffer_load_dwordx4 v240, s[24:27], s6 offen lds
    s_add_u32 m0, s45, 36864
    s_mov_b32 s6, 258048
    buffer_load_dwordx4 v240, s[24:27], s6 offen lds
    s_add_u32 m0, s45, 40960
    s_mov_b32 s6, 286720
    buffer_load_dwordx4 v240, s[24:27], s6 offen lds
    s_add_u32 m0, s45, 45056
    s_mov_b32 s6, 315392
    buffer_load_dwordx4 v240, s[24:27], s6 offen lds
    s_add_u32 m0, s45, 49152
    s_mov_b32 s6, 344064
    buffer_load_dwordx4 v240, s[24:27], s6 offen lds
    s_add_u32 m0, s45, 53248
    s_mov_b32 s6, 372736
    buffer_load_dwordx4 v240, s[24:27], s6 offen lds
    s_mov_b32 s10, 40
L_plN:
    buffer_load_dword v32, v7, s[20:23], 0 offen sc1
    s_sub_u32 s10, s10, 1
    s_cbranch_scc1 L_pdN
    s_waitcnt vmcnt(0)
    v_cmp_ne_u32 vcc, v32, v250
    s_nop 0
    s_and_b64 exec, exec, vcc
    s_cbranch_scc1 L_plN
L_pdN:
    s_or_b32 s43, exec_lo, exec_hi
    s_mov_b64 exec, -1
    v_lshlrev_b32 v5, 10, v252
    v_sub_u32 v2, v241, v5
    v_sub_u32 v3, v242, v5
    v_sub_u32 v4, v243, v5
    v_sub_u32 v5, v244, v5
    s_movk_i32 s58, 4096
    s_movk_i32 s59, 8192
    s_movk_i32 s60, 12288
    s_mov_b32 s11, 0
    s_waitcnt vmcnt(0) lgkmcnt(0)
    s_barrier
    s_branch L_P2
.p2align 12
L_B2:
    buffer_load_dword v21, v7, s[20:23], 0 offen sc1
    s_mov_b32 s30, 0x380000
    s_mov_b32 s31, 0x20000
    s_lshr_b32 s6, s57, 1
    s_add_u32 s48, s6, s40
    s_sub_u32 s48, s48, 28
    v_cvt_f32_u32 v12, v253
    v_mul_f32 v12, 0x3c800000, v12
    v_lshlrev_b32 v13, 2, v252
    v_cvt_f32_u32 v13, v13
    v_mul_f32_e64 v13, v13, v12
    v_fmamk_f32 v32, v12, 0x00000000, v13
    v_fmamk_f32 v33, v12, 0x3f800000, v13
    v_fmamk_f32 v34, v12, 0x40000000, v13
    v_fmamk_f32 v35, v12, 0x40400000, v13
    v_fmamk_f32 v36, v12, 0x41800000, v13
    v_fmamk_f32 v37, v12, 0x41880000, v13
    v_fmamk_f32 v38, v12, 0x41900000, v13
    v_fmamk_f32 v39, v12, 0x41980000, v13
    v_cos_f32 v40, v32
    v_cos_f32 v41, v33
    v_cos_f32 v42, v34
    v_cos_f32 v43, v35
    v_cos_f32 v44, v36
    v_cos_f32 v45, v37
    v_cos_f32 v46, v38
    v_cos_f32 v47, v39
    v_sin_f32 v48, v32
    v_sin_f32 v49, v33
    v_sin_f32 v50, v34
    v_sin_f32 v51, v35
    v_sin_f32 v52, v36
    v_sin_f32 v53, v37
    v_sin_f32 v54, v38
    v_sin_f32 v55, v39
    v_cvt_pk_bf16_f32 v128, v40, -v48
    v_cvt_pk_bf16_f32 v129, v41, -v49
    v_cvt_pk_bf16_f32 v130, v42, -v50
    v_cvt_pk_bf16_f32 v131, v43, -v51
    v_cvt_pk_bf16_f32 v132, v44, -v52
    v_cvt_pk_bf16_f32 v133, v45, -v53
    v_cvt_pk_bf16_f32 v134, v46, -v54
    v_cvt_pk_bf16_f32 v135, v47, -v55
    v_cvt_pk_bf16_f32 v144, v40, -v48
    v_cvt_pk_bf16_f32 v145, -v49, -v41
    v_cvt_pk_bf16_f32 v146, -v42, v50
    v_cvt_pk_bf16_f32 v147, v51, v43
    v_cvt_pk_bf16_f32 v148, v44, -v52
    v_cvt_pk_bf16_f32 v149, -v53, -v45
    v_cvt_pk_bf16_f32 v150, -v46, v54
    v_cvt_pk_bf16_f32 v151, v55, v47
    v_cvt_pk_bf16_f32 v160, v40, -v48
    v_cvt_pk_bf16_f32 v161, -v41, v49
    v_cvt_pk_bf16_f32 v162, v42, -v50
    v_cvt_pk_bf16_f32 v163, -v43, v51
    v_cvt_pk_bf16_f32 v164, v44, -v52
    v_cvt_pk_bf16_f32 v165, -v45, v53
    v_cvt_pk_bf16_f32 v166, v46, -v54
    v_cvt_pk_bf16_f32 v167, -v47, v55
    v_cvt_pk_bf16_f32 v176, v40, -v48
    v_cvt_pk_bf16_f32 v177, v49, v41
    v_cvt_pk_bf16_f32 v178, -v42, v50
    v_cvt_pk_bf16_f32 v179, -v51, -v43
    v_cvt_pk_bf16_f32 v180, v44, -v52
    v_cvt_pk_bf16_f32 v181, v53, v45
    v_cvt_pk_bf16_f32 v182, -v46, v54
    v_cvt_pk_bf16_f32 v183, -v55, -v47
    s_waitcnt vmcnt(0)
    s_cmp_eq_u32 s3, 0
    s_cselect_b32 s6, 0, 0x40000000
    s_mov_b64 exec, 1
    s_barrier
    buffer_store_dword v250, v19, s[20:23], s6 offen sc1
    s_mov_b64 exec, -1
    v_fmamk_f32 v32, v12, 0x42000000, v13
    v_fmamk_f32 v33, v12, 0x42040000, v13
    v_fmamk_f32 v34, v12, 0x42080000, v13
    v_fmamk_f32 v35, v12, 0x420c0000, v13
    v_fmamk_f32 v36, v12, 0x42400000, v13
    v_fmamk_f32 v37, v12, 0x42440000, v13
    v_fmamk_f32 v38, v12, 0x42480000, v13
    v_fmamk_f32 v39, v12, 0x424c0000, v13
    v_cos_f32 v40, v32
    v_cos_f32 v41, v33
    v_cos_f32 v42, v34
    v_cos_f32 v43, v35
    v_cos_f32 v44, v36
    v_cos_f32 v45, v37
    v_cos_f32 v46, v38
    v_cos_f32 v47, v39
    v_sin_f32 v48, v32
    v_sin_f32 v49, v33
    v_sin_f32 v50, v34
    v_sin_f32 v51, v35
    v_sin_f32 v52, v36
    v_sin_f32 v53, v37
    v_sin_f32 v54, v38
    v_sin_f32 v55, v39
    v_cvt_pk_bf16_f32 v136, v40, -v48
    v_cvt_pk_bf16_f32 v137, v41, -v49
    v_cvt_pk_bf16_f32 v138, v42, -v50
    v_cvt_pk_bf16_f32 v139, v43, -v51
    v_cvt_pk_bf16_f32 v140, v44, -v52
    v_cvt_pk_bf16_f32 v141, v45, -v53
    v_cvt_pk_bf16_f32 v142, v46, -v54
    v_cvt_pk_bf16_f32 v143, v47, -v55
    v_cvt_pk_bf16_f32 v152, v40, -v48
    v_cvt_pk_bf16_f32 v153, -v49, -v41
    v_cvt_pk_bf16_f32 v154, -v42, v50
    v_cvt_pk_bf16_f32 v155, v51, v43
    v_cvt_pk_bf16_f32 v156, v44, -v52
    v_cvt_pk_bf16_f32 v157, -v53, -v45
    v_cvt_pk_bf16_f32 v158, -v46, v54
    v_cvt_pk_bf16_f32 v159, v55, v47
    v_cvt_pk_bf16_f32 v168, v40, -v48
    v_cvt_pk_bf16_f32 v169, -v41, v49
    v_cvt_pk_bf16_f32 v170, v42, -v50
    v_cvt_pk_bf16_f32 v171, -v43, v51
    v_cvt_pk_bf16_f32 v172, v44, -v52
    v_cvt_pk_bf16_f32 v173, -v45, v53
    v_cvt_pk_bf16_f32 v174, v46, -v54
    v_cvt_pk_bf16_f32 v175, -v47, v55
    v_cvt_pk_bf16_f32 v184, v40, -v48
    v_cvt_pk_bf16_f32 v185, v49, v41
    v_cvt_pk_bf16_f32 v186, -v42, v50
    v_cvt_pk_bf16_f32 v187, -v51, -v43
    v_cvt_pk_bf16_f32 v188, v44, -v52
    v_cvt_pk_bf16_f32 v189, v53, v45
    v_cvt_pk_bf16_f32 v190, -v46, v54
    v_cvt_pk_bf16_f32 v191, -v55, -v47
    v_bfe_u32 v33, v1, 5, 1
    v_xor_b32 v33, v33, v1
    s_mul_i32 s6, s48, 65664
    s_lshl_b32 s11, s3, 13
    s_add_u32 s6, s6, s11
    s_add_u32 s6, s6, 2097152
    v_lshl_add_u32 v2, v33, 4, s6
    s_add_u32 s11, s11, 65536
    v_bfe_u32 v4, v1, 3, 1
    v_lshl_add_u32 v4, v252, 2, v4
    v_lshlrev_b32 v4, 7, v4
    v_and_b32 v32, 1, v252
    v_lshl_add_u32 v4, v32, 4, v4
    v_and_b32 v32, 3, v1
    v_lshl_add_u32 v4, v32, 5, v4
    v_bfe_u32 v33, v1, 2, 1
    v_lshl_add_u32 v4, v33, 3, v4
    v_add_u32 v4, s11, v4
    v_xor_b32 v5, 16, v4
    s_movk_i32 s61, 528
    v_mul_u32_u24 v6, 528, v253
    v_lshl_add_u32 v6, v252, 4, v6
    v_lshl_add_u32 v6, s3, 6, v6
    v_lshl_add_u32 v33, s3, 2, v252
    v_lshlrev_b32 v32, 4, v253
    v_mad_u32_u24 v8, v33, s61, v32
    v_lshl_add_u32 v9, v33, 5, s48
    v_sub_u32 v10, 2048, v9
    v_and_b32 v11, 2047, v10
    v_subrev_u32 v10, 1536, v10
    v_mul_u32_u24 v9, 1792, v9
    v_mul_u32_u24 v10, 1792, v10
    v_mul_u32_u24 v11, 1792, v11
    v_add_u32 v9, v9, v32
    v_sub_u32 v32, 240, v32
    v_add_u32 v10, v10, v32
    v_add_u32 v11, v11, v32
    v_cmp_gt_u32 vcc, 12, v253
    v_mov_b32 v16, 0xffff
    s_mov_b32 s58, 917504
    s_mov_b32 s59, 1835008
    s_mov_b32 s60, 2752512
    v_cndmask_b32 v10, 2.0, v10, vcc
    v_cndmask_b32 v11, 2.0, v11, vcc
    s_mov_b32 s6, 0x9e3779b1
    v_mul_lo_u32 v251, v251, s6
    v_add_u32 v251, 0x7f4a7c15, v251
    v_lshlrev_b32 v3, 7, v1
    v_add_u32 v3, 5242880, v3
    v_cmp_ne_u32 vcc, v21, v250
    s_lshl_b32 s6, s3, 4
    s_or_b32 s43, vcc_lo, vcc_hi
    s_bfm_b64 exec, 16, s6
    s_mov_b32 s10, 65536
L_plB:
    buffer_load_dword v32, v3, s[20:23], 0 offen sc1
    s_sub_u32 s10, s10, 1
    s_cbranch_scc1 L_pdB
    s_waitcnt vmcnt(0)
    v_cmp_ne_u32 vcc, v32, v251
    s_nop 0
    s_and_b64 exec, exec, vcc
    s_cbranch_scc1 L_plB
L_pdB:
    s_mov_b64 exec, -1
    s_barrier
    s_add_u32 m0, s11, 32768
    s_mov_b32 s9, 32768
    buffer_load_dwordx4 v2, s[20:23], s9 offen offset:0 sc1 lds
    buffer_load_dwordx4 v2, s[20:23], s9 offen offset:1024 sc1 lds
    buffer_load_dwordx4 v2, s[20:23], s9 offen offset:2048 sc1 lds
    buffer_load_dwordx4 v2, s[20:23], s9 offen offset:3072 sc1 lds
    s_add_u32 m0, s11, 36864
    s_mov_b32 s9, 36864
    buffer_load_dwordx4 v2, s[20:23], s9 offen offset:0 sc1 lds
    buffer_load_dwordx4 v2, s[20:23], s9 offen offset:1024 sc1 lds
    buffer_load_dwordx4 v2, s[20:23], s9 offen offset:2048 sc1 lds
    buffer_load_dwordx4 v2, s[20:23], s9 offen offset:3072 sc1 lds
    s_add_u32 m0, s11, 0
    s_mov_b32 s9, 0
    buffer_load_dwordx4 v2, s[20:23], s9 offen offset:0 sc1 lds
    buffer_load_dwordx4 v2, s[20:23], s9 offen offset:1024 sc1 lds
    s_waitcnt vmcnt(8)
    ds_read_b64_tr_b16 v[96:97], v4 offset:32768
    ds_read_b64_tr_b16 v[98:99], v4 offset:33024
    ds_read_b64_tr_b16 v[100:101], v5 offset:32768
    ds_read_b64_tr_b16 v[102:103], v5 offset:33024
    s_waitcnt vmcnt(6)
    s_waitcnt lgkmcnt(2)
    v_mfma_f32_16x16x32_bf16 v[64:67], v[96:99], v[128:131], 0
    ds_read_b64_tr_b16 v[104:105], v4 offset:34816
    buffer_load_dwordx4 v2, s[20:23], s9 offen offset:2048 sc1 lds
    s_waitcnt lgkmcnt(1)
    v_mfma_f32_16x16x32_bf16 v[68:71], v[100:103], v[128:131], 0
    ds_read_b64_tr_b16 v[106:107], v4 offset:35072
    v_mfma_f32_16x16x32_bf16 v[72:75], v[96:99], v[144:147], 0
    ds_read_b64_tr_b16 v[108:109], v5 offset:34816
    v_mfma_f32_16x16x32_bf16 v[76:79], v[100:103], v[144:147], 0
    ds_read_b64_tr_b16 v[110:111], v5 offset:35072
    v_mfma_f32_16x16x32_bf16 v[80:83], v[96:99], v[160:163], 0
    buffer_load_dwordx4 v2, s[20:23], s9 offen offset:3072 sc1 lds
    v_mfma_f32_16x16x32_bf16 v[84:87], v[100:103], v[160:163], 0
    v_mfma_f32_16x16x32_bf16 v[88:91], v[96:99], v[176:179], 0
    v_mfma_f32_16x16x32_bf16 v[92:95], v[100:103], v[176:179], 0
    s_waitcnt vmcnt(6)
    s_waitcnt lgkmcnt(2)
    v_mfma_f32_16x16x32_bf16 v[64:67], v[104:107], v[132:135], v[64:67]
    ds_read_b64_tr_b16 v[112:113], v4 offset:36864
    s_add_u32 m0, s11, 4096
    s_waitcnt lgkmcnt(1)
    v_mfma_f32_16x16x32_bf16 v[68:71], v[108:111], v[132:135], v[68:71]
    ds_read_b64_tr_b16 v[114:115], v4 offset:37120
    s_mov_b32 s9, 4096
    v_mfma_f32_16x16x32_bf16 v[72:75], v[104:107], v[148:151], v[72:75]
    ds_read_b64_tr_b16 v[116:117], v5 offset:36864
    buffer_load_dwordx4 v2, s[20:23], s9 offen offset:0 sc1 lds
    v_mfma_f32_16x16x32_bf16 v[76:79], v[108:111], v[148:151], v[76:79]
    ds_read_b64_tr_b16 v[118:119], v5 offset:37120
    v_mfma_f32_16x16x32_bf16 v[80:83], v[104:107], v[164:167], v[80:83]
    buffer_load_dwordx4 v2, s[20:23], s9 offen offset:1024 sc1 lds
    v_mfma_f32_16x16x32_bf16 v[84:87], v[108:111], v[164:167], v[84:87]
    v_mfma_f32_16x16x32_bf16 v[88:91], v[104:107], v[180:183], v[88:91]
    v_mfma_f32_16x16x32_bf16 v[92:95], v[108:111], v[180:183], v[92:95]
    s_waitcnt vmcnt(6)
    s_waitcnt lgkmcnt(2)
    v_mfma_f32_16x16x32_bf16 v[64:67], v[112:115], v[136:139], v[64:67]
    ds_read_b64_tr_b16 v[120:121], v4 offset:38912
    buffer_load_dwordx4 v2, s[20:23], s9 offen offset:2048 sc1 lds
    s_waitcnt lgkmcnt(1)
    v_mfma_f32_16x16x32_bf16 v[68:71], v[116:119], v[136:139], v[68:71]
    ds_read_b64_tr_b16 v[122:123], v4 offset:39168
    v_mfma_f32_16x16x32_bf16 v[72:75], v[112:115], v[152:155], v[72:75]
    ds_read_b64_tr_b16 v[124:125], v5 offset:38912
    v_mfma_f32_16x16x32_bf16 v[76:79], v[116:119], v[152:155], v[76:79]
    ds_read_b64_tr_b16 v[126:127], v5 offset:39168
    v_mfma_f32_16x16x32_bf16 v[80:83], v[112:115], v[168:171], v[80:83]
    buffer_load_dwordx4 v2, s[20:23], s9 offen offset:3072 sc1 lds
    v_mfma_f32_16x16x32_bf16 v[84:87], v[116:119], v[168:171], v[84:87]
    v_mfma_f32_16x16x32_bf16 v[88:91], v[112:115], v[184:187], v[88:91]
    v_mfma_f32_16x16x32_bf16 v[92:95], v[116:119], v[184:187], v[92:95]
    s_waitcnt vmcnt(6)
    s_waitcnt lgkmcnt(2)
    v_mfma_f32_16x16x32_bf16 v[64:67], v[120:123], v[140:143], v[64:67]
    ds_read_b64_tr_b16 v[96:97], v4 offset:0
    s_waitcnt lgkmcnt(1)
    v_mfma_f32_16x16x32_bf16 v[68:71], v[124:127], v[140:143], v[68:71]
    ds_read_b64_tr_b16 v[98:99], v4 offset:256
    v_mfma_f32_16x16x32_bf16 v[72:75], v[120:123], v[156:159], v[72:75]
    ds_read_b64_tr_b16 v[100:101], v5 offset:0
    v_mfma_f32_16x16x32_bf16 v[76:79], v[124:127], v[156:159], v[76:79]
    ds_read_b64_tr_b16 v[102:103], v5 offset:256
    v_mfma_f32_16x16x32_bf16 v[80:83], v[120:123], v[172:175], v[80:83]
    v_mfma_f32_16x16x32_bf16 v[84:87], v[124:127], v[172:175], v[84:87]
    v_mfma_f32_16x16x32_bf16 v[88:91], v[120:123], v[188:191], v[88:91]
    v_mfma_f32_16x16x32_bf16 v[92:95], v[124:127], v[188:191], v[92:95]
    s_waitcnt vmcnt(4)
    s_waitcnt lgkmcnt(2)
    v_mfma_f32_16x16x32_bf16 v[32:35], v[96:99], v[128:131], 0
    ds_read_b64_tr_b16 v[104:105], v4 offset:2048
    v_cvt_pk_bf16_f32 v216, v64, v65
    s_waitcnt lgkmcnt(1)
    v_mfma_f32_16x16x32_bf16 v[36:39], v[100:103], v[128:131], 0
    ds_read_b64_tr_b16 v[106:107], v4 offset:2304
    v_cvt_pk_bf16_f32 v217, v66, v67
    v_mfma_f32_16x16x32_bf16 v[40:43], v[96:99], v[144:147], 0
    ds_read_b64_tr_b16 v[108:109], v5 offset:2048
    v_cvt_pk_bf16_f32 v218, v68, v69
    v_mfma_f32_16x16x32_bf16 v[44:47], v[100:103], v[144:147], 0
    ds_read_b64_tr_b16 v[110:111], v5 offset:2304
    v_cvt_pk_bf16_f32 v219, v70, v71
    v_mfma_f32_16x16x32_bf16 v[48:51], v[96:99], v[160:163], 0
    ds_write_b128 v6, v[216:219] offset:256
    v_cvt_pk_bf16_f32 v220, v72, v73
    v_mfma_f32_16x16x32_bf16 v[52:55], v[100:103], v[160:163], 0
    v_cvt_pk_bf16_f32 v224, v80, v81
    v_cvt_pk_bf16_f32 v221, v74, v75
    v_mfma_f32_16x16x32_bf16 v[56:59], v[96:99], v[176:179], 0
    v_cvt_pk_bf16_f32 v225, v82, v83
    v_cvt_pk_bf16_f32 v222, v76, v77
    v_mfma_f32_16x16x32_bf16 v[60:63], v[100:103], v[176:179], 0
    v_cvt_pk_bf16_f32 v223, v78, v79
    v_cvt_pk_bf16_f32 v226, v84, v85
    ds_write_b128 v6, v[220:223] offset:8704
    v_cvt_pk_bf16_f32 v227, v86, v87
    s_waitcnt vmcnt(2)
    s_waitcnt lgkmcnt(4)
    v_mfma_f32_16x16x32_bf16 v[32:35], v[104:107], v[132:135], v[32:35]
    ds_write_b128 v6, v[224:227] offset:17152
    v_cvt_pk_bf16_f32 v228, v88, v89
    s_waitcnt lgkmcnt(3)
    v_mfma_f32_16x16x32_bf16 v[36:39], v[108:111], v[132:135], v[36:39]
    ds_read_b64_tr_b16 v[112:113], v4 offset:4096
    v_cvt_pk_bf16_f32 v229, v90, v91
    v_mfma_f32_16x16x32_bf16 v[40:43], v[104:107], v[148:151], v[40:43]
    ds_read_b64_tr_b16 v[114:115], v4 offset:4352
    v_cvt_pk_bf16_f32 v230, v92, v93
    v_mfma_f32_16x16x32_bf16 v[44:47], v[108:111], v[148:151], v[44:47]
    ds_read_b64_tr_b16 v[116:117], v5 offset:4096
    v_cvt_pk_bf16_f32 v231, v94, v95
    v_mfma_f32_16x16x32_bf16 v[48:51], v[104:107], v[164:167], v[48:51]
    ds_read_b64_tr_b16 v[118:119], v5 offset:4352
    v_mfma_f32_16x16x32_bf16 v[52:55], v[108:111], v[164:167], v[52:55]
    ds_write_b128 v6, v[228:231] offset:25600
    v_mfma_f32_16x16x32_bf16 v[56:59], v[104:107], v[180:183], v[56:59]
    v_mfma_f32_16x16x32_bf16 v[60:63], v[108:111], v[180:183], v[60:63]
    s_waitcnt vmcnt(0)
    s_waitcnt lgkmcnt(3)
    v_mfma_f32_16x16x32_bf16 v[32:35], v[112:115], v[136:139], v[32:35]
    s_waitcnt lgkmcnt(1)
    v_mfma_f32_16x16x32_bf16 v[36:39], v[116:119], v[136:139], v[36:39]
    s_waitcnt lgkmcnt(0)
    s_barrier
    v_mfma_f32_16x16x32_bf16 v[40:43], v[112:115], v[152:155], v[40:43]
    ds_read_b128 v[192:195], v8 offset:256
    ds_read_b128 v[198:201], v8 offset:8704
    v_mfma_f32_16x16x32_bf16 v[44:47], v[116:119], v[152:155], v[44:47]
    ds_read_b64_tr_b16 v[120:121], v4 offset:6144
    v_mfma_f32_16x16x32_bf16 v[48:51], v[112:115], v[168:171], v[48:51]
    ds_read_b64_tr_b16 v[122:123], v4 offset:6400
    ds_read_b128 v[204:207], v8 offset:17152
    v_mfma_f32_16x16x32_bf16 v[52:55], v[116:119], v[168:171], v[52:55]
    ds_read_b64_tr_b16 v[124:125], v5 offset:6144
    v_mfma_f32_16x16x32_bf16 v[56:59], v[112:115], v[184:187], v[56:59]
    ds_read_b64_tr_b16 v[126:127], v5 offset:6400
    ds_read_b128 v[210:213], v8 offset:25600
    v_mfma_f32_16x16x32_bf16 v[60:63], v[116:119], v[184:187], v[60:63]
    s_waitcnt lgkmcnt(7)
    buffer_store_dwordx4 v[192:195], v9, s[28:31], 0 offen offset:1344 sc1
    v_mov_b32_dpp v196, v192 row_shl:1 row_mask:0xf bank_mask:0xf bound_ctrl:0
    v_bfi_b32 v243, v16, v193, v192
    v_bfi_b32 v242, v16, v194, v193
    v_bfi_b32 v241, v16, v195, v194
    v_bfi_b32 v240, v16, v196, v195
    buffer_store_dwordx4 v[240:243], v11, s[28:31], 0 offen offset:1088 sc1
    s_waitcnt lgkmcnt(4)
    v_mfma_f32_16x16x32_bf16 v[32:35], v[120:123], v[140:143], v[32:35]
    buffer_store_dwordx4 v[198:201], v9, s[28:31], s58 offen offset:1344 sc1
    v_mov_b32_dpp v202, v198 row_shl:1 row_mask:0xf bank_mask:0xf bound_ctrl:0
    s_waitcnt lgkmcnt(1)
    v_mfma_f32_16x16x32_bf16 v[36:39], v[124:127], v[140:143], v[36:39]
    v_bfi_b32 v247, v16, v199, v198
    v_bfi_b32 v246, v16, v200, v199
    v_mfma_f32_16x16x32_bf16 v[40:43], v[120:123], v[156:159], v[40:43]
    v_bfi_b32 v245, v16, v201, v200
    v_bfi_b32 v244, v16, v202, v201
    v_mfma_f32_16x16x32_bf16 v[44:47], v[124:127], v[156:159], v[44:47]
    buffer_store_dwordx4 v[244:247], v10, s[28:31], s59 offen offset:1088 sc1
    buffer_store_dwordx4 v[204:207], v9, s[28:31], s59 offen offset:1344 sc1
    v_mfma_f32_16x16x32_bf16 v[48:51], v[120:123], v[172:175], v[48:51]
    v_mov_b32_dpp v208, v204 row_shl:1 row_mask:0xf bank_mask:0xf bound_ctrl:0
    v_bfi_b32 v243, v16, v205, v204
    v_mfma_f32_16x16x32_bf16 v[52:55], v[124:127], v[172:175], v[52:55]
    v_bfi_b32 v242, v16, v206, v205
    v_bfi_b32 v241, v16, v207, v206
    v_mfma_f32_16x16x32_bf16 v[56:59], v[120:123], v[188:191], v[56:59]
    v_bfi_b32 v240, v16, v208, v207
    buffer_store_dwordx4 v[240:243], v10, s[28:31], s58 offen offset:1088 sc1
    v_mfma_f32_16x16x32_bf16 v[60:63], v[124:127], v[188:191], v[60:63]
    v_cvt_pk_bf16_f32 v216, v32, v33
    v_cvt_pk_bf16_f32 v217, v34, v35
    v_cvt_pk_bf16_f32 v218, v36, v37
    v_cvt_pk_bf16_f32 v219, v38, v39
    ds_write_b128 v6, v[216:219] offset:0
    s_waitcnt lgkmcnt(1)
    buffer_store_dwordx4 v[210:213], v9, s[28:31], s60 offen offset:1344 sc1
    v_cvt_pk_bf16_f32 v220, v40, v41
    v_cvt_pk_bf16_f32 v221, v42, v43
    v_cvt_pk_bf16_f32 v222, v44, v45
    v_cvt_pk_bf16_f32 v223, v46, v47
    ds_write_b128 v6, v[220:223] offset:8448
    v_mov_b32_dpp v214, v210 row_shl:1 row_mask:0xf bank_mask:0xf bound_ctrl:0
    v_bfi_b32 v247, v16, v211, v210
    v_bfi_b32 v246, v16, v212, v211
    v_bfi_b32 v245, v16, v213, v212
    v_bfi_b32 v244, v16, v214, v213
    buffer_store_dwordx4 v[244:247], v10, s[28:31], 0 offen offset:1088 sc1
    s_waitcnt lgkmcnt(0)
    s_barrier
    ds_read_b128 v[192:195], v8 offset:0
    ds_read_b128 v[198:201], v8 offset:8448
    v_cvt_pk_bf16_f32 v224, v48, v49
    v_cvt_pk_bf16_f32 v225, v50, v51
    v_cvt_pk_bf16_f32 v226, v52, v53
    v_cvt_pk_bf16_f32 v227, v54, v55
    ds_write_b128 v6, v[224:227] offset:16896
    v_cvt_pk_bf16_f32 v228, v56, v57
    v_cvt_pk_bf16_f32 v229, v58, v59
    v_cvt_pk_bf16_f32 v230, v60, v61
    v_cvt_pk_bf16_f32 v231, v62, v63
    ds_write_b128 v6, v[228:231] offset:25344
    s_waitcnt lgkmcnt(3)
    buffer_store_dwordx4 v[192:195], v9, s[28:31], 0 offen offset:896 sc1
    v_mov_b32_dpp v196, v192 row_shl:1 row_mask:0xf bank_mask:0xf bound_ctrl:0
    v_bfi_b32 v243, v16, v193, v192
    v_bfi_b32 v242, v16, v194, v193
    v_bfi_b32 v241, v16, v195, v194
    v_bfi_b32 v240, v16, v196, v195
    buffer_store_dwordx4 v[240:243], v11, s[28:31], 0 offen offset:1536 sc1
    s_waitcnt lgkmcnt(0)
    s_barrier
    ds_read_b128 v[204:207], v8 offset:16896
    ds_read_b128 v[210:213], v8 offset:25344
    buffer_store_dwordx4 v[198:201], v9, s[28:31], s58 offen offset:896 sc1
    v_mov_b32_dpp v202, v198 row_shl:1 row_mask:0xf bank_mask:0xf bound_ctrl:0
    v_bfi_b32 v247, v16, v199, v198
    v_bfi_b32 v246, v16, v200, v199
    v_bfi_b32 v245, v16, v201, v200
    v_bfi_b32 v244, v16, v202, v201
    buffer_store_dwordx4 v[244:247], v10, s[28:31], s59 offen offset:1536 sc1
    s_waitcnt lgkmcnt(1)
    buffer_store_dwordx4 v[204:207], v9, s[28:31], s59 offen offset:896 sc1
    v_mov_b32_dpp v208, v204 row_shl:1 row_mask:0xf bank_mask:0xf bound_ctrl:0
    v_bfi_b32 v243, v16, v205, v204
    v_bfi_b32 v242, v16, v206, v205
    v_bfi_b32 v241, v16, v207, v206
    v_bfi_b32 v240, v16, v208, v207
    buffer_store_dwordx4 v[240:243], v10, s[28:31], s58 offen offset:1536 sc1
    s_waitcnt lgkmcnt(0)
    buffer_store_dwordx4 v[210:213], v9, s[28:31], s60 offen offset:896 sc1
    v_mov_b32_dpp v214, v210 row_shl:1 row_mask:0xf bank_mask:0xf bound_ctrl:0
    v_bfi_b32 v247, v16, v211, v210
    v_bfi_b32 v246, v16, v212, v211
    v_bfi_b32 v245, v16, v213, v212
    v_bfi_b32 v244, v16, v214, v213
    buffer_store_dwordx4 v[244:247], v10, s[28:31], 0 offen offset:1536 sc1
    s_cmp_lg_u32 s47, 16
    s_cbranch_scc1 L_fin
    s_cmp_eq_u32 s43, 0
    s_cbranch_scc1 L_adv
    s_mul_i32 s6, s57, 17920
    s_add_u32 s6, s6, 6429696
    v_lshrrev_b32 v33, 2, v1
    v_and_b32 v34, 3, v1
    v_lshlrev_b32 v34, 2, v34
    v_lshl_add_u32 v33, v33, 7, v34
    v_add_u32 v33, s6, v33
    v_add_u32 v34, 1024, v33
    s_mov_b32 s10, 65536
L_plK:
    buffer_load_dword v32, v33, s[20:23], 0 offen sc1
    s_sub_u32 s10, s10, 1
    s_cbranch_scc1 L_pdK
    s_waitcnt vmcnt(0)
    v_cmp_ne_u32 vcc, v32, v250
    s_nop 0
    s_and_b64 exec, exec, vcc
    s_cbranch_scc1 L_plK
L_pdK:
    s_mov_b64 exec, -1
    s_mov_b32 s10, 65536
L_plL:
    buffer_load_dword v32, v34, s[20:23], 0 offen sc1
    s_sub_u32 s10, s10, 1
    s_cbranch_scc1 L_pdL
    s_waitcnt vmcnt(0)
    v_cmp_ne_u32 vcc, v32, v250
    s_nop 0
    s_and_b64 exec, exec, vcc
    s_cbranch_scc1 L_plL
L_pdL:
    s_mov_b64 exec, -1
L_adv:
    s_add_u32 s6, s57, 5259264
    buffer_store_dword v250, off, s[20:23], s6 sc1
L_fin:
L_end:
    s_endpgm
.section .rodata,"a"
.p2align 6
.amdhsa_kernel concat_heads__sliding_local_dilated__spectral_fnet__prompt_kernel
  .amdhsa_next_free_vgpr 512
  .amdhsa_next_free_sgpr 102
  .amdhsa_accum_offset 256
  .amdhsa_group_segment_fixed_size 0
  .amdhsa_kernarg_size 88
  .amdhsa_user_sgpr_count 2
  .amdhsa_user_sgpr_kernarg_segment_ptr 1
  .amdhsa_system_sgpr_workgroup_id_x 1
  .amdhsa_float_denorm_mode_32 3
.end_amdhsa_kernel
```

```asm
; @launch grid=(256,1,1) block=(512,1,1) lds=163840
.amdgcn_target "amdgcn-amd-amdhsa--gfx950"
.text
.p2align 12
.fill 0x340, 4, 0xbf800000
.text
.globl concat_heads__sliding_local_dilated__spectral_fnet__prompt_kernel
.p2align 8
.type concat_heads__sliding_local_dilated__spectral_fnet__prompt_kernel,@function
concat_heads__sliding_local_dilated__spectral_fnet__prompt_kernel:
    s_load_dwordx2 s[16:17], s[0:1], 8
    s_load_dwordx2 s[20:21], s[0:1], 80
    s_cmpk_ge_u32 s2, 256
    s_cbranch_scc1 L_end
    s_lshr_b32 s40, s2, 3
    s_getpc_b64 s[4:5]
L_pc:
    v_lshrrev_b32 v3, 6, v0
    v_and_b32 v1, 63, v0
    v_lshl_add_u32 v2, s40, 3, v3
    v_readfirstlane_b32 s11, v3
    v_min_u32 v2, (L_end - L_pc) / 128, v2
    v_lshlrev_b32 v2, 7, v2
    global_load_dword v255, v2, s[4:5]
    s_load_dwordx2 s[12:13], s[0:1], 0
    s_load_dwordx2 s[32:33], s[0:1], 24
    s_load_dwordx2 s[24:25], s[0:1], 16
    s_load_dwordx2 s[28:29], s[0:1], 64
    v_and_b32 v0, 0xff, v0
    s_and_b32 s3, s11, 3
    s_and_b32 s9, s2, 7
    s_lshl_b32 s57, s9, 3
    s_min_u32 s100, s9, 6
    v_lshrrev_b32 v252, 4, v1
    v_and_b32 v253, 15, v1
    s_lshr_b32 s44, s2, 6
    s_cmp_lg_u32 s44, 3
    s_cbranch_scc1 L_A
    s_add_u32 s46, s57, s40
    s_sub_u32 s46, s46, 24
    s_mov_b32 s34, 0x1c0000
    s_mov_b32 s35, 0x20000
    s_lshl_b32 s6, s11, 8
    s_add_u32 s6, s6, s46
    s_mul_i32 s6, s6, 896
    v_mul_u32_u24 v2, 64*896, v252
    v_cmp_gt_u32 vcc, 14, v253
    v_add_u32 v2, s6, v2
    v_lshlrev_b32 v3, 4, v253
    v_cndmask_b32 v4, 2.0, v2, vcc
    v_add_u32 v2, v4, v3
    v_sub_u32 v3, v4, v3
    v_add_u32 v3, 432, v3
    s_waitcnt lgkmcnt(0)
    s_branch L_B
L_A:
    s_and_b32 s47, s40, 7
    s_mul_i32 s48, s44, 88
    s_and_b32 s6, s2, 6
    s_lshl_b32 s6, s6, 7
    s_add_u32 s48, s48, s6
    s_lshr_b32 s56, s44, 1
    s_and_b32 s7, s2, 1
    s_cmp_ge_u32 s11, 4
    s_cbranch_scc1 L_M
    s_mov_b32 s14, 0x1c0000
    s_mov_b32 s15, 0x20000
    s_cmp_lg_u32 s47, 7
    s_cbranch_scc1 L_G
    s_lshl1_add_u32 s6, s48, s7
    s_cmp_eq_u32 s3, 3
    s_cselect_b32 s6, 0x100000, s6
    v_and_b32 v4, -2, v0
    v_add_u32 v4, s6, v4
    v_subrev_u32 v4, 16, v4 clamp
    v_and_b32 v5, 1, v0
    v_add_u32 v5, s100, v5
    v_add_u32 v5, 1, v5
    v_subrev_u32 v6, 7, v5
    v_min_u32 v5, v5, v6
    v_mad_u32_u24 v7, v4, 7, v5
    v_lshlrev_b32 v7, 7, v7
    s_waitcnt lgkmcnt(0)
    buffer_load_dword v255, v7, s[12:15], 0 offen
    s_branch L_SH
L_G:
    s_mov_b32 s18, 0x126000
    s_mov_b32 s19, 0x20000
    v_and_b32 v34, 8, v1
    v_lshrrev_b32 v35, 1, v1
    v_and_or_b32 v34, v35, 16, v34
    v_lshrrev_b32 v35, 2, v1
    v_and_or_b32 v34, v35, 4, v34
    v_add_u32 v34, s3, v34
    v_mul_u32_u24 v34, 2688, v34
    v_and_b32 v33, 7, v1
    v_lshl_add_u32 v34, v33, 4, v34
    v_lshl_add_u32 v34, s47, 7, v34
    s_mul_i32 s8, s3, 1056
    s_mov_b32 s6, s44
    s_mul_i32 s9, s6, 896
    v_add_u32 v5, s9, v34
    s_mul_i32 s9, s6, 4224
    s_add_u32 s50, s9, s8
    s_add_u32 s6, s6, 1
    s_cmp_eq_u32 s6, 3
    s_cselect_b32 s6, 0, s6
    s_mul_i32 s9, s6, 896
    v_add_u32 v8, s9, v34
    s_mul_i32 s9, s6, 4224
    s_add_u32 s46, s9, s8
    s_add_u32 s6, s6, 1
    s_cmp_eq_u32 s6, 3
    s_cselect_b32 s6, 0, s6
    s_mul_i32 s9, s6, 896
    v_add_u32 v9, s9, v34
    s_mul_i32 s9, s6, 4224
    s_add_u32 s98, s9, s8
    s_mul_i32 s52, s100, 64*2688
    s_lshl_b32 s51, s100, 7
    s_add_u32 s53, s52, 32*2688
    s_add_u32 s100, s100, 1
    s_sub_u32 s10, s100, 7
    s_min_u32 s100, s100, s10
    s_lshl1_add_u32 s7, s48, s7
    s_sub_u32 s7, s7, 16
    v_lshrrev_b32 v32, 3, v1
    v_xor_b32 v34, v33, v252
    v_mul_u32_u24 v35, 1792, v32
    v_lshl_add_u32 v34, v34, 4, v35
    s_cmp_eq_u32 s48, 0
    s_cselect_b32 s10, 0, -1
    s_cmp_eq_u32 s56, 0
    s_cselect_b32 s10, s10, 11
    s_mul_i32 s38, s3, 3
    s_lshl_b32 s6, s47, 1
    s_lshr_b32 s6, 0x924, s6
    s_and_b32 s6, s6, 3
    s_add_u32 s8, s38, s6
    s_lshl_b32 s49, s8, 10
    s_lshl4_add_u32 s9, s8, s7
    s_mul_i32 s9, s9, 896
    s_cmp_eq_u32 s8, s10
    s_cselect_b32 s9, 0x40000000, s9
    s_lshl_b32 s8, s8, 6
    s_and_b32 s8, s8, 64
    v_xor_b32 v35, s8, v34
    v_add_u32 v2, s9, v35
    s_add_u32 s6, s6, 1
    s_cmp_eq_u32 s6, 3
    s_cselect_b32 s6, 0, s6
    s_add_u32 s8, s38, s6
    s_lshl_b32 s99, s8, 10
    s_lshl4_add_u32 s9, s8, s7
    s_mul_i32 s9, s9, 896
    s_cmp_eq_u32 s8, s10
    s_cselect_b32 s9, 0x40000000, s9
    s_lshl_b32 s8, s8, 6
    s_and_b32 s8, s8, 64
    v_xor_b32 v35, s8, v34
    v_add_u32 v3, s9, v35
    s_add_u32 s6, s6, 1
    s_cmp_eq_u32 s6, 3
    s_cselect_b32 s6, 0, s6
    s_add_u32 s8, s38, s6
    s_lshl_b32 s101, s8, 10
    s_lshl4_add_u32 s9, s8, s7
    s_mul_i32 s9, s9, 896
    s_cmp_eq_u32 s8, s10
    s_cselect_b32 s9, 0x40000000, s9
    s_lshl_b32 s8, s8, 6
    s_and_b32 s8, s8, 64
    v_xor_b32 v35, s8, v34
    v_add_u32 v4, s9, v35
    s_waitcnt lgkmcnt(0)
    s_add_u32 m0, s50, 37632
    s_add_u32 s6, s57, 5308416
    buffer_load_dwordx4 v5, s[16:19], s52 offen lds
    s_load_dword s36, s[20:21], s6
    s_add_u32 m0, s50, 50304
    v_mov_b32 v34, 0
    buffer_load_dwordx4 v5, s[16:19], s53 offen lds
    v_lshlrev_b32 v32, 2, v0
    s_add_u32 m0, s49, 62976
    v_add_u32 v32, 162816, v32
    buffer_load_dwordx4 v2, s[12:15], s51 offen lds
    ds_write_b32 v32, v34
    s_add_u32 m0, s46, 37632
    s_mov_b32 s22, 0x1000000
    buffer_load_dwordx4 v8, s[16:19], s52 offen lds
    s_mov_b32 s23, 0x20000
    s_add_u32 m0, s46, 50304
    s_mov_b32 s26, 0x62000
    buffer_load_dwordx4 v8, s[16:19], s53 offen lds
    s_mov_b32 s27, 0x20000
    s_mov_b32 s30, 0x380000
    s_mov_b32 s31, 0x20000
    s_mul_i32 s6, s40, 37
    s_lshr_b32 s6, s6, 8
    s_mul_i32 s7, s6, 7
    s_sub_u32 s41, s40, s7
    s_add_u32 m0, s99, 62976
    s_lshr_b32 s7, s57, 3
    buffer_load_dwordx4 v3, s[12:15], s51 offen lds
    s_add_u32 s41, s41, s7
    s_sub_u32 s7, s41, 7
    s_min_u32 s41, s41, s7
    s_lshl_b32 s6, s6, 2
    s_add_u32 s6, s6, s3
    v_bfe_u32 v32, v1, 1, 1
    v_lshl_add_u32 v32, s6, 1, v32
    s_add_u32 m0, s98, 37632
    v_mul_u32_u24 v33, 47, v32
    buffer_load_dwordx4 v9, s[16:19], s52 offen lds
    v_lshrrev_b32 v33, 9, v33
    v_mul_u32_u24 v34, 11, v33
    v_sub_u32 v32, v32, v34
    v_add_u32 v32, 3, v32
    v_and_b32 v32, 8, v32
    v_lshl_add_u32 v32, v33, 10, v32
    v_and_b32 v33, 1, v1
    s_add_u32 m0, s98, 50304
    v_lshl_add_u32 v32, v33, 2, v32
    buffer_load_dwordx4 v9, s[16:19], s53 offen lds
    v_bfe_u32 v33, v1, 2, 3
    v_lshl_add_u32 v32, v33, 7, v32
    s_mul_i32 s7, s57, 17920
    s_add_u32 s7, s7, 6429696
    v_add_u32 v246, s7, v32
    s_and_b32 s7, s2, 6
    s_lshl3_add_u32 s6, s7, s6
    s_add_u32 m0, s101, 62976
    s_and_b32 s8, s2, 1
    buffer_load_dwordx4 v4, s[12:15], s51 offen lds
    s_lshl_b32 s7, s8, 6
    s_add_u32 s42, s6, s7
    v_lshrrev_b32 v32, 3, v1
    v_and_b32 v33, 6, v32
    v_and_b32 v34, 7, v1
    v_xor_b32 v33, v33, v34
    v_lshrrev_b32 v32, 3, v0
    s_mul_i32 s59, s100, 64*2688
    s_lshl_b32 s58, s100, 7
    s_add_u32 s60, s59, 32*2688
    s_add_u32 s100, s100, 1
    s_sub_u32 s10, s100, 7
    s_min_u32 s100, s100, s10
    s_add_u32 m0, s50, 75264
    v_mul_u32_u24 v32, 896, v32
    buffer_load_dwordx4 v5, s[16:19], s59 offen lds
    v_lshl_add_u32 v32, v33, 4, v32
    s_lshl_b32 s7, s41, 7
    v_add_u32 v240, s7, v32
    s_lshl_b32 s45, s3, 10
    s_add_u32 s45, s45, 105472
    v_lshrrev_b32 v32, 2, v1
    v_bfe_u32 v33, v1, 3, 2
    s_add_u32 m0, s50, 87936
    v_lshlrev_b32 v33, 5, v33
    buffer_load_dwordx4 v5, s[16:19], s60 offen lds
    v_lshl_add_u32 v33, v32, 7, v33
    v_and_b32 v34, 3, v1
    v_lshl_add_u32 v33, v34, 3, v33
    v_add_u32 v241, 105472, v33
    v_xor_b32 v242, 32, v241
    v_xor_b32 v243, 64, v241
    v_xor_b32 v244, 96, v241
    s_add_u32 m0, s49, 100608
    s_lshl_b32 s9, s42, 14
    buffer_load_dwordx4 v2, s[12:15], s58 offen lds
    v_lshl_add_u32 v245, v1, 4, s9
    s_lshl_b32 s6, s6, 5
    s_add_u32 s6, s6, s8
    s_mul_i32 s6, s6, 1792
    s_add_u32 s6, s6, s7
    v_lshrrev_b32 v32, 3, v1
    v_and_b32 v33, 7, v1
    s_add_u32 m0, s46, 75264
    v_lshlrev_b32_e64 v33, 4, v33
    buffer_load_dwordx4 v8, s[16:19], s59 offen lds
    v_mul_u32_u24 v34, 3584, v32
    v_add3_u32 v247, v34, v33, s6
    s_mul_i32 s6, s3, 2304
    v_mul_u32_u24 v32, 144, v32
    v_add3_u32 v251, v32, v33, s6
    v_mul_u32_u24 v32, 144, v253
    v_lshl_add_u32 v32, v252, 3, v32
    s_add_u32 m0, s46, 87936
    v_add_u32 v248, s6, v32
    buffer_load_dwordx4 v8, s[16:19], s60 offen lds
    s_waitcnt lgkmcnt(0)
    s_mul_i32 s36, s36, 0x9e3779b1
    s_add_u32 s36, s36, 0x7f4a7c15
    v_mov_b32 v250, s36
    s_getreg_b32 s7, hwreg(HW_REG_XCC_ID, 0, 3)
    s_mul_i32 s8, s57, 17920
    s_lshl_b32 s7, s7, 7
    s_add_u32 m0, s99, 100608
    s_add_u32 s8, s8, s7
    buffer_load_dwordx4 v3, s[12:15], s58 offen lds
    s_add_u32 s8, s8, 6432768
    v_and_b32 v249, 31, v1
    v_lshl_add_u32 v249, v249, 2, s8
    s_lshl2_add_u32 s37, s40, s8
    s_add_u32 m0, s98, 75264
    s_nop 0
    buffer_load_dwordx4 v9, s[16:19], s59 offen lds
    s_add_u32 m0, s98, 87936
    s_nop 0
    buffer_load_dwordx4 v9, s[16:19], s60 offen lds
    s_add_u32 m0, s101, 100608
    s_nop 0
    buffer_load_dwordx4 v4, s[12:15], s58 offen lds
    s_mul_i32 s52, s100, 64*2688
    s_lshl_b32 s51, s100, 7
    s_add_u32 s53, s52, 32*2688
    s_add_u32 s100, s100, 1
    s_sub_u32 s10, s100, 7
    s_min_u32 s100, s100, s10
    s_add_u32 m0, s50, 0
    s_waitcnt vmcnt(9)
    s_barrier
    buffer_store_dword v250, off, s[20:23], s37
    buffer_load_dwordx4 v5, s[16:19], s52 offen lds
    s_add_u32 m0, s50, 12672
    s_nop 0
    buffer_load_dwordx4 v5, s[16:19], s53 offen lds
    s_add_u32 m0, s49, 25344
    s_nop 0
    buffer_load_dwordx4 v2, s[12:15], s51 offen lds
    s_add_u32 m0, s46, 0
    s_nop 0
    buffer_load_dwordx4 v8, s[16:19], s52 offen lds
    s_add_u32 m0, s46, 12672
    s_nop 0
    buffer_load_dwordx4 v8, s[16:19], s53 offen lds
    s_add_u32 m0, s99, 25344
    s_nop 0
    buffer_load_dwordx4 v3, s[12:15], s51 offen lds
    s_add_u32 m0, s98, 0
    s_nop 0
    buffer_load_dwordx4 v9, s[16:19], s52 offen lds
    s_add_u32 m0, s98, 12672
    s_nop 0
    buffer_load_dwordx4 v9, s[16:19], s53 offen lds
    s_add_u32 m0, s101, 25344
    s_nop 0
    buffer_load_dwordx4 v4, s[12:15], s51 offen lds
    s_mul_i32 s59, s100, 64*2688
    s_lshl_b32 s58, s100, 7
    s_add_u32 s60, s59, 32*2688
    s_add_u32 s100, s100, 1
    s_sub_u32 s10, s100, 7
    s_min_u32 s100, s100, s10
    s_add_u32 m0, s50, 37632
    s_waitcnt vmcnt(10)
    s_barrier
    buffer_load_dwordx4 v5, s[16:19], s59 offen lds
    s_add_u32 m0, s50, 50304
    s_nop 0
    buffer_load_dwordx4 v5, s[16:19], s60 offen lds
    s_add_u32 m0, s49, 62976
    s_nop 0
    buffer_load_dwordx4 v2, s[12:15], s58 offen lds
    s_add_u32 m0, s46, 37632
    s_nop 0
    buffer_load_dwordx4 v8, s[16:19], s59 offen lds
    s_add_u32 m0, s46, 50304
    s_nop 0
    buffer_load_dwordx4 v8, s[16:19], s60 offen lds
    s_add_u32 m0, s99, 62976
    s_nop 0
    buffer_load_dwordx4 v3, s[12:15], s58 offen lds
    s_add_u32 m0, s98, 37632
    s_nop 0
    buffer_load_dwordx4 v9, s[16:19], s59 offen lds
    s_add_u32 m0, s98, 50304
    s_nop 0
    buffer_load_dwordx4 v9, s[16:19], s60 offen lds
    s_add_u32 m0, s101, 62976
    s_nop 0
    buffer_load_dwordx4 v4, s[12:15], s58 offen lds
    s_mul_i32 s52, s100, 64*2688
    s_lshl_b32 s51, s100, 7
    s_add_u32 s53, s52, 32*2688
    s_add_u32 s100, s100, 1
    s_sub_u32 s10, s100, 7
    s_min_u32 s100, s100, s10
    s_add_u32 m0, s50, 75264
    s_waitcnt vmcnt(9)
    s_barrier
    buffer_load_dwordx4 v5, s[16:19], s52 offen lds
    s_add_u32 m0, s50, 87936
    s_nop 0
    buffer_load_dwordx4 v5, s[16:19], s53 offen lds
    s_add_u32 m0, s49, 100608
    s_nop 0
    buffer_load_dwordx4 v2, s[12:15], s51 offen lds
    s_add_u32 m0, s46, 75264
    s_nop 0
    buffer_load_dwordx4 v8, s[16:19], s52 offen lds
    s_add_u32 m0, s46, 87936
    s_nop 0
    buffer_load_dwordx4 v8, s[16:19], s53 offen lds
    s_add_u32 m0, s99, 100608
    s_nop 0
    buffer_load_dwordx4 v3, s[12:15], s51 offen lds
    s_add_u32 m0, s98, 75264
    s_nop 0
    buffer_load_dwordx4 v9, s[16:19], s52 offen lds
    s_add_u32 m0, s98, 87936
    s_nop 0
    buffer_load_dwordx4 v9, s[16:19], s53 offen lds
    s_add_u32 m0, s101, 100608
    s_nop 0
    buffer_load_dwordx4 v4, s[12:15], s51 offen lds
    s_mul_i32 s59, s100, 64*2688
    s_lshl_b32 s58, s100, 7
    s_add_u32 s60, s59, 32*2688
    s_add_u32 s100, s100, 1
    s_sub_u32 s10, s100, 7
    s_min_u32 s100, s100, s10
    s_add_u32 m0, s50, 0
    s_waitcnt vmcnt(9)
    s_barrier
    buffer_load_dwordx4 v5, s[16:19], s59 offen lds
    s_add_u32 m0, s50, 12672
    s_nop 0
    buffer_load_dwordx4 v5, s[16:19], s60 offen lds
    s_add_u32 m0, s49, 25344
    s_nop 0
    buffer_load_dwordx4 v2, s[12:15], s58 offen lds
    s_add_u32 m0, s46, 0
    s_nop 0
    buffer_load_dwordx4 v8, s[16:19], s59 offen lds
    s_add_u32 m0, s46, 12672
    s_nop 0
    buffer_load_dwordx4 v8, s[16:19], s60 offen lds
    s_add_u32 m0, s99, 25344
    s_nop 0
    buffer_load_dwordx4 v3, s[12:15], s58 offen lds
    s_add_u32 m0, s98, 0
    s_nop 0
    buffer_load_dwordx4 v9, s[16:19], s59 offen lds
    s_add_u32 m0, s98, 12672
    s_nop 0
    buffer_load_dwordx4 v9, s[16:19], s60 offen lds
    s_add_u32 m0, s101, 25344
    s_nop 0
    buffer_load_dwordx4 v4, s[12:15], s58 offen lds
    s_mul_i32 s52, s100, 64*2688
    s_lshl_b32 s51, s100, 7
    s_add_u32 s53, s52, 32*2688
    s_add_u32 m0, s50, 37632
    s_waitcnt vmcnt(9)
    s_barrier
    buffer_load_dwordx4 v5, s[16:19], s52 offen lds
    s_add_u32 m0, s50, 50304
    s_nop 0
    buffer_load_dwordx4 v5, s[16:19], s53 offen lds
    s_add_u32 m0, s49, 62976
    s_nop 0
    buffer_load_dwordx4 v2, s[12:15], s51 offen lds
    s_add_u32 m0, s46, 37632
    s_nop 0
    buffer_load_dwordx4 v8, s[16:19], s52 offen lds
    s_add_u32 m0, s46, 50304
    s_nop 0
    buffer_load_dwordx4 v8, s[16:19], s53 offen lds
    s_add_u32 m0, s99, 62976
    s_nop 0
    buffer_load_dwordx4 v3, s[12:15], s51 offen lds
    s_add_u32 m0, s98, 37632
    s_nop 0
    buffer_load_dwordx4 v9, s[16:19], s52 offen lds
    s_add_u32 m0, s98, 50304
    s_nop 0
    buffer_load_dwordx4 v9, s[16:19], s53 offen lds
    s_add_u32 m0, s101, 62976
    s_nop 0
    buffer_load_dwordx4 v4, s[12:15], s51 offen lds
    s_waitcnt vmcnt(9)
    s_barrier
    s_add_u32 m0, s45, 0
    s_mov_b32 s6, 0
    buffer_load_dwordx4 v240, s[24:27], s6 offen lds
    s_add_u32 m0, s45, 4096
    s_mov_b32 s6, 28672
    buffer_load_dwordx4 v240, s[24:27], s6 offen lds
    s_add_u32 m0, s45, 8192
    s_mov_b32 s6, 57344
    buffer_load_dwordx4 v240, s[24:27], s6 offen lds
    s_add_u32 m0, s45, 12288
    s_mov_b32 s6, 86016
    buffer_load_dwordx4 v240, s[24:27], s6 offen lds
    s_add_u32 m0, s45, 16384
    s_mov_b32 s6, 114688
    buffer_load_dwordx4 v240, s[24:27], s6 offen lds
    s_add_u32 m0, s45, 20480
    s_mov_b32 s6, 143360
    buffer_load_dwordx4 v240, s[24:27], s6 offen lds
    s_add_u32 m0, s45, 24576
    s_mov_b32 s6, 172032
    buffer_load_dwordx4 v240, s[24:27], s6 offen lds
    s_add_u32 m0, s45, 28672
    s_mov_b32 s6, 200704
    buffer_load_dwordx4 v240, s[24:27], s6 offen lds
    s_waitcnt vmcnt(8)
    s_barrier
    v_lshlrev_b32 v5, 10, v252
    v_sub_u32 v2, v241, v5
    v_sub_u32 v3, v242, v5
    v_sub_u32 v4, v243, v5
    v_sub_u32 v5, v244, v5
    s_movk_i32 s58, 4096
    s_movk_i32 s59, 8192
    s_movk_i32 s60, 12288
    s_barrier
    s_add_u32 m0, s45, 32768
    s_mov_b32 s6, 229376
    buffer_load_dwordx4 v240, s[24:27], s6 offen lds
    s_add_u32 m0, s45, 36864
    s_mov_b32 s6, 258048
    buffer_load_dwordx4 v240, s[24:27], s6 offen lds
    s_add_u32 m0, s45, 40960
    s_mov_b32 s6, 286720
    buffer_load_dwordx4 v240, s[24:27], s6 offen lds
    s_add_u32 m0, s45, 45056
    s_mov_b32 s6, 315392
    buffer_load_dwordx4 v240, s[24:27], s6 offen lds
    s_add_u32 m0, s45, 49152
    s_mov_b32 s6, 344064
    buffer_load_dwordx4 v240, s[24:27], s6 offen lds
    s_add_u32 m0, s45, 53248
    s_mov_b32 s6, 372736
    buffer_load_dwordx4 v240, s[24:27], s6 offen lds
    s_waitcnt vmcnt(6)
    s_barrier
    buffer_load_dword v24, v249, s[20:23], 0 offen sc1
    ds_read_b64_tr_b16 v[56:57], v241 offset:0
    ds_read_b64_tr_b16 v[58:59], v241 offset:2048
    ds_read_b64_tr_b16 v[60:61], v242 offset:0
    ds_read_b64_tr_b16 v[62:63], v242 offset:2048
    ds_read_b64_tr_b16 v[64:65], v243 offset:0
    ds_read_b64_tr_b16 v[66:67], v243 offset:2048
    ds_read_b64_tr_b16 v[68:69], v244 offset:0
    ds_read_b64_tr_b16 v[70:71], v244 offset:2048
    ds_read_b64_tr_b16 v[72:73], v243 offset:3584
    ds_read_b64_tr_b16 v[74:75], v243 offset:5632
    ds_read_b64_tr_b16 v[76:77], v244 offset:3584
    ds_read_b64_tr_b16 v[78:79], v244 offset:5632
    ds_read_b64_tr_b16 v[80:81], v241 offset:3584
    ds_read_b64_tr_b16 v[82:83], v241 offset:5632
    ds_read_b64_tr_b16 v[84:85], v242 offset:3584
    ds_read_b64_tr_b16 v[86:87], v242 offset:5632
    ds_read_b64_tr_b16 v[88:89], v243 offset:10752
    ds_read_b64_tr_b16 v[90:91], v243 offset:12800
    ds_read_b64_tr_b16 v[92:93], v244 offset:10752
    ds_read_b64_tr_b16 v[94:95], v244 offset:12800
    ds_read_b64_tr_b16 v[96:97], v241 offset:10752
    ds_read_b64_tr_b16 v[98:99], v241 offset:12800
    ds_read_b64_tr_b16 v[100:101], v242 offset:10752
    ds_read_b64_tr_b16 v[102:103], v242 offset:12800
    ds_read_b64_tr_b16 v[104:105], v243 offset:17920
    ds_read_b64_tr_b16 v[106:107], v243 offset:19968
    ds_read_b64_tr_b16 v[108:109], v244 offset:17920
    ds_read_b64_tr_b16 v[110:111], v244 offset:19968
    ds_read_b64_tr_b16 v[112:113], v241 offset:17920
    ds_read_b64_tr_b16 v[114:115], v241 offset:19968
    ds_read_b64_tr_b16 v[116:117], v242 offset:17920
    ds_read_b64_tr_b16 v[118:119], v242 offset:19968
    ds_read_b64_tr_b16 v[120:121], v243 offset:25088
    ds_read_b64_tr_b16 v[122:123], v243 offset:27136
    ds_read_b64_tr_b16 v[124:125], v244 offset:25088
    ds_read_b64_tr_b16 v[126:127], v244 offset:27136
    ds_read_b64_tr_b16 v[128:129], v241 offset:25088
    ds_read_b64_tr_b16 v[130:131], v241 offset:27136
    ds_read_b64_tr_b16 v[132:133], v242 offset:25088
    ds_read_b64_tr_b16 v[134:135], v242 offset:27136
    ds_read_b64_tr_b16 v[136:137], v241 offset:28672
    ds_read_b64_tr_b16 v[138:139], v241 offset:30720
    ds_read_b64_tr_b16 v[140:141], v242 offset:28672
    ds_read_b64_tr_b16 v[142:143], v242 offset:30720
    ds_read_b64_tr_b16 v[144:145], v243 offset:28672
    ds_read_b64_tr_b16 v[146:147], v243 offset:30720
    ds_read_b64_tr_b16 v[148:149], v244 offset:28672
    ds_read_b64_tr_b16 v[150:151], v244 offset:30720
    s_mov_b32 s38, 1
    s_waitcnt vmcnt(0)
    s_branch L_P2
.type L_tab,@object
L_tab:
    .long 0xf6543210, 0x01000000, 0x00000100, 0
    .long 0xedcba987, 0x00000000, 0x00000101, 0
    .long 0xfed01234, 0x05040300, 0x00000312, 0
    .long 0xcba98765, 0x02000000, 0x00000103, 0
    .long 0x29876543, 0x08000000, 0x00000105, 0
    .long 0x10fedcba, 0x07060000, 0x00333206, 0
    .long 0x07654321, 0x09000000, 0x00000107, 0
    .long 0xfedcba98, 0x0a000000, 0x00000108, 0
    .long 0xfe012345, 0x0d0c0000, 0x0033a219, 0
    .long 0xdcba9876, 0x0b000000, 0x0000010a, 0
    .long 0x3a987654, 0x11000000, 0x0000010c, 0
    .long 0x210fedcb, 0x100f0e00, 0x0066d30d, 0
    .long 0x18765432, 0x13000000, 0x0000010e, 0
    .long 0x0fedcba9, 0x12000000, 0x0000010f, 0
    .long 0x00000000, 0x00000000, 0x00212404, 0
    .long 0x00000000, 0x00000000, 0x0054b40b, 0
.size L_tab, 256
.p2align 12
L_SH:
    s_add_u32 s6, s57, 5308416
    s_load_dword s36, s[20:21], s6
    s_mov_b32 s22, 0x1000000
    s_mov_b32 s23, 0x20000
    s_mov_b32 s26, 0x62000
    s_mov_b32 s27, 0x20000
    v_mov_b32 v34, 0
    v_lshlrev_b32 v32, 2, v0
    v_add_u32 v32, 162816, v32
    ds_write_b32 v32, v34
    s_waitcnt lgkmcnt(0)
    s_barrier
    v_add_u32 v5, 2, v5
    v_subrev_u32 v6, 7, v5
    v_min_u32 v5, v5, v6
    v_mad_u32_u24 v7, v4, 7, v5
    v_lshlrev_b32 v7, 7, v7
    buffer_load_dword v255, v7, s[12:15], 0 offen
    v_add_u32 v5, 2, v5
    v_subrev_u32 v6, 7, v5
    v_min_u32 v5, v5, v6
    v_mad_u32_u24 v7, v4, 7, v5
    v_lshlrev_b32 v7, 7, v7
    buffer_load_dword v255, v7, s[12:15], 0 offen
    s_lshl2_add_u32 s7, s44, s3
    s_mul_i32 s6, s57, 49*128
    s_mul_i32 s8, s7, 33*128
    s_add_u32 s6, s6, s8
    v_min_u32 v6, 32, v1
    v_lshlrev_b32 v6, 7, v6
    buffer_load_dword v255, v6, s[24:27], s6 offen
    s_mul_i32 s6, s57, 17920
    s_mul_i32 s8, s7, 47*128
    s_add_u32 s6, s6, s8
    s_add_u32 s6, s6, 6291456
    s_add_u32 s8, s6, 70144
    v_min_u32 v6, 46, v1
    v_lshlrev_b32 v6, 7, v6
    buffer_load_dword v255, v6, s[20:23], s8 offen
    buffer_load_dword v255, v6, s[20:23], s6 offen
    s_mul_i32 s36, s36, 0x9e3779b1
    s_add_u32 s36, s36, 0x7f4a7c15
    v_mov_b32 v250, s36
    s_getreg_b32 s7, hwreg(HW_REG_XCC_ID, 0, 3)
    s_mul_i32 s8, s57, 17920
    s_lshl_b32 s7, s7, 7
    s_add_u32 s8, s8, s7
    s_add_u32 s8, s8, 6432768
    v_and_b32 v249, 31, v1
    v_lshl_add_u32 v249, v249, 2, s8
    s_lshl2_add_u32 s37, s40, s8
    v_mov_b32 v25, 2.0
    s_mov_b32 s22, 0x1000000
    s_mov_b32 s23, 0x20000
    s_mov_b32 s26, 0x62000
    s_mov_b32 s27, 0x20000
    s_mov_b32 s30, 0x380000
    s_mov_b32 s31, 0x20000
    s_mul_i32 s6, s40, 37
    s_lshr_b32 s6, s6, 8
    s_mul_i32 s7, s6, 7
    s_sub_u32 s41, s40, s7
    s_lshr_b32 s7, s57, 3
    s_add_u32 s41, s41, s7
    s_sub_u32 s7, s41, 7
    s_min_u32 s41, s41, s7
    s_lshl_b32 s6, s6, 2
    s_add_u32 s6, s6, s3
    v_bfe_u32 v32, v1, 1, 1
    v_lshl_add_u32 v32, s6, 1, v32
    v_mul_u32_u24 v33, 47, v32
    v_lshrrev_b32 v33, 9, v33
    v_mul_u32_u24 v34, 11, v33
    v_sub_u32 v32, v32, v34
    v_add_u32 v32, 3, v32
    v_and_b32 v32, 8, v32
    v_lshl_add_u32 v32, v33, 10, v32
    v_and_b32 v33, 1, v1
    v_lshl_add_u32 v32, v33, 2, v32
    v_bfe_u32 v33, v1, 2, 3
    v_lshl_add_u32 v32, v33, 7, v32
    s_mul_i32 s7, s57, 17920
    s_add_u32 s7, s7, 6429696
    v_add_u32 v246, s7, v32
    s_and_b32 s7, s2, 6
    s_lshl3_add_u32 s6, s7, s6
    s_and_b32 s8, s2, 1
    s_lshl_b32 s7, s8, 6
    s_add_u32 s42, s6, s7
    v_lshrrev_b32 v32, 3, v1
    v_and_b32 v33, 6, v32
    v_and_b32 v34, 7, v1
    v_xor_b32 v33, v33, v34
    v_lshrrev_b32 v32, 3, v0
    v_mul_u32_u24 v32, 896, v32
    v_lshl_add_u32 v32, v33, 4, v32
    s_lshl_b32 s7, s41, 7
    v_add_u32 v240, s7, v32
    s_lshl_b32 s45, s3, 10
    s_add_u32 s45, s45, 105472
    v_lshrrev_b32 v32, 2, v1
    v_bfe_u32 v33, v1, 3, 2
    v_lshlrev_b32 v33, 5, v33
    v_lshl_add_u32 v33, v32, 7, v33
    v_and_b32 v34, 3, v1
    v_lshl_add_u32 v33, v34, 3, v33
    v_add_u32 v241, 105472, v33
    v_xor_b32 v242, 32, v241
    v_xor_b32 v243, 64, v241
    v_xor_b32 v244, 96, v241
    s_lshl_b32 s9, s42, 14
    v_lshl_add_u32 v245, v1, 4, s9
    s_lshl_b32 s6, s6, 5
    s_add_u32 s6, s6, s8
    s_mul_i32 s6, s6, 1792
    s_add_u32 s6, s6, s7
    v_lshrrev_b32 v32, 3, v1
    v_and_b32 v33, 7, v1
    v_lshlrev_b32 v33, 4, v33
    v_mul_u32_u24 v34, 3584, v32
    v_add3_u32 v247, v34, v33, s6
    s_mul_i32 s6, s3, 2304
    v_mul_u32_u24 v32, 144, v32
    v_add3_u32 v251, v32, v33, s6
    v_mul_u32_u24 v32, 144, v253
    v_lshl_add_u32 v32, v252, 3, v32
    v_add_u32 v248, s6, v32
L_HT:
    s_add_u32 m0, s45, 32768
    s_mov_b32 s6, 229376
    buffer_load_dwordx4 v240, s[24:27], s6 offen lds
    s_add_u32 m0, s45, 36864
    s_mov_b32 s6, 258048
    buffer_load_dwordx4 v240, s[24:27], s6 offen lds
    s_add_u32 m0, s45, 40960
    s_mov_b32 s6, 286720
    buffer_load_dwordx4 v240, s[24:27], s6 offen lds
    s_add_u32 m0, s45, 45056
    s_mov_b32 s6, 315392
    buffer_load_dwordx4 v240, s[24:27], s6 offen lds
    s_add_u32 m0, s45, 49152
    s_mov_b32 s6, 344064
    buffer_load_dwordx4 v240, s[24:27], s6 offen lds
    s_add_u32 m0, s45, 53248
    s_mov_b32 s6, 372736
    buffer_load_dwordx4 v240, s[24:27], s6 offen lds
    s_add_u32 m0, s45, 0
    s_mov_b32 s6, 0
    buffer_load_dwordx4 v240, s[24:27], s6 offen lds
    s_add_u32 m0, s45, 4096
    s_mov_b32 s6, 28672
    buffer_load_dwordx4 v240, s[24:27], s6 offen lds
    s_add_u32 m0, s45, 8192
    s_mov_b32 s6, 57344
    buffer_load_dwordx4 v240, s[24:27], s6 offen lds
    s_add_u32 m0, s45, 12288
    s_mov_b32 s6, 86016
    buffer_load_dwordx4 v240, s[24:27], s6 offen lds
    s_add_u32 m0, s45, 16384
    s_mov_b32 s6, 114688
    buffer_load_dwordx4 v240, s[24:27], s6 offen lds
    s_add_u32 m0, s45, 20480
    s_mov_b32 s6, 143360
    buffer_load_dwordx4 v240, s[24:27], s6 offen lds
    s_add_u32 m0, s45, 24576
    s_mov_b32 s6, 172032
    buffer_load_dwordx4 v240, s[24:27], s6 offen lds
    s_add_u32 m0, s45, 28672
    s_mov_b32 s6, 200704
    buffer_load_dwordx4 v240, s[24:27], s6 offen lds
    buffer_load_dword v24, v249, s[20:23], 0 offen sc1
    s_barrier
    s_waitcnt vmcnt(0)
    v_lshlrev_b32 v5, 10, v252
    v_sub_u32 v2, v241, v5
    v_sub_u32 v3, v242, v5
    v_sub_u32 v4, v243, v5
    v_sub_u32 v5, v244, v5
    s_movk_i32 s58, 4096
    s_movk_i32 s59, 8192
    s_movk_i32 s60, 12288
    s_mov_b32 s38, 0
L_P2:
    v_mov_b32 v6, 163836
    v_mov_b32 v7, 1
    s_mov_b32 s10, 65536
    s_mov_b64 exec, 1
    ds_add_u32 v6, v7
L_cntH:
    ds_read_b32 v7, v6
    s_sub_u32 s10, s10, 1
    s_cbranch_scc1 L_cntdH
    s_waitcnt lgkmcnt(0)
    v_cmp_gt_u32 vcc, 4, v7
    s_cbranch_vccnz L_cntH
L_cntdH:
    s_mov_b64 exec, -1
    v_cmp_ne_u32 vcc, v24, v250
    s_mov_b32 s43, 0
    s_cbranch_vccz L_mkok
    s_mov_b32 s10, 40
L_plN:
    buffer_load_dword v6, v249, s[20:23], 0 offen sc1
    s_sub_u32 s10, s10, 1
    s_cbranch_scc1 L_pdN
    s_waitcnt vmcnt(0)
    v_cmp_ne_u32 vcc, v6, v250
    s_nop 0
    s_and_b64 exec, exec, vcc
    s_cbranch_scc1 L_plN
L_pdN:
    s_or_b32 s43, exec_lo, exec_hi
    s_mov_b64 exec, -1
L_mkok:
    s_cmp_lg_u32 s38, 0
    s_cbranch_scc1 L_rdB
    ds_read_b64_tr_b16 v[56:57], v241 offset:0
    ds_read_b64_tr_b16 v[58:59], v241 offset:2048
    ds_read_b64_tr_b16 v[60:61], v242 offset:0
    ds_read_b64_tr_b16 v[62:63], v242 offset:2048
    ds_read_b64_tr_b16 v[64:65], v243 offset:0
    ds_read_b64_tr_b16 v[66:67], v243 offset:2048
    ds_read_b64_tr_b16 v[68:69], v244 offset:0
    ds_read_b64_tr_b16 v[70:71], v244 offset:2048
    ds_read_b64_tr_b16 v[72:73], v243 offset:3584
    ds_read_b64_tr_b16 v[74:75], v243 offset:5632
    ds_read_b64_tr_b16 v[76:77], v244 offset:3584
    ds_read_b64_tr_b16 v[78:79], v244 offset:5632
    ds_read_b64_tr_b16 v[80:81], v241 offset:3584
    ds_read_b64_tr_b16 v[82:83], v241 offset:5632
    ds_read_b64_tr_b16 v[84:85], v242 offset:3584
    ds_read_b64_tr_b16 v[86:87], v242 offset:5632
    ds_read_b64_tr_b16 v[88:89], v243 offset:10752
    ds_read_b64_tr_b16 v[90:91], v243 offset:12800
    ds_read_b64_tr_b16 v[92:93], v244 offset:10752
    ds_read_b64_tr_b16 v[94:95], v244 offset:12800
    ds_read_b64_tr_b16 v[96:97], v241 offset:10752
    ds_read_b64_tr_b16 v[98:99], v241 offset:12800
    ds_read_b64_tr_b16 v[100:101], v242 offset:10752
    ds_read_b64_tr_b16 v[102:103], v242 offset:12800
    ds_read_b64_tr_b16 v[104:105], v243 offset:17920
    ds_read_b64_tr_b16 v[106:107], v243 offset:19968
    ds_read_b64_tr_b16 v[108:109], v244 offset:17920
    ds_read_b64_tr_b16 v[110:111], v244 offset:19968
    ds_read_b64_tr_b16 v[112:113], v241 offset:17920
    ds_read_b64_tr_b16 v[114:115], v241 offset:19968
    ds_read_b64_tr_b16 v[116:117], v242 offset:17920
    ds_read_b64_tr_b16 v[118:119], v242 offset:19968
    ds_read_b64_tr_b16 v[120:121], v243 offset:25088
    ds_read_b64_tr_b16 v[122:123], v243 offset:27136
    ds_read_b64_tr_b16 v[124:125], v244 offset:25088
    ds_read_b64_tr_b16 v[126:127], v244 offset:27136
    ds_read_b64_tr_b16 v[128:129], v241 offset:25088
    ds_read_b64_tr_b16 v[130:131], v241 offset:27136
    ds_read_b64_tr_b16 v[132:133], v242 offset:25088
    ds_read_b64_tr_b16 v[134:135], v242 offset:27136
    ds_read_b64_tr_b16 v[136:137], v241 offset:28672
    ds_read_b64_tr_b16 v[138:139], v241 offset:30720
    ds_read_b64_tr_b16 v[140:141], v242 offset:28672
    ds_read_b64_tr_b16 v[142:143], v242 offset:30720
    ds_read_b64_tr_b16 v[144:145], v243 offset:28672
    ds_read_b64_tr_b16 v[146:147], v243 offset:30720
    ds_read_b64_tr_b16 v[148:149], v244 offset:28672
    ds_read_b64_tr_b16 v[150:151], v244 offset:30720
L_rdB:
    ds_read_b64_tr_b16 v[152:153], v241 offset:35840
    ds_read_b64_tr_b16 v[154:155], v241 offset:37888
    ds_read_b64_tr_b16 v[156:157], v242 offset:35840
    ds_read_b64_tr_b16 v[158:159], v242 offset:37888
    ds_read_b64_tr_b16 v[160:161], v243 offset:35840
    ds_read_b64_tr_b16 v[162:163], v243 offset:37888
    ds_read_b64_tr_b16 v[164:165], v244 offset:35840
    ds_read_b64_tr_b16 v[166:167], v244 offset:37888
    ds_read_b64_tr_b16 v[168:169], v241 offset:43008
    ds_read_b64_tr_b16 v[170:171], v241 offset:45056
    ds_read_b64_tr_b16 v[172:173], v242 offset:43008
    ds_read_b64_tr_b16 v[174:175], v242 offset:45056
    ds_read_b64_tr_b16 v[176:177], v243 offset:43008
    ds_read_b64_tr_b16 v[178:179], v243 offset:45056
    ds_read_b64_tr_b16 v[180:181], v244 offset:43008
    ds_read_b64_tr_b16 v[182:183], v244 offset:45056
    buffer_load_dword v6, v246, s[20:23], 0 offen sc1
    ds_read_b64_tr_b16 v[184:185], v241 offset:50176
    ds_read_b64_tr_b16 v[186:187], v241 offset:52224
    ds_read_b64_tr_b16 v[188:189], v242 offset:50176
    ds_read_b64_tr_b16 v[190:191], v242 offset:52224
    ds_read_b64_tr_b16 v[192:193], v243 offset:50176
    ds_read_b64_tr_b16 v[194:195], v243 offset:52224
    ds_read_b64_tr_b16 v[196:197], v244 offset:50176
    ds_read_b64_tr_b16 v[198:199], v244 offset:52224
    ds_read_b64_tr_b16 v[200:201], v243 offset:53760
    ds_read_b64_tr_b16 v[202:203], v243 offset:55808
    ds_read_b64_tr_b16 v[204:205], v244 offset:53760
    ds_read_b64_tr_b16 v[206:207], v244 offset:55808
    ds_read_b64_tr_b16 v[208:209], v241 offset:53760
    ds_read_b64_tr_b16 v[210:211], v241 offset:55808
    ds_read_b64_tr_b16 v[212:213], v242 offset:53760
    ds_read_b64_tr_b16 v[214:215], v242 offset:55808
    ds_read_b64_tr_b16 v[216:217], v2 offset:10240
    ds_read_b64_tr_b16 v[218:219], v2 offset:8192
    ds_read_b64_tr_b16 v[220:221], v3 offset:10240
    ds_read_b64_tr_b16 v[222:223], v3 offset:8192
    ds_read_b64_tr_b16 v[224:225], v4 offset:10240
    ds_read_b64_tr_b16 v[226:227], v4 offset:8192
    ds_read_b64_tr_b16 v[228:229], v5 offset:10240
    ds_read_b64_tr_b16 v[230:231], v5 offset:8192
    s_cmp_lg_u32 s43, 0
    s_cselect_b32 s6, -1, 0xf5af5af
    s_waitcnt vmcnt(0)
    v_cmp_ne_u32 vcc, v6, v250
    s_mov_b32 exec_hi, 0
    s_and_b32 exec_lo, vcc_lo, s6
    s_cbranch_scc0 L_pdP
    s_mov_b32 s10, 65536
L_plP:
    buffer_load_dword v6, v246, s[20:23], 0 offen sc1
    s_sub_u32 s10, s10, 1
    s_cbranch_scc1 L_pdP
    s_waitcnt vmcnt(0)
    v_cmp_ne_u32 vcc, v6, v250
    s_nop 0
    s_and_b64 exec, exec, vcc
    s_cbranch_scc1 L_plP
L_pdP:
    s_mov_b64 exec, -1
    s_cmp_lg_u32 s43, 0
    s_cbranch_scc1 L_asP
L_adP:
    buffer_load_dwordx4 v[24:27], v245, s[20:23], 0 offen offset:0 sc1
    buffer_load_dwordx4 v[28:31], v245, s[20:23], 0 offen offset:1024 sc1
    buffer_load_dwordx4 v[32:35], v245, s[20:23], 0 offen offset:3072 sc1
    buffer_load_dwordx4 v[36:39], v245, s[20:23], s58 offen offset:1024 sc1
    buffer_load_dwordx4 v[40:43], v245, s[20:23], s58 offen offset:3072 sc1
    buffer_load_dwordx4 v[44:47], v245, s[20:23], s59 offen offset:0 sc1
    buffer_load_dwordx4 v[48:51], v245, s[20:23], s59 offen offset:2048 sc1
    s_waitcnt lgkmcnt(0)
    s_waitcnt vmcnt(6)
    v_mfma_f32_16x16x32_bf16 v[8:11], v[56:59], v[24:27], 0
    buffer_load_dword v6, v246, s[20:23], 0 offen sc1
    v_mfma_f32_16x16x32_bf16 v[12:15], v[60:63], v[24:27], 0
    v_mfma_f32_16x16x32_bf16 v[16:19], v[64:67], v[24:27], 0
    v_mfma_f32_16x16x32_bf16 v[20:23], v[68:71], v[24:27], 0
    s_waitcnt vmcnt(6)
    v_mfma_f32_16x16x32_bf16 v[8:11], v[72:75], v[28:31], v[8:11]
    ds_read_b64_tr_b16 v[56:57], v241 offset:21504
    buffer_load_dwordx4 v[52:55], v245, s[20:23], s60 offen offset:0 sc1
    v_mfma_f32_16x16x32_bf16 v[12:15], v[76:79], v[28:31], v[12:15]
    ds_read_b64_tr_b16 v[58:59], v241 offset:23552
    v_mfma_f32_16x16x32_bf16 v[16:19], v[80:83], v[28:31], v[16:19]
    ds_read_b64_tr_b16 v[60:61], v242 offset:21504
    v_mfma_f32_16x16x32_bf16 v[20:23], v[84:87], v[28:31], v[20:23]
    ds_read_b64_tr_b16 v[62:63], v242 offset:23552
    s_waitcnt vmcnt(6)
    v_mfma_f32_16x16x32_bf16 v[8:11], v[88:91], v[32:35], v[8:11]
    ds_read_b64_tr_b16 v[64:65], v243 offset:21504
    buffer_load_dwordx4 v[24:27], v245, s[20:23], s60 offen offset:2048 sc1
    v_mfma_f32_16x16x32_bf16 v[12:15], v[92:95], v[32:35], v[12:15]
    ds_read_b64_tr_b16 v[66:67], v243 offset:23552
    v_mfma_f32_16x16x32_bf16 v[16:19], v[96:99], v[32:35], v[16:19]
    ds_read_b64_tr_b16 v[68:69], v244 offset:21504
    v_mfma_f32_16x16x32_bf16 v[20:23], v[100:103], v[32:35], v[20:23]
    ds_read_b64_tr_b16 v[70:71], v244 offset:23552
    s_waitcnt vmcnt(6)
    v_mfma_f32_16x16x32_bf16 v[8:11], v[104:107], v[36:39], v[8:11]
    ds_read_b64_tr_b16 v[72:73], v4 offset:35328
    buffer_load_dwordx4 v[28:31], v245, s[20:23], s60 offen offset:3072 sc1
    v_mfma_f32_16x16x32_bf16 v[12:15], v[108:111], v[36:39], v[12:15]
    ds_read_b64_tr_b16 v[74:75], v4 offset:33280
    v_mfma_f32_16x16x32_bf16 v[16:19], v[112:115], v[36:39], v[16:19]
    ds_read_b64_tr_b16 v[76:77], v5 offset:35328
    v_mfma_f32_16x16x32_bf16 v[20:23], v[116:119], v[36:39], v[20:23]
    ds_read_b64_tr_b16 v[78:79], v5 offset:33280
    s_waitcnt vmcnt(6)
    v_mfma_f32_16x16x32_bf16 v[8:11], v[120:123], v[40:43], v[8:11]
    ds_read_b64_tr_b16 v[80:81], v2 offset:35328
    v_mfma_f32_16x16x32_bf16 v[12:15], v[124:127], v[40:43], v[12:15]
    ds_read_b64_tr_b16 v[82:83], v2 offset:33280
    v_mfma_f32_16x16x32_bf16 v[16:19], v[128:131], v[40:43], v[16:19]
    ds_read_b64_tr_b16 v[84:85], v3 offset:35328
    v_mfma_f32_16x16x32_bf16 v[20:23], v[132:135], v[40:43], v[20:23]
    ds_read_b64_tr_b16 v[86:87], v3 offset:33280
    s_waitcnt vmcnt(5)
    v_mfma_f32_16x16x32_bf16 v[8:11], v[136:139], v[44:47], v[8:11]
    ds_read_b64_tr_b16 v[88:89], v243 offset:46592
    v_mfma_f32_16x16x32_bf16 v[12:15], v[140:143], v[44:47], v[12:15]
    ds_read_b64_tr_b16 v[90:91], v243 offset:48640
    v_mfma_f32_16x16x32_bf16 v[16:19], v[144:147], v[44:47], v[16:19]
    ds_read_b64_tr_b16 v[92:93], v244 offset:46592
    v_mfma_f32_16x16x32_bf16 v[20:23], v[148:151], v[44:47], v[20:23]
    ds_read_b64_tr_b16 v[94:95], v244 offset:48640
    s_waitcnt vmcnt(4)
    v_mfma_f32_16x16x32_bf16 v[8:11], v[152:155], v[48:51], v[8:11]
    ds_read_b64_tr_b16 v[96:97], v241 offset:46592
    v_mfma_f32_16x16x32_bf16 v[12:15], v[156:159], v[48:51], v[12:15]
    ds_read_b64_tr_b16 v[98:99], v241 offset:48640
    v_mfma_f32_16x16x32_bf16 v[16:19], v[160:163], v[48:51], v[16:19]
    ds_read_b64_tr_b16 v[100:101], v242 offset:46592
    v_mfma_f32_16x16x32_bf16 v[20:23], v[164:167], v[48:51], v[20:23]
    ds_read_b64_tr_b16 v[102:103], v242 offset:48640
    s_waitcnt vmcnt(3)
    v_cmp_ne_u32 vcc, v6, v250
    s_nop 0
    s_and_b32 exec_lo, vcc_lo, 0xf0a50a50
    s_mov_b32 exec_hi, 0
    s_cbranch_scc0 L_pdQ
    s_mov_b32 s10, 65536
L_plQ:
    buffer_load_dword v6, v246, s[20:23], 0 offen sc1
    s_sub_u32 s10, s10, 1
    s_cbranch_scc1 L_pdQ
    s_waitcnt vmcnt(0)
    v_cmp_ne_u32 vcc, v6, v250
    s_nop 0
    s_and_b64 exec, exec, vcc
    s_cbranch_scc1 L_plQ
L_pdQ:
    s_mov_b64 exec, -1
    buffer_load_dwordx4 v[32:35], v245, s[20:23], 0 offen offset:2048 sc1
    buffer_load_dwordx4 v[36:39], v245, s[20:23], s58 offen offset:2048 sc1
    buffer_load_dwordx4 v[40:43], v245, s[20:23], s59 offen offset:1024 sc1
    buffer_load_dwordx4 v[44:47], v245, s[20:23], s60 offen offset:1024 sc1
    s_waitcnt vmcnt(6)
    v_mfma_f32_16x16x32_bf16 v[8:11], v[168:171], v[52:55], v[8:11]
    ds_read_b64_tr_b16 v[104:105], v241 offset:14336
    buffer_load_dwordx4 v[48:51], v245, s[20:23], s58 offen offset:0 sc1
    v_mfma_f32_16x16x32_bf16 v[12:15], v[172:175], v[52:55], v[12:15]
    ds_read_b64_tr_b16 v[106:107], v241 offset:16384
    v_mfma_f32_16x16x32_bf16 v[16:19], v[176:179], v[52:55], v[16:19]
    ds_read_b64_tr_b16 v[108:109], v242 offset:14336
    v_mfma_f32_16x16x32_bf16 v[20:23], v[180:183], v[52:55], v[20:23]
    ds_read_b64_tr_b16 v[110:111], v242 offset:16384
    s_waitcnt vmcnt(6)
    v_mfma_f32_16x16x32_bf16 v[8:11], v[184:187], v[24:27], v[8:11]
    ds_read_b64_tr_b16 v[112:113], v243 offset:14336
    buffer_load_dwordx4 v[52:55], v245, s[20:23], s59 offen offset:3072 sc1
    v_mfma_f32_16x16x32_bf16 v[12:15], v[188:191], v[24:27], v[12:15]
    ds_read_b64_tr_b16 v[114:115], v243 offset:16384
    v_mfma_f32_16x16x32_bf16 v[16:19], v[192:195], v[24:27], v[16:19]
    ds_read_b64_tr_b16 v[116:117], v244 offset:14336
    v_mfma_f32_16x16x32_bf16 v[20:23], v[196:199], v[24:27], v[20:23]
    ds_read_b64_tr_b16 v[118:119], v244 offset:16384
    s_waitcnt vmcnt(6)
    v_mfma_f32_16x16x32_bf16 v[8:11], v[200:203], v[28:31], v[8:11]
    ds_read_b64_tr_b16 v[120:121], v243 offset:39424
    v_mfma_f32_16x16x32_bf16 v[12:15], v[204:207], v[28:31], v[12:15]
    ds_read_b64_tr_b16 v[122:123], v243 offset:41472
    v_mfma_f32_16x16x32_bf16 v[16:19], v[208:211], v[28:31], v[16:19]
    ds_read_b64_tr_b16 v[124:125], v244 offset:39424
    v_mfma_f32_16x16x32_bf16 v[20:23], v[212:215], v[28:31], v[20:23]
    ds_read_b64_tr_b16 v[126:127], v244 offset:41472
    s_waitcnt vmcnt(5)
    v_mfma_f32_16x16x32_bf16 v[8:11], v[216:219], v[32:35], v[8:11]
    ds_read_b64_tr_b16 v[128:129], v241 offset:39424
    v_mfma_f32_16x16x32_bf16 v[12:15], v[220:223], v[32:35], v[12:15]
    ds_read_b64_tr_b16 v[130:131], v241 offset:41472
    v_mfma_f32_16x16x32_bf16 v[16:19], v[224:227], v[32:35], v[16:19]
    ds_read_b64_tr_b16 v[132:133], v242 offset:39424
    v_mfma_f32_16x16x32_bf16 v[20:23], v[228:231], v[32:35], v[20:23]
    ds_read_b64_tr_b16 v[134:135], v242 offset:41472
    s_waitcnt lgkmcnt(15) vmcnt(4)
    v_mfma_f32_16x16x32_bf16 v[8:11], v[56:59], v[36:39], v[8:11]
    v_mfma_f32_16x16x32_bf16 v[12:15], v[60:63], v[36:39], v[12:15]
    v_mfma_f32_16x16x32_bf16 v[16:19], v[64:67], v[36:39], v[16:19]
    v_mfma_f32_16x16x32_bf16 v[20:23], v[68:71], v[36:39], v[20:23]
    s_waitcnt vmcnt(3)
    v_mfma_f32_16x16x32_bf16 v[8:11], v[72:75], v[40:43], v[8:11]
    v_mfma_f32_16x16x32_bf16 v[12:15], v[76:79], v[40:43], v[12:15]
    v_mfma_f32_16x16x32_bf16 v[16:19], v[80:83], v[40:43], v[16:19]
    v_mfma_f32_16x16x32_bf16 v[20:23], v[84:87], v[40:43], v[20:23]
    s_waitcnt vmcnt(2)
    v_mfma_f32_16x16x32_bf16 v[8:11], v[88:91], v[44:47], v[8:11]
    v_mfma_f32_16x16x32_bf16 v[12:15], v[92:95], v[44:47], v[12:15]
    v_mfma_f32_16x16x32_bf16 v[16:19], v[96:99], v[44:47], v[16:19]
    v_mfma_f32_16x16x32_bf16 v[20:23], v[100:103], v[44:47], v[20:23]
    s_waitcnt lgkmcnt(14) vmcnt(1)
    v_mfma_f32_16x16x32_bf16 v[8:11], v[104:107], v[48:51], v[8:11]
    s_waitcnt lgkmcnt(12)
    v_mfma_f32_16x16x32_bf16 v[12:15], v[108:111], v[48:51], v[12:15]
    s_waitcnt lgkmcnt(10)
    v_mfma_f32_16x16x32_bf16 v[16:19], v[112:115], v[48:51], v[16:19]
    s_waitcnt lgkmcnt(8)
    v_mfma_f32_16x16x32_bf16 v[20:23], v[116:119], v[48:51], v[20:23]
    s_waitcnt lgkmcnt(6) vmcnt(0)
    v_mfma_f32_16x16x32_bf16 v[8:11], v[120:123], v[52:55], v[8:11]
    s_waitcnt lgkmcnt(4)
    v_mfma_f32_16x16x32_bf16 v[12:15], v[124:127], v[52:55], v[12:15]
    s_waitcnt lgkmcnt(2)
    v_mfma_f32_16x16x32_bf16 v[16:19], v[128:131], v[52:55], v[16:19]
    s_waitcnt lgkmcnt(0)
    v_mfma_f32_16x16x32_bf16 v[20:23], v[132:135], v[52:55], v[20:23]
    s_movk_i32 s6, 28672
    s_nop 0
    v_cvt_pk_bf16_f32 v24, v8, v9
    v_cvt_pk_bf16_f32 v25, v10, v11
    ds_write_b64 v248, v[24:25] offset:0
    v_cvt_pk_bf16_f32 v26, v12, v13
    v_cvt_pk_bf16_f32 v27, v14, v15
    ds_write_b64 v248, v[26:27] offset:32
    v_cvt_pk_bf16_f32 v28, v16, v17
    v_cvt_pk_bf16_f32 v29, v18, v19
    ds_write_b64 v248, v[28:29] offset:64
    v_cvt_pk_bf16_f32 v30, v20, v21
    v_cvt_pk_bf16_f32 v31, v22, v23
    ds_write_b64 v248, v[30:31] offset:96
    ds_read_b128 v[32:35], v251 offset:0
    ds_read_b128 v[36:39], v251 offset:1152
    s_waitcnt lgkmcnt(1)
    buffer_store_dwordx4 v[32:35], v247, s[28:31], 0 offen sc1
    s_waitcnt lgkmcnt(0)
    buffer_store_dwordx4 v[36:39], v247, s[28:31], s6 offen sc1
    s_endpgm
L_asP:
    buffer_inv sc1
    s_waitcnt vmcnt(0)
    s_branch L_adP
.p2align 12
L_M:
    s_lshr_b32 s55, s3, 1
    s_cmp_eq_u32 s55, 0
    s_cselect_b32 s54, 0xff800000, 0
    s_cmp_eq_u32 s48, 0
    s_cselect_b32 s61, s54, 0
    s_and_b32 s8, s3, 1
    s_lshl1_add_u32 s6, s47, s8
    s_lshl_b32 s6, s6, 4
    s_add_u32 s6, s6, L_tab - L_pc
    s_waitcnt lgkmcnt(0)
    s_load_dwordx4 s[32:35], s[4:5], s6
    s_add_u32 s6, s57, 5308416
    s_load_dword s36, s[20:21], s6
    s_mov_b32 s22, 0x1000000
    s_mov_b32 s23, 0x20000
    v_lshlrev_b32 v208, 2, v252
    v_sub_u32 v208, v253, v208
    v_mov_b32 v209, 0xff800000
    v_subrev_u32 v212, 0, v208
    v_subrev_u32 v213, 1, v208
    v_subrev_u32 v214, 2, v208
    v_subrev_u32 v215, 3, v208
    v_cmp_gt_u32 s[4:5], 8, v212
    v_cmp_gt_u32 s[8:9], 8, v213
    v_cmp_gt_u32 vcc, 8, v214
    v_cmp_gt_u32 s[6:7], 8, v215
    v_cndmask_b32 v24, v209, 0, s[4:5]
    v_cndmask_b32 v25, v209, 0, s[8:9]
    v_cndmask_b32 v26, v209, 0, vcc
    v_cndmask_b32 v27, v209, 0, s[6:7]
    v_cmp_ge_i32 s[4:5], -9, v212
    v_cmp_ge_i32 s[8:9], -9, v213
    v_cmp_ge_i32 vcc, -9, v214
    v_cmp_ge_i32 s[6:7], -9, v215
    v_cndmask_b32 v20, v209, 0, s[4:5]
    v_cndmask_b32 v21, v209, 0, s[8:9]
    v_cndmask_b32 v22, v209, 0, vcc
    v_cndmask_b32 v23, v209, 0, s[6:7]
    v_ashrrev_i32 v212, 31, v212
    v_ashrrev_i32 v213, 31, v213
    v_ashrrev_i32 v214, 31, v214
    v_ashrrev_i32 v215, 31, v215
    v_mov_b32 v208, 0xffff
    v_bfi_b32 v28, v208, v212, v213
    v_bfi_b32 v29, v208, v214, v215
    v_mov_b32 v30, 0x3e8b97f6
    v_or_b32 v56, s54, v20
    v_or_b32 v57, s54, v21
    v_or_b32 v58, s54, v22
    v_or_b32 v59, s54, v23
    v_subrev_u32 v208, 32, v1
    v_ashrrev_i32 v208, 31, v208
    v_and_b32 v208, s61, v208
    v_or_b32 v60, v208, v24
    v_or_b32 v61, v208, v25
    v_or_b32 v62, v208, v26
    v_or_b32 v63, v208, v27
    v_mov_b32 v240, 0x3f803f80
    v_mov_b32 v241, 0x3f803f80
    v_mov_b32 v242, 0x3f803f80
    v_mov_b32 v243, 0x3f803f80
    s_mul_i32 s6, s55, 48
    s_add_u32 s6, s6, s48
    s_and_b32 s7, s2, 1
    s_lshl_b32 s7, s7, 10
    s_add_u32 s6, s6, s7
    s_add_u32 s6, s6, 8
    s_waitcnt lgkmcnt(0)
    s_and_b32 s10, s34, 15
    v_add_u32 v32, s6, v253
    v_lshrrev_b32 v33, 4, v32
    v_lshlrev_b32 v33, 14, v33
    v_and_b32 v32, 15, v32
    v_lshl_add_u32 v32, v32, 4, v33
    v_lshl_add_u32 v32, v252, 8, v32
    s_lshl_b32 s7, s10, 10
    v_add_u32 v18, s7, v32
    s_cmp_eq_u32 s55, 0
    s_cselect_b32 s8, 8, 0
    s_and_b32 s9, s55, s56
    s_cselect_b32 s9, 8, 16
    v_cmp_le_u32 s[4:5], s8, v253
    v_cmp_gt_u32 s[62:63], s9, v253
    v_subrev_u32 v32, 16384, v18
    v_add_u32 v33, 16384, v18
    v_cndmask_b32 v17, 2.0, v32, s[4:5]
    v_cndmask_b32 v19, 2.0, v33, s[62:63]
    s_mul_i32 s9, s57, 17920
    s_lshl_b32 s7, s40, 7
    s_add_u32 s6, s9, s7
    s_lshl2_add_u32 s6, s3, s6
    s_add_u32 s6, s6, 6429696
    v_mov_b32 v248, s6
    v_and_b32 v32, 4, v1
    v_add_u32 v32, 16, v32
    v_bfe_u32 v32, s34, v32, 4
    v_and_b32 v33, 3, v1
    v_lshlrev_b32 v34, 2, v33
    v_lshl_add_u32 v32, v32, 7, v34
    s_lshl_b32 s6, s44, 10
    s_add_u32 s6, s6, s9
    s_add_u32 s6, s6, 6429712
    v_add_u32 v40, s6, v32
    s_mul_i32 s6, s44, 46080
    s_add_u32 s9, s9, s6
    s_add_u32 s9, s9, 6291456
    s_lshl_b32 s38, s55, 10
    s_lshl_b32 s39, s55, 3
    v_lshl_add_u32 v42, v253, 4, s9
    v_lshl_add_u32 v43, v252, 2, v33
    v_lshl_add_u32 v43, v43, 4, s9
    v_lshrrev_b32 v35, 2, v253
    s_bfe_u32 s6, s34, 0x40008
    s_sub_u32 s6, 4, s6
    v_cmp_le_u32 s[62:63], s6, v252
    v_cmp_le_u32 s[64:65], s6, v35
    s_movk_i32 s8, 2304
    v_lshlrev_b32 v32, 3, v252
    v_bfe_u32 v32, s33, v32, 8
    v_mad_u32_u24 v32, v32, s8, v42
    v_cndmask_b32 v36, 2.0, v32, s[62:63]
    v_lshlrev_b32 v32, 3, v35
    v_bfe_u32 v32, s33, v32, 8
    v_mad_u32_u24 v32, v32, s8, v43
    v_cndmask_b32 v37, 2.0, v32, s[64:65]
    s_bfe_u32 s6, s34, 0x4000c
    s_bitcmp1_b32 s34, 4
    s_cselect_b32 s7, 2, 4
    s_cselect_b32 s9, -1, 1
    s_add_u32 s6, s6, s7
    v_mul_i32_i24 v32, s9, v252
    v_add_u32 v32, s6, v32
    v_cmp_ne_u32 vcc, 3, v252
    v_mad_u32_u24 v32, v32, s8, v42
    v_subrev_u32 v2, 9216, v32
    v_cndmask_b32 v38, 2.0, v32, vcc
    v_mul_i32_i24 v32, s9, v35
    v_add_u32 v32, s6, v32
    v_cmp_ne_u32 vcc, 3, v35
    v_mad_u32_u24 v32, v32, s8, v43
    v_subrev_u32 v3, 9216, v32
    v_cndmask_b32 v39, 2.0, v32, vcc
    s_mul_i32 s36, s36, 0x9e3779b1
    s_add_u32 s36, s36, 0x7f4a7c15
    v_mov_b32 v250, s36
    s_getreg_b32 s7, hwreg(HW_REG_XCC_ID, 0, 3)
    s_mul_i32 s8, s57, 17920
    s_lshl_b32 s7, s7, 7
    s_add_u32 s8, s8, s7
    s_add_u32 s8, s8, 6432768
    v_and_b32 v41, 31, v1
    v_lshl_add_u32 v41, v41, 2, s8
    s_lshl2_add_u32 s37, s40, s8
    s_cmp_eq_u32 s47, 7
    s_cbranch_scc1 L_SM
    v_lshrrev_b32 v32, 5, v1
    v_lshlrev_b32 v32, 9, v32
    v_bfe_u32 v33, v1, 4, 1
    v_lshl_add_u32 v32, v33, 7, v32
    s_movk_i32 s6, 1056
    v_mad_u32_u24 v32, v35, s6, v32
    v_bfe_u32 v33, s32, v34, 4
    v_lshl_add_u32 v9, v33, 3, v32
    v_add_u32 v34, 16, v34
    v_bfe_u32 v33, s32, v34, 4
    v_lshl_add_u32 v10, v33, 3, v32
    v_lshrrev_b32 v32, 1, v253
    v_xor_b32 v32, v32, v252
    v_lshlrev_b32 v32, 4, v32
    v_lshl_add_u32 v32, v253, 7, v32
    s_mul_i32 s6, s55, 6144
    s_add_u32 s6, s6, 25344
    v_add_u32 v11, s6, v32
    v_xor_b32 v32, 64, v32
    v_add_u32 v12, s6, v32
    v_add_u32 v13, 75264, v9
    v_add_u32 v15, 75264, v11
    v_add_u32 v14, 75264, v10
    v_add_u32 v16, 75264, v12
    s_lshl_b32 s6, s3, 11
    s_add_u32 s6, s6, 75264
    v_lshl_add_u32 v6, v1, 4, s6
    s_lshl_b32 s6, s55, 12
    v_subrev_u32 v7, s6, v6
    v_mov_b32 v8, 163832
    v_mov_b32 v31, 1
    s_mov_b64 exec, 0
    s_cmp_eq_u32 s3, 1
    s_cbranch_scc1 L_padM
L_back:
    s_mov_b64 exec, -1
    s_waitcnt lgkmcnt(0)
    s_barrier
    ds_read_b128 v[136:139], v11 offset:37632
    ds_read_b64_tr_b16 v[164:165], v10 offset:37632
    ds_read_b64_tr_b16 v[166:167], v10 offset:37888
    ds_read_b128 v[140:143], v11 offset:39680
    ds_read_b128 v[144:147], v11 offset:41728
    ds_read_b64_tr_b16 v[172:173], v10 offset:41856
    ds_read_b64_tr_b16 v[174:175], v10 offset:42112
    ds_read_b64_tr_b16 v[180:181], v10 offset:46080
    ds_read_b64_tr_b16 v[182:183], v10 offset:46336
    ds_read_b64_tr_b16 v[160:161], v9 offset:37632
    ds_read_b64_tr_b16 v[162:163], v9 offset:37888
    ds_read_b64_tr_b16 v[168:169], v9 offset:41856
    ds_read_b64_tr_b16 v[170:171], v9 offset:42112
    ds_read_b64_tr_b16 v[176:177], v9 offset:46080
    ds_read_b64_tr_b16 v[178:179], v9 offset:46336
    s_waitcnt lgkmcnt(12)
    v_mfma_f32_16x16x32_bf16 v[68:71], v[164:167], v[136:139], 0
    ds_read_b128 v[148:151], v12 offset:37632
    s_waitcnt lgkmcnt(12)
    v_mfma_f32_16x16x32_bf16 v[92:95], v[164:167], v[140:143], 0
    ds_read_b64_tr_b16 v[188:189], v10 offset:50304
    s_waitcnt lgkmcnt(12)
    v_mfma_f32_16x16x32_bf16 v[116:119], v[164:167], v[144:147], 0
    ds_read_b64_tr_b16 v[190:191], v10 offset:50560
    s_waitcnt lgkmcnt(11)
    v_mfma_f32_16x16x32_bf16 v[76:79], v[172:175], v[136:139], 0
    ds_read_b128 v[152:155], v12 offset:39680
    v_mfma_f32_16x16x32_bf16 v[100:103], v[172:175], v[140:143], 0
    ds_read_b128 v[156:159], v12 offset:41728
    v_mfma_f32_16x16x32_bf16 v[124:127], v[172:175], v[144:147], 0
    ds_read_b64_tr_b16 v[196:197], v10 offset:54528
    s_waitcnt lgkmcnt(12)
    v_mfma_f32_16x16x32_bf16 v[84:87], v[136:139], v[180:183], 0
    ds_read_b64_tr_b16 v[198:199], v10 offset:54784
    v_mfma_f32_16x16x32_bf16 v[108:111], v[140:143], v[180:183], 0
    ds_read_b64_tr_b16 v[204:205], v10 offset:58752
    v_mfma_f32_16x16x32_bf16 v[132:135], v[144:147], v[180:183], 0
    ds_read_b64_tr_b16 v[206:207], v10 offset:59008
    s_waitcnt lgkmcnt(13)
    v_mfma_f32_16x16x32_bf16 v[64:67], v[160:163], v[136:139], 0
    ds_read_b64_tr_b16 v[184:185], v9 offset:50304
    v_mfma_f32_16x16x32_bf16 v[88:91], v[160:163], v[140:143], 0
    ds_read_b64_tr_b16 v[186:187], v9 offset:50560
    v_mfma_f32_16x16x32_bf16 v[112:115], v[160:163], v[144:147], 0
    ds_read_b64_tr_b16 v[192:193], v9 offset:54528
    s_waitcnt lgkmcnt(14)
    v_mfma_f32_16x16x32_bf16 v[72:75], v[168:171], v[136:139], 0
    ds_read_b64_tr_b16 v[194:195], v9 offset:54784
    v_mfma_f32_16x16x32_bf16 v[96:99], v[168:171], v[140:143], 0
    ds_read_b64_tr_b16 v[200:201], v9 offset:58752
    v_mfma_f32_16x16x32_bf16 v[120:123], v[168:171], v[144:147], 0
    ds_read_b64_tr_b16 v[202:203], v9 offset:59008
    s_waitcnt lgkmcnt(15)
    v_mfma_f32_16x16x32_bf16 v[80:83], v[136:139], v[176:179], 0
    v_mfma_f32_16x16x32_bf16 v[104:107], v[140:143], v[176:179], 0
    v_mfma_f32_16x16x32_bf16 v[128:131], v[144:147], v[176:179], 0
    s_waitcnt lgkmcnt(0)
    v_mfma_f32_16x16x32_bf16 v[68:71], v[188:191], v[148:151], v[68:71]
    v_mfma_f32_16x16x32_bf16 v[92:95], v[188:191], v[152:155], v[92:95]
    v_mfma_f32_16x16x32_bf16 v[116:119], v[188:191], v[156:159], v[116:119]
    s_waitcnt lgkmcnt(0)
    s_barrier
    v_mfma_f32_16x16x32_bf16 v[76:79], v[196:199], v[148:151], v[76:79]
    ds_read_b128 v[136:139], v15 offset:0
    ds_read_b64_tr_b16 v[164:165], v14 offset:0
    v_mfma_f32_16x16x32_bf16 v[100:103], v[196:199], v[152:155], v[100:103]
    ds_read_b64_tr_b16 v[166:167], v14 offset:256
    v_mfma_f32_16x16x32_bf16 v[124:127], v[196:199], v[156:159], v[124:127]
    ds_read_b128 v[140:143], v15 offset:2048
    v_mfma_f32_16x16x32_bf16 v[84:87], v[148:151], v[204:207], v[84:87]
    ds_read_b128 v[144:147], v15 offset:4096
    v_mfma_f32_16x16x32_bf16 v[108:111], v[152:155], v[204:207], v[108:111]
    ds_read_b64_tr_b16 v[172:173], v14 offset:4224
    ds_read_b64_tr_b16 v[174:175], v14 offset:4480
    v_mfma_f32_16x16x32_bf16 v[132:135], v[156:159], v[204:207], v[132:135]
    ds_read_b64_tr_b16 v[180:181], v14 offset:8448
    v_mfma_f32_16x16x32_bf16 v[64:67], v[184:187], v[148:151], v[64:67]
    ds_read_b64_tr_b16 v[182:183], v14 offset:8704
    v_mfma_f32_16x16x32_bf16 v[88:91], v[184:187], v[152:155], v[88:91]
    ds_read_b64_tr_b16 v[160:161], v13 offset:0
    v_mfma_f32_16x16x32_bf16 v[112:115], v[184:187], v[156:159], v[112:115]
    ds_read_b64_tr_b16 v[162:163], v13 offset:256
    ds_read_b64_tr_b16 v[168:169], v13 offset:4224
    v_mfma_f32_16x16x32_bf16 v[72:75], v[192:195], v[148:151], v[72:75]
    ds_read_b64_tr_b16 v[170:171], v13 offset:4480
    v_mfma_f32_16x16x32_bf16 v[96:99], v[192:195], v[152:155], v[96:99]
    ds_read_b64_tr_b16 v[176:177], v13 offset:8448
    v_mfma_f32_16x16x32_bf16 v[120:123], v[192:195], v[156:159], v[120:123]
    ds_read_b64_tr_b16 v[178:179], v13 offset:8704
    v_mfma_f32_16x16x32_bf16 v[80:83], v[148:151], v[200:203], v[80:83]
    v_mfma_f32_16x16x32_bf16 v[104:107], v[152:155], v[200:203], v[104:107]
    v_mfma_f32_16x16x32_bf16 v[128:131], v[156:159], v[200:203], v[128:131]
    s_waitcnt lgkmcnt(0)
    v_mfma_f32_16x16x32_bf16 v[68:71], v[164:167], v[136:139], v[68:71]
    ds_read_b128 v[148:151], v16 offset:0
    v_mfma_f32_16x16x32_bf16 v[92:95], v[164:167], v[140:143], v[92:95]
    ds_read_b64_tr_b16 v[188:189], v14 offset:12672
    v_mfma_f32_16x16x32_bf16 v[116:119], v[164:167], v[144:147], v[116:119]
    ds_read_b64_tr_b16 v[190:191], v14 offset:12928
    v_mfma_f32_16x16x32_bf16 v[76:79], v[172:175], v[136:139], v[76:79]
    ds_read_b128 v[152:155], v16 offset:2048
    v_mfma_f32_16x16x32_bf16 v[100:103], v[172:175], v[140:143], v[100:103]
    ds_read_b128 v[156:159], v16 offset:4096
    v_mfma_f32_16x16x32_bf16 v[124:127], v[172:175], v[144:147], v[124:127]
    ds_read_b64_tr_b16 v[196:197], v14 offset:16896
    v_mfma_f32_16x16x32_bf16 v[84:87], v[136:139], v[180:183], v[84:87]
    ds_read_b64_tr_b16 v[198:199], v14 offset:17152
    v_mfma_f32_16x16x32_bf16 v[108:111], v[140:143], v[180:183], v[108:111]
    ds_read_b64_tr_b16 v[204:205], v14 offset:21120
    v_mfma_f32_16x16x32_bf16 v[132:135], v[144:147], v[180:183], v[132:135]
    ds_read_b64_tr_b16 v[206:207], v14 offset:21376
    v_mfma_f32_16x16x32_bf16 v[64:67], v[160:163], v[136:139], v[64:67]
    ds_read_b64_tr_b16 v[184:185], v13 offset:12672
    v_mfma_f32_16x16x32_bf16 v[88:91], v[160:163], v[140:143], v[88:91]
    ds_read_b64_tr_b16 v[186:187], v13 offset:12928
    v_mfma_f32_16x16x32_bf16 v[112:115], v[160:163], v[144:147], v[112:115]
    ds_read_b64_tr_b16 v[192:193], v13 offset:16896
    v_mfma_f32_16x16x32_bf16 v[72:75], v[168:171], v[136:139], v[72:75]
    ds_read_b64_tr_b16 v[194:195], v13 offset:17152
    v_mfma_f32_16x16x32_bf16 v[96:99], v[168:171], v[140:143], v[96:99]
    ds_read_b64_tr_b16 v[200:201], v13 offset:21120
    v_mfma_f32_16x16x32_bf16 v[120:123], v[168:171], v[144:147], v[120:123]
    ds_read_b64_tr_b16 v[202:203], v13 offset:21376
    v_mfma_f32_16x16x32_bf16 v[80:83], v[136:139], v[176:179], v[80:83]
    v_mfma_f32_16x16x32_bf16 v[104:107], v[140:143], v[176:179], v[104:107]
    v_mfma_f32_16x16x32_bf16 v[128:131], v[144:147], v[176:179], v[128:131]
    s_waitcnt lgkmcnt(0)
    v_mfma_f32_16x16x32_bf16 v[68:71], v[188:191], v[148:151], v[68:71]
    v_mfma_f32_16x16x32_bf16 v[92:95], v[188:191], v[152:155], v[92:95]
    v_mfma_f32_16x16x32_bf16 v[116:119], v[188:191], v[156:159], v[116:119]
    s_waitcnt lgkmcnt(0)
    s_barrier
    v_mfma_f32_16x16x32_bf16 v[76:79], v[196:199], v[148:151], v[76:79]
    ds_read_b128 v[136:139], v11 offset:0
    ds_read_b64_tr_b16 v[164:165], v10 offset:0
    v_mfma_f32_16x16x32_bf16 v[100:103], v[196:199], v[152:155], v[100:103]
    ds_read_b64_tr_b16 v[166:167], v10 offset:256
    v_mfma_f32_16x16x32_bf16 v[124:127], v[196:199], v[156:159], v[124:127]
    ds_read_b128 v[140:143], v11 offset:2048
    v_mfma_f32_16x16x32_bf16 v[84:87], v[148:151], v[204:207], v[84:87]
    ds_read_b128 v[144:147], v11 offset:4096
    v_mfma_f32_16x16x32_bf16 v[108:111], v[152:155], v[204:207], v[108:111]
    ds_read_b64_tr_b16 v[172:173], v10 offset:4224
    ds_read_b64_tr_b16 v[174:175], v10 offset:4480
    v_mfma_f32_16x16x32_bf16 v[132:135], v[156:159], v[204:207], v[132:135]
    ds_read_b64_tr_b16 v[180:181], v10 offset:8448
    v_mfma_f32_16x16x32_bf16 v[64:67], v[184:187], v[148:151], v[64:67]
    ds_read_b64_tr_b16 v[182:183], v10 offset:8704
    v_mfma_f32_16x16x32_bf16 v[88:91], v[184:187], v[152:155], v[88:91]
    ds_read_b64_tr_b16 v[160:161], v9 offset:0
    v_mfma_f32_16x16x32_bf16 v[112:115], v[184:187], v[156:159], v[112:115]
    ds_read_b64_tr_b16 v[162:163], v9 offset:256
    ds_read_b64_tr_b16 v[168:169], v9 offset:4224
    v_mfma_f32_16x16x32_bf16 v[72:75], v[192:195], v[148:151], v[72:75]
    ds_read_b64_tr_b16 v[170:171], v9 offset:4480
    v_mfma_f32_16x16x32_bf16 v[96:99], v[192:195], v[152:155], v[96:99]
    ds_read_b64_tr_b16 v[176:177], v9 offset:8448
    v_mfma_f32_16x16x32_bf16 v[120:123], v[192:195], v[156:159], v[120:123]
    ds_read_b64_tr_b16 v[178:179], v9 offset:8704
    v_mfma_f32_16x16x32_bf16 v[80:83], v[148:151], v[200:203], v[80:83]
    v_mfma_f32_16x16x32_bf16 v[104:107], v[152:155], v[200:203], v[104:107]
    v_mfma_f32_16x16x32_bf16 v[128:131], v[156:159], v[200:203], v[128:131]
    s_waitcnt lgkmcnt(0)
    v_mfma_f32_16x16x32_bf16 v[68:71], v[164:167], v[136:139], v[68:71]
    ds_read_b128 v[148:151], v12 offset:0
    v_mfma_f32_16x16x32_bf16 v[92:95], v[164:167], v[140:143], v[92:95]
    ds_read_b64_tr_b16 v[188:189], v10 offset:12672
    v_mfma_f32_16x16x32_bf16 v[116:119], v[164:167], v[144:147], v[116:119]
    ds_read_b64_tr_b16 v[190:191], v10 offset:12928
    v_mfma_f32_16x16x32_bf16 v[76:79], v[172:175], v[136:139], v[76:79]
    ds_read_b128 v[152:155], v12 offset:2048
    v_mfma_f32_16x16x32_bf16 v[100:103], v[172:175], v[140:143], v[100:103]
    ds_read_b128 v[156:159], v12 offset:4096
    v_mfma_f32_16x16x32_bf16 v[124:127], v[172:175], v[144:147], v[124:127]
    ds_read_b64_tr_b16 v[196:197], v10 offset:16896
    v_mfma_f32_16x16x32_bf16 v[84:87], v[136:139], v[180:183], v[84:87]
    ds_read_b64_tr_b16 v[198:199], v10 offset:17152
    v_mfma_f32_16x16x32_bf16 v[108:111], v[140:143], v[180:183], v[108:111]
    ds_read_b64_tr_b16 v[204:205], v10 offset:21120
    v_mfma_f32_16x16x32_bf16 v[132:135], v[144:147], v[180:183], v[132:135]
    ds_read_b64_tr_b16 v[206:207], v10 offset:21376
    v_mfma_f32_16x16x32_bf16 v[64:67], v[160:163], v[136:139], v[64:67]
    ds_read_b64_tr_b16 v[184:185], v9 offset:12672
    v_mfma_f32_16x16x32_bf16 v[88:91], v[160:163], v[140:143], v[88:91]
    ds_read_b64_tr_b16 v[186:187], v9 offset:12928
    v_mfma_f32_16x16x32_bf16 v[112:115], v[160:163], v[144:147], v[112:115]
    ds_read_b64_tr_b16 v[192:193], v9 offset:16896
    v_mfma_f32_16x16x32_bf16 v[72:75], v[168:171], v[136:139], v[72:75]
    ds_read_b64_tr_b16 v[194:195], v9 offset:17152
    v_mfma_f32_16x16x32_bf16 v[96:99], v[168:171], v[140:143], v[96:99]
    ds_read_b64_tr_b16 v[200:201], v9 offset:21120
    v_mfma_f32_16x16x32_bf16 v[120:123], v[168:171], v[144:147], v[120:123]
    ds_read_b64_tr_b16 v[202:203], v9 offset:21376
    v_mfma_f32_16x16x32_bf16 v[80:83], v[136:139], v[176:179], v[80:83]
    v_mfma_f32_16x16x32_bf16 v[104:107], v[140:143], v[176:179], v[104:107]
    v_mfma_f32_16x16x32_bf16 v[128:131], v[144:147], v[176:179], v[128:131]
    s_waitcnt lgkmcnt(0)
    v_mfma_f32_16x16x32_bf16 v[68:71], v[188:191], v[148:151], v[68:71]
    v_mfma_f32_16x16x32_bf16 v[92:95], v[188:191], v[152:155], v[92:95]
    v_mfma_f32_16x16x32_bf16 v[116:119], v[188:191], v[156:159], v[116:119]
    s_waitcnt lgkmcnt(0)
    s_barrier
    v_mfma_f32_16x16x32_bf16 v[76:79], v[196:199], v[148:151], v[76:79]
    ds_read_b128 v[136:139], v11 offset:37632
    ds_read_b64_tr_b16 v[164:165], v10 offset:37632
    v_mfma_f32_16x16x32_bf16 v[100:103], v[196:199], v[152:155], v[100:103]
    ds_read_b64_tr_b16 v[166:167], v10 offset:37888
    v_mfma_f32_16x16x32_bf16 v[124:127], v[196:199], v[156:159], v[124:127]
    ds_read_b128 v[140:143], v11 offset:39680
    v_mfma_f32_16x16x32_bf16 v[84:87], v[148:151], v[204:207], v[84:87]
    ds_read_b128 v[144:147], v11 offset:41728
    v_mfma_f32_16x16x32_bf16 v[108:111], v[152:155], v[204:207], v[108:111]
    ds_read_b64_tr_b16 v[172:173], v10 offset:41856
    ds_read_b64_tr_b16 v[174:175], v10 offset:42112
    v_mfma_f32_16x16x32_bf16 v[132:135], v[156:159], v[204:207], v[132:135]
    ds_read_b64_tr_b16 v[180:181], v10 offset:46080
    v_mfma_f32_16x16x32_bf16 v[64:67], v[184:187], v[148:151], v[64:67]
    ds_read_b64_tr_b16 v[182:183], v10 offset:46336
    v_mfma_f32_16x16x32_bf16 v[88:91], v[184:187], v[152:155], v[88:91]
    ds_read_b64_tr_b16 v[160:161], v9 offset:37632
    v_mfma_f32_16x16x32_bf16 v[112:115], v[184:187], v[156:159], v[112:115]
    ds_read_b64_tr_b16 v[162:163], v9 offset:37888
    ds_read_b64_tr_b16 v[168:169], v9 offset:41856
    v_mfma_f32_16x16x32_bf16 v[72:75], v[192:195], v[148:151], v[72:75]
    ds_read_b64_tr_b16 v[170:171], v9 offset:42112
    v_mfma_f32_16x16x32_bf16 v[96:99], v[192:195], v[152:155], v[96:99]
    ds_read_b64_tr_b16 v[176:177], v9 offset:46080
    v_mfma_f32_16x16x32_bf16 v[120:123], v[192:195], v[156:159], v[120:123]
    ds_read_b64_tr_b16 v[178:179], v9 offset:46336
    v_mfma_f32_16x16x32_bf16 v[80:83], v[148:151], v[200:203], v[80:83]
    v_mfma_f32_16x16x32_bf16 v[104:107], v[152:155], v[200:203], v[104:107]
    v_mfma_f32_16x16x32_bf16 v[128:131], v[156:159], v[200:203], v[128:131]
    s_waitcnt lgkmcnt(0)
    v_mfma_f32_16x16x32_bf16 v[68:71], v[164:167], v[136:139], v[68:71]
    ds_read_b128 v[148:151], v12 offset:37632
    v_mfma_f32_16x16x32_bf16 v[92:95], v[164:167], v[140:143], v[92:95]
    ds_read_b64_tr_b16 v[188:189], v10 offset:50304
    v_mfma_f32_16x16x32_bf16 v[116:119], v[164:167], v[144:147], v[116:119]
    ds_read_b64_tr_b16 v[190:191], v10 offset:50560
    v_mfma_f32_16x16x32_bf16 v[76:79], v[172:175], v[136:139], v[76:79]
    ds_read_b128 v[152:155], v12 offset:39680
    v_mfma_f32_16x16x32_bf16 v[100:103], v[172:175], v[140:143], v[100:103]
    ds_read_b128 v[156:159], v12 offset:41728
    v_mfma_f32_16x16x32_bf16 v[124:127], v[172:175], v[144:147], v[124:127]
    ds_read_b64_tr_b16 v[196:197], v10 offset:54528
    v_mfma_f32_16x16x32_bf16 v[84:87], v[136:139], v[180:183], v[84:87]
    ds_read_b64_tr_b16 v[198:199], v10 offset:54784
    v_mfma_f32_16x16x32_bf16 v[108:111], v[140:143], v[180:183], v[108:111]
    ds_read_b64_tr_b16 v[204:205], v10 offset:58752
    v_mfma_f32_16x16x32_bf16 v[132:135], v[144:147], v[180:183], v[132:135]
    ds_read_b64_tr_b16 v[206:207], v10 offset:59008
    v_mfma_f32_16x16x32_bf16 v[64:67], v[160:163], v[136:139], v[64:67]
    ds_read_b64_tr_b16 v[184:185], v9 offset:50304
    v_mfma_f32_16x16x32_bf16 v[88:91], v[160:163], v[140:143], v[88:91]
    ds_read_b64_tr_b16 v[186:187], v9 offset:50560
    v_mfma_f32_16x16x32_bf16 v[112:115], v[160:163], v[144:147], v[112:115]
    ds_read_b64_tr_b16 v[192:193], v9 offset:54528
    v_mfma_f32_16x16x32_bf16 v[72:75], v[168:171], v[136:139], v[72:75]
    ds_read_b64_tr_b16 v[194:195], v9 offset:54784
    v_mfma_f32_16x16x32_bf16 v[96:99], v[168:171], v[140:143], v[96:99]
    ds_read_b64_tr_b16 v[200:201], v9 offset:58752
    v_mfma_f32_16x16x32_bf16 v[120:123], v[168:171], v[144:147], v[120:123]
    ds_read_b64_tr_b16 v[202:203], v9 offset:59008
    v_mfma_f32_16x16x32_bf16 v[80:83], v[136:139], v[176:179], v[80:83]
    v_mfma_f32_16x16x32_bf16 v[104:107], v[140:143], v[176:179], v[104:107]
    v_mfma_f32_16x16x32_bf16 v[128:131], v[144:147], v[176:179], v[128:131]
    s_waitcnt lgkmcnt(0)
    v_mfma_f32_16x16x32_bf16 v[68:71], v[188:191], v[148:151], v[68:71]
    v_mfma_f32_16x16x32_bf16 v[92:95], v[188:191], v[152:155], v[92:95]
    v_mfma_f32_16x16x32_bf16 v[116:119], v[188:191], v[156:159], v[116:119]
    s_waitcnt lgkmcnt(0)
    s_barrier
    v_mfma_f32_16x16x32_bf16 v[76:79], v[196:199], v[148:151], v[76:79]
    ds_read_b128 v[136:139], v15 offset:0
    ds_read_b64_tr_b16 v[164:165], v14 offset:0
    v_mfma_f32_16x16x32_bf16 v[100:103], v[196:199], v[152:155], v[100:103]
    ds_read_b64_tr_b16 v[166:167], v14 offset:256
    v_mfma_f32_16x16x32_bf16 v[124:127], v[196:199], v[156:159], v[124:127]
    ds_read_b128 v[140:143], v15 offset:2048
    v_mfma_f32_16x16x32_bf16 v[84:87], v[148:151], v[204:207], v[84:87]
    ds_read_b128 v[144:147], v15 offset:4096
    v_mfma_f32_16x16x32_bf16 v[108:111], v[152:155], v[204:207], v[108:111]
    ds_read_b64_tr_b16 v[172:173], v14 offset:4224
    ds_read_b64_tr_b16 v[174:175], v14 offset:4480
    v_mfma_f32_16x16x32_bf16 v[132:135], v[156:159], v[204:207], v[132:135]
    ds_read_b64_tr_b16 v[180:181], v14 offset:8448
    v_mfma_f32_16x16x32_bf16 v[64:67], v[184:187], v[148:151], v[64:67]
    ds_read_b64_tr_b16 v[182:183], v14 offset:8704
    v_mfma_f32_16x16x32_bf16 v[88:91], v[184:187], v[152:155], v[88:91]
    ds_read_b64_tr_b16 v[160:161], v13 offset:0
    v_mfma_f32_16x16x32_bf16 v[112:115], v[184:187], v[156:159], v[112:115]
    ds_read_b64_tr_b16 v[162:163], v13 offset:256
    ds_read_b64_tr_b16 v[168:169], v13 offset:4224
    v_mfma_f32_16x16x32_bf16 v[72:75], v[192:195], v[148:151], v[72:75]
    ds_read_b64_tr_b16 v[170:171], v13 offset:4480
    v_mfma_f32_16x16x32_bf16 v[96:99], v[192:195], v[152:155], v[96:99]
    ds_read_b64_tr_b16 v[176:177], v13 offset:8448
    v_mfma_f32_16x16x32_bf16 v[120:123], v[192:195], v[156:159], v[120:123]
    ds_read_b64_tr_b16 v[178:179], v13 offset:8704
    v_mfma_f32_16x16x32_bf16 v[80:83], v[148:151], v[200:203], v[80:83]
    v_mfma_f32_16x16x32_bf16 v[104:107], v[152:155], v[200:203], v[104:107]
    v_mfma_f32_16x16x32_bf16 v[128:131], v[156:159], v[200:203], v[128:131]
    s_waitcnt lgkmcnt(0)
    v_mfma_f32_16x16x32_bf16 v[68:71], v[164:167], v[136:139], v[68:71]
    ds_read_b128 v[148:151], v16 offset:0
    v_mfma_f32_16x16x32_bf16 v[92:95], v[164:167], v[140:143], v[92:95]
    ds_read_b64_tr_b16 v[188:189], v14 offset:12672
    v_mfma_f32_16x16x32_bf16 v[116:119], v[164:167], v[144:147], v[116:119]
    ds_read_b64_tr_b16 v[190:191], v14 offset:12928
    v_mfma_f32_16x16x32_bf16 v[76:79], v[172:175], v[136:139], v[76:79]
    ds_read_b128 v[152:155], v16 offset:2048
    v_mfma_f32_16x16x32_bf16 v[100:103], v[172:175], v[140:143], v[100:103]
    ds_read_b128 v[156:159], v16 offset:4096
    v_mfma_f32_16x16x32_bf16 v[124:127], v[172:175], v[144:147], v[124:127]
    ds_read_b64_tr_b16 v[196:197], v14 offset:16896
    v_mfma_f32_16x16x32_bf16 v[84:87], v[136:139], v[180:183], v[84:87]
    ds_read_b64_tr_b16 v[198:199], v14 offset:17152
    v_mfma_f32_16x16x32_bf16 v[108:111], v[140:143], v[180:183], v[108:111]
    ds_read_b64_tr_b16 v[204:205], v14 offset:21120
    v_mfma_f32_16x16x32_bf16 v[132:135], v[144:147], v[180:183], v[132:135]
    ds_read_b64_tr_b16 v[206:207], v14 offset:21376
    v_mfma_f32_16x16x32_bf16 v[64:67], v[160:163], v[136:139], v[64:67]
    ds_read_b64_tr_b16 v[184:185], v13 offset:12672
    v_mfma_f32_16x16x32_bf16 v[88:91], v[160:163], v[140:143], v[88:91]
    ds_read_b64_tr_b16 v[186:187], v13 offset:12928
    v_mfma_f32_16x16x32_bf16 v[112:115], v[160:163], v[144:147], v[112:115]
    ds_read_b64_tr_b16 v[192:193], v13 offset:16896
    v_mfma_f32_16x16x32_bf16 v[72:75], v[168:171], v[136:139], v[72:75]
    ds_read_b64_tr_b16 v[194:195], v13 offset:17152
    v_mfma_f32_16x16x32_bf16 v[96:99], v[168:171], v[140:143], v[96:99]
    ds_read_b64_tr_b16 v[200:201], v13 offset:21120
    v_mfma_f32_16x16x32_bf16 v[120:123], v[168:171], v[144:147], v[120:123]
    ds_read_b64_tr_b16 v[202:203], v13 offset:21376
    v_mfma_f32_16x16x32_bf16 v[80:83], v[136:139], v[176:179], v[80:83]
    v_mfma_f32_16x16x32_bf16 v[104:107], v[140:143], v[176:179], v[104:107]
    buffer_load_dword v43, v41, s[20:23], 0 offen sc1
    v_mfma_f32_16x16x32_bf16 v[128:131], v[144:147], v[176:179], v[128:131]
    s_waitcnt lgkmcnt(0)
    v_mfma_f32_16x16x32_bf16 v[68:71], v[188:191], v[148:151], v[68:71]
    v_mfma_f32_16x16x32_bf16 v[92:95], v[188:191], v[152:155], v[92:95]
    v_mfma_f32_16x16x32_bf16 v[116:119], v[188:191], v[156:159], v[116:119]
    s_waitcnt lgkmcnt(0)
    s_barrier
    v_mfma_f32_16x16x32_bf16 v[76:79], v[196:199], v[148:151], v[76:79]
    ds_read_b128 v[136:139], v11 offset:0
    ds_read_b64_tr_b16 v[164:165], v10 offset:0
    v_mfma_f32_16x16x32_bf16 v[100:103], v[196:199], v[152:155], v[100:103]
    ds_read_b64_tr_b16 v[166:167], v10 offset:256
    v_mfma_f32_16x16x32_bf16 v[124:127], v[196:199], v[156:159], v[124:127]
    ds_read_b128 v[140:143], v11 offset:2048
    v_mfma_f32_16x16x32_bf16 v[84:87], v[148:151], v[204:207], v[84:87]
    ds_read_b128 v[144:147], v11 offset:4096
    v_mfma_f32_16x16x32_bf16 v[108:111], v[152:155], v[204:207], v[108:111]
    ds_read_b64_tr_b16 v[172:173], v10 offset:4224
    ds_read_b64_tr_b16 v[174:175], v10 offset:4480
    v_mfma_f32_16x16x32_bf16 v[132:135], v[156:159], v[204:207], v[132:135]
    ds_read_b64_tr_b16 v[180:181], v10 offset:8448
    v_mfma_f32_16x16x32_bf16 v[64:67], v[184:187], v[148:151], v[64:67]
    ds_read_b64_tr_b16 v[182:183], v10 offset:8704
    v_mfma_f32_16x16x32_bf16 v[88:91], v[184:187], v[152:155], v[88:91]
    ds_read_b64_tr_b16 v[160:161], v9 offset:0
    v_mfma_f32_16x16x32_bf16 v[112:115], v[184:187], v[156:159], v[112:115]
    ds_read_b64_tr_b16 v[162:163], v9 offset:256
    ds_read_b64_tr_b16 v[168:169], v9 offset:4224
    v_mfma_f32_16x16x32_bf16 v[72:75], v[192:195], v[148:151], v[72:75]
    ds_read_b64_tr_b16 v[170:171], v9 offset:4480
    v_mfma_f32_16x16x32_bf16 v[96:99], v[192:195], v[152:155], v[96:99]
    ds_read_b64_tr_b16 v[176:177], v9 offset:8448
    v_mfma_f32_16x16x32_bf16 v[120:123], v[192:195], v[156:159], v[120:123]
    ds_read_b64_tr_b16 v[178:179], v9 offset:8704
    v_mfma_f32_16x16x32_bf16 v[80:83], v[148:151], v[200:203], v[80:83]
    v_mfma_f32_16x16x32_bf16 v[104:107], v[152:155], v[200:203], v[104:107]
    v_mfma_f32_16x16x32_bf16 v[128:131], v[156:159], v[200:203], v[128:131]
    s_waitcnt lgkmcnt(0)
    v_mfma_f32_16x16x32_bf16 v[68:71], v[164:167], v[136:139], v[68:71]
    ds_read_b128 v[148:151], v12 offset:0
    v_mfma_f32_16x16x32_bf16 v[92:95], v[164:167], v[140:143], v[92:95]
    ds_read_b64_tr_b16 v[188:189], v10 offset:12672
    v_mfma_f32_16x16x32_bf16 v[116:119], v[164:167], v[144:147], v[116:119]
    ds_read_b64_tr_b16 v[190:191], v10 offset:12928
    v_mfma_f32_16x16x32_bf16 v[76:79], v[172:175], v[136:139], v[76:79]
    ds_read_b128 v[152:155], v12 offset:2048
    v_mfma_f32_16x16x32_bf16 v[100:103], v[172:175], v[140:143], v[100:103]
    ds_read_b128 v[156:159], v12 offset:4096
    v_mfma_f32_16x16x32_bf16 v[124:127], v[172:175], v[144:147], v[124:127]
    ds_read_b64_tr_b16 v[196:197], v10 offset:16896
    v_mfma_f32_16x16x32_bf16 v[84:87], v[136:139], v[180:183], v[84:87]
    ds_read_b64_tr_b16 v[198:199], v10 offset:17152
L_padM:
    s_cbranch_execz L_back
    v_mfma_f32_16x16x32_bf16 v[108:111], v[140:143], v[180:183], v[108:111]
    ds_read_b64_tr_b16 v[204:205], v10 offset:21120
    v_mfma_f32_16x16x32_bf16 v[132:135], v[144:147], v[180:183], v[132:135]
    ds_read_b64_tr_b16 v[206:207], v10 offset:21376
    v_mfma_f32_16x16x32_bf16 v[64:67], v[160:163], v[136:139], v[64:67]
    ds_read_b64_tr_b16 v[184:185], v9 offset:12672
    v_mfma_f32_16x16x32_bf16 v[88:91], v[160:163], v[140:143], v[88:91]
    ds_read_b64_tr_b16 v[186:187], v9 offset:12928
    v_mfma_f32_16x16x32_bf16 v[112:115], v[160:163], v[144:147], v[112:115]
    ds_read_b64_tr_b16 v[192:193], v9 offset:16896
    v_mfma_f32_16x16x32_bf16 v[72:75], v[168:171], v[136:139], v[72:75]
    ds_read_b64_tr_b16 v[194:195], v9 offset:17152
    v_mfma_f32_16x16x32_bf16 v[96:99], v[168:171], v[140:143], v[96:99]
    ds_read_b64_tr_b16 v[200:201], v9 offset:21120
    v_mfma_f32_16x16x32_bf16 v[120:123], v[168:171], v[144:147], v[120:123]
    ds_read_b64_tr_b16 v[202:203], v9 offset:21376
    v_mfma_f32_16x16x32_bf16 v[80:83], v[136:139], v[176:179], v[80:83]
    v_mfma_f32_16x16x32_bf16 v[104:107], v[140:143], v[176:179], v[104:107]
    v_mfma_f32_16x16x32_bf16 v[128:131], v[144:147], v[176:179], v[128:131]
    s_waitcnt lgkmcnt(0)
    v_mfma_f32_16x16x32_bf16 v[68:71], v[188:191], v[148:151], v[68:71]
    v_mfma_f32_16x16x32_bf16 v[92:95], v[188:191], v[152:155], v[92:95]
    v_mfma_f32_16x16x32_bf16 v[116:119], v[188:191], v[156:159], v[116:119]
    v_mfma_f32_16x16x32_bf16 v[76:79], v[196:199], v[148:151], v[76:79]
    v_mfma_f32_16x16x32_bf16 v[100:103], v[196:199], v[152:155], v[100:103]
    v_mfma_f32_16x16x32_bf16 v[124:127], v[196:199], v[156:159], v[124:127]
    v_mfma_f32_16x16x32_bf16 v[84:87], v[148:151], v[204:207], v[84:87]
    v_mfma_f32_16x16x32_bf16 v[108:111], v[152:155], v[204:207], v[108:111]
    v_mfma_f32_16x16x32_bf16 v[132:135], v[156:159], v[204:207], v[132:135]
    s_setprio 1
    s_waitcnt vmcnt(0) lgkmcnt(0)
    s_barrier
    ds_read_b128 v[144:147], v11 offset:41728
    ds_read_b64_tr_b16 v[164:165], v10 offset:37632
    v_mfma_f32_16x16x32_bf16 v[64:67], v[184:187], v[148:151], v[64:67]
    ds_read_b64_tr_b16 v[166:167], v10 offset:37888
    ds_read_b64_tr_b16 v[172:173], v10 offset:41856
    v_mfma_f32_16x16x32_bf16 v[88:91], v[184:187], v[152:155], v[88:91]
    ds_read_b64_tr_b16 v[174:175], v10 offset:42112
    ds_read_b128 v[244:247], v12 offset:41728
    v_mfma_f32_16x16x32_bf16 v[112:115], v[184:187], v[156:159], v[112:115]
    ds_read_b64_tr_b16 v[188:189], v10 offset:50304
    ds_read_b64_tr_b16 v[190:191], v10 offset:50560
    v_mfma_f32_16x16x32_bf16 v[72:75], v[192:195], v[148:151], v[72:75]
    ds_read_b64_tr_b16 v[196:197], v10 offset:54528
    ds_read_b64_tr_b16 v[198:199], v10 offset:54784
    v_mfma_f32_16x16x32_bf16 v[96:99], v[192:195], v[152:155], v[96:99]
    ds_read_b128 v[140:143], v11 offset:39680
    ds_read_b128 v[32:35], v12 offset:39680
    v_mfma_f32_16x16x32_bf16 v[120:123], v[192:195], v[156:159], v[120:123]
    ds_read_b128 v[136:139], v11 offset:37632
    ds_read_b128 v[2:5], v12 offset:37632
    v_mfma_f32_16x16x32_bf16 v[80:83], v[148:151], v[200:203], v[80:83]
    ds_read_b64_tr_b16 v[180:181], v10 offset:46080
    ds_read_b64_tr_b16 v[182:183], v10 offset:46336
    v_mfma_f32_16x16x32_bf16 v[104:107], v[152:155], v[200:203], v[104:107]
    ds_read_b64_tr_b16 v[204:205], v10 offset:58752
    ds_read_b64_tr_b16 v[206:207], v10 offset:59008
    v_mfma_f32_16x16x32_bf16 v[128:131], v[156:159], v[200:203], v[128:131]
    ds_read_b64_tr_b16 v[168:169], v9 offset:41856
    v_cmp_ne_u32 vcc, v43, v250
    s_waitcnt lgkmcnt(15)
    v_mfma_f32_16x16x32_bf16 v[116:119], v[164:167], v[144:147], v[116:119]
    ds_read_b64_tr_b16 v[170:171], v9 offset:42112
    s_waitcnt lgkmcnt(15)
    v_mfma_f32_16x16x32_bf16 v[124:127], v[172:175], v[144:147], v[124:127]
    ds_read_b64_tr_b16 v[176:177], v9 offset:46080
    s_or_b32 s43, vcc_lo, vcc_hi
    s_waitcnt lgkmcnt(13)
    v_mfma_f32_16x16x32_bf16 v[116:119], v[188:191], v[244:247], v[116:119]
    ds_read_b64_tr_b16 v[178:179], v9 offset:46336
    s_waitcnt lgkmcnt(12)
    v_mfma_f32_16x16x32_bf16 v[124:127], v[196:199], v[244:247], v[124:127]
    ds_read_b64_tr_b16 v[160:161], v9 offset:37632
    s_waitcnt lgkmcnt(12)
    v_mfma_f32_16x16x32_bf16 v[92:95], v[164:167], v[140:143], v[92:95]
    ds_read_b64_tr_b16 v[162:163], v9 offset:37888
    v_mfma_f32_16x16x32_bf16 v[100:103], v[172:175], v[140:143], v[100:103]
    v_cvt_pk_bf16_f32 v218, v116, v117
    v_cvt_pk_bf16_f32 v219, v118, v119
    s_waitcnt lgkmcnt(12)
    v_mfma_f32_16x16x32_bf16 v[92:95], v[188:191], v[32:35], v[92:95]
    v_cvt_pk_bf16_f32 v216, v124, v125
    v_cvt_pk_bf16_f32 v217, v126, v127
    v_mfma_f32_16x16x32_bf16 v[100:103], v[196:199], v[32:35], v[100:103]
    buffer_store_dwordx4 v[216:219], v36, s[20:23], s38 offen offset:512
    ds_read_b64_tr_b16 v[192:193], v9 offset:54528
    s_waitcnt lgkmcnt(12)
    v_mfma_f32_16x16x32_bf16 v[68:71], v[164:167], v[136:139], v[68:71]
    ds_read_b64_tr_b16 v[194:195], v9 offset:54784
    v_mfma_f32_16x16x32_bf16 v[76:79], v[172:175], v[136:139], v[76:79]
    v_cvt_pk_bf16_f32 v214, v92, v93
    v_cvt_pk_bf16_f32 v215, v94, v95
    s_waitcnt lgkmcnt(12)
    v_mfma_f32_16x16x32_bf16 v[68:71], v[188:191], v[2:5], v[68:71]
    v_cvt_pk_bf16_f32 v212, v100, v101
    v_cvt_pk_bf16_f32 v213, v102, v103
    v_mfma_f32_16x16x32_bf16 v[76:79], v[196:199], v[2:5], v[76:79]
    buffer_store_dwordx4 v[212:215], v36, s[20:23], s38 offen offset:256
    ds_read_b64_tr_b16 v[200:201], v9 offset:58752
    s_waitcnt lgkmcnt(11)
    v_mfma_f32_16x16x32_bf16 v[132:135], v[144:147], v[180:183], v[132:135]
    ds_read_b64_tr_b16 v[202:203], v9 offset:59008
    v_mfma_f32_16x16x32_bf16 v[108:111], v[140:143], v[180:183], v[108:111]
    v_cvt_pk_bf16_f32 v210, v68, v69
    v_cvt_pk_bf16_f32 v211, v70, v71
    v_mfma_f32_16x16x32_bf16 v[84:87], v[136:139], v[180:183], v[84:87]
    v_cvt_pk_bf16_f32 v208, v76, v77
    v_cvt_pk_bf16_f32 v209, v78, v79
    s_waitcnt lgkmcnt(10)
    v_mfma_f32_16x16x32_bf16 v[132:135], v[244:247], v[204:207], v[132:135]
    buffer_store_dwordx4 v[208:211], v36, s[20:23], s38 offen offset:0
    ds_read_b64_tr_b16 v[184:185], v9 offset:50304
    v_mfma_f32_16x16x32_bf16 v[108:111], v[32:35], v[204:207], v[108:111]
    ds_read_b64_tr_b16 v[186:187], v9 offset:50560
    v_mfma_f32_16x16x32_bf16 v[84:87], v[2:5], v[204:207], v[84:87]
    s_waitcnt lgkmcnt(10)
    v_mfma_f32_16x16x32_bf16 v[120:123], v[168:171], v[144:147], v[120:123]
    s_nop 0
    v_cvt_pk_bf16_f32 v238, v132, v133
    v_cvt_pk_bf16_f32 v239, v134, v135
    v_mfma_f32_16x16x32_bf16 v[96:99], v[168:171], v[140:143], v[96:99]
    v_cvt_pk_bf16_f32 v236, v108, v109
    v_cvt_pk_bf16_f32 v237, v110, v111
    v_mfma_f32_16x16x32_bf16 v[72:75], v[168:171], v[136:139], v[72:75]
    buffer_store_dwordx4 v[236:239], v37, s[20:23], s38 offen offset:768
    s_waitcnt lgkmcnt(8)
    v_mfma_f32_16x16x32_bf16 v[128:131], v[144:147], v[176:179], v[128:131]
    v_cvt_pk_bf16_f32 v234, v84, v85
    v_cvt_pk_bf16_f32 v235, v86, v87
    v_mfma_f32_16x16x32_bf16 v[104:107], v[140:143], v[176:179], v[104:107]
    v_mfma_f32_16x16x32_bf16 v[80:83], v[136:139], v[176:179], v[80:83]
    buffer_store_dwordx2 v[234:235], v37, s[20:23], s39 offen offset:2048
    s_waitcnt lgkmcnt(6)
    v_mfma_f32_16x16x32_bf16 v[112:115], v[160:163], v[144:147], v[112:115]
    s_barrier
    v_mfma_f32_16x16x32_bf16 v[88:91], v[160:163], v[140:143], v[88:91]
    ds_write_b64 v6, v[216:217] offset:0
    v_mfma_f32_16x16x32_bf16 v[64:67], v[160:163], v[136:139], v[64:67]
    ds_write_b64 v6, v[238:239] offset:1032
    s_waitcnt lgkmcnt(6)
    v_mfma_f32_16x16x32_bf16 v[120:123], v[192:195], v[244:247], v[120:123]
    s_waitcnt lgkmcnt(4)
    v_mfma_f32_16x16x32_bf16 v[128:131], v[244:247], v[200:203], v[128:131]
    s_waitcnt lgkmcnt(2)
    v_mfma_f32_16x16x32_bf16 v[112:115], v[184:187], v[244:247], v[112:115]
    v_mfma_f32_16x16x32_bf16 v[96:99], v[192:195], v[32:35], v[96:99]
    v_mfma_f32_16x16x32_bf16 v[104:107], v[32:35], v[200:203], v[104:107]
    s_nop 1
    v_cvt_pk_bf16_f32 v52, v120, v121
    v_cvt_pk_bf16_f32 v53, v122, v123
    v_mfma_f32_16x16x32_bf16 v[88:91], v[184:187], v[32:35], v[88:91]
    v_cvt_pk_bf16_f32 v230, v128, v129
    v_cvt_pk_bf16_f32 v231, v130, v131
    v_mfma_f32_16x16x32_bf16 v[72:75], v[192:195], v[2:5], v[72:75]
    ds_write_b64 v6, v[52:53] offset:8
    v_cvt_pk_bf16_f32 v54, v112, v113
    v_mfma_f32_16x16x32_bf16 v[80:83], v[2:5], v[200:203], v[80:83]
    ds_write_b64 v6, v[230:231] offset:1024
    v_cvt_pk_bf16_f32 v55, v114, v115
    v_mfma_f32_16x16x32_bf16 v[64:67], v[184:187], v[2:5], v[64:67]
    v_cvt_pk_bf16_f32 v48, v96, v97
    v_cvt_pk_bf16_f32 v49, v98, v99
    v_cvt_pk_bf16_f32 v228, v104, v105
    v_cvt_pk_bf16_f32 v229, v106, v107
    v_cvt_pk_bf16_f32 v50, v88, v89
    v_cvt_pk_bf16_f32 v51, v90, v91
    s_cmp_lg_u32 s43, 0
    s_waitcnt vmcnt(0)
    s_cbranch_scc1 L_rsX
L_rfX:
    buffer_store_dword v250, v248, s[20:23], 0 offen offset:16
L_rdX:
    s_waitcnt lgkmcnt(0)
    s_barrier
    ds_read_b128 v[220:223], v7
    ds_read_b64 v[224:225], v7 offset:1024
    ds_read_b64 v[232:233], v7 offset:1032
    v_cvt_pk_bf16_f32 v44, v72, v73
    v_cvt_pk_bf16_f32 v45, v74, v75
    v_cvt_pk_bf16_f32 v46, v64, v65
    v_cvt_pk_bf16_f32 v47, v66, v67
    v_cvt_pk_bf16_f32 v226, v80, v81
    v_cvt_pk_bf16_f32 v227, v82, v83
    v_mfma_f32_16x16x16_bf16 v[164:167], v[52:53], v[54:55], v[24:27]
    v_mfma_f32_16x16x16_bf16 v[160:163], v[48:49], v[54:55], v[20:23]
    v_mfma_f32_16x16x16_bf16 v[172:175], v[48:49], v[50:51], v[24:27]
    v_mfma_f32_16x16x16_bf16 v[168:171], v[44:45], v[50:51], v[20:23]
    v_mfma_f32_16x16x16_bf16 v[188:191], v[44:45], v[46:47], v[60:63]
    s_waitcnt lgkmcnt(2)
    v_mfma_f32_16x16x16_bf16 v[184:187], v[222:223], v[46:47], v[56:59]
    s_bitcmp1_b32 s34, 9
    s_waitcnt lgkmcnt(0)
    s_cbranch_scc1 L_get
    s_mov_b64 exec, s[62:63]
    v_mov_b32 v218, 0
    v_mov_b32 v219, 0
    v_mov_b32 v214, 0
    v_mov_b32 v215, 0
    v_mov_b32 v210, 0
    v_mov_b32 v211, 0
    s_mov_b64 exec, s[64:65]
    v_mov_b32 v232, 0
    v_mov_b32 v233, 0
    v_mov_b32 v234, 0
    v_mov_b32 v235, 0
    v_mov_b32 v236, 0
    v_mov_b32 v237, 0
    v_mov_b32 v238, 0
    v_mov_b32 v239, 0
    s_mov_b64 exec, -1
    s_branch L_imp
L_SM:
    s_barrier
    buffer_store_dword v250, off, s[20:23], s37
    s_setprio 1
    s_barrier
    s_mov_b32 s10, 40
L_plM:
    buffer_load_dword v42, v41, s[20:23], 0 offen sc1
    s_sub_u32 s10, s10, 1
    s_cbranch_scc1 L_pdM
    s_waitcnt vmcnt(0)
    v_cmp_ne_u32 vcc, v42, v250
    s_nop 0
    s_and_b64 exec, exec, vcc
    s_cbranch_scc1 L_plM
L_pdM:
    s_or_b32 s43, exec_lo, exec_hi
    s_mov_b64 exec, -1
    s_mov_b32 s10, 65536
L_plS:
    buffer_load_dword v42, v40, s[20:23], 0 offen sc1
    s_sub_u32 s10, s10, 1
    s_cbranch_scc1 L_pdS
    s_waitcnt vmcnt(0)
    v_cmp_ne_u32 vcc, v42, v250
    s_nop 0
    s_and_b64 exec, exec, vcc
    s_cbranch_scc1 L_plS
L_pdS:
    s_mov_b64 exec, -1
    s_cmp_lg_u32 s43, 0
    s_cbranch_scc1 L_asS
L_adS:
    buffer_load_dwordx4 v[52:55], v2, s[20:23], s38 offen offset:512 sc1
    buffer_load_dwordx4 v[216:219], v38, s[20:23], s38 offen offset:512 sc1
    buffer_load_dwordx4 v[48:51], v2, s[20:23], s38 offen offset:256 sc1
    buffer_load_dwordx4 v[212:215], v38, s[20:23], s38 offen offset:256 sc1
    buffer_load_dwordx4 v[44:47], v2, s[20:23], s38 offen offset:0 sc1
    buffer_load_dwordx4 v[208:211], v38, s[20:23], s38 offen offset:0 sc1
    buffer_load_dwordx2 v[222:223], v2, s[20:23], 0 offen offset:512 sc1
    buffer_load_dwordx2 v[220:221], v38, s[20:23], 0 offen offset:512 sc1
    s_waitcnt vmcnt(7)
    v_mfma_f32_16x16x16_bf16 v[164:167], v[52:53], v[54:55], v[24:27]
    buffer_load_dwordx4 v[228:231], v3, s[20:23], s38 offen offset:768 sc1
    s_waitcnt vmcnt(7)
    v_mfma_f32_16x16x16_bf16 v[164:167], v[216:217], v[218:219], v[164:167]
    s_waitcnt vmcnt(6)
    v_mfma_f32_16x16x16_bf16 v[160:163], v[48:49], v[54:55], v[20:23]
    buffer_load_dwordx2 v[226:227], v3, s[20:23], s39 offen offset:2048 sc1
    s_waitcnt vmcnt(6)
    v_mfma_f32_16x16x16_bf16 v[160:163], v[212:213], v[218:219], v[160:163]
    v_mfma_f32_16x16x16_bf16 v[172:175], v[48:49], v[50:51], v[24:27]
    buffer_load_dwordx2 v[224:225], v3, s[20:23], 0 offen offset:776 sc1
    v_mfma_f32_16x16x16_bf16 v[172:175], v[212:213], v[214:215], v[172:175]
    s_waitcnt vmcnt(6)
    v_mfma_f32_16x16x16_bf16 v[168:171], v[44:45], v[50:51], v[20:23]
    buffer_load_dwordx4 v[236:239], v39, s[20:23], s38 offen offset:768 sc1
    s_waitcnt vmcnt(6)
    v_mfma_f32_16x16x16_bf16 v[168:171], v[208:209], v[214:215], v[168:171]
    v_mfma_f32_16x16x16_bf16 v[188:191], v[44:45], v[46:47], v[60:63]
    buffer_load_dwordx2 v[234:235], v39, s[20:23], s39 offen offset:2048 sc1
    v_mfma_f32_16x16x16_bf16 v[188:191], v[208:209], v[210:211], v[188:191]
    s_waitcnt vmcnt(6)
    v_mfma_f32_16x16x16_bf16 v[184:187], v[222:223], v[46:47], v[56:59]
    buffer_load_dwordx2 v[232:233], v39, s[20:23], 0 offen offset:776 sc1
    s_waitcnt vmcnt(6)
    v_mfma_f32_16x16x16_bf16 v[184:187], v[220:221], v[210:211], v[184:187]
    s_branch L_sm
L_get:
    s_mov_b32 s10, 65536
L_plX:
    buffer_load_dword v42, v40, s[20:23], 0 offen sc1
    s_sub_u32 s10, s10, 1
    s_cbranch_scc1 L_pdX
    s_waitcnt vmcnt(0)
    v_cmp_ne_u32 vcc, v42, v250
    s_nop 0
    s_and_b64 exec, exec, vcc
    s_cbranch_scc1 L_plX
L_pdX:
    s_mov_b64 exec, -1
    s_cmp_lg_u32 s43, 0
    s_cbranch_scc1 L_asX
L_adX:
    s_mov_b64 exec, s[62:63]
    buffer_load_dwordx4 v[216:219], v38, s[20:23], s38 offen offset:512 sc1
    buffer_load_dwordx4 v[212:215], v38, s[20:23], s38 offen offset:256 sc1
    buffer_load_dwordx4 v[208:211], v38, s[20:23], s38 offen offset:0 sc1
    buffer_load_dwordx2 v[220:221], v38, s[20:23], 0 offen offset:512 sc1
    s_mov_b64 exec, s[64:65]
    buffer_load_dwordx4 v[236:239], v39, s[20:23], s38 offen offset:768 sc1
    buffer_load_dwordx2 v[234:235], v39, s[20:23], s39 offen offset:2048 sc1
    buffer_load_dwordx2 v[232:233], v39, s[20:23], 0 offen offset:776 sc1
    s_mov_b64 exec, -1
L_imp:
    s_waitcnt vmcnt(6)
    v_mfma_f32_16x16x16_bf16 v[164:167], v[216:217], v[218:219], v[164:167]
    s_waitcnt vmcnt(5)
    v_mfma_f32_16x16x16_bf16 v[160:163], v[212:213], v[218:219], v[160:163]
    v_mfma_f32_16x16x16_bf16 v[172:175], v[212:213], v[214:215], v[172:175]
    s_waitcnt vmcnt(4)
    v_mfma_f32_16x16x16_bf16 v[168:171], v[208:209], v[214:215], v[168:171]
    v_mfma_f32_16x16x16_bf16 v[188:191], v[208:209], v[210:211], v[188:191]
    s_waitcnt vmcnt(3)
    v_mfma_f32_16x16x16_bf16 v[184:187], v[220:221], v[210:211], v[184:187]
L_sm:
    s_nop 1
    v_max_f32 v160, v160, v164
    v_max_f32 v161, v161, v165
    v_max_f32 v162, v162, v166
    v_max_f32 v163, v163, v167
    v_max_f32 v168, v168, v172
    v_max_f32 v169, v169, v173
    v_max_f32 v170, v170, v174
    v_max_f32 v171, v171, v175
    v_max_f32 v184, v184, v188
    v_max_f32 v185, v185, v189
    v_max_f32 v186, v186, v190
    v_max_f32 v187, v187, v191
    v_max3_f32 v75, v160, v161, v162
    v_max3_f32 v74, v168, v169, v170
    v_max3_f32 v73, v184, v185, v186
    v_max_f32 v68, v75, v163
    v_max_f32 v72, v75, v163
    v_max_f32 v66, v74, v171
    v_max_f32 v71, v74, v171
    v_max_f32 v64, v73, v187
    v_max_f32 v70, v73, v187
    v_permlane32_swap_b32 v68, v72
    v_permlane32_swap_b32 v66, v71
    v_permlane32_swap_b32 v64, v70
    v_max_f32 v75, v68, v72
    v_max_f32 v68, v68, v72
    v_max_f32 v74, v66, v71
    v_max_f32 v66, v66, v71
    v_max_f32 v73, v64, v70
    v_max_f32 v64, v64, v70
    v_permlane16_swap_b32 v68, v75
    v_permlane16_swap_b32 v66, v74
    v_permlane16_swap_b32 v64, v73
    v_max_f32 v68, v68, v75
    v_max_f32 v66, v66, v74
    v_max_f32 v64, v64, v73
    v_mul_f32 v68, v30, v68
    v_mul_f32 v66, v30, v66
    v_mul_f32 v64, v30, v64
    v_pk_fma_f32 v[160:161], v[160:161], v[30:31], v[68:69] op_sel_hi:[1,0,0] neg_lo:[0,0,1] neg_hi:[0,0,1]
    v_pk_fma_f32 v[162:163], v[162:163], v[30:31], v[68:69] op_sel_hi:[1,0,0] neg_lo:[0,0,1] neg_hi:[0,0,1]
    v_pk_fma_f32 v[168:169], v[168:169], v[30:31], v[66:67] op_sel_hi:[1,0,0] neg_lo:[0,0,1] neg_hi:[0,0,1]
    v_pk_fma_f32 v[170:171], v[170:171], v[30:31], v[66:67] op_sel_hi:[1,0,0] neg_lo:[0,0,1] neg_hi:[0,0,1]
    v_pk_fma_f32 v[184:185], v[184:185], v[30:31], v[64:65] op_sel_hi:[1,0,0] neg_lo:[0,0,1] neg_hi:[0,0,1]
    v_pk_fma_f32 v[186:187], v[186:187], v[30:31], v[64:65] op_sel_hi:[1,0,0] neg_lo:[0,0,1] neg_hi:[0,0,1]
    v_exp_f32 v160, v160
    v_exp_f32 v161, v161
    v_exp_f32 v162, v162
    v_exp_f32 v163, v163
    v_exp_f32 v168, v168
    v_exp_f32 v169, v169
    v_exp_f32 v170, v170
    v_exp_f32 v171, v171
    v_cvt_pk_bf16_f32 v164, v160, v161
    v_cvt_pk_bf16_f32 v165, v162, v163
    v_and_b32 v96, v28, v164
    v_and_b32 v97, v29, v165
    v_bfi_b32 v98, v28, 0, v164
    v_bfi_b32 v99, v29, 0, v165
    v_exp_f32 v184, v184
    v_exp_f32 v185, v185
    v_mfma_f32_16x16x32_bf16 v[120:123], v[240:243], v[96:99], 0
    v_exp_f32 v186, v186
    v_exp_f32 v187, v187
    s_waitcnt vmcnt(2)
    v_mfma_f32_16x16x32_bf16 v[156:159], v[236:239], v[96:99], 0
    v_cvt_pk_bf16_f32 v172, v168, v169
    v_cvt_pk_bf16_f32 v173, v170, v171
    v_mfma_f32_16x16x32_bf16 v[152:155], v[228:231], v[96:99], 0
    v_and_b32 v92, v28, v172
    v_and_b32 v93, v29, v173
    v_bfi_b32 v94, v28, 0, v172
    v_bfi_b32 v95, v29, 0, v173
    v_cvt_pk_bf16_f32 v188, v184, v185
    v_cvt_pk_bf16_f32 v189, v186, v187
    v_mfma_f32_16x16x32_bf16 v[116:119], v[240:243], v[92:95], 0
    v_and_b32 v88, v28, v188
    v_and_b32 v89, v29, v189
    s_waitcnt vmcnt(1)
    v_mfma_f32_16x16x32_bf16 v[148:151], v[234:237], v[92:95], 0
    v_bfi_b32 v90, v28, 0, v188
    v_bfi_b32 v91, v29, 0, v189
    v_mfma_f32_16x16x32_bf16 v[144:147], v[226:229], v[92:95], 0
    v_rcp_f32 v68, v120
    v_mfma_f32_16x16x32_bf16 v[112:115], v[240:243], v[88:91], 0
    s_waitcnt vmcnt(0)
    v_mfma_f32_16x16x32_bf16 v[140:143], v[232:235], v[88:91], 0
    v_mfma_f32_16x16x32_bf16 v[136:139], v[224:227], v[88:91], 0
    v_pk_mul_f32 v[152:153], v[152:153], v[68:69] op_sel_hi:[1,0]
    v_pk_mul_f32 v[154:155], v[154:155], v[68:69] op_sel_hi:[1,0]
    v_pk_mul_f32 v[156:157], v[156:157], v[68:69] op_sel_hi:[1,0]
    v_pk_mul_f32 v[158:159], v[158:159], v[68:69] op_sel_hi:[1,0]
    v_rcp_f32 v66, v116
    v_cvt_pk_bf16_f32 v200, v152, v153
    v_cvt_pk_bf16_f32 v201, v154, v155
    v_cvt_pk_bf16_f32 v202, v156, v157
    v_cvt_pk_bf16_f32 v203, v158, v159
    buffer_store_dwordx4 v[200:203], v19, s[20:23], 0 offen sc1
    v_pk_mul_f32 v[144:145], v[144:145], v[66:67] op_sel_hi:[1,0]
    v_pk_mul_f32 v[146:147], v[146:147], v[66:67] op_sel_hi:[1,0]
    v_pk_mul_f32 v[148:149], v[148:149], v[66:67] op_sel_hi:[1,0]
    v_pk_mul_f32 v[150:151], v[150:151], v[66:67] op_sel_hi:[1,0]
    v_rcp_f32_e64 v64, v112
    v_cvt_pk_bf16_f32 v196, v144, v145
    v_cvt_pk_bf16_f32 v197, v146, v147
    v_cvt_pk_bf16_f32 v198, v148, v149
    v_cvt_pk_bf16_f32 v199, v150, v151
    buffer_store_dwordx4 v[196:199], v18, s[20:23], 0 offen sc1
    v_pk_mul_f32 v[136:137], v[136:137], v[64:65] op_sel_hi:[1,0]
    v_pk_mul_f32 v[138:139], v[138:139], v[64:65] op_sel_hi:[1,0]
    v_pk_mul_f32 v[140:141], v[140:141], v[64:65] op_sel_hi:[1,0]
    v_pk_mul_f32 v[142:143], v[142:143], v[64:65] op_sel_hi:[1,0]
    v_cvt_pk_bf16_f32 v192, v136, v137
    v_cvt_pk_bf16_f32 v193, v138, v139
    v_cvt_pk_bf16_f32 v194, v140, v141
    v_cvt_pk_bf16_f32 v195, v142, v143
    buffer_store_dwordx4 v[192:195], v17, s[20:23], 0 offen sc1
    v_and_b32 v32, 3, v1
    v_cmp_eq_u32 s[4:5], 0, v32
    v_cmp_eq_u32 vcc, 1, v32
    s_nop 0
    v_cndmask_b32 v33, v19, v17, s[4:5]
    v_cndmask_b32 v33, v33, v18, vcc
    s_mov_b32 exec_lo, 0x07070707
    s_mov_b32 exec_hi, 0x07070707
    s_and_b32 s6, s34, 0x600
    s_cselect_b32 s6, 0, 2.0
    s_waitcnt vmcnt(0)
L_odone:
    s_cmp_lg_u32 s43, 0
    s_cbranch_scc1 L_rsO
L_rfO:
    buffer_store_dword v250, v248, s[20:23], 0 offen offset:0
L_rdO:
    buffer_load_dword v255, v33, s[20:23], s6 offen sc1
    s_mov_b64 exec, -1
    s_endpgm
L_rsX:
    s_mov_b32 s10, 40
L_plRX:
    buffer_load_dword v42, v41, s[20:23], 0 offen sc1
    s_sub_u32 s10, s10, 1
    s_cbranch_scc1 L_pdRX
    s_waitcnt vmcnt(0)
    v_cmp_ne_u32 vcc, v42, v250
    s_nop 0
    s_and_b64 exec, exec, vcc
    s_cbranch_scc1 L_plRX
L_pdRX:
    s_or_b32 s43, exec_lo, exec_hi
    s_mov_b64 exec, -1
    s_cmp_eq_u32 s43, 0
    s_cbranch_scc1 L_rfX
    buffer_wbl2 sc1
    s_waitcnt vmcnt(0)
    buffer_store_dword v250, v248, s[20:23], 0 offen offset:16 sc1
    s_branch L_rdX
L_rsO:
    buffer_wbl2 sc1
    s_waitcnt vmcnt(0)
    buffer_store_dword v250, v248, s[20:23], 0 offen offset:0 sc1
    s_branch L_rdO
L_asX:
    buffer_inv sc1
    s_waitcnt vmcnt(0)
    s_branch L_adX
L_asS:
    buffer_inv sc1
    s_waitcnt vmcnt(0)
    s_branch L_adS
.p2align 12
L_B:
    s_setprio 1
    buffer_load_dwordx4 v[192:195], v2, s[32:35], 0 offen offset:0
    s_mov_b32 s22, 0x1000000
    s_mov_b32 s23, 0x20000
    s_mov_b32 s18, 0x126000
    s_mov_b32 s19, 0x20000
    buffer_load_dwordx4 v[200:203], v3, s[32:35], 0 offen offset:0
    s_add_u32 s6, s57, 5308416
    s_load_dword s36, s[20:21], s6
    s_lshl_b32 s6, s11, 3
    s_add_u32 s6, s6, 5308416
    buffer_load_dwordx4 v[196:199], v2, s[32:35], 0 offen offset:448
    s_load_dword s50, s[20:21], s6
    s_lshr_b32 s49, s11, 2
    s_sub_u32 s6, s40, 24
    s_lshl3_add_u32 s47, s6, s11
    buffer_load_dwordx4 v[204:207], v3, s[32:35], 0 offen offset:448
    s_mul_i32 s6, s47, 2688
    v_min_u32 v7, 20, v1
    v_lshl_add_u32 v7, v7, 7, s6
    s_add_u32 s100, s100, 1
    s_lshl_b32 s6, s3, 5
    s_add_u32 s6, s6, s49
    v_lshl_add_u32 v11, v253, 1, s6
    v_cvt_f32_u32 v11, v11
    v_lshlrev_b32 v12, 5, v252
    v_cvt_f32_u32 v12, v12
    v_mul_f32 v13, 0x3b124925, v11
    v_mul_f32 v224, v12, v13
    v_add_f32 v14, v13, v13
    v_fract_f32 v224, v224
    v_cos_f32 v16, v14
    v_add_f32 v225, v224, v13
    v_add_f32 v226, v224, v14
    v_add_f32 v227, v225, v14
    v_add_f32 v16, v16, v16
    v_cos_f32 v228, v224
    v_cos_f32 v229, v225
    v_cos_f32 v230, v226
    v_cos_f32 v231, v227
    v_sin_f32 v224, v224
    v_sin_f32 v225, v225
    v_sin_f32 v226, v226
    v_sin_f32 v227, v227
    v_cvt_pk_bf16_f32 v64, v228, v230
    v_cvt_pk_bf16_f32 v72, v229, v231
    v_cvt_pk_bf16_f32 v80, v224, v226
    v_cvt_pk_bf16_f32 v88, v225, v227
    v_pk_fma_f32 v[228:229], v[16:17], v[230:231], v[228:229] op_sel_hi:[0,1,1] neg_lo:[0,0,1] neg_hi:[0,0,1]
    v_pk_fma_f32 v[224:225], v[16:17], v[226:227], v[224:225] op_sel_hi:[0,1,1] neg_lo:[0,0,1] neg_hi:[0,0,1]
    v_pk_fma_f32 v[230:231], v[16:17], v[228:229], v[230:231] op_sel_hi:[0,1,1] neg_lo:[0,0,1] neg_hi:[0,0,1]
    v_pk_fma_f32 v[226:227], v[16:17], v[224:225], v[226:227] op_sel_hi:[0,1,1] neg_lo:[0,0,1] neg_hi:[0,0,1]
    v_cvt_pk_bf16_f32 v65, v228, v230
    v_cvt_pk_bf16_f32 v73, v229, v231
    v_cvt_pk_bf16_f32 v81, v224, v226
    v_cvt_pk_bf16_f32 v89, v225, v227
    v_pk_fma_f32 v[228:229], v[16:17], v[230:231], v[228:229] op_sel_hi:[0,1,1] neg_lo:[0,0,1] neg_hi:[0,0,1]
    v_pk_fma_f32 v[224:225], v[16:17], v[226:227], v[224:225] op_sel_hi:[0,1,1] neg_lo:[0,0,1] neg_hi:[0,0,1]
    v_pk_fma_f32 v[230:231], v[16:17], v[228:229], v[230:231] op_sel_hi:[0,1,1] neg_lo:[0,0,1] neg_hi:[0,0,1]
    v_pk_fma_f32 v[226:227], v[16:17], v[224:225], v[226:227] op_sel_hi:[0,1,1] neg_lo:[0,0,1] neg_hi:[0,0,1]
    v_cvt_pk_bf16_f32 v66, v228, v230
    v_cvt_pk_bf16_f32 v74, v229, v231
    v_cvt_pk_bf16_f32 v82, v224, v226
    v_cvt_pk_bf16_f32 v90, v225, v227
    v_pk_fma_f32 v[228:229], v[16:17], v[230:231], v[228:229] op_sel_hi:[0,1,1] neg_lo:[0,0,1] neg_hi:[0,0,1]
    v_pk_fma_f32 v[224:225], v[16:17], v[226:227], v[224:225] op_sel_hi:[0,1,1] neg_lo:[0,0,1] neg_hi:[0,0,1]
    v_pk_fma_f32 v[230:231], v[16:17], v[228:229], v[230:231] op_sel_hi:[0,1,1] neg_lo:[0,0,1] neg_hi:[0,0,1]
    v_pk_fma_f32 v[226:227], v[16:17], v[224:225], v[226:227] op_sel_hi:[0,1,1] neg_lo:[0,0,1] neg_hi:[0,0,1]
    v_cvt_pk_bf16_f32 v67, v228, v230
    v_cvt_pk_bf16_f32 v75, v229, v231
    v_cvt_pk_bf16_f32 v83, v224, v226
    v_cvt_pk_bf16_f32 v91, v225, v227
    v_pk_fma_f32 v[228:229], v[16:17], v[230:231], v[228:229] op_sel_hi:[0,1,1] neg_lo:[0,0,1] neg_hi:[0,0,1]
    v_pk_fma_f32 v[224:225], v[16:17], v[226:227], v[224:225] op_sel_hi:[0,1,1] neg_lo:[0,0,1] neg_hi:[0,0,1]
    v_pk_fma_f32 v[230:231], v[16:17], v[228:229], v[230:231] op_sel_hi:[0,1,1] neg_lo:[0,0,1] neg_hi:[0,0,1]
    v_pk_fma_f32 v[226:227], v[16:17], v[224:225], v[226:227] op_sel_hi:[0,1,1] neg_lo:[0,0,1] neg_hi:[0,0,1]
    v_cvt_pk_bf16_f32 v68, v228, v230
    v_cvt_pk_bf16_f32 v76, v229, v231
    v_cvt_pk_bf16_f32 v84, v224, v226
    v_cvt_pk_bf16_f32 v92, v225, v227
    v_pk_fma_f32 v[228:229], v[16:17], v[230:231], v[228:229] op_sel_hi:[0,1,1] neg_lo:[0,0,1] neg_hi:[0,0,1]
    v_pk_fma_f32 v[224:225], v[16:17], v[226:227], v[224:225] op_sel_hi:[0,1,1] neg_lo:[0,0,1] neg_hi:[0,0,1]
    v_pk_fma_f32 v[230:231], v[16:17], v[228:229], v[230:231] op_sel_hi:[0,1,1] neg_lo:[0,0,1] neg_hi:[0,0,1]
    v_pk_fma_f32 v[226:227], v[16:17], v[224:225], v[226:227] op_sel_hi:[0,1,1] neg_lo:[0,0,1] neg_hi:[0,0,1]
    v_cvt_pk_bf16_f32 v69, v228, v230
    v_cvt_pk_bf16_f32 v77, v229, v231
    v_cvt_pk_bf16_f32 v85, v224, v226
    v_cvt_pk_bf16_f32 v93, v225, v227
    v_pk_fma_f32 v[228:229], v[16:17], v[230:231], v[228:229] op_sel_hi:[0,1,1] neg_lo:[0,0,1] neg_hi:[0,0,1]
    v_pk_fma_f32 v[224:225], v[16:17], v[226:227], v[224:225] op_sel_hi:[0,1,1] neg_lo:[0,0,1] neg_hi:[0,0,1]
    v_pk_fma_f32 v[230:231], v[16:17], v[228:229], v[230:231] op_sel_hi:[0,1,1] neg_lo:[0,0,1] neg_hi:[0,0,1]
    v_pk_fma_f32 v[226:227], v[16:17], v[224:225], v[226:227] op_sel_hi:[0,1,1] neg_lo:[0,0,1] neg_hi:[0,0,1]
    v_cvt_pk_bf16_f32 v70, v228, v230
    v_cvt_pk_bf16_f32 v78, v229, v231
    v_cvt_pk_bf16_f32 v86, v224, v226
    v_cvt_pk_bf16_f32 v94, v225, v227
    v_pk_fma_f32 v[228:229], v[16:17], v[230:231], v[228:229] op_sel_hi:[0,1,1] neg_lo:[0,0,1] neg_hi:[0,0,1]
    v_pk_fma_f32 v[224:225], v[16:17], v[226:227], v[224:225] op_sel_hi:[0,1,1] neg_lo:[0,0,1] neg_hi:[0,0,1]
    v_pk_fma_f32 v[230:231], v[16:17], v[228:229], v[230:231] op_sel_hi:[0,1,1] neg_lo:[0,0,1] neg_hi:[0,0,1]
    v_pk_fma_f32 v[226:227], v[16:17], v[224:225], v[226:227] op_sel_hi:[0,1,1] neg_lo:[0,0,1] neg_hi:[0,0,1]
    v_cvt_pk_bf16_f32 v71, v228, v230
    v_cvt_pk_bf16_f32 v79, v229, v231
    v_cvt_pk_bf16_f32 v87, v224, v226
    v_cvt_pk_bf16_f32 v95, v225, v227
    s_lshl_b32 s6, s46, 7
    s_add_u32 s6, s6, 5242880
    v_and_b32 v19, 7, v1
    v_lshl_add_u32 v19, v19, 13, s6
    s_and_b32 s6, s2, 1
    s_bfe_u32 s7, s2, 0x20001
    s_lshl2_add_u32 s6, s6, s7
    s_lshl_b32 s6, s6, 7
    s_add_u32 s6, s6, s47
    s_add_u32 s6, s6, 64
    s_lshl_b32 s6, s6, 11
    v_lshrrev_b32 v6, 2, v1
    v_lshl_add_u32 v6, v6, 7, s6
    s_add_u32 s100, s100, 1
    s_sub_u32 s10, s100, 7
    s_min_u32 s100, s100, s10
    s_mul_i32 s51, s100, 64*2688
    v_lshlrev_b32 v232, 8, v252
    buffer_load_dword v255, v7, s[16:19], s51 offen
    v_add_u32 v232, s46, v232
    v_cvt_f32_u32 v232, v232
    v_lshl_add_u32 v233, s49, 4, v253
    v_cvt_f32_u32 v233, v233
    v_mul_f32 v233, 0x3a000000, v233
    v_cvt_f32_u32 v234, s3
    v_mul_f32 v234, 0xbe800000, v234
    v_fma_f32 v236, v232, v233, v234
    v_fmamk_f32 v237, v233, 0x42800000, v236
    v_fmamk_f32 v238, v233, 0x43000000, v236
    v_fmamk_f32 v239, v233, 0x43400000, v236
    v_cos_f32 v236, v236
    v_cos_f32 v237, v237
    v_cos_f32 v238, v238
    v_cos_f32 v239, v239
    v_bfe_i32 v234, v1, 0, 1
    v_and_b32 v234, 0x80008000, v234
    v_cvt_pk_bf16_f32 v240, v236, v237
    v_cvt_pk_bf16_f32 v241, v238, v239
    v_xor_b32 v242, v234, v240
    v_xor_b32 v243, v234, v241
    s_add_u32 s100, s100, 1
    s_sub_u32 s10, s100, 7
    s_min_u32 s100, s100, s10
    s_mul_i32 s51, s100, 64*2688
    v_lshlrev_b32 v5, 4, v1
    buffer_load_dword v255, v7, s[16:19], s51 offen
    v_add_u32 v5, 73728, v5
    v_lshl_add_u32 v232, s11, 10, v5
    ds_write_b128 v232, v[240:243]
    v_lshl_add_u32 v32, s3, 2, v252
    v_lshrrev_b32 v33, 1, v253
    v_xor_b32 v32, v32, v33
    v_lshlrev_b32 v32, 4, v32
    v_lshl_add_u32 v32, v33, 8, v32
    v_and_b32 v33, 1, v1
    v_lshl_add_u32 v32, v33, 3, v32
    v_lshl_add_u32 v8, s49, 11, v32
    v_lshlrev_b32 v33, 1, v252
    v_xor_b32 v32, v33, v253
    v_lshlrev_b32 v32, 4, v32
    v_lshl_add_u32 v32, v33, 8, v32
    v_lshl_add_u32 v60, s49, 14, v32
    v_xor_b32 v61, 16, v60
    v_mov_b32 v34, 0
    v_lshlrev_b32 v32, 2, v0
    v_add_u32 v32, 162816, v32
    ds_write_b32 v32, v34
    s_waitcnt lgkmcnt(0)
    s_mul_i32 s36, s36, 0x9e3779b1
    s_add_u32 s36, s36, 0x7f4a7c15
    v_mov_b32 v250, s36
    s_getreg_b32 s7, hwreg(HW_REG_XCC_ID, 0, 3)
    s_mul_i32 s8, s57, 17920
    s_lshl_b32 s7, s7, 7
    s_add_u32 s8, s8, s7
    s_add_u32 s8, s8, 6432768
    v_and_b32 v249, 31, v1
    v_lshl_add_u32 v249, v249, 2, s8
    s_lshl2_add_u32 s37, s40, s8
    s_mov_b32 s8, 0xffff0000
    s_waitcnt vmcnt(2)
    s_add_u32 s100, s100, 1
    s_sub_u32 s10, s100, 7
    s_min_u32 s100, s100, s10
    s_mul_i32 s51, s100, 64*2688
    v_mov_b32_dpp v40, v200 row_shr:1 row_mask:0xf bank_mask:0xf bound_ctrl:0
    buffer_load_dword v255, v7, s[16:19], s51 offen
    v_mov_b32_dpp v41, v204 row_shr:1 row_mask:0xf bank_mask:0xf bound_ctrl:0
    v_lshlrev_b32 v28, 16, v192
    v_lshlrev_b32 v30, 16, v41
    v_lshlrev_b32 v32, 16, v196
    v_lshlrev_b32 v34, 16, v40
    v_lshlrev_b32 v29, 16, v193
    v_lshlrev_b32 v31, 16, v207
    v_lshlrev_b32 v33, 16, v197
    v_lshlrev_b32 v35, 16, v203
    v_pk_add_f32 v[36:37], v[28:29], v[30:31]
    v_pk_add_f32 v[38:39], v[32:33], v[34:35]
    v_pk_add_f32 v[28:29], v[28:29], v[30:31] neg_lo:[0,1] neg_hi:[0,1]
    v_pk_add_f32 v[32:33], v[32:33], v[34:35] neg_lo:[0,1] neg_hi:[0,1]
    s_add_u32 s100, s100, 1
    s_sub_u32 s10, s100, 7
    s_min_u32 s100, s100, s10
    s_mul_i32 s51, s100, 64*2688
    v_pk_add_f32 v[30:31], v[36:37], v[38:39]
    buffer_load_dword v255, v7, s[16:19], s51 offen
    v_pk_add_f32 v[34:35], v[28:29], v[32:33]
    v_pk_add_f32 v[36:37], v[36:37], v[38:39] neg_lo:[0,1] neg_hi:[0,1]
    v_pk_add_f32 v[28:29], v[28:29], v[32:33] neg_lo:[0,1] neg_hi:[0,1]
    v_cvt_pk_bf16_f32 v104, v30, v31
    v_cvt_pk_bf16_f32 v106, v34, v35
    v_cvt_pk_bf16_f32 v108, v36, v37
    v_cvt_pk_bf16_f32 v110, v28, v29
    v_lshlrev_b32 v28, 16, v194
    v_lshlrev_b32 v30, 16, v206
    v_lshlrev_b32 v32, 16, v198
    v_lshlrev_b32 v34, 16, v202
    v_lshlrev_b32 v29, 16, v195
    v_lshlrev_b32 v31, 16, v205
    s_add_u32 s100, s100, 1
    s_sub_u32 s10, s100, 7
    s_min_u32 s100, s100, s10
    s_mul_i32 s51, s100, 64*2688
    v_lshlrev_b32 v33, 16, v199
    buffer_load_dword v255, v7, s[16:19], s51 offen
    v_lshlrev_b32 v35, 16, v201
    v_pk_add_f32 v[36:37], v[28:29], v[30:31]
    v_pk_add_f32 v[38:39], v[32:33], v[34:35]
    v_pk_add_f32 v[28:29], v[28:29], v[30:31] neg_lo:[0,1] neg_hi:[0,1]
    v_pk_add_f32 v[32:33], v[32:33], v[34:35] neg_lo:[0,1] neg_hi:[0,1]
    v_pk_add_f32 v[30:31], v[36:37], v[38:39]
    v_pk_add_f32 v[34:35], v[28:29], v[32:33]
    v_pk_add_f32 v[36:37], v[36:37], v[38:39] neg_lo:[0,1] neg_hi:[0,1]
    v_pk_add_f32 v[28:29], v[28:29], v[32:33] neg_lo:[0,1] neg_hi:[0,1]
    v_cvt_pk_bf16_f32 v105, v30, v31
    v_cvt_pk_bf16_f32 v107, v34, v35
    v_cvt_pk_bf16_f32 v109, v36, v37
    v_cvt_pk_bf16_f32 v111, v28, v29
    ds_write_b64 v8, v[104:105] offset:0
    v_and_b32 v28, s8, v192
    v_and_b32 v30, s8, v207
    v_and_b32 v32, s8, v196
    v_and_b32 v34, s8, v203
    v_and_b32 v29, s8, v193
    v_and_b32 v31, s8, v206
    v_and_b32 v33, s8, v197
    v_and_b32 v35, s8, v202
    v_pk_add_f32 v[36:37], v[28:29], v[30:31]
    v_pk_add_f32 v[38:39], v[32:33], v[34:35]
    ds_write_b64 v8, v[106:107] offset:8192
    v_pk_add_f32 v[28:29], v[28:29], v[30:31] neg_lo:[0,1] neg_hi:[0,1]
    v_pk_add_f32 v[32:33], v[32:33], v[34:35] neg_lo:[0,1] neg_hi:[0,1]
    v_pk_add_f32 v[30:31], v[36:37], v[38:39]
    v_pk_add_f32 v[34:35], v[28:29], v[32:33]
    v_pk_add_f32 v[36:37], v[36:37], v[38:39] neg_lo:[0,1] neg_hi:[0,1]
    v_pk_add_f32 v[28:29], v[28:29], v[32:33] neg_lo:[0,1] neg_hi:[0,1]
    v_cvt_pk_bf16_f32 v112, v30, v31
    v_cvt_pk_bf16_f32 v114, v34, v35
    v_cvt_pk_bf16_f32 v116, v36, v37
    v_cvt_pk_bf16_f32 v118, v28, v29
    ds_write_b64 v8, v[108:109] offset:16384
    v_and_b32 v28, s8, v194
    v_and_b32 v30, s8, v205
    v_and_b32 v32, s8, v198
    v_and_b32 v34, s8, v201
    v_and_b32 v29, s8, v195
    v_and_b32 v31, s8, v204
    v_and_b32 v33, s8, v199
    v_and_b32 v35, s8, v200
    v_pk_add_f32 v[36:37], v[28:29], v[30:31]
    v_pk_add_f32 v[38:39], v[32:33], v[34:35]
    ds_write_b64 v8, v[110:111] offset:24576
    v_pk_add_f32 v[28:29], v[28:29], v[30:31] neg_lo:[0,1] neg_hi:[0,1]
    v_pk_add_f32 v[32:33], v[32:33], v[34:35] neg_lo:[0,1] neg_hi:[0,1]
    v_pk_add_f32 v[30:31], v[36:37], v[38:39]
    v_pk_add_f32 v[34:35], v[28:29], v[32:33]
    v_pk_add_f32 v[36:37], v[36:37], v[38:39] neg_lo:[0,1] neg_hi:[0,1]
    v_pk_add_f32 v[28:29], v[28:29], v[32:33] neg_lo:[0,1] neg_hi:[0,1]
    v_cvt_pk_bf16_f32 v113, v30, v31
    v_cvt_pk_bf16_f32 v115, v34, v35
    v_cvt_pk_bf16_f32 v117, v36, v37
    v_cvt_pk_bf16_f32 v119, v28, v29
    ds_write_b64 v8, v[112:113] offset:4096
    ds_write_b64 v8, v[114:115] offset:12288
    ds_write_b64 v8, v[116:117] offset:20480
    ds_write_b64 v8, v[118:119] offset:28672
    s_waitcnt lgkmcnt(0)
    s_barrier
    ds_read_b128 v[128:131], v60 offset:0
    ds_read_b128 v[136:139], v60 offset:2048
    ds_read_b128 v[144:147], v60 offset:8192
    ds_read_b128 v[152:155], v60 offset:10240
    ds_read_b128 v[132:135], v61 offset:256
    ds_read_b128 v[140:143], v61 offset:2304
    ds_read_b128 v[148:151], v61 offset:8448
    ds_read_b128 v[180:183], v61 offset:12544
    s_waitcnt lgkmcnt(7)
    v_mfma_f32_16x16x32_bf16 v[192:195], v[128:131], v[64:67], 0
    ds_read_b128 v[156:159], v61 offset:10496
    ds_read_b128 v[188:191], v61 offset:14592
    s_waitcnt lgkmcnt(8)
    v_mfma_f32_16x16x32_bf16 v[196:199], v[136:139], v[64:67], 0
    ds_read_b128 v[160:163], v60 offset:4096
    s_mul_i32 s6, s11, 4608
    s_waitcnt lgkmcnt(8)
    v_mfma_f32_16x16x32_bf16 v[200:203], v[144:147], v[80:83], 0
    ds_read_b128 v[168:171], v60 offset:6144
    s_add_u32 s6, s6, 32768
    s_waitcnt lgkmcnt(8)
    v_mfma_f32_16x16x32_bf16 v[204:207], v[152:155], v[80:83], 0
    ds_read_b128 v[176:179], v60 offset:12288
    v_mul_u32_u24 v2, 144, v253
    s_waitcnt lgkmcnt(8)
    v_mfma_f32_16x16x32_bf16 v[192:195], v[132:135], v[68:71], v[192:195]
    ds_read_b128 v[184:187], v60 offset:14336
    v_lshl_add_u32 v2, v252, 4, v2
    s_waitcnt lgkmcnt(8)
    v_mfma_f32_16x16x32_bf16 v[196:199], v[140:143], v[68:71], v[196:199]
    ds_read_b128 v[164:167], v61 offset:4352
    v_add_u32 v10, s6, v2
    s_waitcnt lgkmcnt(8)
    v_mfma_f32_16x16x32_bf16 v[200:203], v[148:151], v[84:87], v[200:203]
    ds_read_b128 v[172:175], v61 offset:6400
    v_lshrrev_b32 v2, 3, v1
    s_waitcnt lgkmcnt(7)
    v_mfma_f32_16x16x32_bf16 v[204:207], v[156:159], v[84:87], v[204:207]
    v_and_b32 v3, 7, v1
    v_mul_u32_u24 v4, 144, v2
    ds_read_b128 v[44:47], v5 offset:0
    s_waitcnt lgkmcnt(6)
    v_mfma_f32_16x16x32_bf16 v[208:211], v[160:163], v[72:75], 0
    ds_read_b128 v[48:51], v5 offset:4096
    s_waitcnt lgkmcnt(6)
    v_mfma_f32_16x16x32_bf16 v[212:215], v[168:171], v[72:75], 0
    ds_read_b128 v[52:55], v5 offset:1024
    s_waitcnt lgkmcnt(6)
    v_mfma_f32_16x16x32_bf16 v[216:219], v[176:179], v[88:91], 0
    ds_read_b128 v[56:59], v5 offset:5120
    v_cvt_pk_bf16_f32 v28, v192, v193
    s_waitcnt lgkmcnt(6)
    v_mfma_f32_16x16x32_bf16 v[220:223], v[184:187], v[88:91], 0
    ds_read_b128 v[20:23], v5 offset:3072
    v_cvt_pk_bf16_f32 v29, v194, v195
    s_waitcnt lgkmcnt(6)
    v_mfma_f32_16x16x32_bf16 v[208:211], v[164:167], v[76:79], v[208:211]
    ds_read_b128 v[24:27], v5 offset:7168
    v_cvt_pk_bf16_f32 v30, v196, v197
    s_waitcnt lgkmcnt(6)
    v_mfma_f32_16x16x32_bf16 v[212:215], v[172:175], v[76:79], v[212:215]
    v_cvt_pk_bf16_f32 v33, v202, v203
    v_cvt_pk_bf16_f32 v31, v198, v199
    v_mfma_f32_16x16x32_bf16 v[216:219], v[180:183], v[92:95], v[216:219]
    v_cvt_pk_bf16_f32 v34, v204, v205
    v_cvt_pk_bf16_f32 v32, v200, v201
    v_mfma_f32_16x16x32_bf16 v[220:223], v[188:191], v[92:95], v[220:223]
    v_cvt_pk_bf16_f32 v35, v206, v207
    ds_read_b128 v[96:99], v5 offset:2048
    s_waitcnt lgkmcnt(6)
    v_mfma_f32_16x16x32_bf16 v[64:67], v[28:31], v[44:47], 0
    ds_read_b128 v[100:103], v5 offset:6144
    s_waitcnt lgkmcnt(5)
    v_mfma_f32_16x16x32_bf16 v[68:71], v[28:31], v[52:55], 0
    v_lshl_add_u32 v4, v3, 4, v4
    v_add_u32 v15, s6, v4
    v_mfma_f32_16x16x32_bf16 v[80:83], v[28:31], v[48:51], 0
    v_mul_u32_u24 v2, 65664, v2
    v_lshl_add_u32 v2, v3, 4, v2
    s_waitcnt lgkmcnt(4)
    v_mfma_f32_16x16x32_bf16 v[84:87], v[28:31], v[56:59], 0
    v_cvt_pk_bf16_f32 v36, v208, v209
    v_cvt_pk_bf16_f32 v37, v210, v211
    s_waitcnt lgkmcnt(3)
    v_mfma_f32_16x16x32_bf16 v[64:67], v[32:35], v[20:23], v[64:67]
    v_cvt_pk_bf16_f32 v38, v212, v213
    v_cvt_pk_bf16_f32 v39, v214, v215
    v_mfma_f32_16x16x32_bf16 v[68:71], v[32:35], v[44:47], v[68:71]
    v_cvt_pk_bf16_f32 v40, v216, v217
    v_cvt_pk_bf16_f32 v41, v218, v219
    s_waitcnt lgkmcnt(2)
    v_mfma_f32_16x16x32_bf16 v[80:83], v[32:35], v[24:27], v[80:83]
    v_cvt_pk_bf16_f32 v42, v220, v221
    v_cvt_pk_bf16_f32 v43, v222, v223
    v_mfma_f32_16x16x32_bf16 v[84:87], v[32:35], v[48:51], v[84:87]
    s_lshl1_add_u32 s7, s3, s49
    s_lshl_b32 s7, s7, 6
    s_waitcnt lgkmcnt(1)
    v_mfma_f32_16x16x32_bf16 v[72:75], v[36:39], v[96:99], v[64:67]
    s_add_u32 s7, s7, s46
    s_lshl_b32 s6, s7, 7
    v_mfma_f32_16x16x32_bf16 v[76:79], v[36:39], v[20:23], v[68:71]
    s_add_u32 s6, s6, 2097152
    v_add_u32 v18, s6, v2
    v_mfma_f32_16x16x32_bf16 v[64:67], v[36:39], v[44:47], v[64:67]
    s_mov_b32 s52, 525312
    s_mov_b32 s53, 1050624
    v_mfma_f32_16x16x32_bf16 v[68:71], v[36:39], v[52:55], v[68:71]
    s_mov_b32 s54, 1575936
    buffer_load_dword v255, v19, s[20:23], 0 offen sc1
    v_mfma_f32_16x16x32_bf16 v[72:75], v[40:43], v[52:55], v[72:75]
    s_cmp_lg_u32 s11, 0
    v_mfma_f32_16x16x32_bf16 v[76:79], v[40:43], v[96:99], v[76:79]
    s_cbranch_scc1 L_nomk
    buffer_store_dword v250, off, s[20:23], s37
L_nomk:
    v_mfma_f32_16x16x32_bf16 v[64:67], v[40:43], v[20:23], v[64:67]
    v_mfma_f32_16x16x32_bf16 v[68:71], v[40:43], v[44:47], v[68:71]
    s_waitcnt lgkmcnt(0)
    v_mfma_f32_16x16x32_bf16 v[88:91], v[36:39], v[100:103], v[80:83]
    v_mfma_f32_16x16x32_bf16 v[92:95], v[36:39], v[24:27], v[84:87]
    v_mfma_f32_16x16x32_bf16 v[80:83], v[36:39], v[48:51], v[80:83]
    v_mfma_f32_16x16x32_bf16 v[84:87], v[36:39], v[56:59], v[84:87]
    v_cvt_pk_bf16_f32 v108, v72, v73
    v_cvt_pk_bf16_f32 v109, v74, v75
    v_mfma_f32_16x16x32_bf16 v[88:91], v[40:43], v[56:59], v[88:91]
    v_cvt_pk_bf16_f32 v110, v76, v77
    v_cvt_pk_bf16_f32 v111, v78, v79
    v_mfma_f32_16x16x32_bf16 v[92:95], v[40:43], v[100:103], v[92:95]
    ds_write_b128 v10, v[108:111] offset:64
    v_cvt_pk_bf16_f32 v104, v64, v65
    v_mfma_f32_16x16x32_bf16 v[80:83], v[40:43], v[24:27], v[80:83]
    v_cvt_pk_bf16_f32 v105, v66, v67
    v_cvt_pk_bf16_f32 v106, v68, v69
    v_mfma_f32_16x16x32_bf16 v[84:87], v[40:43], v[48:51], v[84:87]
    v_cvt_pk_bf16_f32 v107, v70, v71
    ds_write_b128 v10, v[104:107] offset:0
    ds_read_b128 v[112:115], v15 offset:0
    ds_read_b128 v[116:119], v15 offset:1152
    v_cvt_pk_bf16_f32 v108, v88, v89
    v_cvt_pk_bf16_f32 v109, v90, v91
    v_cvt_pk_bf16_f32 v110, v92, v93
    v_cvt_pk_bf16_f32 v111, v94, v95
    ds_write_b128 v10, v[108:111] offset:2368
    v_cvt_pk_bf16_f32 v104, v80, v81
    v_cvt_pk_bf16_f32 v105, v82, v83
    v_cvt_pk_bf16_f32 v106, v84, v85
    v_cvt_pk_bf16_f32 v107, v86, v87
    ds_write_b128 v10, v[104:107] offset:2304
    ds_read_b128 v[120:123], v15 offset:2304
    ds_read_b128 v[124:127], v15 offset:3456
    s_waitcnt lgkmcnt(5)
    buffer_store_dwordx4 v[112:115], v18, s[20:23], 0 offen sc1
    s_waitcnt lgkmcnt(4)
    buffer_store_dwordx4 v[116:119], v18, s[20:23], s52 offen sc1
    s_waitcnt lgkmcnt(1)
    buffer_store_dwordx4 v[120:123], v18, s[20:23], s53 offen sc1
    s_waitcnt lgkmcnt(0)
    buffer_store_dwordx4 v[124:127], v18, s[20:23], s54 offen sc1
    s_setprio 0
    s_cmp_ge_u32 s40, 28
    s_cbranch_scc1 L_B2
    s_cmp_lg_u32 s49, 0
    s_cbranch_scc1 L_bm
    s_mov_b32 s22, 0x1000000
    s_mov_b32 s23, 0x20000
    s_mov_b32 s26, 0x62000
    s_mov_b32 s27, 0x20000
    s_mov_b32 s30, 0x380000
    s_mov_b32 s31, 0x20000
    s_mul_i32 s6, s40, 37
    s_lshr_b32 s6, s6, 8
    s_mul_i32 s7, s6, 7
    s_sub_u32 s41, s40, s7
    s_lshr_b32 s7, s57, 3
    s_add_u32 s41, s41, s7
    s_sub_u32 s7, s41, 7
    s_min_u32 s41, s41, s7
    s_lshl_b32 s6, s6, 2
    s_add_u32 s6, s6, s3
    v_bfe_u32 v32, v1, 1, 1
    v_lshl_add_u32 v32, s6, 1, v32
    v_mul_u32_u24 v33, 47, v32
    v_lshrrev_b32 v33, 9, v33
    v_mul_u32_u24 v34, 11, v33
    v_sub_u32 v32, v32, v34
    v_add_u32 v32, 3, v32
    v_and_b32 v32, 8, v32
    v_lshl_add_u32 v32, v33, 10, v32
    v_and_b32 v33, 1, v1
    v_lshl_add_u32 v32, v33, 2, v32
    v_bfe_u32 v33, v1, 2, 3
    v_lshl_add_u32 v32, v33, 7, v32
    s_mul_i32 s7, s57, 17920
    s_add_u32 s7, s7, 6429696
    v_add_u32 v246, s7, v32
    s_and_b32 s7, s2, 6
    s_lshl3_add_u32 s6, s7, s6
    s_and_b32 s8, s2, 1
    s_lshl_b32 s7, s8, 6
    s_add_u32 s42, s6, s7
    v_lshrrev_b32 v32, 3, v1
    v_and_b32 v33, 6, v32
    v_and_b32 v34, 7, v1
    v_xor_b32 v33, v33, v34
    v_lshrrev_b32 v32, 3, v0
    v_mul_u32_u24 v32, 896, v32
    v_lshl_add_u32 v32, v33, 4, v32
    s_lshl_b32 s7, s41, 7
    v_add_u32 v240, s7, v32
    s_lshl_b32 s45, s3, 10
    s_add_u32 s45, s45, 105472
    v_lshrrev_b32 v32, 2, v1
    v_bfe_u32 v33, v1, 3, 2
    v_lshlrev_b32 v33, 5, v33
    v_lshl_add_u32 v33, v32, 7, v33
    v_and_b32 v34, 3, v1
    v_lshl_add_u32 v33, v34, 3, v33
    v_add_u32 v241, 105472, v33
    v_xor_b32 v242, 32, v241
    v_xor_b32 v243, 64, v241
    v_xor_b32 v244, 96, v241
    s_lshl_b32 s9, s42, 14
    v_lshl_add_u32 v245, v1, 4, s9
    s_lshl_b32 s6, s6, 5
    s_add_u32 s6, s6, s8
    s_mul_i32 s6, s6, 1792
    s_add_u32 s6, s6, s7
    v_lshrrev_b32 v32, 3, v1
    v_and_b32 v33, 7, v1
    v_lshlrev_b32 v33, 4, v33
    v_mul_u32_u24 v34, 3584, v32
    v_add3_u32 v247, v34, v33, s6
    s_mul_i32 s6, s3, 2304
    v_mul_u32_u24 v32, 144, v32
    v_add3_u32 v251, v32, v33, s6
    v_mul_u32_u24 v32, 144, v253
    v_lshl_add_u32 v32, v252, 3, v32
    v_add_u32 v248, s6, v32
    s_and_b32 s6, s2, 1
    s_bfe_u32 s7, s2, 0x20001
    s_lshl2_add_u32 s6, s6, s7
    s_lshl3_add_u32 s6, s6, s40
    s_sub_u32 s6, s6, 24
    s_lshl_b32 s6, s6, 15
    v_mov_b32 v25, 2.0
L_bm:
    s_lshr_b32 s6, s57, 3
    s_or_b32 s6, s6, 4
    s_cmp_eq_u32 s11, s6
    s_cselect_b32 s6, 0, 0x40000000
    s_mov_b64 exec, 255
    s_waitcnt vmcnt(0)
    s_barrier
    buffer_store_dword v250, v19, s[20:23], s6 offen sc1
    s_mov_b64 exec, -1
    s_cmp_eq_u32 s49, 0
    s_cbranch_scc1 L_HT
    s_endpgm
.p2align 12
L_B2:
    buffer_load_dword v21, v249, s[20:23], 0 offen sc1
    s_mov_b32 s30, 0x380000
    s_mov_b32 s31, 0x20000
    s_lshr_b32 s6, s57, 1
    s_add_u32 s48, s6, s40
    s_sub_u32 s48, s48, 28
    s_cmp_lg_u32 s49, 0
    s_cbranch_scc1 L_not2
    v_cvt_f32_u32 v12, v253
    v_mul_f32 v12, 0x3c800000, v12
    v_lshl_add_u32 v13, s3, 2, v252
    v_lshlrev_b32 v13, 2, v13
    v_cvt_f32_u32 v13, v13
    v_mul_f32 v32, v13, v12
    v_add_f32 v33, v12, v32
    v_add_f32 v34, v12, v33
    v_add_f32 v35, v12, v34
    v_cos_f32 v40, v32
    v_cos_f32 v41, v33
    v_cos_f32 v42, v34
    v_cos_f32 v43, v35
    v_sin_f32 v48, v32
    v_sin_f32 v49, v33
    v_sin_f32 v50, v34
    v_sin_f32 v51, v35
    v_lshlrev_b32_e64 v12, 4, v0
    v_add_u32 v12, 131072, v12
    v_cvt_pk_bf16_f32 v128, v40, -v48
    v_cvt_pk_bf16_f32 v129, v41, -v49
    v_cvt_pk_bf16_f32 v130, v42, -v50
    v_cvt_pk_bf16_f32 v131, v43, -v51
    ds_write_b128 v12, v[128:131] offset:0
    v_cvt_pk_bf16_f32 v132, v40, -v48
    v_cvt_pk_bf16_f32 v133, -v49, -v41
    v_cvt_pk_bf16_f32 v134, -v42, v50
    v_cvt_pk_bf16_f32 v135, v51, v43
    ds_write_b128 v12, v[132:135] offset:4096
    v_cvt_pk_bf16_f32 v136, v40, -v48
    v_cvt_pk_bf16_f32 v137, -v41, v49
    v_cvt_pk_bf16_f32 v138, v42, -v50
    v_cvt_pk_bf16_f32 v139, -v43, v51
    ds_write_b128 v12, v[136:139] offset:8192
    v_cvt_pk_bf16_f32 v140, v40, -v48
    v_cvt_pk_bf16_f32 v141, v49, v41
    v_cvt_pk_bf16_f32 v142, -v42, v50
    v_cvt_pk_bf16_f32 v143, -v51, -v43
    ds_write_b128 v12, v[140:143] offset:12288
    s_waitcnt lgkmcnt(0)
L_not2:
    s_lshr_b32 s6, s57, 3
    s_cmp_eq_u32 s11, s6
    s_cselect_b32 s6, 0, 0x40000000
    s_mov_b64 exec, 255
    s_waitcnt vmcnt(1)
    s_barrier
    buffer_store_dword v250, v19, s[20:23], s6 offen sc1
    s_mov_b64 exec, -1
    v_lshrrev_b32 v33, 3, v1
    v_and_b32 v33, 4, v33
    v_xor_b32 v33, v33, v1
    s_mul_i32 s6, s48, 65664
    s_lshl_b32 s52, s11, 10
    s_add_u32 s6, s6, s52
    s_add_u32 s6, s6, 2097152
    v_lshl_add_u32 v2, v33, 4, s6
    s_lshl_b32 s6, s57, 10
    s_add_u32 s6, s6, s52
    s_add_u32 s6, s6, 5242880
    v_lshl_add_u32 v3, v1, 7, s6
    s_add_u32 s52, s52, 65536
    s_mul_i32 s50, s50, 0x9e3779b1
    s_add_u32 s50, s50, 0x7f4a7c15
    v_mov_b32 v22, s50
    v_bfe_u32 v4, v1, 3, 1
    v_lshl_add_u32 v4, v252, 2, v4
    v_lshlrev_b32 v4, 7, v4
    v_xor_b32 v32, s49, v252
    v_and_b32 v32, 1, v32
    v_lshl_add_u32 v4, v32, 6, v4
    v_and_b32 v32, 3, v1
    v_lshl_add_u32 v4, v32, 4, v4
    v_bfe_u32 v33, v1, 2, 1
    v_lshl_add_u32 v4, v33, 3, v4
    v_lshl_add_u32 v4, s3, 14, v4
    v_add_u32 v4, 65536, v4
    s_movk_i32 s61, 528
    v_mul_u32_u24 v6, 528, v253
    v_lshl_add_u32 v6, v252, 4, v6
    v_lshl_add_u32 v6, s11, 6, v6
    v_lshl_add_u32 v33, s3, 2, v252
    v_lshlrev_b32 v32, 4, v253
    v_mad_u32_u24 v8, v33, s61, v32
    v_lshl_add_u32 v8, s49, 8, v8
    v_lshl_add_u32 v9, v33, 5, s48
    v_sub_u32 v10, 2048, v9
    v_and_b32 v11, 2047, v10
    v_subrev_u32 v10, 1536, v10
    s_mul_i32 s6, s49, 448
    v_add_u32 v32, s6, v32
    s_movk_i32 s7, 1792
    v_mad_u32_u24 v9, v9, s7, v32
    v_sub_u32 v32, 1776, v32
    v_mad_u32_u24 v10, v10, s7, v32
    v_mad_u32_u24 v11, v11, s7, v32
    v_cmp_gt_u32 vcc, 12, v253
    v_mov_b32 v16, 0xffff
    s_mov_b32 s58, 917504
    s_mov_b32 s59, 1835008
    s_mov_b32 s60, 2752512
    v_cndmask_b32 v10, 2.0, v10, vcc
    v_cndmask_b32 v11, 2.0, v11, vcc
    v_add_u32 v12, 57344, v5
    ds_read_b128 v[128:131], v12 offset:0
    ds_read_b128 v[132:135], v12 offset:1024
    ds_read_b128 v[136:139], v12 offset:2048
    ds_read_b128 v[140:143], v12 offset:3072
    ds_read_b128 v[144:147], v12 offset:4096
    ds_read_b128 v[148:151], v12 offset:5120
    ds_read_b128 v[152:155], v12 offset:6144
    ds_read_b128 v[156:159], v12 offset:7168
    ds_read_b128 v[160:163], v12 offset:8192
    ds_read_b128 v[164:167], v12 offset:9216
    ds_read_b128 v[168:171], v12 offset:10240
    ds_read_b128 v[172:175], v12 offset:11264
    ds_read_b128 v[176:179], v12 offset:12288
    ds_read_b128 v[180:183], v12 offset:13312
    ds_read_b128 v[184:187], v12 offset:14336
    ds_read_b128 v[188:191], v12 offset:15360
    s_mov_b64 exec, 255
    s_mov_b32 s10, 65536
L_plB:
    buffer_load_dword v32, v3, s[20:23], 0 offen sc1
    s_sub_u32 s10, s10, 1
    s_cbranch_scc1 L_pdB
    s_waitcnt vmcnt(0)
    v_cmp_ne_u32 vcc, v32, v22
    s_nop 0
    s_and_b64 exec, exec, vcc
    s_cbranch_scc1 L_plB
L_pdB:
    s_mov_b64 exec, -1
    s_add_u32 m0, s52, 0
    s_mov_b32 s9, 0
    buffer_load_dwordx4 v2, s[20:23], s9 offen sc1 lds
    s_add_u32 m0, s52, 8192
    s_mov_b32 s9, 8192
    buffer_load_dwordx4 v2, s[20:23], s9 offen sc1 lds
    s_add_u32 m0, s52, 16384
    s_mov_b32 s9, 16384
    buffer_load_dwordx4 v2, s[20:23], s9 offen sc1 lds
    s_add_u32 m0, s52, 24576
    s_mov_b32 s9, 24576
    buffer_load_dwordx4 v2, s[20:23], s9 offen sc1 lds
    s_add_u32 m0, s52, 32768
    s_mov_b32 s9, 32768
    buffer_load_dwordx4 v2, s[20:23], s9 offen sc1 lds
    s_add_u32 m0, s52, 40960
    s_mov_b32 s9, 40960
    buffer_load_dwordx4 v2, s[20:23], s9 offen sc1 lds
    s_add_u32 m0, s52, 49152
    s_mov_b32 s9, 49152
    buffer_load_dwordx4 v2, s[20:23], s9 offen sc1 lds
    s_add_u32 m0, s52, 57344
    s_mov_b32 s9, 57344
    buffer_load_dwordx4 v2, s[20:23], s9 offen sc1 lds
    v_cmp_ne_u32 vcc, v21, v250
    s_waitcnt vmcnt(0) lgkmcnt(0)
    s_or_b32 s43, vcc_lo, vcc_hi
    s_barrier
    ds_read_b64_tr_b16 v[64:65], v4 offset:0
    ds_read_b64_tr_b16 v[66:67], v4 offset:256
    ds_read_b64_tr_b16 v[68:69], v4 offset:8192
    ds_read_b64_tr_b16 v[70:71], v4 offset:8448
    ds_read_b64_tr_b16 v[72:73], v4 offset:2048
    ds_read_b64_tr_b16 v[74:75], v4 offset:2304
    ds_read_b64_tr_b16 v[76:77], v4 offset:10240
    ds_read_b64_tr_b16 v[78:79], v4 offset:10496
    ds_read_b64_tr_b16 v[80:81], v4 offset:4096
    ds_read_b64_tr_b16 v[82:83], v4 offset:4352
    s_waitcnt lgkmcnt(8)
    v_mfma_f32_16x16x32_bf16 v[32:35], v[64:67], v[128:131], 0
    ds_read_b64_tr_b16 v[84:85], v4 offset:12288
    s_waitcnt lgkmcnt(7)
    v_mfma_f32_16x16x32_bf16 v[36:39], v[68:71], v[128:131], 0
    ds_read_b64_tr_b16 v[86:87], v4 offset:12544
    s_waitcnt lgkmcnt(6)
    v_mfma_f32_16x16x32_bf16 v[32:35], v[72:75], v[132:135], v[32:35]
    ds_read_b64_tr_b16 v[88:89], v4 offset:6144
    s_waitcnt lgkmcnt(5)
    v_mfma_f32_16x16x32_bf16 v[36:39], v[76:79], v[132:135], v[36:39]
    ds_read_b64_tr_b16 v[90:91], v4 offset:6400
    s_waitcnt lgkmcnt(4)
    v_mfma_f32_16x16x32_bf16 v[32:35], v[80:83], v[136:139], v[32:35]
    ds_read_b64_tr_b16 v[92:93], v4 offset:14336
    s_waitcnt lgkmcnt(3)
    v_mfma_f32_16x16x32_bf16 v[36:39], v[84:87], v[136:139], v[36:39]
    ds_read_b64_tr_b16 v[94:95], v4 offset:14592
    s_waitcnt lgkmcnt(2)
    v_mfma_f32_16x16x32_bf16 v[32:35], v[88:91], v[140:143], v[32:35]
    s_waitcnt lgkmcnt(0)
    v_mfma_f32_16x16x32_bf16 v[36:39], v[92:95], v[140:143], v[36:39]
    s_nop 7
    v_cvt_pk_bf16_f32 v96, v32, v36
    v_cvt_pk_bf16_f32 v97, v33, v37
    v_cvt_pk_bf16_f32 v98, v34, v38
    v_cvt_pk_bf16_f32 v99, v35, v39
    ds_write_b128 v6, v[96:99] offset:0
    v_mfma_f32_16x16x32_bf16 v[40:43], v[64:67], v[144:147], 0
    v_mfma_f32_16x16x32_bf16 v[44:47], v[68:71], v[144:147], 0
    v_mfma_f32_16x16x32_bf16 v[40:43], v[72:75], v[148:151], v[40:43]
    v_mfma_f32_16x16x32_bf16 v[44:47], v[76:79], v[148:151], v[44:47]
    s_waitcnt lgkmcnt(0)
    s_barrier
    ds_read_b128 v[192:195], v8 offset:0
    v_mfma_f32_16x16x32_bf16 v[40:43], v[80:83], v[152:155], v[40:43]
    v_mfma_f32_16x16x32_bf16 v[44:47], v[84:87], v[152:155], v[44:47]
    v_mfma_f32_16x16x32_bf16 v[40:43], v[88:91], v[156:159], v[40:43]
    v_mfma_f32_16x16x32_bf16 v[44:47], v[92:95], v[156:159], v[44:47]
    s_waitcnt lgkmcnt(0)
    buffer_store_dwordx4 v[192:195], v9, s[28:31], 0 offen offset:896 sc1
    s_nop 5
    v_cvt_pk_bf16_f32 v100, v40, v44
    v_cvt_pk_bf16_f32 v101, v41, v45
    v_cvt_pk_bf16_f32 v102, v42, v46
    v_cvt_pk_bf16_f32 v103, v43, v47
    ds_write_b128 v6, v[100:103] offset:8448
    v_mfma_f32_16x16x32_bf16 v[48:51], v[64:67], v[160:163], 0
    v_mov_b32_dpp v196, v192 row_shl:1 row_mask:0xf bank_mask:0xf bound_ctrl:0
    v_bfi_b32 v219, v16, v193, v192
    v_mfma_f32_16x16x32_bf16 v[52:55], v[68:71], v[160:163], 0
    v_bfi_b32 v218, v16, v194, v193
    v_bfi_b32 v217, v16, v195, v194
    v_mfma_f32_16x16x32_bf16 v[48:51], v[72:75], v[164:167], v[48:51]
    v_bfi_b32 v216, v16, v196, v195
    buffer_store_dwordx4 v[216:219], v11, s[28:31], 0 offen sc1
    v_mfma_f32_16x16x32_bf16 v[52:55], v[76:79], v[164:167], v[52:55]
    s_waitcnt lgkmcnt(0)
    s_barrier
    ds_read_b128 v[198:201], v8 offset:8448
    v_mfma_f32_16x16x32_bf16 v[48:51], v[80:83], v[168:171], v[48:51]
    v_mfma_f32_16x16x32_bf16 v[52:55], v[84:87], v[168:171], v[52:55]
    v_mfma_f32_16x16x32_bf16 v[48:51], v[88:91], v[172:175], v[48:51]
    v_mfma_f32_16x16x32_bf16 v[52:55], v[92:95], v[172:175], v[52:55]
    s_waitcnt lgkmcnt(0)
    buffer_store_dwordx4 v[198:201], v9, s[28:31], s58 offen offset:896 sc1
    s_nop 5
    v_cvt_pk_bf16_f32 v104, v48, v52
    v_cvt_pk_bf16_f32 v105, v49, v53
    v_cvt_pk_bf16_f32 v106, v50, v54
    v_cvt_pk_bf16_f32 v107, v51, v55
    ds_write_b128 v6, v[104:107] offset:16896
    v_mfma_f32_16x16x32_bf16 v[56:59], v[64:67], v[176:179], 0
    v_mov_b32_dpp v202, v198 row_shl:1 row_mask:0xf bank_mask:0xf bound_ctrl:0
    v_bfi_b32 v223, v16, v199, v198
    v_mfma_f32_16x16x32_bf16 v[60:63], v[68:71], v[176:179], 0
    v_bfi_b32 v222, v16, v200, v199
    v_bfi_b32 v221, v16, v201, v200
    v_mfma_f32_16x16x32_bf16 v[56:59], v[72:75], v[180:183], v[56:59]
    v_bfi_b32 v220, v16, v202, v201
    buffer_store_dwordx4 v[220:223], v10, s[28:31], s59 offen sc1
    v_mfma_f32_16x16x32_bf16 v[60:63], v[76:79], v[180:183], v[60:63]
    s_waitcnt lgkmcnt(0)
    s_barrier
    ds_read_b128 v[204:207], v8 offset:16896
    v_mfma_f32_16x16x32_bf16 v[56:59], v[80:83], v[184:187], v[56:59]
    v_mfma_f32_16x16x32_bf16 v[60:63], v[84:87], v[184:187], v[60:63]
    v_mfma_f32_16x16x32_bf16 v[56:59], v[88:91], v[188:191], v[56:59]
    v_mfma_f32_16x16x32_bf16 v[60:63], v[92:95], v[188:191], v[60:63]
    s_waitcnt lgkmcnt(0)
    buffer_store_dwordx4 v[204:207], v9, s[28:31], s59 offen offset:896 sc1
    s_nop 5
    v_cvt_pk_bf16_f32 v108, v56, v60
    v_cvt_pk_bf16_f32 v109, v57, v61
    v_cvt_pk_bf16_f32 v110, v58, v62
    v_cvt_pk_bf16_f32 v111, v59, v63
    ds_write_b128 v6, v[108:111] offset:25344
    v_mov_b32_dpp v208, v204 row_shl:1 row_mask:0xf bank_mask:0xf bound_ctrl:0
    v_bfi_b32 v227, v16, v205, v204
    v_bfi_b32 v226, v16, v206, v205
    v_bfi_b32 v225, v16, v207, v206
    v_bfi_b32 v224, v16, v208, v207
    buffer_store_dwordx4 v[224:227], v10, s[28:31], s58 offen sc1
    s_waitcnt lgkmcnt(0)
    s_barrier
    ds_read_b128 v[210:213], v8 offset:25344
    s_waitcnt lgkmcnt(0)
    buffer_store_dwordx4 v[210:213], v9, s[28:31], s60 offen offset:896 sc1
    v_mov_b32_dpp v214, v210 row_shl:1 row_mask:0xf bank_mask:0xf bound_ctrl:0
    v_bfi_b32 v231, v16, v211, v210
    v_bfi_b32 v230, v16, v212, v211
    v_bfi_b32 v229, v16, v213, v212
    v_bfi_b32 v228, v16, v214, v213
    buffer_store_dwordx4 v[228:231], v10, s[28:31], 0 offen sc1
    s_cmp_lg_u32 s47, 32
    s_cbranch_scc1 L_fin
    s_cmp_eq_u32 s43, 0
    s_cbranch_scc1 L_adv
    s_mul_i32 s6, s57, 17920
    s_add_u32 s6, s6, 6429696
    v_lshrrev_b32 v33, 2, v1
    v_and_b32 v34, 3, v1
    v_lshlrev_b32 v34, 2, v34
    v_lshl_add_u32 v33, v33, 7, v34
    v_add_u32 v33, s6, v33
    v_add_u32 v34, 1024, v33
    s_mov_b32 s10, 65536
L_plK:
    buffer_load_dword v32, v33, s[20:23], 0 offen sc1
    s_sub_u32 s10, s10, 1
    s_cbranch_scc1 L_pdK
    s_waitcnt vmcnt(0)
    v_cmp_ne_u32 vcc, v32, v250
    s_nop 0
    s_and_b64 exec, exec, vcc
    s_cbranch_scc1 L_plK
L_pdK:
    s_mov_b64 exec, -1
    s_mov_b32 s10, 65536
L_plL:
    buffer_load_dword v32, v34, s[20:23], 0 offen sc1
    s_sub_u32 s10, s10, 1
    s_cbranch_scc1 L_pdL
    s_waitcnt vmcnt(0)
    v_cmp_ne_u32 vcc, v32, v250
    s_nop 0
    s_and_b64 exec, exec, vcc
    s_cbranch_scc1 L_plL
L_pdL:
    s_mov_b64 exec, -1
L_adv:
    s_add_u32 s6, s57, 5308416
    buffer_store_dword v250, off, s[20:23], s6 sc1
L_fin:
L_end:
    s_endpgm
.section .rodata,"a"
.p2align 6
.amdhsa_kernel concat_heads__sliding_local_dilated__spectral_fnet__prompt_kernel
  .amdhsa_next_free_vgpr 256
  .amdhsa_next_free_sgpr 102
  .amdhsa_accum_offset 256
  .amdhsa_group_segment_fixed_size 0
  .amdhsa_kernarg_size 88
  .amdhsa_user_sgpr_count 2
  .amdhsa_user_sgpr_kernarg_segment_ptr 1
  .amdhsa_system_sgpr_workgroup_id_x 1
  .amdhsa_float_denorm_mode_32 3
.end_amdhsa_kernel
```
